```python
import torch

def _softmax(x, axis=-1):
    return torch.softmax(x, dim=axis)

def _gelu(x):
    return torch.nn.functional.gelu(x, approximate='tanh')

def _silu(x):
    return torch.nn.functional.silu(x)

def _sigmoid(x):
    return torch.sigmoid(x)

def _layernorm(x, axis=-1, eps=1e-05):
    m = x.mean(dim=axis, keepdim=True)
    v = x.var(dim=axis, keepdim=True, unbiased=False)
    return (x - m) / torch.sqrt(v + eps)

def _scatter_add(tgt, idx, src, axis=0):
    return tgt.clone().index_add_(axis, idx, src)

def _segment_sum(src, seg, n):
    out = torch.zeros((n,) + src.shape[1:], dtype=src.dtype)
    return out.index_add_(0, seg, src)

def _pad(x, pw):
    flat = tuple((v for pair in reversed(pw) for v in pair))
    return torch.nn.functional.pad(x, flat)
kernel_name = 'sequential_preLN__compressed_kv_cla__mixer_gmlp__prompt'

def setup_inputs():

    _w = lambda a: (lambda t: t.to(torch.bfloat16) if t.is_floating_point() else t)(torch.as_tensor(a))

    def _A_setup():
        B, H, Sq, Sk, D, M = (1, 32, 2048, 2048, 128, 512)
        Dc = 4 * D
        return {'x': _w((lambda *s: torch.randn(*s, dtype=torch.bfloat16) * 0.05)(B, Sq, M)), 'c_kv': _w((lambda *s: torch.randn(*s, dtype=torch.bfloat16) * 0.4)(B, Sk, Dc)), 'w_q': _w((lambda *s: torch.randn(*s, dtype=torch.bfloat16) * 3.2)(M, H, D) * M ** (-0.5)), 'w_uk': _w((lambda *s: torch.randn(*s, dtype=torch.bfloat16) * 3.2)(Dc, H, D) * Dc ** (-0.5)), 'w_uv': _w((lambda *s: torch.randn(*s, dtype=torch.bfloat16) * 0.4)(Dc, H, D) * Dc ** (-0.5)), 'w_o': _w((lambda *s: torch.randn(*s, dtype=torch.bfloat16) * 0.4)(H, D, M) * (H * D) ** (-0.5))}
    _A_in = _A_setup()

    def _B_setup():
        B, S, D, F = (1, 2048, 512, 1792)
        Fh = F // 2
        return {'x': _w((lambda *s: torch.randn(*s, dtype=torch.bfloat16) * 0.05)(B, S, D)), 'w_in': _w((lambda *s: torch.randn(*s, dtype=torch.bfloat16) * 0.4)(D, 2 * Fh)), 'w_sp': _w(0.01 * (lambda *s: torch.randn(*s, dtype=torch.bfloat16) * 0.4)(S, S)), 'b_sp': _w(1.0 + 0.01 * (lambda *s: torch.randn(*s, dtype=torch.bfloat16) * 0.05)(S)), 'w_out': _w((lambda *s: torch.randn(*s, dtype=torch.bfloat16) * 0.05)(Fh, D))}
    _B_in = _B_setup()
    return {'A_x': _A_in['x'], 'A_c_kv': _A_in['c_kv'], 'A_w_q': _A_in['w_q'], 'A_w_uk': _A_in['w_uk'], 'A_w_uv': _A_in['w_uv'], 'A_w_o': _A_in['w_o'], 'B_x': _B_in['x'], 'B_w_in': _B_in['w_in'], 'B_w_sp': _B_in['w_sp'], 'B_b_sp': _B_in['b_sp'], 'B_w_out': _B_in['w_out']}

def reference(A_x, A_c_kv, A_w_q, A_w_uk, A_w_uv, A_w_o, B_x, B_w_in, B_w_sp, B_b_sp, B_w_out):

    def _A_ref(x, c_kv, w_q, w_uk, w_uv, w_o):
        B, Sq, M = (x.shape[0], x.shape[1], x.shape[2])
        Sk = c_kv.shape[1]
        H, D = (w_q.shape[1], w_q.shape[2])
        q = torch.einsum('bqm,mhd->bhqd', x, w_q)
        k = torch.einsum('bkc,chd->bhkd', c_kv, w_uk)
        v = torch.einsum('bkc,chd->bhkd', c_kv, w_uv)
        scores = torch.einsum('bhqd,bhkd->bhqk', q, k) * D ** (-0.5)
        off = Sk - Sq
        qi = torch.arange(Sq)[:, None]
        kj = torch.arange(Sk)[None, :]
        cmask = kj <= qi + off
        scores = torch.where(cmask[None, None], scores, -1000000000.0)
        p = _softmax(scores, axis=-1)
        ctx = torch.einsum('bhqk,bhkd->bhqd', p, v)
        return torch.einsum('bhqd,hdm->bqm', ctx, w_o)

    def _B_ref(x, w_in, w_sp, b_sp, w_out):
        B, S, D = x.shape
        F = w_in.shape[-1]
        Fh = F // 2
        z = _gelu(torch.einsum('bsd,df->bsf', x, w_in))
        z1 = z[..., :Fh].clone()
        z2 = _layernorm(z[..., Fh:], axis=-1)
        g = torch.einsum('ts,bsf->btf', w_sp, z2) + b_sp[None, :, None]
        return torch.einsum('bsf,fd->bsd', z1 * g, w_out)
    x = A_x
    h = x + _A_ref(_layernorm(x, axis=-1), A_c_kv, A_w_q, A_w_uk, A_w_uv, A_w_o)
    h2 = h + _B_ref(_layernorm(h, axis=-1), B_w_in, B_w_sp, B_b_sp, B_w_out)
    return h2
```

```asm
; @launch grid=(256,1,1) block=(256,1,1) lds=163840
.amdgcn_target "amdgcn-amd-amdhsa--gfx950"
.text
.globl sequential_preLN__compressed_kv_cla__mixer_gmlp__prompt_kernel
.p2align 8
.type sequential_preLN__compressed_kv_cla__mixer_gmlp__prompt_kernel,@function
sequential_preLN__compressed_kv_cla__mixer_gmlp__prompt_kernel:
 s_cmp_ge_u32 s2, 256
 s_cbranch_scc1 sequential_preLN__compressed_kv_cla__mixer_gmlp__prompt_kernel_end
 s_load_dwordx2 s[8:9], s[0:1], 8
 s_load_dwordx2 s[16:17], s[0:1], 24
 s_load_dwordx2 s[4:5], s[0:1], 0
 s_mov_b32 s10, 2097152
 s_mov_b32 s11, 0x20000
 s_mov_b32 s18, 4194304
 s_mov_b32 s19, 0x20000
 s_mov_b32 s6, 2097152
 s_mov_b32 s7, 0x20000
 v_and_b32 v253, 63, v0
 v_lshrrev_b32 v252, 6, v0
 v_lshlrev_b32 v251, 4, v253
 s_and_b32 s62, s2, 7
 s_lshl_b32 s62, s62, 2
 s_lshr_b32 s62, 1732588033, s62
 s_and_b32 s62, s62, 7
 s_and_b32 s61, s2, 24
 s_or_b32 s61, s61, s62
 s_lshr_b32 s62, s2, 5
 v_readfirstlane_b32 s60, v252
 v_lshrrev_b32 v250, 3, v253
 v_lshrrev_b32 v249, 4, v253
 v_xor_b32 v249, v249, v253
 v_and_b32 v249, 7, v249
 v_lshlrev_b32 v249, 4, v249
 v_lshl_add_u32 v250, v250, 10, v249
 v_lshl_add_u32 v250, v252, 16, v250
 v_xor_b32 v249, 64, v250
 v_add_u32 v128, 0, v250
 v_add_u32 v129, 7168, v249
 v_add_u32 v130, 14336, v250
 v_add_u32 v131, 21504, v249
 v_add_u32 v132, 32768, v250
 v_add_u32 v133, 39936, v249
 v_add_u32 v134, 47104, v250
 v_add_u32 v135, 54272, v249
 v_bfe_u32 v250, v253, 2, 2
 v_lshlrev_b32 v250, 13, v250
 v_lshrrev_b32 v249, 4, v253
 v_lshl_add_u32 v250, v249, 6, v250
 v_and_b32 v249, 1, v253
 v_lshl_add_u32 v250, v249, 5, v250
 v_bfe_u32 v249, v253, 1, 1
 v_lshl_add_u32 v250, v249, 4, v250
 v_lshl_add_u32 v250, v252, 17, v250
 v_xor_b32 v249, 16, v250
 v_add_u32 v224, 0, v250
 v_add_u32 v225, 31744, v250
 v_add_u32 v226, 63488, v249
 v_add_u32 v227, 95232, v249
 s_lshl_b32 s74, s62, 18
 s_lshl_b32 s75, s61, 8
 s_lshl_b32 s76, s60, 13
 s_lshl_b32 s73, s60, 12
 s_add_u32 s78, s62, s61
 s_and_b32 s78, s78, 1
 s_mul_i32 s72, s78, 512
 s_add_u32 s74, s74, s72
 s_lshl_b32 s80, s72, 4
 s_lshl_b32 s72, s72, 12
 s_add_u32 s75, s75, s72
 s_waitcnt lgkmcnt(0)
 s_add_u32 m0, s73, 0
 s_nop 0
 buffer_load_dwordx4 v224, s[16:19], s75 offen offset:0 lds
 buffer_load_dwordx4 v225, s[16:19], s75 offen offset:1024 lds
 buffer_load_dwordx4 v226, s[16:19], s75 offen offset:2048 lds
 buffer_load_dwordx4 v227, s[16:19], s75 offen offset:3072 lds
 s_add_u32 s75, s75, 524288
 s_bitset0_b32 s75, 22
 s_add_u32 m0, s76, 32768
 s_nop 0
 buffer_load_dwordx4 v128, s[8:11], s74 offen offset:0 lds
 buffer_load_dwordx4 v129, s[8:11], s74 offen offset:1024 lds
 buffer_load_dwordx4 v130, s[8:11], s74 offen offset:2048 lds
 buffer_load_dwordx4 v131, s[8:11], s74 offen offset:3072 lds
 s_add_u32 m0, s76, 36864
 s_nop 0
 buffer_load_dwordx4 v132, s[8:11], s74 offen offset:0 lds
 buffer_load_dwordx4 v133, s[8:11], s74 offen offset:1024 lds
 buffer_load_dwordx4 v134, s[8:11], s74 offen offset:2048 lds
 buffer_load_dwordx4 v135, s[8:11], s74 offen offset:3072 lds
 s_add_u32 s74, s74, 128
 s_bitset0_b32 s74, 10
 v_and_b32 v250, 3, v253
 v_lshlrev_b32 v250, 10, v250
 v_bfe_u32 v249, v253, 2, 1
 v_lshl_add_u32 v250, v249, 13, v250
 v_lshrrev_b32 v249, 3, v253
 v_lshl_add_u32 v250, v249, 4, v250
 v_lshl_add_u32 v144, v252, 8, v250
 s_lshr_b32 s82, s2, 2
 s_lshl_b32 s82, s82, 15
 s_and_b32 s77, s2, 1
 s_lshl_b32 s77, s77, 14
 s_add_u32 s82, s82, s77
 s_bfe_u32 s77, s2, 0x10001
 s_lshl_b32 s77, s77, 12
 s_add_u32 s82, s82, s77
 buffer_load_dwordx4 v[136:139], v144, s[4:7], s82 offen
 buffer_load_dwordx4 v[140:143], v144, s[4:7], s82 offen offset:128
 s_load_dwordx2 s[12:13], s[0:1], 16
 s_load_dwordx2 s[20:21], s[0:1], 32
 s_load_dwordx2 s[24:25], s[0:1], 40
 s_load_dwordx2 s[28:29], s[0:1], 56
 s_load_dwordx2 s[32:33], s[0:1], 64
 s_load_dwordx2 s[36:37], s[0:1], 72
 s_load_dwordx2 s[40:41], s[0:1], 80
 s_load_dwordx2 s[44:45], s[0:1], 88
 s_load_dwordx2 s[48:49], s[0:1], 96
 s_load_dwordx2 s[52:53], s[0:1], 104
 s_mov_b32 s14, 4194304
 s_mov_b32 s15, 0x20000
 s_mov_b32 s22, 4194304
 s_mov_b32 s23, 0x20000
 s_mov_b32 s26, 4194304
 s_mov_b32 s27, 0x20000
 s_mov_b32 s30, 1835008
 s_mov_b32 s31, 0x20000
 s_mov_b32 s34, 8388608
 s_mov_b32 s35, 0x20000
 s_mov_b32 s38, 4096
 s_mov_b32 s39, 0x20000
 s_mov_b32 s42, 917504
 s_mov_b32 s43, 0x20000
 s_mov_b32 s46, 2097152
 s_mov_b32 s47, 0x20000
 s_mov_b32 s50, 256
 s_mov_b32 s51, 0x20000
 s_mov_b32 s54, 268435456
 s_mov_b32 s55, 0x20000
 s_getpc_b64 s[84:85]
Lpc1:
 v_and_b32 v250, 7, v253
 v_lshl_add_u32 v250, v252, 3, v250
 v_lshlrev_b32 v250, 7, v250
 s_lshr_b32 s72, s2, 3
 s_lshl_b32 s72, s72, 12
 v_add_u32 v250, s72, v250
 v_min_u32 v250, sequential_preLN__compressed_kv_cla__mixer_gmlp__prompt_kernel_last-Lpc1, v250
 global_load_dword v239, v250, s[84:85]
 s_lshl_b32 s78, s2, 7
 s_add_u32 s78, s78, 71303168
 v_lshl_add_u32 v250, v0, 4, s78
 v_bfe_u32 v249, v0, 3, 1
 v_mul_u32_u24 v249, 32640, v249
 v_add_u32 v250, v250, v249
 s_lshl_b32 s78, s2, 10
 s_add_u32 s78, s78, 71564288
 v_lshl_add_u32 v249, v0, 4, s78
 v_mov_b32 v150, 0x7ffffff0
 v_cmp_gt_u32 vcc, 16, v0
 v_sub_u32 v146, 0, v252
 v_mov_b32 v147, v146
 v_cndmask_b32 v150, v150, v250, vcc
 v_cmp_eq_u32 vcc, 1, v252
 v_mov_b32 v148, v146
 v_mov_b32 v149, v146
 v_cndmask_b32 v150, v150, v249, vcc
 v_and_b32 v250, 15, v253
 v_lshrrev_b32 v249, 1, v250
 v_lshrrev_b32 v248, 4, v253
 v_xor_b32 v249, v249, v248
 v_lshlrev_b32 v249, 4, v249
 v_lshl_add_u32 v250, v250, 7, v249
 v_lshl_add_u32 v250, v252, 13, v250
 v_add_u32 v151, 0x8000, v250
 v_xor_b32 v152, 64, v151
 v_add_u32 v153, 0x18000, v151
 v_add_u32 v154, 0x18000, v152
 v_lshlrev_b32 v250, 11, v248
 v_bfe_u32 v249, v253, 2, 2
 v_lshl_add_u32 v250, v249, 6, v250
 v_and_b32 v249, 1, v248
 v_lshl_add_u32 v250, v249, 5, v250
 v_and_b32 v249, 3, v253
 v_lshl_add_u32 v192, v249, 3, v250
 v_xor_b32 v193, 32, v192
 v_add_u32 v194, 0x18000, v192
 v_add_u32 v195, 0x18000, v193
 s_add_u32 m0, s73, 16384
 s_nop 0
 buffer_load_dwordx4 v224, s[16:19], s75 offen offset:0 lds
 buffer_load_dwordx4 v225, s[16:19], s75 offen offset:1024 lds
 buffer_load_dwordx4 v226, s[16:19], s75 offen offset:2048 lds
 buffer_load_dwordx4 v227, s[16:19], s75 offen offset:3072 lds
 s_add_u32 s75, s75, 524288
 s_bitset0_b32 s75, 22
 s_add_u32 m0, s76, 65536
 s_nop 0
 buffer_load_dwordx4 v128, s[8:11], s74 offen offset:0 lds
 buffer_load_dwordx4 v129, s[8:11], s74 offen offset:1024 lds
 buffer_load_dwordx4 v130, s[8:11], s74 offen offset:2048 lds
 buffer_load_dwordx4 v131, s[8:11], s74 offen offset:3072 lds
 s_add_u32 m0, s76, 69632
 s_nop 0
 buffer_load_dwordx4 v132, s[8:11], s74 offen offset:0 lds
 buffer_load_dwordx4 v133, s[8:11], s74 offen offset:1024 lds
 buffer_load_dwordx4 v134, s[8:11], s74 offen offset:2048 lds
 buffer_load_dwordx4 v135, s[8:11], s74 offen offset:3072 lds
 s_add_u32 s74, s74, 128
 s_bitset0_b32 s74, 10
 s_waitcnt vmcnt(13)
 v_lshlrev_b32 v156, 16, v136
 v_and_b32 v157, 0xffff0000, v136
 v_lshlrev_b32 v158, 16, v137
 v_and_b32 v159, 0xffff0000, v137
 v_lshlrev_b32 v160, 16, v138
 v_and_b32 v161, 0xffff0000, v138
 v_lshlrev_b32 v162, 16, v139
 v_and_b32 v163, 0xffff0000, v139
 v_lshlrev_b32 v164, 16, v140
 v_and_b32 v165, 0xffff0000, v140
 v_lshlrev_b32 v166, 16, v141
 v_and_b32 v167, 0xffff0000, v141
 v_lshlrev_b32 v168, 16, v142
 v_and_b32 v169, 0xffff0000, v142
 v_lshlrev_b32 v170, 16, v143
 v_and_b32 v171, 0xffff0000, v143
 v_add_f32 v172, v156, v157
 v_mul_f32 v173, v156, v156
 v_fmac_f32 v173, v157, v157
 v_add_f32 v172, v172, v158
 v_fmac_f32 v173, v158, v158
 v_add_f32 v172, v172, v159
 v_fmac_f32 v173, v159, v159
 v_add_f32 v172, v172, v160
 v_fmac_f32 v173, v160, v160
 v_add_f32 v172, v172, v161
 v_fmac_f32 v173, v161, v161
 v_add_f32 v172, v172, v162
 v_fmac_f32 v173, v162, v162
 v_add_f32 v172, v172, v163
 v_fmac_f32 v173, v163, v163
 v_add_f32 v172, v172, v164
 v_fmac_f32 v173, v164, v164
 v_add_f32 v172, v172, v165
 v_fmac_f32 v173, v165, v165
 v_add_f32 v172, v172, v166
 v_fmac_f32 v173, v166, v166
 v_add_f32 v172, v172, v167
 v_fmac_f32 v173, v167, v167
 v_add_f32 v172, v172, v168
 v_fmac_f32 v173, v168, v168
 v_add_f32 v172, v172, v169
 v_fmac_f32 v173, v169, v169
 v_add_f32 v172, v172, v170
 v_fmac_f32 v173, v170, v170
 v_add_f32 v172, v172, v171
 v_fmac_f32 v173, v171, v171
 s_nop 1
 v_add_f32_dpp v172, v172, v172 row_ror:8 row_mask:0xf bank_mask:0xf
 v_add_f32_dpp v173, v173, v173 row_ror:8 row_mask:0xf bank_mask:0xf
 v_mov_b32 v174, v172
 v_mov_b32 v175, v173
 s_nop 0
 v_permlane16_swap_b32 v174, v172
 v_permlane16_swap_b32 v175, v173
 v_add_f32 v172, v172, v174
 v_add_f32 v173, v173, v175
 v_mov_b32 v174, v172
 v_mov_b32 v175, v173
 s_nop 0
 v_permlane32_swap_b32 v174, v172
 v_permlane32_swap_b32 v175, v173
 v_add_f32 v172, v172, v174
 v_add_f32 v173, v173, v175
 v_and_b32 v174, 7, v253
 v_lshlrev_b32 v174, 5, v174
 v_add_u32 v174, 0x20000, v174
 v_lshl_add_u32 v184, v252, 13, v174
 v_bfe_u32 v175, v253, 3, 2
 v_lshl_add_u32 v174, v175, 13, v174
 v_lshl_add_u32 v174, v252, 2, v174
 ds_write2_b32 v174, v172, v173 offset0:0 offset1:4
 v_lshrrev_b32 v174, 3, v253
 v_lshlrev_b32 v174, 8, v174
 v_and_b32 v175, 7, v253
 v_lshl_add_u32 v174, v175, 4, v174
 v_lshl_add_u32 v144, v252, 12, v174
 s_lshr_b32 s72, s2, 1
 s_lshl_b32 s72, s72, 14
 s_and_b32 s78, s2, 1
 s_lshl_b32 s78, s78, 7
 s_add_u32 s72, s72, s78
 v_min_u32 v248, 1, v0
 v_lshlrev_b32 v248, 30, v248
 v_mov_b32 v249, 1
 s_waitcnt vmcnt(15)
 s_waitcnt lgkmcnt(0)
 s_barrier
 ds_read_b128 v[176:179], v184
 ds_read_b128 v[180:183], v184 offset:16
 ds_read_b64_tr_b16 v[200:201], v192 offset:0
 ds_read_b64_tr_b16 v[202:203], v192 offset:1024
 ds_read_b64_tr_b16 v[204:205], v192 offset:8192
 ds_read_b64_tr_b16 v[206:207], v192 offset:9216
 ds_read_b128 a[0:3], v151 offset:0
 ds_read_b128 a[16:19], v152 offset:0
 ds_read_b128 a[4:7], v151 offset:2048
 ds_read_b128 a[20:23], v152 offset:2048
 ds_read_b128 a[8:11], v151 offset:4096
 ds_read_b128 a[24:27], v152 offset:4096
 ds_read_b128 a[12:15], v151 offset:6144
 ds_read_b128 a[28:31], v152 offset:6144
 ds_read_b64_tr_b16 v[208:209], v193 offset:0
 ds_read_b64_tr_b16 v[210:211], v193 offset:1024
 ds_read_b64_tr_b16 v[212:213], v193 offset:8192
 ds_read_b64_tr_b16 v[214:215], v193 offset:9216
 s_waitcnt lgkmcnt(10)
 v_mfma_f32_16x16x32_bf16 v[0:3], v[200:203], a[0:3], 0
 s_add_u32 m0, s76, 131072
 ds_read_b64_tr_b16 v[216:217], v192 offset:256
 v_add_f32 v172, v176, v177
 v_mfma_f32_16x16x32_bf16 v[0:3], v[204:207], a[16:19], v[0:3]
 s_waitcnt lgkmcnt(9)
 ds_read_b64_tr_b16 v[218:219], v192 offset:1280
 v_add_f32 v173, v180, v181
 v_mfma_f32_16x16x32_bf16 v[32:35], v[204:207], a[20:23], 0
 buffer_load_dwordx4 v128, s[8:11], s74 offen offset:0 lds
 v_mfma_f32_16x16x32_bf16 v[32:35], v[200:203], a[4:7], v[32:35]
 s_waitcnt lgkmcnt(8)
 v_add_f32 v174, v178, v179
 v_add_f32 v175, v182, v183
 v_mfma_f32_16x16x32_bf16 v[64:67], v[200:203], a[8:11], 0
 buffer_load_dwordx4 v129, s[8:11], s74 offen offset:1024 lds
 v_mfma_f32_16x16x32_bf16 v[64:67], v[204:207], a[24:27], v[64:67]
 s_waitcnt lgkmcnt(6)
 ds_read_b64_tr_b16 v[220:221], v192 offset:8448
 v_add_f32 v172, v172, v174
 v_mfma_f32_16x16x32_bf16 v[96:99], v[204:207], a[28:31], 0
 s_waitcnt lgkmcnt(3)
 ds_read_b64_tr_b16 v[222:223], v192 offset:9472
 v_add_f32 v173, v173, v175
 v_mfma_f32_16x16x32_bf16 v[96:99], v[200:203], a[12:15], v[96:99]
 v_mul_f32 v172, 0x3b000000, v172
 v_mul_f32 v173, 0x3b000000, v173
 v_mfma_f32_16x16x32_bf16 v[4:7], v[208:211], a[0:3], 0
 buffer_load_dwordx4 v130, s[8:11], s74 offen offset:2048 lds
 v_mfma_f32_16x16x32_bf16 v[4:7], v[212:215], a[16:19], v[4:7]
 ds_read_b64_tr_b16 v[200:201], v193 offset:256
 v_fma_f32 v173, -v172, v172, v173
 v_mfma_f32_16x16x32_bf16 v[36:39], v[212:215], a[20:23], 0
 ds_read_b64_tr_b16 v[202:203], v193 offset:1280
 v_max_f32 v173, 0, v173
 v_mfma_f32_16x16x32_bf16 v[36:39], v[208:211], a[4:7], v[36:39]
 buffer_load_dwordx4 v131, s[8:11], s74 offen offset:3072 lds
 v_mfma_f32_16x16x32_bf16 v[68:71], v[208:211], a[8:11], 0
 ds_read_b64_tr_b16 v[204:205], v193 offset:8448
 v_add_f32 v173, 0x3727c5ac, v173
 v_mfma_f32_16x16x32_bf16 v[68:71], v[212:215], a[24:27], v[68:71]
 v_rsq_f32 v173, v173
 v_mfma_f32_16x16x32_bf16 v[100:103], v[212:215], a[28:31], 0
 s_waitcnt lgkmcnt(3)
 ds_read_b64_tr_b16 v[206:207], v193 offset:9472
 v_nop
 v_mfma_f32_16x16x32_bf16 v[100:103], v[208:211], a[12:15], v[100:103]
 s_add_u32 m0, s76, 135168
 v_mfma_f32_16x16x32_bf16 v[8:11], v[216:219], a[0:3], 0
 buffer_load_dwordx4 v132, s[8:11], s74 offen offset:0 lds
 v_mfma_f32_16x16x32_bf16 v[8:11], v[220:223], a[16:19], v[8:11]
 ds_read_b64_tr_b16 v[208:209], v192 offset:512
 v_mul_f32 v173, 0x3e0293ee, v173
 v_mfma_f32_16x16x32_bf16 v[40:43], v[220:223], a[20:23], 0
 ds_read_b64_tr_b16 v[210:211], v192 offset:1536
 v_mul_f32 v172, v172, v173
 v_mfma_f32_16x16x32_bf16 v[40:43], v[216:219], a[4:7], v[40:43]
 ds_read_b64_tr_b16 v[212:213], v192 offset:8704
 v_fma_f32 v156, v156, v173, -v172
 v_mfma_f32_16x16x32_bf16 v[72:75], v[216:219], a[8:11], 0
 buffer_load_dwordx4 v133, s[8:11], s74 offen offset:1024 lds
 v_mfma_f32_16x16x32_bf16 v[72:75], v[220:223], a[24:27], v[72:75]
 v_fma_f32 v157, v157, v173, -v172
 v_fma_f32 v158, v158, v173, -v172
 v_mfma_f32_16x16x32_bf16 v[104:107], v[220:223], a[28:31], 0
 s_waitcnt lgkmcnt(3)
 ds_read_b64_tr_b16 v[214:215], v192 offset:9728
 v_fma_f32 v159, v159, v173, -v172
 v_mfma_f32_16x16x32_bf16 v[104:107], v[216:219], a[12:15], v[104:107]
 buffer_load_dwordx4 v134, s[8:11], s74 offen offset:2048 lds
 v_mfma_f32_16x16x32_bf16 v[12:15], v[200:203], a[0:3], 0
 ds_read_b64_tr_b16 v[216:217], v193 offset:512
 v_fma_f32 v160, v160, v173, -v172
 v_mfma_f32_16x16x32_bf16 v[12:15], v[204:207], a[16:19], v[12:15]
 ds_read_b64_tr_b16 v[218:219], v193 offset:1536
 v_fma_f32 v161, v161, v173, -v172
 v_mfma_f32_16x16x32_bf16 v[44:47], v[204:207], a[20:23], 0
 v_fma_f32 v162, v162, v173, -v172
 v_fma_f32 v163, v163, v173, -v172
 v_mfma_f32_16x16x32_bf16 v[44:47], v[200:203], a[4:7], v[44:47]
 buffer_load_dwordx4 v135, s[8:11], s74 offen offset:3072 lds
 v_mfma_f32_16x16x32_bf16 v[76:79], v[200:203], a[8:11], 0
 ds_read_b64_tr_b16 v[220:221], v193 offset:8704
 v_fma_f32 v164, v164, v173, -v172
 v_mfma_f32_16x16x32_bf16 v[76:79], v[204:207], a[24:27], v[76:79]
 ds_read_b64_tr_b16 v[222:223], v193 offset:9728
 v_fma_f32 v165, v165, v173, -v172
 v_mfma_f32_16x16x32_bf16 v[108:111], v[204:207], a[28:31], 0
 s_waitcnt vmcnt(8)
 ds_read_b128 a[32:35], v151 offset:32768
 v_fma_f32 v166, v166, v173, -v172
 v_mfma_f32_16x16x32_bf16 v[108:111], v[200:203], a[12:15], v[108:111]
 s_waitcnt lgkmcnt(5)
 v_mfma_f32_16x16x32_bf16 v[16:19], v[208:211], a[0:3], 0
 s_add_u32 s74, s74, 128
 ds_read_b64_tr_b16 v[200:201], v192 offset:768
 v_fma_f32 v167, v167, v173, -v172
 v_mfma_f32_16x16x32_bf16 v[16:19], v[212:215], a[16:19], v[16:19]
 s_bitset0_b32 s74, 10
 ds_read_b128 a[48:51], v152 offset:32768
 v_fma_f32 v168, v168, v173, -v172
 v_mfma_f32_16x16x32_bf16 v[48:51], v[212:215], a[20:23], 0
 s_add_u32 m0, s73, 98304
 ds_read_b64_tr_b16 v[202:203], v192 offset:1792
 v_fma_f32 v169, v169, v173, -v172
 v_mfma_f32_16x16x32_bf16 v[48:51], v[208:211], a[4:7], v[48:51]
 buffer_load_dwordx4 v224, s[16:19], s75 offen offset:0 lds
 v_mfma_f32_16x16x32_bf16 v[80:83], v[208:211], a[8:11], 0
 buffer_load_dwordx4 v225, s[16:19], s75 offen offset:1024 lds
 v_mfma_f32_16x16x32_bf16 v[80:83], v[212:215], a[24:27], v[80:83]
 ds_read_b64_tr_b16 v[204:205], v192 offset:8960
 v_fma_f32 v170, v170, v173, -v172
 v_mfma_f32_16x16x32_bf16 v[112:115], v[212:215], a[28:31], 0
 s_waitcnt lgkmcnt(5)
 ds_read_b128 a[36:39], v151 offset:34816
 v_fma_f32 v171, v171, v173, -v172
 v_mfma_f32_16x16x32_bf16 v[112:115], v[208:211], a[12:15], v[112:115]
 ds_read_b64_tr_b16 v[206:207], v192 offset:9984
 v_cvt_pk_bf16_f32 v136, v156, v157
 v_mfma_f32_16x16x32_bf16 v[20:23], v[216:219], a[0:3], 0
 buffer_load_dwordx4 v226, s[16:19], s75 offen offset:2048 lds
 v_mfma_f32_16x16x32_bf16 v[20:23], v[220:223], a[16:19], v[20:23]
 ds_read_b64_tr_b16 v[208:209], v193 offset:768
 v_cvt_pk_bf16_f32 v137, v158, v159
 v_mfma_f32_16x16x32_bf16 v[52:55], v[220:223], a[20:23], 0
 ds_read_b128 a[52:55], v152 offset:34816
 v_cvt_pk_bf16_f32 v138, v160, v161
 v_mfma_f32_16x16x32_bf16 v[52:55], v[216:219], a[4:7], v[52:55]
 ds_read_b64_tr_b16 v[210:211], v193 offset:1792
 v_cvt_pk_bf16_f32 v139, v162, v163
 v_mfma_f32_16x16x32_bf16 v[84:87], v[216:219], a[8:11], 0
 buffer_load_dwordx4 v227, s[16:19], s75 offen offset:3072 lds
 v_mfma_f32_16x16x32_bf16 v[84:87], v[220:223], a[24:27], v[84:87]
 s_add_u32 s75, s75, 524288
 ds_read_b64_tr_b16 v[212:213], v193 offset:8960
 v_cvt_pk_bf16_f32 v140, v164, v165
 v_mfma_f32_16x16x32_bf16 v[116:119], v[220:223], a[28:31], 0
 s_bitset0_b32 s75, 22
 ds_read_b64_tr_b16 v[214:215], v193 offset:9984
 ds_read_b128 a[40:43], v151 offset:36864
 v_mfma_f32_16x16x32_bf16 v[116:119], v[216:219], a[12:15], v[116:119]
 s_waitcnt vmcnt(20)
 s_waitcnt lgkmcnt(6)
 v_cvt_pk_bf16_f32 v141, v166, v167
 v_cvt_pk_bf16_f32 v142, v168, v169
 v_cvt_pk_bf16_f32 v143, v170, v171
 v_mfma_f32_16x16x32_bf16 v[24:27], v[200:203], a[0:3], 0
 s_barrier
 ds_read_b128 a[56:59], v152 offset:36864
 ds_read_b64_tr_b16 v[216:217], v192 offset:16384
 v_mfma_f32_16x16x32_bf16 v[24:27], v[204:207], a[16:19], v[24:27]
 buffer_store_dwordx4 v[136:139], v144, s[52:55], s72 offen sc1
 v_mfma_f32_16x16x32_bf16 v[56:59], v[204:207], a[20:23], 0
 ds_read_b64_tr_b16 v[218:219], v192 offset:17408
 ds_read_b128 a[44:47], v151 offset:38912
 v_mfma_f32_16x16x32_bf16 v[56:59], v[200:203], a[4:7], v[56:59]
 ds_read_b64_tr_b16 v[220:221], v192 offset:24576
 ds_read_b64_tr_b16 v[222:223], v192 offset:25600
 v_mfma_f32_16x16x32_bf16 v[88:91], v[200:203], a[8:11], 0
 v_mfma_f32_16x16x32_bf16 v[88:91], v[204:207], a[24:27], v[88:91]
 buffer_store_dwordx4 v[140:143], v144, s[52:55], s72 offen offset:2048 sc1
 v_mfma_f32_16x16x32_bf16 v[120:123], v[204:207], a[28:31], 0
 s_waitcnt lgkmcnt(7)
 ds_read_b128 a[60:63], v152 offset:38912
 v_mfma_f32_16x16x32_bf16 v[120:123], v[200:203], a[12:15], v[120:123]
 v_mfma_f32_16x16x32_bf16 v[28:31], v[208:211], a[0:3], 0
 ds_read_b64_tr_b16 v[200:201], v193 offset:16384
 ds_read_b64_tr_b16 v[202:203], v193 offset:17408
 v_mfma_f32_16x16x32_bf16 v[28:31], v[212:215], a[16:19], v[28:31]
 buffer_store_dwordx4 v[146:149], v150, s[52:55], 0 offen sc1
 v_mfma_f32_16x16x32_bf16 v[60:63], v[212:215], a[20:23], 0
 v_mfma_f32_16x16x32_bf16 v[60:63], v[208:211], a[4:7], v[60:63]
 ds_read_b64_tr_b16 v[204:205], v193 offset:24576
 ds_read_b64_tr_b16 v[206:207], v193 offset:25600
 v_mfma_f32_16x16x32_bf16 v[92:95], v[208:211], a[8:11], 0
 s_add_u32 m0, s76, 32768
 v_mfma_f32_16x16x32_bf16 v[92:95], v[212:215], a[24:27], v[92:95]
 buffer_load_dwordx4 v128, s[8:11], s74 offen offset:0 lds
 v_mfma_f32_16x16x32_bf16 v[124:127], v[212:215], a[28:31], 0
 s_waitcnt lgkmcnt(4)
 v_mfma_f32_16x16x32_bf16 v[124:127], v[208:211], a[12:15], v[124:127]
 v_mfma_f32_16x16x32_bf16 v[0:3], v[216:219], a[32:35], v[0:3]
 ds_read_b64_tr_b16 v[208:209], v192 offset:16640
 ds_read_b64_tr_b16 v[210:211], v192 offset:17664
 v_mfma_f32_16x16x32_bf16 v[0:3], v[220:223], a[48:51], v[0:3]
 buffer_load_dwordx4 v129, s[8:11], s74 offen offset:1024 lds
 v_mfma_f32_16x16x32_bf16 v[32:35], v[220:223], a[52:55], v[32:35]
 v_mfma_f32_16x16x32_bf16 v[32:35], v[216:219], a[36:39], v[32:35]
 ds_read_b64_tr_b16 v[212:213], v192 offset:24832
 ds_read_b64_tr_b16 v[214:215], v192 offset:25856
 v_mfma_f32_16x16x32_bf16 v[64:67], v[216:219], a[40:43], v[64:67]
 v_mfma_f32_16x16x32_bf16 v[64:67], v[220:223], a[56:59], v[64:67]
 buffer_load_dwordx4 v130, s[8:11], s74 offen offset:2048 lds
 v_mfma_f32_16x16x32_bf16 v[96:99], v[220:223], a[60:63], v[96:99]
 s_waitcnt lgkmcnt(4)
 v_mfma_f32_16x16x32_bf16 v[96:99], v[216:219], a[44:47], v[96:99]
 v_mfma_f32_16x16x32_bf16 v[4:7], v[200:203], a[32:35], v[4:7]
 ds_read_b64_tr_b16 v[216:217], v193 offset:16640
 ds_read_b64_tr_b16 v[218:219], v193 offset:17664
 v_mfma_f32_16x16x32_bf16 v[4:7], v[204:207], a[48:51], v[4:7]
 buffer_load_dwordx4 v131, s[8:11], s74 offen offset:3072 lds
 v_mfma_f32_16x16x32_bf16 v[36:39], v[204:207], a[52:55], v[36:39]
 v_mfma_f32_16x16x32_bf16 v[36:39], v[200:203], a[36:39], v[36:39]
 ds_read_b64_tr_b16 v[220:221], v193 offset:24832
 ds_read_b64_tr_b16 v[222:223], v193 offset:25856
 v_mfma_f32_16x16x32_bf16 v[68:71], v[200:203], a[40:43], v[68:71]
 s_add_u32 m0, s76, 36864
 v_mfma_f32_16x16x32_bf16 v[68:71], v[204:207], a[56:59], v[68:71]
 buffer_load_dwordx4 v132, s[8:11], s74 offen offset:0 lds
 v_mfma_f32_16x16x32_bf16 v[100:103], v[204:207], a[60:63], v[100:103]
 s_waitcnt lgkmcnt(4)
 v_mfma_f32_16x16x32_bf16 v[100:103], v[200:203], a[44:47], v[100:103]
 v_mfma_f32_16x16x32_bf16 v[8:11], v[208:211], a[32:35], v[8:11]
 ds_read_b64_tr_b16 v[200:201], v192 offset:16896
 ds_read_b64_tr_b16 v[202:203], v192 offset:17920
 v_mfma_f32_16x16x32_bf16 v[8:11], v[212:215], a[48:51], v[8:11]
 v_mfma_f32_16x16x32_bf16 v[40:43], v[212:215], a[52:55], v[40:43]
 buffer_load_dwordx4 v133, s[8:11], s74 offen offset:1024 lds
 v_mfma_f32_16x16x32_bf16 v[40:43], v[208:211], a[36:39], v[40:43]
 ds_read_b64_tr_b16 v[204:205], v192 offset:25088
 ds_read_b64_tr_b16 v[206:207], v192 offset:26112
 v_mfma_f32_16x16x32_bf16 v[72:75], v[208:211], a[40:43], v[72:75]
 v_mfma_f32_16x16x32_bf16 v[72:75], v[212:215], a[56:59], v[72:75]
 v_mfma_f32_16x16x32_bf16 v[104:107], v[212:215], a[60:63], v[104:107]
 buffer_load_dwordx4 v134, s[8:11], s74 offen offset:2048 lds
 v_mfma_f32_16x16x32_bf16 v[104:107], v[208:211], a[44:47], v[104:107]
 s_waitcnt lgkmcnt(4)
 v_mfma_f32_16x16x32_bf16 v[12:15], v[216:219], a[32:35], v[12:15]
 ds_read_b64_tr_b16 v[208:209], v193 offset:16896
 ds_read_b64_tr_b16 v[210:211], v193 offset:17920
 v_mfma_f32_16x16x32_bf16 v[12:15], v[220:223], a[48:51], v[12:15]
 v_mfma_f32_16x16x32_bf16 v[44:47], v[220:223], a[52:55], v[44:47]
 buffer_load_dwordx4 v135, s[8:11], s74 offen offset:3072 lds
 v_mfma_f32_16x16x32_bf16 v[44:47], v[216:219], a[36:39], v[44:47]
 ds_read_b64_tr_b16 v[212:213], v193 offset:25088
 ds_read_b64_tr_b16 v[214:215], v193 offset:26112
 v_mfma_f32_16x16x32_bf16 v[76:79], v[216:219], a[40:43], v[76:79]
 v_mfma_f32_16x16x32_bf16 v[76:79], v[220:223], a[56:59], v[76:79]
 s_add_u32 s74, s74, 128
 v_mfma_f32_16x16x32_bf16 v[108:111], v[220:223], a[60:63], v[108:111]
 s_waitcnt vmcnt(15)
 ds_read_b128 a[64:67], v153 offset:0
 v_mfma_f32_16x16x32_bf16 v[108:111], v[216:219], a[44:47], v[108:111]
 s_waitcnt lgkmcnt(5)
 v_mfma_f32_16x16x32_bf16 v[16:19], v[200:203], a[32:35], v[16:19]
 s_bitset0_b32 s74, 10
 ds_read_b64_tr_b16 v[216:217], v192 offset:17152
 ds_read_b128 a[80:83], v154 offset:0
 v_mfma_f32_16x16x32_bf16 v[16:19], v[204:207], a[48:51], v[16:19]
 s_add_u32 m0, s73, 114688
 ds_read_b64_tr_b16 v[218:219], v192 offset:18176
 ds_read_b64_tr_b16 v[220:221], v192 offset:25344
 v_mfma_f32_16x16x32_bf16 v[48:51], v[204:207], a[52:55], v[48:51]
 buffer_load_dwordx4 v224, s[16:19], s75 offen offset:0 lds
 v_mfma_f32_16x16x32_bf16 v[48:51], v[200:203], a[36:39], v[48:51]
 buffer_load_dwordx4 v225, s[16:19], s75 offen offset:1024 lds
 v_mfma_f32_16x16x32_bf16 v[80:83], v[200:203], a[40:43], v[80:83]
 ds_read_b128 a[68:71], v153 offset:2048
 ds_read_b64_tr_b16 v[222:223], v192 offset:26368
 v_mfma_f32_16x16x32_bf16 v[80:83], v[204:207], a[56:59], v[80:83]
 v_mfma_f32_16x16x32_bf16 v[112:115], v[204:207], a[60:63], v[112:115]
 buffer_load_dwordx4 v226, s[16:19], s75 offen offset:2048 lds
 v_mfma_f32_16x16x32_bf16 v[112:115], v[200:203], a[44:47], v[112:115]
 s_waitcnt lgkmcnt(7)
 v_mfma_f32_16x16x32_bf16 v[20:23], v[208:211], a[32:35], v[20:23]
 ds_read_b64_tr_b16 v[200:201], v193 offset:17152
 ds_read_b128 a[84:87], v154 offset:2048
 v_mfma_f32_16x16x32_bf16 v[20:23], v[212:215], a[48:51], v[20:23]
 ds_read_b64_tr_b16 v[202:203], v193 offset:18176
 ds_read_b64_tr_b16 v[204:205], v193 offset:25344
 v_mfma_f32_16x16x32_bf16 v[52:55], v[212:215], a[52:55], v[52:55]
 buffer_load_dwordx4 v227, s[16:19], s75 offen offset:3072 lds
 v_mfma_f32_16x16x32_bf16 v[52:55], v[208:211], a[36:39], v[52:55]
 ds_read_b128 a[72:75], v153 offset:4096
 ds_read_b64_tr_b16 v[206:207], v193 offset:26368
 v_mfma_f32_16x16x32_bf16 v[84:87], v[208:211], a[40:43], v[84:87]
 v_mfma_f32_16x16x32_bf16 v[84:87], v[212:215], a[56:59], v[84:87]
 s_add_u32 s75, s75, 524288
 v_mfma_f32_16x16x32_bf16 v[116:119], v[212:215], a[60:63], v[116:119]
 s_bitset0_b32 s75, 22
 v_mfma_f32_16x16x32_bf16 v[116:119], v[208:211], a[44:47], v[116:119]
 s_waitcnt vmcnt(15)
 s_waitcnt lgkmcnt(6)
 ds_read_b128 a[88:91], v154 offset:4096
 v_mfma_f32_16x16x32_bf16 v[24:27], v[216:219], a[32:35], v[24:27]
 s_barrier
 ds_read_b64_tr_b16 v[208:209], v194 offset:0
 ds_read_b64_tr_b16 v[210:211], v194 offset:1024
 v_mfma_f32_16x16x32_bf16 v[24:27], v[220:223], a[48:51], v[24:27]
 s_add_u32 m0, s76, 65536
 v_mfma_f32_16x16x32_bf16 v[56:59], v[220:223], a[52:55], v[56:59]
 buffer_load_dwordx4 v128, s[8:11], s74 offen offset:0 lds
 v_mfma_f32_16x16x32_bf16 v[56:59], v[216:219], a[36:39], v[56:59]
 ds_read_b128 a[76:79], v153 offset:6144
 ds_read_b64_tr_b16 v[212:213], v194 offset:8192
 v_mfma_f32_16x16x32_bf16 v[88:91], v[216:219], a[40:43], v[88:91]
 v_mfma_f32_16x16x32_bf16 v[88:91], v[220:223], a[56:59], v[88:91]
 ds_read_b64_tr_b16 v[214:215], v194 offset:9216
 ds_read_b128 a[92:95], v154 offset:6144
 v_mfma_f32_16x16x32_bf16 v[120:123], v[220:223], a[60:63], v[120:123]
 buffer_load_dwordx4 v129, s[8:11], s74 offen offset:1024 lds
 v_mfma_f32_16x16x32_bf16 v[120:123], v[216:219], a[44:47], v[120:123]
 s_waitcnt lgkmcnt(7)
 v_mfma_f32_16x16x32_bf16 v[28:31], v[200:203], a[32:35], v[28:31]
 ds_read_b64_tr_b16 v[216:217], v195 offset:0
 ds_read_b64_tr_b16 v[218:219], v195 offset:1024
 v_mfma_f32_16x16x32_bf16 v[28:31], v[204:207], a[48:51], v[28:31]
 v_mfma_f32_16x16x32_bf16 v[60:63], v[204:207], a[52:55], v[60:63]
 v_mfma_f32_16x16x32_bf16 v[60:63], v[200:203], a[36:39], v[60:63]
 buffer_load_dwordx4 v130, s[8:11], s74 offen offset:2048 lds
 v_mfma_f32_16x16x32_bf16 v[92:95], v[200:203], a[40:43], v[92:95]
 ds_read_b64_tr_b16 v[220:221], v195 offset:8192
 ds_read_b64_tr_b16 v[222:223], v195 offset:9216
 v_mfma_f32_16x16x32_bf16 v[92:95], v[204:207], a[56:59], v[92:95]
 v_mfma_f32_16x16x32_bf16 v[124:127], v[204:207], a[60:63], v[124:127]
 s_waitcnt lgkmcnt(4)
 v_mfma_f32_16x16x32_bf16 v[124:127], v[200:203], a[44:47], v[124:127]
 v_mfma_f32_16x16x32_bf16 v[0:3], v[208:211], a[64:67], v[0:3]
 ds_read_b64_tr_b16 v[200:201], v194 offset:256
 v_bfe_u32 v196, v253, 1, 4
 v_mfma_f32_16x16x32_bf16 v[0:3], v[212:215], a[80:83], v[0:3]
 buffer_load_dwordx4 v131, s[8:11], s74 offen offset:3072 lds
 v_mfma_f32_16x16x32_bf16 v[32:35], v[212:215], a[84:87], v[32:35]
 ds_read_b64_tr_b16 v[202:203], v194 offset:1280
 ds_read_b64_tr_b16 v[204:205], v194 offset:8448
 v_mfma_f32_16x16x32_bf16 v[32:35], v[208:211], a[68:71], v[32:35]
 v_mfma_f32_16x16x32_bf16 v[64:67], v[208:211], a[72:75], v[64:67]
 s_add_u32 m0, s76, 69632
 ds_read_b64_tr_b16 v[206:207], v194 offset:9472
 v_lshl_add_u32 v196, v252, 4, v196
 v_mfma_f32_16x16x32_bf16 v[64:67], v[212:215], a[88:91], v[64:67]
 buffer_load_dwordx4 v132, s[8:11], s74 offen offset:0 lds
 v_mfma_f32_16x16x32_bf16 v[96:99], v[212:215], a[92:95], v[96:99]
 s_waitcnt lgkmcnt(4)
 v_mfma_f32_16x16x32_bf16 v[96:99], v[208:211], a[76:79], v[96:99]
 v_mfma_f32_16x16x32_bf16 v[4:7], v[216:219], a[64:67], v[4:7]
 ds_read_b64_tr_b16 v[208:209], v195 offset:256
 v_lshlrev_b32 v196, 13, v196
 v_mfma_f32_16x16x32_bf16 v[4:7], v[220:223], a[80:83], v[4:7]
 ds_read_b64_tr_b16 v[210:211], v195 offset:1280
 ds_read_b64_tr_b16 v[212:213], v195 offset:8448
 v_mfma_f32_16x16x32_bf16 v[36:39], v[220:223], a[84:87], v[36:39]
 buffer_load_dwordx4 v133, s[8:11], s74 offen offset:1024 lds
 v_mfma_f32_16x16x32_bf16 v[36:39], v[216:219], a[68:71], v[36:39]
 v_mfma_f32_16x16x32_bf16 v[68:71], v[216:219], a[72:75], v[68:71]
 ds_read_b64_tr_b16 v[214:215], v195 offset:9472
 v_and_b32 v197, 1, v253
 v_mfma_f32_16x16x32_bf16 v[68:71], v[220:223], a[88:91], v[68:71]
 v_mfma_f32_16x16x32_bf16 v[100:103], v[220:223], a[92:95], v[100:103]
 s_waitcnt lgkmcnt(4)
 v_mfma_f32_16x16x32_bf16 v[100:103], v[216:219], a[76:79], v[100:103]
 buffer_load_dwordx4 v134, s[8:11], s74 offen offset:2048 lds
 v_mfma_f32_16x16x32_bf16 v[8:11], v[200:203], a[64:67], v[8:11]
 ds_read_b64_tr_b16 v[216:217], v194 offset:512
 v_lshl_add_u32 v155, v197, 7, v196
 v_mfma_f32_16x16x32_bf16 v[8:11], v[204:207], a[80:83], v[8:11]
 ds_read_b64_tr_b16 v[218:219], v194 offset:1536
 ds_read_b64_tr_b16 v[220:221], v194 offset:8704
 v_mfma_f32_16x16x32_bf16 v[40:43], v[204:207], a[84:87], v[40:43]
 v_mfma_f32_16x16x32_bf16 v[40:43], v[200:203], a[68:71], v[40:43]
 s_lshl_b32 s86, s62, 19
 v_mfma_f32_16x16x32_bf16 v[72:75], v[200:203], a[72:75], v[72:75]
 v_mfma_f32_16x16x32_bf16 v[72:75], v[204:207], a[88:91], v[72:75]
 buffer_load_dwordx4 v135, s[8:11], s74 offen offset:3072 lds
 v_mfma_f32_16x16x32_bf16 v[104:107], v[204:207], a[92:95], v[104:107]
 s_waitcnt lgkmcnt(3)
 ds_read_b64_tr_b16 v[222:223], v194 offset:9728
 v_mfma_f32_16x16x32_bf16 v[104:107], v[200:203], a[76:79], v[104:107]
 s_lshl_b32 s77, s61, 8
 v_mfma_f32_16x16x32_bf16 v[12:15], v[208:211], a[64:67], v[12:15]
 ds_read_b64_tr_b16 v[200:201], v195 offset:512
 ds_read_b64_tr_b16 v[202:203], v195 offset:1536
 v_mfma_f32_16x16x32_bf16 v[12:15], v[212:215], a[80:83], v[12:15]
 s_add_u32 s74, s74, 128
 v_mfma_f32_16x16x32_bf16 v[44:47], v[212:215], a[84:87], v[44:47]
 s_bitset0_b32 s74, 10
 v_mfma_f32_16x16x32_bf16 v[44:47], v[208:211], a[68:71], v[44:47]
 s_add_u32 m0, s73, 0
 ds_read_b64_tr_b16 v[204:205], v195 offset:8704
 ds_read_b64_tr_b16 v[206:207], v195 offset:9728
 v_mfma_f32_16x16x32_bf16 v[76:79], v[208:211], a[72:75], v[76:79]
 buffer_load_dwordx4 v224, s[16:19], s75 offen offset:0 lds
 v_mfma_f32_16x16x32_bf16 v[76:79], v[212:215], a[88:91], v[76:79]
 s_add_u32 s86, s86, s77
 v_mfma_f32_16x16x32_bf16 v[108:111], v[212:215], a[92:95], v[108:111]
 s_waitcnt vmcnt(13)
 ds_read_b128 a[96:99], v151 offset:0
 v_mfma_f32_16x16x32_bf16 v[108:111], v[208:211], a[76:79], v[108:111]
 s_waitcnt lgkmcnt(5)
 v_mfma_f32_16x16x32_bf16 v[16:19], v[216:219], a[64:67], v[16:19]
 buffer_load_dwordx4 v225, s[16:19], s75 offen offset:1024 lds
 v_mfma_f32_16x16x32_bf16 v[16:19], v[220:223], a[80:83], v[16:19]
 ds_read_b64_tr_b16 v[208:209], v194 offset:768
 ds_read_b128 a[112:115], v152 offset:0
 v_mfma_f32_16x16x32_bf16 v[48:51], v[220:223], a[84:87], v[48:51]
 ds_read_b64_tr_b16 v[210:211], v194 offset:1792
 v_lshl_add_u32 v229, v252, 14, v251
 v_mfma_f32_16x16x32_bf16 v[48:51], v[216:219], a[68:71], v[48:51]
 ds_read_b64_tr_b16 v[212:213], v194 offset:8960
 ds_read_b128 a[100:103], v151 offset:2048
 v_mfma_f32_16x16x32_bf16 v[80:83], v[216:219], a[72:75], v[80:83]
 buffer_load_dwordx4 v226, s[16:19], s75 offen offset:2048 lds
 v_mfma_f32_16x16x32_bf16 v[80:83], v[220:223], a[88:91], v[80:83]
 ds_read_b64_tr_b16 v[214:215], v194 offset:9984
 v_add_u32 v230, 0x10000, v229
 v_mfma_f32_16x16x32_bf16 v[112:115], v[220:223], a[92:95], v[112:115]
 s_waitcnt lgkmcnt(7)
 v_mfma_f32_16x16x32_bf16 v[112:115], v[216:219], a[76:79], v[112:115]
 v_mfma_f32_16x16x32_bf16 v[20:23], v[200:203], a[64:67], v[20:23]
 ds_read_b64_tr_b16 v[216:217], v195 offset:768
 ds_read_b128 a[116:119], v152 offset:2048
 v_mfma_f32_16x16x32_bf16 v[20:23], v[204:207], a[80:83], v[20:23]
 buffer_load_dwordx4 v227, s[16:19], s75 offen offset:3072 lds
 v_mfma_f32_16x16x32_bf16 v[52:55], v[204:207], a[84:87], v[52:55]
 ds_read_b64_tr_b16 v[218:219], v195 offset:1792
 v_and_b32 v238, 1, v253
 v_mfma_f32_16x16x32_bf16 v[52:55], v[200:203], a[68:71], v[52:55]
 ds_read_b64_tr_b16 v[220:221], v195 offset:8960
 ds_read_b128 a[104:107], v151 offset:4096
 v_mfma_f32_16x16x32_bf16 v[84:87], v[200:203], a[72:75], v[84:87]
 v_mfma_f32_16x16x32_bf16 v[84:87], v[204:207], a[88:91], v[84:87]
 s_add_u32 s75, s75, 524288
 ds_read_b64_tr_b16 v[222:223], v195 offset:9984
 v_lshlrev_b32 v238, 7, v238
 v_mfma_f32_16x16x32_bf16 v[116:119], v[204:207], a[92:95], v[116:119]
 s_bitset0_b32 s75, 22
 v_mfma_f32_16x16x32_bf16 v[116:119], v[200:203], a[76:79], v[116:119]
 s_waitcnt vmcnt(12)
 s_waitcnt lgkmcnt(6)
 ds_read_b128 a[120:123], v152 offset:4096
 v_mfma_f32_16x16x32_bf16 v[24:27], v[208:211], a[64:67], v[24:27]
 s_barrier
 ds_read_b64_tr_b16 v[200:201], v194 offset:16384
 ds_read_b64_tr_b16 v[202:203], v194 offset:17408
 v_mfma_f32_16x16x32_bf16 v[24:27], v[212:215], a[80:83], v[24:27]
 s_add_u32 m0, s76, 131072
 v_mfma_f32_16x16x32_bf16 v[56:59], v[212:215], a[84:87], v[56:59]
 buffer_load_dwordx4 v128, s[8:11], s74 offen offset:0 lds
 v_mfma_f32_16x16x32_bf16 v[56:59], v[208:211], a[68:71], v[56:59]
 s_lshl_b32 s77, s61, 20
 ds_read_b128 a[108:111], v151 offset:6144
 ds_read_b64_tr_b16 v[204:205], v194 offset:24576
 v_mfma_f32_16x16x32_bf16 v[88:91], v[208:211], a[72:75], v[88:91]
 v_mfma_f32_16x16x32_bf16 v[88:91], v[212:215], a[88:91], v[88:91]
 buffer_load_dwordx4 v129, s[8:11], s74 offen offset:1024 lds
 v_mfma_f32_16x16x32_bf16 v[120:123], v[212:215], a[92:95], v[120:123]
 s_waitcnt lgkmcnt(5)
 ds_read_b64_tr_b16 v[206:207], v194 offset:25600
 ds_read_b128 a[124:127], v152 offset:6144
 v_mfma_f32_16x16x32_bf16 v[120:123], v[208:211], a[76:79], v[120:123]
 s_add_u32 s77, s77, 4194304
 v_mfma_f32_16x16x32_bf16 v[28:31], v[216:219], a[64:67], v[28:31]
 ds_read_b64_tr_b16 v[208:209], v195 offset:16384
 ds_read_b64_tr_b16 v[210:211], v195 offset:17408
 v_mfma_f32_16x16x32_bf16 v[28:31], v[220:223], a[80:83], v[28:31]
 s_add_u32 s56, s52, s77
 s_addc_u32 s57, s53, 0
 ds_read_b64_tr_b16 v[212:213], v195 offset:24576
 v_mfma_f32_16x16x32_bf16 v[60:63], v[220:223], a[84:87], v[60:63]
 buffer_load_dwordx4 v130, s[8:11], s74 offen offset:2048 lds
 v_mfma_f32_16x16x32_bf16 v[60:63], v[216:219], a[68:71], v[60:63]
 v_mfma_f32_16x16x32_bf16 v[92:95], v[216:219], a[72:75], v[92:95]
 v_mfma_f32_16x16x32_bf16 v[92:95], v[220:223], a[88:91], v[92:95]
 s_sub_u32 s78, 16, s62
 ds_read_b64_tr_b16 v[214:215], v195 offset:25600
 v_mfma_f32_16x16x32_bf16 v[124:127], v[220:223], a[92:95], v[124:127]
 s_waitcnt lgkmcnt(4)
 v_mfma_f32_16x16x32_bf16 v[124:127], v[216:219], a[76:79], v[124:127]
 buffer_load_dwordx4 v131, s[8:11], s74 offen offset:3072 lds
 v_mfma_f32_16x16x32_bf16 v[0:3], v[200:203], a[96:99], v[0:3]
 ds_read_b64_tr_b16 v[216:217], v194 offset:16640
 ds_read_b64_tr_b16 v[218:219], v194 offset:17664
 v_mfma_f32_16x16x32_bf16 v[0:3], v[204:207], a[112:115], v[0:3]
 v_mfma_f32_16x16x32_bf16 v[32:35], v[204:207], a[116:119], v[32:35]
 s_lshl_b32 s58, s78, 16
 v_mfma_f32_16x16x32_bf16 v[32:35], v[200:203], a[100:103], v[32:35]
 s_add_u32 m0, s76, 135168
 ds_read_b64_tr_b16 v[220:221], v194 offset:24832
 ds_read_b64_tr_b16 v[222:223], v194 offset:25856
 v_mfma_f32_16x16x32_bf16 v[64:67], v[200:203], a[104:107], v[64:67]
 buffer_load_dwordx4 v132, s[8:11], s74 offen offset:0 lds
 v_mfma_f32_16x16x32_bf16 v[64:67], v[204:207], a[120:123], v[64:67]
 v_mfma_f32_16x16x32_bf16 v[96:99], v[204:207], a[124:127], v[96:99]
 s_waitcnt lgkmcnt(4)
 v_mfma_f32_16x16x32_bf16 v[96:99], v[200:203], a[108:111], v[96:99]
 s_mov_b32 s59, 0x20000
 v_mfma_f32_16x16x32_bf16 v[4:7], v[208:211], a[96:99], v[4:7]
 ds_read_b64_tr_b16 v[200:201], v195 offset:16640
 ds_read_b64_tr_b16 v[202:203], v195 offset:17664
 v_mfma_f32_16x16x32_bf16 v[4:7], v[212:215], a[112:115], v[4:7]
 buffer_load_dwordx4 v133, s[8:11], s74 offen offset:1024 lds
 v_mfma_f32_16x16x32_bf16 v[36:39], v[212:215], a[116:119], v[36:39]
 s_lshl_b32 s78, s62, 2
 v_mfma_f32_16x16x32_bf16 v[36:39], v[208:211], a[100:103], v[36:39]
 ds_read_b64_tr_b16 v[204:205], v195 offset:24832
 ds_read_b64_tr_b16 v[206:207], v195 offset:25856
 v_mfma_f32_16x16x32_bf16 v[68:71], v[208:211], a[104:107], v[68:71]
 v_mfma_f32_16x16x32_bf16 v[68:71], v[212:215], a[120:123], v[68:71]
 buffer_load_dwordx4 v134, s[8:11], s74 offen offset:2048 lds
 v_mfma_f32_16x16x32_bf16 v[100:103], v[212:215], a[124:127], v[100:103]
 s_waitcnt lgkmcnt(4)
 v_mfma_f32_16x16x32_bf16 v[100:103], v[208:211], a[108:111], v[100:103]
 s_add_u32 s78, s78, s60
 v_mfma_f32_16x16x32_bf16 v[8:11], v[216:219], a[96:99], v[8:11]
 ds_read_b64_tr_b16 v[208:209], v194 offset:16896
 ds_read_b64_tr_b16 v[210:211], v194 offset:17920
 v_mfma_f32_16x16x32_bf16 v[8:11], v[220:223], a[112:115], v[8:11]
 v_mfma_f32_16x16x32_bf16 v[40:43], v[220:223], a[116:119], v[40:43]
 buffer_load_dwordx4 v135, s[8:11], s74 offen offset:3072 lds
 v_mfma_f32_16x16x32_bf16 v[40:43], v[216:219], a[100:103], v[40:43]
 s_lshl_b32 s78, s78, 15
 ds_read_b64_tr_b16 v[212:213], v194 offset:25088
 ds_read_b64_tr_b16 v[214:215], v194 offset:26112
 v_mfma_f32_16x16x32_bf16 v[72:75], v[216:219], a[104:107], v[72:75]
 v_mfma_f32_16x16x32_bf16 v[72:75], v[220:223], a[120:123], v[72:75]
 v_mfma_f32_16x16x32_bf16 v[104:107], v[220:223], a[124:127], v[104:107]
 s_waitcnt lgkmcnt(4)
 v_mfma_f32_16x16x32_bf16 v[104:107], v[216:219], a[108:111], v[104:107]
 s_add_u32 s74, s74, 128
 v_mfma_f32_16x16x32_bf16 v[12:15], v[200:203], a[96:99], v[12:15]
 s_bitset0_b32 s74, 10
 ds_read_b64_tr_b16 v[216:217], v195 offset:16896
 ds_read_b64_tr_b16 v[218:219], v195 offset:17920
 v_mfma_f32_16x16x32_bf16 v[12:15], v[204:207], a[112:115], v[12:15]
 s_add_u32 m0, s73, 16384
 v_mfma_f32_16x16x32_bf16 v[44:47], v[204:207], a[116:119], v[44:47]
 buffer_load_dwordx4 v224, s[16:19], s75 offen offset:0 lds
 v_mfma_f32_16x16x32_bf16 v[44:47], v[200:203], a[100:103], v[44:47]
 buffer_load_dwordx4 v225, s[16:19], s75 offen offset:1024 lds
 v_mfma_f32_16x16x32_bf16 v[76:79], v[200:203], a[104:107], v[76:79]
 s_add_u32 s79, s77, s78
 ds_read_b64_tr_b16 v[220:221], v195 offset:25088
 ds_read_b64_tr_b16 v[222:223], v195 offset:26112
 v_mfma_f32_16x16x32_bf16 v[76:79], v[204:207], a[120:123], v[76:79]
 s_lshl_b32 s78, s62, 3
 v_mfma_f32_16x16x32_bf16 v[108:111], v[204:207], a[124:127], v[108:111]
 s_waitcnt vmcnt(14)
 ds_read_b128 a[128:131], v151 offset:32768
 v_mfma_f32_16x16x32_bf16 v[108:111], v[200:203], a[108:111], v[108:111]
 s_waitcnt lgkmcnt(5)
 v_mfma_f32_16x16x32_bf16 v[16:19], v[208:211], a[96:99], v[16:19]
 s_sub_u32 s77, 120, s78
 ds_read_b64_tr_b16 v[200:201], v194 offset:17152
 ds_read_b128 a[144:147], v152 offset:32768
 v_mfma_f32_16x16x32_bf16 v[16:19], v[212:215], a[112:115], v[16:19]
 buffer_load_dwordx4 v226, s[16:19], s75 offen offset:2048 lds
 v_mfma_f32_16x16x32_bf16 v[48:51], v[212:215], a[116:119], v[48:51]
 ds_read_b64_tr_b16 v[202:203], v194 offset:18176
 ds_read_b64_tr_b16 v[204:205], v194 offset:25344
 v_mfma_f32_16x16x32_bf16 v[48:51], v[208:211], a[100:103], v[48:51]
 v_mfma_f32_16x16x32_bf16 v[80:83], v[208:211], a[104:107], v[80:83]
 s_add_u32 s64, s78, s60
 ds_read_b128 a[132:135], v151 offset:34816
 ds_read_b64_tr_b16 v[206:207], v194 offset:26368
 v_mfma_f32_16x16x32_bf16 v[80:83], v[212:215], a[120:123], v[80:83]
 buffer_load_dwordx4 v227, s[16:19], s75 offen offset:3072 lds
 v_mfma_f32_16x16x32_bf16 v[112:115], v[212:215], a[124:127], v[112:115]
 s_waitcnt lgkmcnt(7)
 v_mfma_f32_16x16x32_bf16 v[112:115], v[208:211], a[108:111], v[112:115]
 v_mfma_f32_16x16x32_bf16 v[20:23], v[216:219], a[96:99], v[20:23]
 s_add_u32 s65, s77, s60
 ds_read_b64_tr_b16 v[208:209], v195 offset:17152
 ds_read_b128 a[148:151], v152 offset:34816
 v_mfma_f32_16x16x32_bf16 v[20:23], v[220:223], a[112:115], v[20:23]
 s_add_u32 s75, s75, 524288
 ds_read_b64_tr_b16 v[210:211], v195 offset:18176
 ds_read_b64_tr_b16 v[212:213], v195 offset:25344
 v_mfma_f32_16x16x32_bf16 v[52:55], v[220:223], a[116:119], v[52:55]
 s_bitset0_b32 s75, 22
 v_mfma_f32_16x16x32_bf16 v[52:55], v[216:219], a[100:103], v[52:55]
 s_and_b32 s72, s2, 1
 ds_read_b128 a[136:139], v151 offset:36864
 ds_read_b64_tr_b16 v[214:215], v195 offset:26368
 v_mfma_f32_16x16x32_bf16 v[84:87], v[216:219], a[104:107], v[84:87]
 s_lshl_b32 s72, s72, 7
 v_mfma_f32_16x16x32_bf16 v[84:87], v[220:223], a[120:123], v[84:87]
 buffer_atomic_add v249, v248, s[48:51], s72 offen sc1
 v_mfma_f32_16x16x32_bf16 v[116:119], v[220:223], a[124:127], v[116:119]
 s_waitcnt lgkmcnt(6)
 v_mfma_f32_16x16x32_bf16 v[116:119], v[216:219], a[108:111], v[116:119]
 s_waitcnt vmcnt(13)
 ds_read_b128 a[152:155], v152 offset:36864
 v_mfma_f32_16x16x32_bf16 v[24:27], v[200:203], a[96:99], v[24:27]
 s_barrier
 ds_read_b64_tr_b16 v[216:217], v192 offset:0
 ds_read_b64_tr_b16 v[218:219], v192 offset:1024
 v_mfma_f32_16x16x32_bf16 v[24:27], v[204:207], a[112:115], v[24:27]
 s_lshl_b32 s77, s77, 14
 v_mfma_f32_16x16x32_bf16 v[56:59], v[204:207], a[116:119], v[56:59]
 s_add_u32 m0, s76, 32768
 ds_read_b128 a[140:143], v151 offset:38912
 ds_read_b64_tr_b16 v[220:221], v192 offset:8192
 v_mfma_f32_16x16x32_bf16 v[56:59], v[200:203], a[100:103], v[56:59]
 buffer_load_dwordx4 v128, s[8:11], s74 offen offset:0 lds
 v_mfma_f32_16x16x32_bf16 v[88:91], v[200:203], a[104:107], v[88:91]
 s_lshl_b32 s78, s78, 14
 v_mfma_f32_16x16x32_bf16 v[88:91], v[204:207], a[120:123], v[88:91]
 s_add_u32 s81, s80, s77
 ds_read_b64_tr_b16 v[222:223], v192 offset:9216
 ds_read_b128 a[156:159], v152 offset:38912
 v_mfma_f32_16x16x32_bf16 v[120:123], v[204:207], a[124:127], v[120:123]
 buffer_load_dwordx4 v129, s[8:11], s74 offen offset:1024 lds
 v_mfma_f32_16x16x32_bf16 v[120:123], v[200:203], a[108:111], v[120:123]
 s_waitcnt lgkmcnt(7)
 v_mfma_f32_16x16x32_bf16 v[28:31], v[208:211], a[96:99], v[28:31]
 ds_read_b64_tr_b16 v[200:201], v193 offset:0
 ds_read_b64_tr_b16 v[202:203], v193 offset:1024
 v_mfma_f32_16x16x32_bf16 v[28:31], v[212:215], a[112:115], v[28:31]
 s_add_u32 s80, s80, s78
 v_mfma_f32_16x16x32_bf16 v[60:63], v[212:215], a[116:119], v[60:63]
 v_mfma_f32_16x16x32_bf16 v[60:63], v[208:211], a[100:103], v[60:63]
 buffer_load_dwordx4 v130, s[8:11], s74 offen offset:2048 lds
 v_mfma_f32_16x16x32_bf16 v[92:95], v[208:211], a[104:107], v[92:95]
 ds_read_b64_tr_b16 v[204:205], v193 offset:8192
 ds_read_b64_tr_b16 v[206:207], v193 offset:9216
 v_mfma_f32_16x16x32_bf16 v[92:95], v[212:215], a[120:123], v[92:95]
 v_mfma_f32_16x16x32_bf16 v[124:127], v[212:215], a[124:127], v[124:127]
 s_waitcnt lgkmcnt(4)
 v_mfma_f32_16x16x32_bf16 v[124:127], v[208:211], a[108:111], v[124:127]
 v_mfma_f32_16x16x32_bf16 v[0:3], v[216:219], a[128:131], v[0:3]
 s_sub_u32 s32, s32, 4096
 s_subb_u32 s33, s33, 0
 ds_read_b64_tr_b16 v[208:209], v192 offset:256
 ds_read_b64_tr_b16 v[210:211], v192 offset:1280
 v_mfma_f32_16x16x32_bf16 v[0:3], v[220:223], a[144:147], v[0:3]
 buffer_load_dwordx4 v131, s[8:11], s74 offen offset:3072 lds
 v_mfma_f32_16x16x32_bf16 v[32:35], v[220:223], a[148:151], v[32:35]
 s_mov_b32 s34, 8392704
 v_mfma_f32_16x16x32_bf16 v[32:35], v[216:219], a[132:135], v[32:35]
 ds_read_b64_tr_b16 v[212:213], v192 offset:8448
 ds_read_b64_tr_b16 v[214:215], v192 offset:9472
 v_mfma_f32_16x16x32_bf16 v[64:67], v[216:219], a[136:139], v[64:67]
 s_add_u32 m0, s76, 36864
 v_mfma_f32_16x16x32_bf16 v[64:67], v[220:223], a[152:155], v[64:67]
 buffer_load_dwordx4 v132, s[8:11], s74 offen offset:0 lds
 v_mfma_f32_16x16x32_bf16 v[96:99], v[220:223], a[156:159], v[96:99]
 s_waitcnt lgkmcnt(4)
 v_mfma_f32_16x16x32_bf16 v[96:99], v[216:219], a[140:143], v[96:99]
 s_mov_b32 s77, s62
 v_mfma_f32_16x16x32_bf16 v[4:7], v[200:203], a[128:131], v[4:7]
 s_lshl_b32 s71, s77, 19
 ds_read_b64_tr_b16 v[216:217], v193 offset:256
 ds_read_b64_tr_b16 v[218:219], v193 offset:1280
 v_mfma_f32_16x16x32_bf16 v[4:7], v[204:207], a[144:147], v[4:7]
 v_mfma_f32_16x16x32_bf16 v[36:39], v[204:207], a[148:151], v[36:39]
 buffer_load_dwordx4 v133, s[8:11], s74 offen offset:1024 lds
 v_mfma_f32_16x16x32_bf16 v[36:39], v[200:203], a[132:135], v[36:39]
 s_lshl_b32 s77, s60, 16
 ds_read_b64_tr_b16 v[220:221], v193 offset:8448
 ds_read_b64_tr_b16 v[222:223], v193 offset:9472
 v_mfma_f32_16x16x32_bf16 v[68:71], v[200:203], a[136:139], v[68:71]
 v_mfma_f32_16x16x32_bf16 v[68:71], v[204:207], a[152:155], v[68:71]
 v_mfma_f32_16x16x32_bf16 v[100:103], v[204:207], a[156:159], v[100:103]
 s_waitcnt lgkmcnt(4)
 v_mfma_f32_16x16x32_bf16 v[100:103], v[200:203], a[140:143], v[100:103]
 buffer_load_dwordx4 v134, s[8:11], s74 offen offset:2048 lds
 v_mfma_f32_16x16x32_bf16 v[8:11], v[208:211], a[128:131], v[8:11]
 s_add_u32 s71, s71, s77
 ds_read_b64_tr_b16 v[200:201], v192 offset:512
 ds_read_b64_tr_b16 v[202:203], v192 offset:1536
 v_mfma_f32_16x16x32_bf16 v[8:11], v[212:215], a[144:147], v[8:11]
 v_mfma_f32_16x16x32_bf16 v[40:43], v[212:215], a[148:151], v[40:43]
 s_bfe_u32 s77, s2, 0x10003
 v_mfma_f32_16x16x32_bf16 v[40:43], v[208:211], a[132:135], v[40:43]
 ds_read_b64_tr_b16 v[204:205], v192 offset:8704
 ds_read_b64_tr_b16 v[206:207], v192 offset:9728
 v_mfma_f32_16x16x32_bf16 v[72:75], v[208:211], a[136:139], v[72:75]
 v_mfma_f32_16x16x32_bf16 v[72:75], v[212:215], a[152:155], v[72:75]
 buffer_load_dwordx4 v135, s[8:11], s74 offen offset:3072 lds
 v_mfma_f32_16x16x32_bf16 v[104:107], v[212:215], a[156:159], v[104:107]
 s_waitcnt lgkmcnt(4)
 v_mfma_f32_16x16x32_bf16 v[104:107], v[208:211], a[140:143], v[104:107]
 s_lshl_b32 s77, s77, 18
 v_mfma_f32_16x16x32_bf16 v[12:15], v[216:219], a[128:131], v[12:15]
 s_add_u32 s71, s71, s77
 ds_read_b64_tr_b16 v[208:209], v193 offset:512
 ds_read_b64_tr_b16 v[210:211], v193 offset:1536
 v_mfma_f32_16x16x32_bf16 v[12:15], v[220:223], a[144:147], v[12:15]
 s_add_u32 s74, s74, 128
 v_mfma_f32_16x16x32_bf16 v[44:47], v[220:223], a[148:151], v[44:47]
 s_bitset0_b32 s74, 10
 v_mfma_f32_16x16x32_bf16 v[44:47], v[216:219], a[132:135], v[44:47]
 s_add_u32 m0, s73, 98304
 ds_read_b64_tr_b16 v[212:213], v193 offset:8704
 ds_read_b64_tr_b16 v[214:215], v193 offset:9728
 v_mfma_f32_16x16x32_bf16 v[76:79], v[216:219], a[136:139], v[76:79]
 buffer_load_dwordx4 v224, s[16:19], s75 offen offset:0 lds
 v_mfma_f32_16x16x32_bf16 v[76:79], v[220:223], a[152:155], v[76:79]
 s_add_u32 s71, s71, 83886080
 v_mfma_f32_16x16x32_bf16 v[108:111], v[220:223], a[156:159], v[108:111]
 s_waitcnt vmcnt(14)
 ds_read_b128 a[160:163], v153 offset:0
 v_mfma_f32_16x16x32_bf16 v[108:111], v[216:219], a[140:143], v[108:111]
 s_waitcnt lgkmcnt(5)
 v_mfma_f32_16x16x32_bf16 v[16:19], v[200:203], a[128:131], v[16:19]
 buffer_load_dwordx4 v225, s[16:19], s75 offen offset:1024 lds
 v_mfma_f32_16x16x32_bf16 v[16:19], v[204:207], a[144:147], v[16:19]
 s_sub_u32 s70, s2, 32
 ds_read_b64_tr_b16 v[216:217], v192 offset:768
 ds_read_b128 a[176:179], v154 offset:0
 v_mfma_f32_16x16x32_bf16 v[48:51], v[204:207], a[148:151], v[48:51]
 ds_read_b64_tr_b16 v[218:219], v192 offset:1792
 ds_read_b64_tr_b16 v[220:221], v192 offset:8960
 v_mfma_f32_16x16x32_bf16 v[48:51], v[200:203], a[132:135], v[48:51]
 s_cmp_ge_u32 s70, 184
 s_cbranch_scc1 Lrout3
 s_cmp_ge_u32 s70, 128
 s_cbranch_scc1 Lrin2
 s_mov_b32 s68, 1024
 s_mov_b32 s69, 0
 s_mov_b32 s43, 11
 s_lshl_b32 s30, s70, 15
 s_lshl_b32 s77, s60, 8
 s_add_u32 s30, s30, s77
 s_lshl_b32 s31, s70, 12
 s_lshl_b32 s77, s60, 20
 s_add_u32 s31, s31, s77
 s_add_u32 s31, s31, 83886080
 s_mov_b32 s42, 524288
 s_branch Lrt4
Lrin2:
 s_mov_b32 s24, s28
 s_mov_b32 s25, s29
 s_mov_b32 s26, 1835008
 s_mov_b32 s68, 3584
 s_mov_b32 s69, 0
 s_mov_b32 s43, 10
 s_sub_u32 s77, s70, 128
 s_lshl_b32 s77, s77, 2
 s_add_u32 s77, s77, s60
 s_mul_i32 s78, s77, 4682
 s_lshr_b32 s78, s78, 16
 s_mul_i32 s42, s78, 14
 s_sub_u32 s77, s77, s42
 s_mul_i32 s30, s78, 114688
 s_lshl_b32 s42, s77, 8
 s_add_u32 s30, s30, s42
 s_lshl_b32 s31, s77, 17
 s_lshl_b32 s78, s78, 12
 s_add_u32 s31, s31, s78
 s_add_u32 s31, s31, 88080384
 s_mov_b32 s42, 65536
 s_branch Lrt4
Lrout3:
 s_mov_b32 s24, s40
 s_mov_b32 s25, s41
 s_mov_b32 s26, 917504
 s_mov_b32 s68, 1024
 s_mov_b32 s43, 10
 s_sub_u32 s77, s70, 184
 s_lshl_b32 s31, s77, 12
 s_mul_i32 s78, s60, 229376
 s_add_u32 s31, s31, s78
 s_add_u32 s31, s31, 90177536
 s_mov_b32 s42, 114688
 s_mul_i32 s78, s77, 9363
 s_lshr_b32 s78, s78, 16
 s_mul_i32 s30, s78, 7
 s_sub_u32 s77, s77, s30
 s_mul_i32 s78, s78, 224
 s_lshl_b32 s30, s77, 5
 s_cmp_ge_u32 s77, 3
 s_cselect_b32 s69, 16, 0
 s_add_u32 s30, s30, s69
 s_cmp_eq_u32 s77, 6
 s_cselect_b32 s30, 96, s30
 s_cselect_b32 s69, 98304, 0
 s_add_u32 s30, s30, s78
 s_lshl_b32 s30, s30, 10
 s_lshl_b32 s77, s60, 8
 s_add_u32 s30, s30, s77
 s_cmp_ge_u32 s70, 212
 s_cselect_b32 s30, 0x10000000, s30
 s_cselect_b32 s31, 0x10000000, s31
Lrt4:
 v_mfma_f32_16x16x32_bf16 v[80:83], v[200:203], a[136:139], v[80:83]
 buffer_load_dwordx4 v226, s[16:19], s75 offen offset:2048 lds
 v_mfma_f32_16x16x32_bf16 v[80:83], v[204:207], a[152:155], v[80:83]
 ds_read_b128 a[164:167], v153 offset:2048
 ds_read_b64_tr_b16 v[222:223], v192 offset:9984
 v_mfma_f32_16x16x32_bf16 v[112:115], v[204:207], a[156:159], v[112:115]
 s_waitcnt lgkmcnt(7)
 v_mfma_f32_16x16x32_bf16 v[112:115], v[200:203], a[140:143], v[112:115]
 s_add_u32 s42, s31, s42
 v_mfma_f32_16x16x32_bf16 v[20:23], v[208:211], a[128:131], v[20:23]
 ds_read_b64_tr_b16 v[200:201], v193 offset:768
 ds_read_b128 a[180:183], v154 offset:2048
 v_mfma_f32_16x16x32_bf16 v[20:23], v[212:215], a[144:147], v[20:23]
 buffer_load_dwordx4 v227, s[16:19], s75 offen offset:3072 lds
 v_mfma_f32_16x16x32_bf16 v[52:55], v[212:215], a[148:151], v[52:55]
 ds_read_b64_tr_b16 v[202:203], v193 offset:1792
 v_lshrrev_b32 v196, 5, v253
 v_mfma_f32_16x16x32_bf16 v[52:55], v[208:211], a[132:135], v[52:55]
 ds_read_b64_tr_b16 v[204:205], v193 offset:8960
 ds_read_b128 a[168:171], v153 offset:4096
 v_mfma_f32_16x16x32_bf16 v[84:87], v[208:211], a[136:139], v[84:87]
 v_mfma_f32_16x16x32_bf16 v[84:87], v[212:215], a[152:155], v[84:87]
 s_add_u32 s75, s75, 524288
 ds_read_b64_tr_b16 v[206:207], v193 offset:9984
 v_lshlrev_b32 v232, s43, v196
 v_mfma_f32_16x16x32_bf16 v[116:119], v[212:215], a[156:159], v[116:119]
 s_bitset0_b32 s75, 22
 v_mfma_f32_16x16x32_bf16 v[116:119], v[208:211], a[140:143], v[116:119]
 s_waitcnt vmcnt(13)
 s_waitcnt lgkmcnt(6)
 ds_read_b128 a[184:187], v154 offset:4096
 v_mfma_f32_16x16x32_bf16 v[24:27], v[216:219], a[128:131], v[24:27]
 s_barrier
 ds_read_b64_tr_b16 v[208:209], v192 offset:16384
 ds_read_b64_tr_b16 v[210:211], v192 offset:17408
 v_mfma_f32_16x16x32_bf16 v[24:27], v[220:223], a[144:147], v[24:27]
 s_add_u32 m0, s76, 65536
 v_mfma_f32_16x16x32_bf16 v[56:59], v[220:223], a[148:151], v[56:59]
 buffer_load_dwordx4 v128, s[8:11], s74 offen offset:0 lds
 v_mfma_f32_16x16x32_bf16 v[56:59], v[216:219], a[132:135], v[56:59]
 ds_read_b128 a[172:175], v153 offset:6144
 v_lshlrev_b32 v197, 1, v196
 v_mfma_f32_16x16x32_bf16 v[88:91], v[216:219], a[136:139], v[88:91]
 ds_read_b64_tr_b16 v[212:213], v192 offset:24576
 v_xor_b32 v197, v197, v253
 v_mfma_f32_16x16x32_bf16 v[88:91], v[220:223], a[152:155], v[88:91]
 ds_read_b64_tr_b16 v[214:215], v192 offset:25600
 ds_read_b128 a[188:191], v154 offset:6144
 v_mfma_f32_16x16x32_bf16 v[120:123], v[220:223], a[156:159], v[120:123]
 buffer_load_dwordx4 v129, s[8:11], s74 offen offset:1024 lds
 v_mfma_f32_16x16x32_bf16 v[120:123], v[216:219], a[140:143], v[120:123]
 s_waitcnt lgkmcnt(7)
 v_mfma_f32_16x16x32_bf16 v[28:31], v[200:203], a[128:131], v[28:31]
 ds_read_b64_tr_b16 v[216:217], v193 offset:16384
 v_and_b32 v197, 3, v197
 v_mfma_f32_16x16x32_bf16 v[28:31], v[204:207], a[144:147], v[28:31]
 ds_read_b64_tr_b16 v[218:219], v193 offset:17408
 ds_read_b64_tr_b16 v[220:221], v193 offset:24576
 v_mfma_f32_16x16x32_bf16 v[60:63], v[204:207], a[148:151], v[60:63]
 v_mfma_f32_16x16x32_bf16 v[60:63], v[200:203], a[132:135], v[60:63]
 buffer_load_dwordx4 v130, s[8:11], s74 offen offset:2048 lds
 v_mfma_f32_16x16x32_bf16 v[92:95], v[200:203], a[136:139], v[92:95]
 ds_read_b64_tr_b16 v[222:223], v193 offset:25600
 v_lshlrev_b32 v231, 4, v197
 v_mfma_f32_16x16x32_bf16 v[92:95], v[204:207], a[152:155], v[92:95]
 v_mfma_f32_16x16x32_bf16 v[124:127], v[204:207], a[156:159], v[124:127]
 s_waitcnt lgkmcnt(4)
 v_mfma_f32_16x16x32_bf16 v[124:127], v[200:203], a[140:143], v[124:127]
 v_bfe_u32 v197, v253, 4, 1
 v_mfma_f32_16x16x32_bf16 v[0:3], v[208:211], a[160:163], v[0:3]
 ds_read_b64_tr_b16 v[200:201], v192 offset:16640
 ds_read_b64_tr_b16 v[202:203], v192 offset:17664
 v_mfma_f32_16x16x32_bf16 v[0:3], v[212:215], a[176:179], v[0:3]
 buffer_load_dwordx4 v131, s[8:11], s74 offen offset:3072 lds
 v_mfma_f32_16x16x32_bf16 v[32:35], v[212:215], a[180:183], v[32:35]
 v_mfma_f32_16x16x32_bf16 v[32:35], v[208:211], a[164:167], v[32:35]
 ds_read_b64_tr_b16 v[204:205], v192 offset:24832
 v_lshl_add_u32 v231, v197, 6, v231
 v_mfma_f32_16x16x32_bf16 v[64:67], v[208:211], a[168:171], v[64:67]
 s_add_u32 m0, s76, 69632
 v_mfma_f32_16x16x32_bf16 v[64:67], v[212:215], a[184:187], v[64:67]
 buffer_load_dwordx4 v132, s[8:11], s74 offen offset:0 lds
 v_mfma_f32_16x16x32_bf16 v[96:99], v[212:215], a[188:191], v[96:99]
 s_waitcnt lgkmcnt(3)
 ds_read_b64_tr_b16 v[206:207], v192 offset:25856
 v_mul_u32_u24 v197, 544, v197
 v_mfma_f32_16x16x32_bf16 v[96:99], v[208:211], a[172:175], v[96:99]
 v_mfma_f32_16x16x32_bf16 v[4:7], v[216:219], a[160:163], v[4:7]
 ds_read_b64_tr_b16 v[208:209], v193 offset:16640
 ds_read_b64_tr_b16 v[210:211], v193 offset:17664
 v_mfma_f32_16x16x32_bf16 v[4:7], v[220:223], a[176:179], v[4:7]
 v_mfma_f32_16x16x32_bf16 v[36:39], v[220:223], a[180:183], v[36:39]
 ds_read_b64_tr_b16 v[212:213], v193 offset:24832
 v_add_u32 v232, v232, v197
 v_mfma_f32_16x16x32_bf16 v[36:39], v[216:219], a[164:167], v[36:39]
 buffer_load_dwordx4 v133, s[8:11], s74 offen offset:1024 lds
 v_mfma_f32_16x16x32_bf16 v[68:71], v[216:219], a[168:171], v[68:71]
 v_mfma_f32_16x16x32_bf16 v[68:71], v[220:223], a[184:187], v[68:71]
 ds_read_b64_tr_b16 v[214:215], v193 offset:25856
 v_bfe_u32 v197, v253, 2, 2
 v_mfma_f32_16x16x32_bf16 v[100:103], v[220:223], a[188:191], v[100:103]
 s_waitcnt lgkmcnt(4)
 v_mfma_f32_16x16x32_bf16 v[100:103], v[216:219], a[172:175], v[100:103]
 buffer_load_dwordx4 v134, s[8:11], s74 offen offset:2048 lds
 v_mfma_f32_16x16x32_bf16 v[8:11], v[200:203], a[160:163], v[8:11]
 ds_read_b64_tr_b16 v[216:217], v192 offset:16896
 v_lshl_add_u32 v232, v197, 6, v232
 v_mfma_f32_16x16x32_bf16 v[8:11], v[204:207], a[176:179], v[8:11]
 ds_read_b64_tr_b16 v[218:219], v192 offset:17920
 ds_read_b64_tr_b16 v[220:221], v192 offset:25088
 v_mfma_f32_16x16x32_bf16 v[40:43], v[204:207], a[180:183], v[40:43]
 v_mfma_f32_16x16x32_bf16 v[40:43], v[200:203], a[164:167], v[40:43]
 v_mfma_f32_16x16x32_bf16 v[72:75], v[200:203], a[168:171], v[72:75]
 ds_read_b64_tr_b16 v[222:223], v192 offset:26112
 v_lshl_add_u32 v196, v196, 2, v197
 v_mfma_f32_16x16x32_bf16 v[72:75], v[204:207], a[184:187], v[72:75]
 buffer_load_dwordx4 v135, s[8:11], s74 offen offset:3072 lds
 v_mfma_f32_16x16x32_bf16 v[104:107], v[204:207], a[188:191], v[104:107]
 s_waitcnt lgkmcnt(4)
 v_mfma_f32_16x16x32_bf16 v[104:107], v[200:203], a[172:175], v[104:107]
 v_mul_u32_u24 v196, s68, v196
 v_mfma_f32_16x16x32_bf16 v[12:15], v[208:211], a[160:163], v[12:15]
 ds_read_b64_tr_b16 v[200:201], v193 offset:16896
 ds_read_b64_tr_b16 v[202:203], v193 offset:17920
 v_mfma_f32_16x16x32_bf16 v[12:15], v[212:215], a[176:179], v[12:15]
 s_add_u32 s74, s74, 128
 v_mfma_f32_16x16x32_bf16 v[44:47], v[212:215], a[180:183], v[44:47]
 s_bitset0_b32 s74, 10
 ds_read_b64_tr_b16 v[204:205], v193 offset:25088
 v_add_u32 v231, v231, v196
 v_mfma_f32_16x16x32_bf16 v[44:47], v[208:211], a[164:167], v[44:47]
 s_add_u32 m0, s73, 114688
 v_mfma_f32_16x16x32_bf16 v[76:79], v[208:211], a[168:171], v[76:79]
 buffer_load_dwordx4 v224, s[16:19], s75 offen offset:0 lds
 v_mfma_f32_16x16x32_bf16 v[76:79], v[212:215], a[184:187], v[76:79]
 s_lshl_b32 s68, s68, 3
 ds_read_b64_tr_b16 v[206:207], v193 offset:26112
 v_mfma_f32_16x16x32_bf16 v[108:111], v[212:215], a[188:191], v[108:111]
 s_waitcnt vmcnt(13)
 ds_read_b128 a[192:195], v151 offset:0
 v_mfma_f32_16x16x32_bf16 v[108:111], v[208:211], a[172:175], v[108:111]
 s_waitcnt lgkmcnt(5)
 v_mfma_f32_16x16x32_bf16 v[16:19], v[216:219], a[160:163], v[16:19]
 buffer_load_dwordx4 v225, s[16:19], s75 offen offset:1024 lds
 v_mfma_f32_16x16x32_bf16 v[16:19], v[220:223], a[176:179], v[16:19]
 s_sub_u32 s68, s68, 1024
 ds_read_b64_tr_b16 v[208:209], v192 offset:17152
 ds_read_b128 a[208:211], v152 offset:0
 v_mfma_f32_16x16x32_bf16 v[48:51], v[220:223], a[180:183], v[48:51]
 ds_read_b64_tr_b16 v[210:211], v192 offset:18176
 ds_read_b64_tr_b16 v[212:213], v192 offset:25344
 v_mfma_f32_16x16x32_bf16 v[48:51], v[216:219], a[164:167], v[48:51]
 s_add_u32 s69, s68, s69
 v_mfma_f32_16x16x32_bf16 v[80:83], v[216:219], a[168:171], v[80:83]
 buffer_load_dwordx4 v226, s[16:19], s75 offen offset:2048 lds
 v_mfma_f32_16x16x32_bf16 v[80:83], v[220:223], a[184:187], v[80:83]
 ds_read_b128 a[196:199], v151 offset:2048
 ds_read_b64_tr_b16 v[214:215], v192 offset:26368
 v_mfma_f32_16x16x32_bf16 v[112:115], v[220:223], a[188:191], v[112:115]
 s_waitcnt lgkmcnt(7)
 v_mfma_f32_16x16x32_bf16 v[112:115], v[216:219], a[172:175], v[112:115]
 v_mfma_f32_16x16x32_bf16 v[20:23], v[200:203], a[160:163], v[20:23]
 ds_read_b64_tr_b16 v[216:217], v193 offset:17152
 v_and_b32 v196, 3, v253
 v_mfma_f32_16x16x32_bf16 v[20:23], v[204:207], a[176:179], v[20:23]
 ds_read_b128 a[212:215], v152 offset:2048
 ds_read_b64_tr_b16 v[218:219], v193 offset:18176
 v_mfma_f32_16x16x32_bf16 v[52:55], v[204:207], a[180:183], v[52:55]
 buffer_load_dwordx4 v227, s[16:19], s75 offen offset:3072 lds
 v_mfma_f32_16x16x32_bf16 v[52:55], v[200:203], a[164:167], v[52:55]
 ds_read_b64_tr_b16 v[220:221], v193 offset:25344
 v_lshl_add_u32 v232, v196, 3, v232
 v_mfma_f32_16x16x32_bf16 v[84:87], v[200:203], a[168:171], v[84:87]
 ds_read_b128 a[200:203], v151 offset:4096
 ds_read_b64_tr_b16 v[222:223], v193 offset:26368
 v_mfma_f32_16x16x32_bf16 v[84:87], v[204:207], a[184:187], v[84:87]
 s_add_u32 s75, s75, 524288
 v_mfma_f32_16x16x32_bf16 v[116:119], v[204:207], a[188:191], v[116:119]
 s_bitset0_b32 s75, 22
 v_mfma_f32_16x16x32_bf16 v[116:119], v[200:203], a[172:175], v[116:119]
 s_waitcnt vmcnt(12)
 s_waitcnt lgkmcnt(6)
 v_lshl_add_u32 v232, v252, 13, v232
 v_mfma_f32_16x16x32_bf16 v[24:27], v[208:211], a[160:163], v[24:27]
 s_barrier
 ds_read_b128 a[216:219], v152 offset:4096
 ds_read_b64_tr_b16 v[200:201], v194 offset:0
 v_mfma_f32_16x16x32_bf16 v[24:27], v[212:215], a[176:179], v[24:27]
 buffer_load_dword v239, v155, s[20:23], s86 offen
 v_mfma_f32_16x16x32_bf16 v[56:59], v[212:215], a[180:183], v[56:59]
 ds_read_b64_tr_b16 v[202:203], v194 offset:1024
 v_xor_b32 v233, 32, v232
 v_mfma_f32_16x16x32_bf16 v[56:59], v[208:211], a[164:167], v[56:59]
 s_sub_u32 s77, 21, s43
 ds_read_b128 a[204:207], v151 offset:6144
 ds_read_b64_tr_b16 v[204:205], v194 offset:8192
 v_mfma_f32_16x16x32_bf16 v[88:91], v[208:211], a[168:171], v[88:91]
 v_mfma_f32_16x16x32_bf16 v[88:91], v[212:215], a[184:187], v[88:91]
 ds_read_b64_tr_b16 v[206:207], v194 offset:9216
 ds_read_b128 a[220:223], v152 offset:6144
 v_mfma_f32_16x16x32_bf16 v[120:123], v[212:215], a[188:191], v[120:123]
 s_waitcnt lgkmcnt(7)
 v_mfma_f32_16x16x32_bf16 v[120:123], v[208:211], a[172:175], v[120:123]
 s_lshl_b32 s77, 1, s77
 v_mfma_f32_16x16x32_bf16 v[28:31], v[216:219], a[160:163], v[28:31]
 ds_read_b64_tr_b16 v[208:209], v195 offset:0
 ds_read_b64_tr_b16 v[210:211], v195 offset:1024
 v_mfma_f32_16x16x32_bf16 v[28:31], v[220:223], a[176:179], v[28:31]
 v_mfma_f32_16x16x32_bf16 v[60:63], v[220:223], a[180:183], v[60:63]
 v_mfma_f32_16x16x32_bf16 v[60:63], v[216:219], a[164:167], v[60:63]
 ds_read_b64_tr_b16 v[212:213], v195 offset:8192
 v_add_u32 v234, s77, v232
 v_mfma_f32_16x16x32_bf16 v[92:95], v[216:219], a[168:171], v[92:95]
 s_add_u32 m0, s73, 0
 v_mfma_f32_16x16x32_bf16 v[92:95], v[220:223], a[184:187], v[92:95]
 buffer_load_dwordx4 v224, s[20:23], s75 offen offset:0 lds
 v_mfma_f32_16x16x32_bf16 v[124:127], v[220:223], a[188:191], v[124:127]
 s_waitcnt lgkmcnt(3)
 ds_read_b64_tr_b16 v[214:215], v195 offset:9216
 v_add_u32 v235, s77, v233
 v_mfma_f32_16x16x32_bf16 v[124:127], v[216:219], a[172:175], v[124:127]
 v_mfma_f32_16x16x32_bf16 v[0:3], v[200:203], a[192:195], v[0:3]
 ds_read_b64_tr_b16 v[216:217], v194 offset:256
 ds_read_b64_tr_b16 v[218:219], v194 offset:1280
 v_mfma_f32_16x16x32_bf16 v[0:3], v[204:207], a[208:211], v[0:3]
 s_mov_b32 s43, 71316224
 v_mfma_f32_16x16x32_bf16 v[32:35], v[204:207], a[212:215], v[32:35]
 v_mfma_f32_16x16x32_bf16 v[32:35], v[200:203], a[196:199], v[32:35]
 ds_read_b64_tr_b16 v[220:221], v194 offset:8448
 ds_read_b64_tr_b16 v[222:223], v194 offset:9472
 v_mfma_f32_16x16x32_bf16 v[64:67], v[200:203], a[200:203], v[64:67]
 s_lshr_b32 s77, s2, 3
 v_mfma_f32_16x16x32_bf16 v[64:67], v[204:207], a[216:219], v[64:67]
 v_mfma_f32_16x16x32_bf16 v[96:99], v[204:207], a[220:223], v[96:99]
 s_waitcnt lgkmcnt(4)
 v_mfma_f32_16x16x32_bf16 v[96:99], v[200:203], a[204:207], v[96:99]
 v_mfma_f32_16x16x32_bf16 v[4:7], v[208:211], a[192:195], v[4:7]
 s_lshl_b32 s28, s77, 18
 ds_read_b64_tr_b16 v[200:201], v195 offset:256
 ds_read_b64_tr_b16 v[202:203], v195 offset:1280
 v_mfma_f32_16x16x32_bf16 v[4:7], v[212:215], a[208:211], v[4:7]
 buffer_load_dwordx4 v225, s[20:23], s75 offen offset:1024 lds
 v_mfma_f32_16x16x32_bf16 v[36:39], v[212:215], a[212:215], v[36:39]
 v_mfma_f32_16x16x32_bf16 v[36:39], v[208:211], a[196:199], v[36:39]
 s_and_b32 s77, s2, 7
 ds_read_b64_tr_b16 v[204:205], v195 offset:8448
 ds_read_b64_tr_b16 v[206:207], v195 offset:9472
 v_mfma_f32_16x16x32_bf16 v[68:71], v[208:211], a[200:203], v[68:71]
 v_mfma_f32_16x16x32_bf16 v[68:71], v[212:215], a[216:219], v[68:71]
 v_mfma_f32_16x16x32_bf16 v[100:103], v[212:215], a[220:223], v[100:103]
 s_waitcnt lgkmcnt(4)
 v_mfma_f32_16x16x32_bf16 v[100:103], v[208:211], a[204:207], v[100:103]
 s_lshl_b32 s77, s77, 2
 v_mfma_f32_16x16x32_bf16 v[8:11], v[216:219], a[192:195], v[8:11]
 ds_read_b64_tr_b16 v[208:209], v194 offset:512
 ds_read_b64_tr_b16 v[210:211], v194 offset:1536
 v_mfma_f32_16x16x32_bf16 v[8:11], v[220:223], a[208:211], v[8:11]
 v_mfma_f32_16x16x32_bf16 v[40:43], v[220:223], a[212:215], v[40:43]
 s_add_u32 s77, s77, s60
 v_mfma_f32_16x16x32_bf16 v[40:43], v[216:219], a[196:199], v[40:43]
 ds_read_b64_tr_b16 v[212:213], v194 offset:8704
 ds_read_b64_tr_b16 v[214:215], v194 offset:9728
 v_mfma_f32_16x16x32_bf16 v[72:75], v[216:219], a[200:203], v[72:75]
 v_mfma_f32_16x16x32_bf16 v[72:75], v[220:223], a[216:219], v[72:75]
 s_lshl_b32 s77, s77, 7
 v_mfma_f32_16x16x32_bf16 v[104:107], v[220:223], a[220:223], v[104:107]
 buffer_load_dwordx4 v226, s[20:23], s75 offen offset:2048 lds
 v_mfma_f32_16x16x32_bf16 v[104:107], v[216:219], a[204:207], v[104:107]
 s_waitcnt lgkmcnt(4)
 v_mfma_f32_16x16x32_bf16 v[12:15], v[200:203], a[192:195], v[12:15]
 s_add_u32 s28, s28, s77
 ds_read_b64_tr_b16 v[216:217], v195 offset:512
 ds_read_b64_tr_b16 v[218:219], v195 offset:1536
 v_mfma_f32_16x16x32_bf16 v[12:15], v[204:207], a[208:211], v[12:15]
 v_mfma_f32_16x16x32_bf16 v[44:47], v[204:207], a[212:215], v[44:47]
 v_mfma_f32_16x16x32_bf16 v[44:47], v[200:203], a[196:199], v[44:47]
 ds_read_b64_tr_b16 v[220:221], v195 offset:8704
 ds_read_b64_tr_b16 v[222:223], v195 offset:9728
 v_mfma_f32_16x16x32_bf16 v[76:79], v[200:203], a[200:203], v[76:79]
 s_lshl_b32 s29, s2, 2
 v_mfma_f32_16x16x32_bf16 v[76:79], v[204:207], a[216:219], v[76:79]
 v_mfma_f32_16x16x32_bf16 v[108:111], v[204:207], a[220:223], v[108:111]
 s_waitcnt vmcnt(8)
 ds_read_b128 a[224:227], v151 offset:32768
 v_mfma_f32_16x16x32_bf16 v[108:111], v[200:203], a[204:207], v[108:111]
 s_waitcnt lgkmcnt(5)
 v_mfma_f32_16x16x32_bf16 v[16:19], v[208:211], a[192:195], v[16:19]
 s_add_u32 s29, s29, s60
 ds_read_b64_tr_b16 v[200:201], v194 offset:768
 ds_read_b128 a[240:243], v152 offset:32768
 v_mfma_f32_16x16x32_bf16 v[16:19], v[212:215], a[208:211], v[16:19]
 ds_read_b64_tr_b16 v[202:203], v194 offset:1792
 ds_read_b64_tr_b16 v[204:205], v194 offset:8960
 v_mfma_f32_16x16x32_bf16 v[48:51], v[212:215], a[212:215], v[48:51]
 buffer_load_dwordx4 v227, s[20:23], s75 offen offset:3072 lds
 v_mfma_f32_16x16x32_bf16 v[48:51], v[208:211], a[196:199], v[48:51]
 s_lshl_b32 s29, s29, 13
 v_mfma_f32_16x16x32_bf16 v[80:83], v[208:211], a[200:203], v[80:83]
 ds_read_b128 a[228:231], v151 offset:34816
 ds_read_b64_tr_b16 v[206:207], v194 offset:9984
 v_mfma_f32_16x16x32_bf16 v[80:83], v[212:215], a[216:219], v[80:83]
 v_mfma_f32_16x16x32_bf16 v[112:115], v[212:215], a[220:223], v[112:115]
 s_waitcnt lgkmcnt(7)
 v_mfma_f32_16x16x32_bf16 v[112:115], v[208:211], a[204:207], v[112:115]
 s_add_u32 s29, s29, 92274688
 v_mfma_f32_16x16x32_bf16 v[20:23], v[216:219], a[192:195], v[20:23]
 ds_read_b64_tr_b16 v[208:209], v195 offset:768
 ds_read_b128 a[244:247], v152 offset:34816
 v_mfma_f32_16x16x32_bf16 v[20:23], v[220:223], a[208:211], v[20:23]
 s_add_u32 s40, s29, 4096
 ds_read_b64_tr_b16 v[210:211], v195 offset:1792
 ds_read_b64_tr_b16 v[212:213], v195 offset:8960
 v_mfma_f32_16x16x32_bf16 v[52:55], v[220:223], a[212:215], v[52:55]
 v_mfma_f32_16x16x32_bf16 v[52:55], v[216:219], a[196:199], v[52:55]
 ds_read_b128 a[232:235], v151 offset:36864
 ds_read_b64_tr_b16 v[214:215], v195 offset:9984
 v_mfma_f32_16x16x32_bf16 v[84:87], v[216:219], a[200:203], v[84:87]
 v_mfma_f32_16x16x32_bf16 v[84:87], v[220:223], a[216:219], v[84:87]
 s_add_u32 s75, s75, 524288
 v_mfma_f32_16x16x32_bf16 v[116:119], v[220:223], a[220:223], v[116:119]
 s_bitset0_b32 s75, 22
 v_mfma_f32_16x16x32_bf16 v[116:119], v[216:219], a[204:207], v[116:119]
 s_waitcnt vmcnt(5)
 s_waitcnt lgkmcnt(6)
 v_lshrrev_b32 v197, 4, v253
 v_mfma_f32_16x16x32_bf16 v[24:27], v[200:203], a[192:195], v[24:27]
 s_barrier
 ds_read_b128 a[248:251], v152 offset:36864
 ds_read_b64_tr_b16 v[216:217], v194 offset:16384
 v_mfma_f32_16x16x32_bf16 v[24:27], v[204:207], a[208:211], v[24:27]
 buffer_load_dword v239, v155, s[12:15], s86 offen
 v_mfma_f32_16x16x32_bf16 v[56:59], v[204:207], a[212:215], v[56:59]
 ds_read_b64_tr_b16 v[218:219], v194 offset:17408
 v_xor_b32 v197, v197, v253
 v_mfma_f32_16x16x32_bf16 v[56:59], v[200:203], a[196:199], v[56:59]
 ds_read_b128 a[236:239], v151 offset:38912
 ds_read_b64_tr_b16 v[220:221], v194 offset:24576
 v_mfma_f32_16x16x32_bf16 v[88:91], v[200:203], a[200:203], v[88:91]
 v_mfma_f32_16x16x32_bf16 v[88:91], v[204:207], a[216:219], v[88:91]
 ds_read_b64_tr_b16 v[222:223], v194 offset:25600
 v_and_b32 v197, 7, v197
 v_mfma_f32_16x16x32_bf16 v[120:123], v[204:207], a[220:223], v[120:123]
 s_waitcnt lgkmcnt(6)
 ds_read_b128 a[252:255], v152 offset:38912
 v_mfma_f32_16x16x32_bf16 v[120:123], v[200:203], a[204:207], v[120:123]
 v_mfma_f32_16x16x32_bf16 v[28:31], v[208:211], a[192:195], v[28:31]
 ds_read_b64_tr_b16 v[200:201], v195 offset:16384
 v_lshlrev_b32 v197, 4, v197
 v_mfma_f32_16x16x32_bf16 v[28:31], v[212:215], a[208:211], v[28:31]
 ds_read_b64_tr_b16 v[202:203], v195 offset:17408
 ds_read_b64_tr_b16 v[204:205], v195 offset:24576
 v_mfma_f32_16x16x32_bf16 v[60:63], v[212:215], a[212:215], v[60:63]
 v_mfma_f32_16x16x32_bf16 v[60:63], v[208:211], a[196:199], v[60:63]
 v_mfma_f32_16x16x32_bf16 v[92:95], v[208:211], a[200:203], v[92:95]
 s_add_u32 m0, s73, 16384
 ds_read_b64_tr_b16 v[206:207], v195 offset:25600
 v_bfe_u32 v196, v253, 3, 2
 v_mfma_f32_16x16x32_bf16 v[92:95], v[212:215], a[216:219], v[92:95]
 buffer_load_dwordx4 v224, s[20:23], s75 offen offset:0 lds
 v_mfma_f32_16x16x32_bf16 v[124:127], v[212:215], a[220:223], v[124:127]
 s_waitcnt lgkmcnt(4)
 v_mfma_f32_16x16x32_bf16 v[124:127], v[208:211], a[204:207], v[124:127]
 v_lshl_add_u32 v197, v196, 12, v197
 v_mfma_f32_16x16x32_bf16 v[0:3], v[216:219], a[224:227], v[0:3]
 ds_read_b64_tr_b16 v[208:209], v194 offset:16640
 ds_read_b64_tr_b16 v[210:211], v194 offset:17664
 v_mfma_f32_16x16x32_bf16 v[0:3], v[220:223], a[240:243], v[0:3]
 v_mfma_f32_16x16x32_bf16 v[32:35], v[220:223], a[244:247], v[32:35]
 v_mfma_f32_16x16x32_bf16 v[32:35], v[216:219], a[228:231], v[32:35]
 ds_read_b64_tr_b16 v[212:213], v194 offset:24832
 v_lshrrev_b32 v196, 5, v253
 v_mfma_f32_16x16x32_bf16 v[64:67], v[216:219], a[232:235], v[64:67]
 v_mfma_f32_16x16x32_bf16 v[64:67], v[220:223], a[248:251], v[64:67]
 ds_read_b64_tr_b16 v[214:215], v194 offset:25856
 v_lshl_add_u32 v197, v196, 15, v197
 v_mfma_f32_16x16x32_bf16 v[96:99], v[220:223], a[252:255], v[96:99]
 s_waitcnt lgkmcnt(4)
 v_mfma_f32_16x16x32_bf16 v[96:99], v[216:219], a[236:239], v[96:99]
 v_mfma_f32_16x16x32_bf16 v[4:7], v[200:203], a[224:227], v[4:7]
 ds_read_b64_tr_b16 v[216:217], v195 offset:16640
 ds_read_b64_tr_b16 v[218:219], v195 offset:17664
 v_mfma_f32_16x16x32_bf16 v[4:7], v[204:207], a[240:243], v[4:7]
 buffer_load_dwordx4 v225, s[20:23], s75 offen offset:1024 lds
 v_mfma_f32_16x16x32_bf16 v[36:39], v[204:207], a[244:247], v[36:39]
 ds_read_b64_tr_b16 v[220:221], v195 offset:24832
 v_xor_b32 v196, 64, v197
 v_mfma_f32_16x16x32_bf16 v[36:39], v[200:203], a[228:231], v[36:39]
 s_bfe_u32 s77, s2, 0x20001
 v_mfma_f32_16x16x32_bf16 v[68:71], v[200:203], a[232:235], v[68:71]
 v_mfma_f32_16x16x32_bf16 v[68:71], v[204:207], a[248:251], v[68:71]
 ds_read_b64_tr_b16 v[222:223], v195 offset:25856
 v_mfma_f32_16x16x32_bf16 v[100:103], v[204:207], a[252:255], v[100:103]
 s_waitcnt lgkmcnt(4)
 v_mfma_f32_16x16x32_bf16 v[100:103], v[200:203], a[236:239], v[100:103]
 s_add_u32 s77, s77, 0
 v_mfma_f32_16x16x32_bf16 v[8:11], v[208:211], a[224:227], v[8:11]
 ds_read_b64_tr_b16 v[200:201], v194 offset:16896
 ds_read_b64_tr_b16 v[202:203], v194 offset:17920
 v_mfma_f32_16x16x32_bf16 v[8:11], v[212:215], a[240:243], v[8:11]
 v_mfma_f32_16x16x32_bf16 v[40:43], v[212:215], a[244:247], v[40:43]
 s_and_b32 s78, s77, 1
 v_mfma_f32_16x16x32_bf16 v[40:43], v[208:211], a[228:231], v[40:43]
 ds_read_b64_tr_b16 v[204:205], v194 offset:25088
 ds_read_b64_tr_b16 v[206:207], v194 offset:26112
 v_mfma_f32_16x16x32_bf16 v[72:75], v[208:211], a[232:235], v[72:75]
 v_mfma_f32_16x16x32_bf16 v[72:75], v[212:215], a[248:251], v[72:75]
 s_lshl_b32 s78, s78, 14
 v_mfma_f32_16x16x32_bf16 v[104:107], v[212:215], a[252:255], v[104:107]
 buffer_load_dwordx4 v226, s[20:23], s75 offen offset:2048 lds
 v_mfma_f32_16x16x32_bf16 v[104:107], v[208:211], a[236:239], v[104:107]
 s_waitcnt lgkmcnt(4)
 v_mfma_f32_16x16x32_bf16 v[12:15], v[216:219], a[224:227], v[12:15]
 s_bfe_u32 s77, s77, 0x10001
 ds_read_b64_tr_b16 v[208:209], v195 offset:16896
 ds_read_b64_tr_b16 v[210:211], v195 offset:17920
 v_mfma_f32_16x16x32_bf16 v[12:15], v[220:223], a[240:243], v[12:15]
 v_mfma_f32_16x16x32_bf16 v[44:47], v[220:223], a[244:247], v[44:47]
 v_mfma_f32_16x16x32_bf16 v[44:47], v[216:219], a[228:231], v[44:47]
 ds_read_b64_tr_b16 v[212:213], v195 offset:25088
 ds_read_b64_tr_b16 v[214:215], v195 offset:26112
 v_mfma_f32_16x16x32_bf16 v[76:79], v[216:219], a[232:235], v[76:79]
 s_lshl_b32 s77, s77, 17
 v_mfma_f32_16x16x32_bf16 v[76:79], v[220:223], a[248:251], v[76:79]
 v_mfma_f32_16x16x32_bf16 v[108:111], v[220:223], a[252:255], v[108:111]
 s_waitcnt lgkmcnt(4)
 v_mfma_f32_16x16x32_bf16 v[108:111], v[216:219], a[236:239], v[108:111]
 s_add_u32 s77, s77, s78
 v_mfma_f32_16x16x32_bf16 v[16:19], v[200:203], a[224:227], v[16:19]
 ds_read_b64_tr_b16 v[216:217], v194 offset:17152
 ds_read_b64_tr_b16 v[218:219], v194 offset:18176
 v_mfma_f32_16x16x32_bf16 v[16:19], v[204:207], a[240:243], v[16:19]
 v_mfma_f32_16x16x32_bf16 v[48:51], v[204:207], a[244:247], v[48:51]
 buffer_load_dwordx4 v227, s[20:23], s75 offen offset:3072 lds
 v_mfma_f32_16x16x32_bf16 v[48:51], v[200:203], a[228:231], v[48:51]
 s_add_u32 s78, s77, 4096
 ds_read_b64_tr_b16 v[220:221], v194 offset:25344
 ds_read_b64_tr_b16 v[222:223], v194 offset:26368
 v_mfma_f32_16x16x32_bf16 v[80:83], v[200:203], a[232:235], v[80:83]
 v_mfma_f32_16x16x32_bf16 v[80:83], v[204:207], a[248:251], v[80:83]
 v_mfma_f32_16x16x32_bf16 v[112:115], v[204:207], a[252:255], v[112:115]
 s_waitcnt lgkmcnt(4)
 v_mfma_f32_16x16x32_bf16 v[112:115], v[200:203], a[236:239], v[112:115]
 v_mfma_f32_16x16x32_bf16 v[20:23], v[208:211], a[224:227], v[20:23]
 ds_read_b64_tr_b16 v[200:201], v195 offset:17152
 v_add_u32 v240, s78, v197
 v_mfma_f32_16x16x32_bf16 v[20:23], v[212:215], a[240:243], v[20:23]
 s_add_u32 s78, s77, 68608
 ds_read_b64_tr_b16 v[202:203], v195 offset:18176
 ds_read_b64_tr_b16 v[204:205], v195 offset:25344
 v_mfma_f32_16x16x32_bf16 v[52:55], v[212:215], a[244:247], v[52:55]
 v_mfma_f32_16x16x32_bf16 v[52:55], v[208:211], a[228:231], v[52:55]
 v_mfma_f32_16x16x32_bf16 v[84:87], v[208:211], a[232:235], v[84:87]
 v_mfma_f32_16x16x32_bf16 v[84:87], v[212:215], a[248:251], v[84:87]
 s_add_u32 s75, s75, 524288
 ds_read_b64_tr_b16 v[206:207], v195 offset:26368
 v_add_u32 v241, s78, v196
 v_mfma_f32_16x16x32_bf16 v[116:119], v[212:215], a[252:255], v[116:119]
 s_bitset0_b32 s75, 22
 v_mfma_f32_16x16x32_bf16 v[116:119], v[208:211], a[236:239], v[116:119]
 s_waitcnt vmcnt(5)
 s_waitcnt lgkmcnt(4)
 v_mfma_f32_16x16x32_bf16 v[24:27], v[216:219], a[224:227], v[24:27]
 s_barrier
 ds_read_b64_tr_b16 v[208:209], v192 offset:0
 ds_read_b64_tr_b16 v[210:211], v192 offset:1024
 v_mfma_f32_16x16x32_bf16 v[24:27], v[220:223], a[240:243], v[24:27]
 s_add_u32 m0, s73, 98304
 v_cvt_pk_bf16_f32 v128, v0, v1
 v_cvt_pk_bf16_f32 v129, v2, v3
 v_mfma_f32_16x16x32_bf16 v[56:59], v[220:223], a[244:247], v[56:59]
 buffer_load_dwordx4 v224, s[20:23], s75 offen offset:0 lds
 v_mfma_f32_16x16x32_bf16 v[56:59], v[216:219], a[228:231], v[56:59]
 s_bfe_u32 s77, s2, 0x20001
 v_cvt_pk_bf16_f32 v144, v32, v33
 v_cvt_pk_bf16_f32 v145, v34, v35
 v_mfma_f32_16x16x32_bf16 v[88:91], v[216:219], a[232:235], v[88:91]
 s_add_u32 s77, s77, 1
 ds_read_b64_tr_b16 v[212:213], v192 offset:8192
 v_cvt_pk_bf16_f32 v160, v64, v65
 v_mfma_f32_16x16x32_bf16 v[88:91], v[220:223], a[248:251], v[88:91]
 ds_read_b64_tr_b16 v[214:215], v192 offset:9216
 v_cvt_pk_bf16_f32 v161, v66, v67
 v_mfma_f32_16x16x32_bf16 v[120:123], v[220:223], a[252:255], v[120:123]
 s_waitcnt lgkmcnt(4)
 v_cvt_pk_bf16_f32 v176, v96, v97
 v_cvt_pk_bf16_f32 v177, v98, v99
 v_mfma_f32_16x16x32_bf16 v[120:123], v[216:219], a[236:239], v[120:123]
 s_and_b32 s78, s77, 1
 v_mfma_f32_16x16x32_bf16 v[28:31], v[200:203], a[224:227], v[28:31]
 ds_read_b64_tr_b16 v[216:217], v193 offset:0
 v_cvt_pk_bf16_f32 v130, v4, v5
 v_mfma_f32_16x16x32_bf16 v[28:31], v[204:207], a[240:243], v[28:31]
 ds_read_b64_tr_b16 v[218:219], v193 offset:1024
 v_cvt_pk_bf16_f32 v131, v6, v7
 v_mfma_f32_16x16x32_bf16 v[60:63], v[204:207], a[244:247], v[60:63]
 s_lshl_b32 s78, s78, 14
 v_cvt_pk_bf16_f32 v146, v36, v37
 v_cvt_pk_bf16_f32 v147, v38, v39
 v_mfma_f32_16x16x32_bf16 v[60:63], v[200:203], a[228:231], v[60:63]
 ds_read_b64_tr_b16 v[220:221], v193 offset:8192
 v_cvt_pk_bf16_f32 v162, v68, v69
 v_mfma_f32_16x16x32_bf16 v[92:95], v[200:203], a[232:235], v[92:95]
 v_mfma_f32_16x16x32_bf16 v[92:95], v[204:207], a[248:251], v[92:95]
 s_bfe_u32 s77, s77, 0x10001
 ds_read_b64_tr_b16 v[222:223], v193 offset:9216
 v_cvt_pk_bf16_f32 v163, v70, v71
 v_mfma_f32_16x16x32_bf16 v[124:127], v[204:207], a[252:255], v[124:127]
 s_waitcnt lgkmcnt(4)
 v_cvt_pk_bf16_f32 v178, v100, v101
 v_cvt_pk_bf16_f32 v179, v102, v103
 v_mfma_f32_16x16x32_bf16 v[124:127], v[200:203], a[236:239], v[124:127]
 v_mfma_f32_16x16x32_bf16 v[0:3], a[0:3], v[208:211], 0
 ds_read_b64_tr_b16 v[200:201], v192 offset:256
 v_cvt_pk_bf16_f32 v132, v8, v9
 v_mfma_f32_16x16x32_bf16 v[0:3], a[16:19], v[212:215], v[0:3]
 buffer_load_dwordx4 v225, s[20:23], s75 offen offset:1024 lds
 v_mfma_f32_16x16x32_bf16 v[32:35], a[20:23], v[212:215], 0
 s_lshl_b32 s77, s77, 17
 ds_read_b64_tr_b16 v[202:203], v192 offset:1280
 v_cvt_pk_bf16_f32 v133, v10, v11
 v_mfma_f32_16x16x32_bf16 v[32:35], a[4:7], v[208:211], v[32:35]
 v_cvt_pk_bf16_f32 v148, v40, v41
 v_cvt_pk_bf16_f32 v149, v42, v43
 v_mfma_f32_16x16x32_bf16 v[64:67], a[8:11], v[208:211], 0
 s_add_u32 s77, s77, s78
 ds_read_b64_tr_b16 v[204:205], v192 offset:8448
 v_cvt_pk_bf16_f32 v164, v72, v73
 v_mfma_f32_16x16x32_bf16 v[64:67], a[24:27], v[212:215], v[64:67]
 v_cvt_pk_bf16_f32 v165, v74, v75
 v_cvt_pk_bf16_f32 v180, v104, v105
 v_mfma_f32_16x16x32_bf16 v[96:99], a[28:31], v[212:215], 0
 s_waitcnt lgkmcnt(3)
 ds_read_b64_tr_b16 v[206:207], v192 offset:9472
 v_cvt_pk_bf16_f32 v181, v106, v107
 v_mfma_f32_16x16x32_bf16 v[96:99], a[12:15], v[208:211], v[96:99]
 v_cvt_pk_bf16_f32 v134, v12, v13
 v_cvt_pk_bf16_f32 v135, v14, v15
 v_mfma_f32_16x16x32_bf16 v[4:7], a[0:3], v[216:219], 0
 s_add_u32 s78, s77, 2048
 ds_read_b64_tr_b16 v[208:209], v193 offset:256
 v_cvt_pk_bf16_f32 v150, v44, v45
 v_mfma_f32_16x16x32_bf16 v[4:7], a[16:19], v[220:223], v[4:7]
 ds_read_b64_tr_b16 v[210:211], v193 offset:1280
 v_cvt_pk_bf16_f32 v151, v46, v47
 v_mfma_f32_16x16x32_bf16 v[36:39], a[20:23], v[220:223], 0
 v_mfma_f32_16x16x32_bf16 v[36:39], a[4:7], v[216:219], v[36:39]
 ds_read_b64_tr_b16 v[212:213], v193 offset:8448
 v_cvt_pk_bf16_f32 v166, v76, v77
 v_mfma_f32_16x16x32_bf16 v[68:71], a[8:11], v[216:219], 0
 v_cvt_pk_bf16_f32 v167, v78, v79
 v_add_u32 v242, s78, v197
 v_mfma_f32_16x16x32_bf16 v[68:71], a[24:27], v[220:223], v[68:71]
 ds_read_b64_tr_b16 v[214:215], v193 offset:9472
 v_cvt_pk_bf16_f32 v182, v108, v109
 v_mfma_f32_16x16x32_bf16 v[100:103], a[28:31], v[220:223], 0
 s_waitcnt lgkmcnt(4)
 v_cvt_pk_bf16_f32 v183, v110, v111
 v_cvt_pk_bf16_f32 v136, v16, v17
 v_mfma_f32_16x16x32_bf16 v[100:103], a[12:15], v[216:219], v[100:103]
 buffer_load_dwordx4 v226, s[20:23], s75 offen offset:2048 lds
 v_mfma_f32_16x16x32_bf16 v[8:11], a[0:3], v[200:203], 0
 s_add_u32 s78, s77, 66560
 ds_read_b64_tr_b16 v[216:217], v192 offset:512
 v_cvt_pk_bf16_f32 v137, v18, v19
 v_mfma_f32_16x16x32_bf16 v[8:11], a[16:19], v[204:207], v[8:11]
 ds_read_b64_tr_b16 v[218:219], v192 offset:1536
 v_cvt_pk_bf16_f32 v152, v48, v49
 v_mfma_f32_16x16x32_bf16 v[40:43], a[20:23], v[204:207], 0
 v_cvt_pk_bf16_f32 v153, v50, v51
 v_cvt_pk_bf16_f32 v168, v80, v81
 v_mfma_f32_16x16x32_bf16 v[40:43], a[4:7], v[200:203], v[40:43]
 ds_read_b64_tr_b16 v[220:221], v192 offset:8704
 v_cvt_pk_bf16_f32 v169, v82, v83
 v_mfma_f32_16x16x32_bf16 v[72:75], a[8:11], v[200:203], 0
 v_add_u32 v243, s78, v196
 v_cvt_pk_bf16_f32 v184, v112, v113
 v_mfma_f32_16x16x32_bf16 v[72:75], a[24:27], v[204:207], v[72:75]
 s_bfe_u32 s77, s2, 0x20001
 ds_read_b64_tr_b16 v[222:223], v192 offset:9728
 v_cvt_pk_bf16_f32 v185, v114, v115
 v_mfma_f32_16x16x32_bf16 v[104:107], a[28:31], v[204:207], 0
 s_waitcnt lgkmcnt(4)
 v_cvt_pk_bf16_f32 v138, v20, v21
 v_cvt_pk_bf16_f32 v139, v22, v23
 v_mfma_f32_16x16x32_bf16 v[104:107], a[12:15], v[200:203], v[104:107]
 v_mfma_f32_16x16x32_bf16 v[12:15], a[0:3], v[208:211], 0
 s_add_u32 s77, s77, 2
 ds_read_b64_tr_b16 v[200:201], v193 offset:512
 v_cvt_pk_bf16_f32 v154, v52, v53
 v_mfma_f32_16x16x32_bf16 v[12:15], a[16:19], v[212:215], v[12:15]
 ds_read_b64_tr_b16 v[202:203], v193 offset:1536
 v_cvt_pk_bf16_f32 v155, v54, v55
 v_mfma_f32_16x16x32_bf16 v[44:47], a[20:23], v[212:215], 0
 v_cvt_pk_bf16_f32 v170, v84, v85
 v_cvt_pk_bf16_f32 v171, v86, v87
 v_mfma_f32_16x16x32_bf16 v[44:47], a[4:7], v[208:211], v[44:47]
 ds_read_b64_tr_b16 v[204:205], v193 offset:8704
 v_cvt_pk_bf16_f32 v186, v116, v117
 v_mfma_f32_16x16x32_bf16 v[76:79], a[8:11], v[208:211], 0
 s_and_b32 s78, s77, 1
 v_mfma_f32_16x16x32_bf16 v[76:79], a[24:27], v[212:215], v[76:79]
 ds_read_b64_tr_b16 v[206:207], v193 offset:9728
 v_cvt_pk_bf16_f32 v187, v118, v119
 v_mfma_f32_16x16x32_bf16 v[108:111], a[28:31], v[212:215], 0
 s_waitcnt lgkmcnt(4)
 v_cvt_pk_bf16_f32 v140, v24, v25
 v_cvt_pk_bf16_f32 v141, v26, v27
 v_mfma_f32_16x16x32_bf16 v[108:111], a[12:15], v[208:211], v[108:111]
 buffer_load_dwordx4 v227, s[20:23], s75 offen offset:3072 lds
 v_mfma_f32_16x16x32_bf16 v[16:19], a[0:3], v[216:219], 0
 s_lshl_b32 s78, s78, 14
 ds_read_b64_tr_b16 v[208:209], v192 offset:768
 v_cvt_pk_bf16_f32 v156, v56, v57
 v_mfma_f32_16x16x32_bf16 v[16:19], a[16:19], v[220:223], v[16:19]
 ds_read_b64_tr_b16 v[210:211], v192 offset:1792
 v_cvt_pk_bf16_f32 v157, v58, v59
 v_mfma_f32_16x16x32_bf16 v[48:51], a[20:23], v[220:223], 0
 v_cvt_pk_bf16_f32 v172, v88, v89
 v_cvt_pk_bf16_f32 v173, v90, v91
 v_mfma_f32_16x16x32_bf16 v[48:51], a[4:7], v[216:219], v[48:51]
 s_bfe_u32 s77, s77, 0x10001
 ds_read_b64_tr_b16 v[212:213], v192 offset:8960
 v_cvt_pk_bf16_f32 v188, v120, v121
 v_mfma_f32_16x16x32_bf16 v[80:83], a[8:11], v[216:219], 0
 v_mfma_f32_16x16x32_bf16 v[80:83], a[24:27], v[220:223], v[80:83]
 ds_read_b64_tr_b16 v[214:215], v192 offset:9984
 v_cvt_pk_bf16_f32 v189, v122, v123
 v_mfma_f32_16x16x32_bf16 v[112:115], a[28:31], v[220:223], 0
 s_waitcnt lgkmcnt(4)
 v_cvt_pk_bf16_f32 v142, v28, v29
 v_cvt_pk_bf16_f32 v143, v30, v31
 v_mfma_f32_16x16x32_bf16 v[112:115], a[12:15], v[216:219], v[112:115]
 s_lshl_b32 s77, s77, 17
 v_mfma_f32_16x16x32_bf16 v[20:23], a[0:3], v[200:203], 0
 ds_read_b64_tr_b16 v[216:217], v193 offset:768
 v_cvt_pk_bf16_f32 v158, v60, v61
 v_mfma_f32_16x16x32_bf16 v[20:23], a[16:19], v[204:207], v[20:23]
 s_add_u32 s77, s77, s78
 ds_read_b64_tr_b16 v[218:219], v193 offset:1792
 v_cvt_pk_bf16_f32 v159, v62, v63
 v_mfma_f32_16x16x32_bf16 v[52:55], a[20:23], v[204:207], 0
 v_cvt_pk_bf16_f32 v174, v92, v93
 v_cvt_pk_bf16_f32 v175, v94, v95
 v_mfma_f32_16x16x32_bf16 v[52:55], a[4:7], v[200:203], v[52:55]
 ds_read_b64_tr_b16 v[220:221], v193 offset:8960
 v_cvt_pk_bf16_f32 v190, v124, v125
 v_mfma_f32_16x16x32_bf16 v[84:87], a[8:11], v[200:203], 0
 ds_read_b64_tr_b16 v[222:223], v193 offset:9984
 v_cvt_pk_bf16_f32 v191, v126, v127
 v_mfma_f32_16x16x32_bf16 v[84:87], a[24:27], v[204:207], v[84:87]
 s_add_u32 s75, s75, 524288
 v_mfma_f32_16x16x32_bf16 v[116:119], a[28:31], v[204:207], 0
 s_bitset0_b32 s75, 22
 v_mfma_f32_16x16x32_bf16 v[116:119], a[12:15], v[200:203], v[116:119]
 s_waitcnt vmcnt(4)
 s_waitcnt lgkmcnt(4)
 v_mfma_f32_16x16x32_bf16 v[24:27], a[0:3], v[208:211], 0
 s_barrier
 ds_read_b64_tr_b16 v[200:201], v192 offset:16384
 ds_read_b64_tr_b16 v[202:203], v192 offset:17408
 v_mfma_f32_16x16x32_bf16 v[24:27], a[16:19], v[212:215], v[24:27]
 buffer_load_dword v239, v238, s[48:51], 0 offen sc1
 v_mfma_f32_16x16x32_bf16 v[56:59], a[20:23], v[212:215], 0
 s_add_u32 s78, s77, 4096
 ds_read_b64_tr_b16 v[204:205], v192 offset:24576
 v_add_u32 v244, s78, v197
 v_mfma_f32_16x16x32_bf16 v[56:59], a[4:7], v[208:211], v[56:59]
 s_add_u32 s78, s77, 68608
 v_mfma_f32_16x16x32_bf16 v[88:91], a[8:11], v[208:211], 0
 v_mfma_f32_16x16x32_bf16 v[88:91], a[24:27], v[212:215], v[88:91]
 ds_read_b64_tr_b16 v[206:207], v192 offset:25600
 v_mfma_f32_16x16x32_bf16 v[120:123], a[28:31], v[212:215], 0
 s_waitcnt lgkmcnt(4)
 v_mfma_f32_16x16x32_bf16 v[120:123], a[12:15], v[208:211], v[120:123]
 v_mfma_f32_16x16x32_bf16 v[28:31], a[0:3], v[216:219], 0
 s_add_u32 m0, s73, 114688
 ds_read_b64_tr_b16 v[208:209], v193 offset:16384
 v_add_u32 v245, s78, v196
 v_mfma_f32_16x16x32_bf16 v[28:31], a[16:19], v[220:223], v[28:31]
 buffer_load_dwordx4 v224, s[20:23], s75 offen offset:0 lds
 v_mfma_f32_16x16x32_bf16 v[60:63], a[20:23], v[220:223], 0
 s_bfe_u32 s77, s2, 0x20001
 ds_read_b64_tr_b16 v[210:211], v193 offset:17408
 ds_read_b64_tr_b16 v[212:213], v193 offset:24576
 v_mfma_f32_16x16x32_bf16 v[60:63], a[4:7], v[216:219], v[60:63]
 v_mfma_f32_16x16x32_bf16 v[92:95], a[8:11], v[216:219], 0
 v_mfma_f32_16x16x32_bf16 v[92:95], a[24:27], v[220:223], v[92:95]
 s_add_u32 s77, s77, 3
 ds_read_b64_tr_b16 v[214:215], v193 offset:25600
 v_mfma_f32_16x16x32_bf16 v[124:127], a[28:31], v[220:223], 0
 s_waitcnt lgkmcnt(4)
 v_mfma_f32_16x16x32_bf16 v[124:127], a[12:15], v[216:219], v[124:127]
 v_mfma_f32_16x16x32_bf16 v[0:3], a[32:35], v[200:203], v[0:3]
 ds_read_b64_tr_b16 v[216:217], v192 offset:16640
 ds_read_b64_tr_b16 v[218:219], v192 offset:17664
 v_mfma_f32_16x16x32_bf16 v[0:3], a[48:51], v[204:207], v[0:3]
 s_add_u32 s82, s79, 0
 v_mfma_f32_16x16x32_bf16 v[32:35], a[52:55], v[204:207], v[32:35]
 buffer_store_dwordx4 v[128:131], v251, s[52:55], s82 offen sc1
 v_mfma_f32_16x16x32_bf16 v[32:35], a[36:39], v[200:203], v[32:35]
 s_and_b32 s78, s77, 1
 ds_read_b64_tr_b16 v[220:221], v192 offset:24832
 ds_read_b64_tr_b16 v[222:223], v192 offset:25856
 v_mfma_f32_16x16x32_bf16 v[64:67], a[40:43], v[200:203], v[64:67]
 s_lshl_b32 s78, s78, 14
 v_mfma_f32_16x16x32_bf16 v[64:67], a[56:59], v[204:207], v[64:67]
 v_mfma_f32_16x16x32_bf16 v[96:99], a[60:63], v[204:207], v[96:99]
 s_waitcnt lgkmcnt(4)
 v_mfma_f32_16x16x32_bf16 v[96:99], a[44:47], v[200:203], v[96:99]
 v_mfma_f32_16x16x32_bf16 v[4:7], a[32:35], v[208:211], v[4:7]
 s_bfe_u32 s77, s77, 0x10001
 ds_read_b64_tr_b16 v[200:201], v193 offset:16640
 ds_read_b64_tr_b16 v[202:203], v193 offset:17664
 v_mfma_f32_16x16x32_bf16 v[4:7], a[48:51], v[212:215], v[4:7]
 v_mfma_f32_16x16x32_bf16 v[36:39], a[52:55], v[212:215], v[36:39]
 v_mfma_f32_16x16x32_bf16 v[36:39], a[36:39], v[208:211], v[36:39]
 buffer_load_dwordx4 v225, s[20:23], s75 offen offset:1024 lds
 v_mfma_f32_16x16x32_bf16 v[68:71], a[40:43], v[208:211], v[68:71]
 s_lshl_b32 s77, s77, 17
 ds_read_b64_tr_b16 v[204:205], v193 offset:24832
 ds_read_b64_tr_b16 v[206:207], v193 offset:25856
 v_mfma_f32_16x16x32_bf16 v[68:71], a[56:59], v[212:215], v[68:71]
 v_mfma_f32_16x16x32_bf16 v[100:103], a[60:63], v[212:215], v[100:103]
 s_waitcnt lgkmcnt(4)
 v_mfma_f32_16x16x32_bf16 v[100:103], a[44:47], v[208:211], v[100:103]
 s_add_u32 s77, s77, s78
 v_mfma_f32_16x16x32_bf16 v[8:11], a[32:35], v[216:219], v[8:11]
 ds_read_b64_tr_b16 v[208:209], v192 offset:16896
 ds_read_b64_tr_b16 v[210:211], v192 offset:17920
 v_mfma_f32_16x16x32_bf16 v[8:11], a[48:51], v[220:223], v[8:11]
 v_mfma_f32_16x16x32_bf16 v[40:43], a[52:55], v[220:223], v[40:43]
 s_add_u32 s78, s77, 2048
 v_mfma_f32_16x16x32_bf16 v[40:43], a[36:39], v[216:219], v[40:43]
 ds_read_b64_tr_b16 v[212:213], v192 offset:25088
 ds_read_b64_tr_b16 v[214:215], v192 offset:26112
 v_mfma_f32_16x16x32_bf16 v[72:75], a[40:43], v[216:219], v[72:75]
 buffer_load_dwordx4 v226, s[20:23], s75 offen offset:2048 lds
 v_mfma_f32_16x16x32_bf16 v[72:75], a[56:59], v[220:223], v[72:75]
 v_mfma_f32_16x16x32_bf16 v[104:107], a[60:63], v[220:223], v[104:107]
 s_waitcnt lgkmcnt(4)
 v_mfma_f32_16x16x32_bf16 v[104:107], a[44:47], v[216:219], v[104:107]
 v_add_u32 v246, s78, v197
 v_mfma_f32_16x16x32_bf16 v[12:15], a[32:35], v[200:203], v[12:15]
 s_add_u32 s78, s77, 66560
 ds_read_b64_tr_b16 v[216:217], v193 offset:16896
 ds_read_b64_tr_b16 v[218:219], v193 offset:17920
 v_mfma_f32_16x16x32_bf16 v[12:15], a[48:51], v[204:207], v[12:15]
 v_mfma_f32_16x16x32_bf16 v[44:47], a[52:55], v[204:207], v[44:47]
 v_mfma_f32_16x16x32_bf16 v[44:47], a[36:39], v[200:203], v[44:47]
 ds_read_b64_tr_b16 v[220:221], v193 offset:25088
 ds_read_b64_tr_b16 v[222:223], v193 offset:26112
 v_mfma_f32_16x16x32_bf16 v[76:79], a[40:43], v[200:203], v[76:79]
 s_add_u32 s82, s79, 4096
 v_mfma_f32_16x16x32_bf16 v[76:79], a[56:59], v[204:207], v[76:79]
 buffer_store_dwordx4 v[144:147], v251, s[52:55], s82 offen sc1
 v_mfma_f32_16x16x32_bf16 v[108:111], a[60:63], v[204:207], v[108:111]
 s_waitcnt lgkmcnt(4)
 v_add_u32 v247, s78, v196
 v_mfma_f32_16x16x32_bf16 v[108:111], a[44:47], v[200:203], v[108:111]
 v_mfma_f32_16x16x32_bf16 v[16:19], a[32:35], v[208:211], v[16:19]
 ds_read_b64_tr_b16 v[200:201], v192 offset:17152
 v_and_b32 v196, 15, v253
 v_mfma_f32_16x16x32_bf16 v[16:19], a[48:51], v[212:215], v[16:19]
 ds_read_b64_tr_b16 v[202:203], v192 offset:18176
 ds_read_b64_tr_b16 v[204:205], v192 offset:25344
 v_mfma_f32_16x16x32_bf16 v[48:51], a[52:55], v[212:215], v[48:51]
 v_mfma_f32_16x16x32_bf16 v[48:51], a[36:39], v[208:211], v[48:51]
 v_mfma_f32_16x16x32_bf16 v[80:83], a[40:43], v[208:211], v[80:83]
 v_mfma_f32_16x16x32_bf16 v[80:83], a[56:59], v[212:215], v[80:83]
 ds_read_b64_tr_b16 v[206:207], v192 offset:26368
 v_lshrrev_b32 v197, 1, v196
 v_mfma_f32_16x16x32_bf16 v[112:115], a[60:63], v[212:215], v[112:115]
 buffer_load_dwordx4 v227, s[20:23], s75 offen offset:3072 lds
 v_mfma_f32_16x16x32_bf16 v[112:115], a[44:47], v[208:211], v[112:115]
 s_waitcnt lgkmcnt(4)
 v_mfma_f32_16x16x32_bf16 v[20:23], a[32:35], v[216:219], v[20:23]
 ds_read_b64_tr_b16 v[208:209], v193 offset:17152
 v_lshrrev_b32 v198, 4, v253
 v_mfma_f32_16x16x32_bf16 v[20:23], a[48:51], v[220:223], v[20:23]
 ds_read_b64_tr_b16 v[210:211], v193 offset:18176
 v_xor_b32 v197, v197, v198
 v_mfma_f32_16x16x32_bf16 v[52:55], a[52:55], v[220:223], v[52:55]
 v_mfma_f32_16x16x32_bf16 v[52:55], a[36:39], v[216:219], v[52:55]
 ds_read_b64_tr_b16 v[212:213], v193 offset:25344
 ds_read_b64_tr_b16 v[214:215], v193 offset:26368
 v_mfma_f32_16x16x32_bf16 v[84:87], a[40:43], v[216:219], v[84:87]
 v_mfma_f32_16x16x32_bf16 v[84:87], a[56:59], v[220:223], v[84:87]
 s_add_u32 s75, s75, 524288
 v_mfma_f32_16x16x32_bf16 v[116:119], a[60:63], v[220:223], v[116:119]
 s_bitset0_b32 s75, 22
 v_mfma_f32_16x16x32_bf16 v[116:119], a[44:47], v[216:219], v[116:119]
 s_waitcnt vmcnt(7)
 s_waitcnt lgkmcnt(4)
 v_lshlrev_b32 v197, 4, v197
 v_mfma_f32_16x16x32_bf16 v[24:27], a[32:35], v[200:203], v[24:27]
 s_barrier
 ds_read_b64_tr_b16 v[216:217], v194 offset:0
 ds_read_b64_tr_b16 v[218:219], v194 offset:1024
 v_mfma_f32_16x16x32_bf16 v[24:27], a[48:51], v[204:207], v[24:27]
 s_waitcnt vmcnt(6)
 v_cmp_gt_u32 vcc, 128, v239
 v_lshl_add_u32 v196, v196, 7, v197
 v_mfma_f32_16x16x32_bf16 v[56:59], a[52:55], v[204:207], v[56:59]
 s_cbranch_vccnz Lfs5
Lfb6:
 v_mfma_f32_16x16x32_bf16 v[56:59], a[36:39], v[200:203], v[56:59]
 ds_read_b64_tr_b16 v[220:221], v194 offset:8192
 v_mov_b32 v238, 0
 v_mfma_f32_16x16x32_bf16 v[88:91], a[40:43], v[200:203], v[88:91]
 v_mfma_f32_16x16x32_bf16 v[88:91], a[56:59], v[204:207], v[88:91]
 ds_read_b64_tr_b16 v[222:223], v194 offset:9216
 v_lshl_add_u32 v236, v252, 13, v196
 v_mfma_f32_16x16x32_bf16 v[120:123], a[60:63], v[204:207], v[120:123]
 buffer_load_dwordx4 a[0:3], v229, s[52:55], s81 offen offset:0 sc1
 v_mfma_f32_16x16x32_bf16 v[120:123], a[44:47], v[200:203], v[120:123]
 s_waitcnt lgkmcnt(4)
 v_mfma_f32_16x16x32_bf16 v[28:31], a[32:35], v[208:211], v[28:31]
 ds_read_b64_tr_b16 v[200:201], v195 offset:0
 v_xor_b32 v237, 64, v236
 v_mfma_f32_16x16x32_bf16 v[28:31], a[48:51], v[212:215], v[28:31]
 ds_read_b64_tr_b16 v[202:203], v195 offset:1024
 ds_read_b64_tr_b16 v[204:205], v195 offset:8192
 v_mfma_f32_16x16x32_bf16 v[60:63], a[52:55], v[212:215], v[60:63]
 s_add_u32 m0, s73, 0
 v_mfma_f32_16x16x32_bf16 v[60:63], a[36:39], v[208:211], v[60:63]
 buffer_load_dwordx4 v224, s[20:23], s75 offen offset:0 lds
 v_mfma_f32_16x16x32_bf16 v[92:95], a[40:43], v[208:211], v[92:95]
 s_lshl_b32 s41, s60, 13
 v_mfma_f32_16x16x32_bf16 v[92:95], a[56:59], v[212:215], v[92:95]
 ds_read_b64_tr_b16 v[206:207], v195 offset:9216
 v_mfma_f32_16x16x32_bf16 v[124:127], a[60:63], v[212:215], v[124:127]
 s_waitcnt lgkmcnt(4)
 v_mfma_f32_16x16x32_bf16 v[124:127], a[44:47], v[208:211], v[124:127]
 s_add_u32 s82, s79, 8192
 v_mfma_f32_16x16x32_bf16 v[0:3], a[64:67], v[216:219], v[0:3]
 ds_read_b64_tr_b16 v[208:209], v194 offset:256
 ds_read_b64_tr_b16 v[210:211], v194 offset:1280
 v_mfma_f32_16x16x32_bf16 v[0:3], a[80:83], v[220:223], v[0:3]
 buffer_store_dwordx4 v[160:163], v251, s[52:55], s82 offen sc1
 v_mfma_f32_16x16x32_bf16 v[32:35], a[84:87], v[220:223], v[32:35]
 v_mfma_f32_16x16x32_bf16 v[32:35], a[68:71], v[216:219], v[32:35]
 ds_read_b64_tr_b16 v[212:213], v194 offset:8448
 ds_read_b64_tr_b16 v[214:215], v194 offset:9472
 v_mfma_f32_16x16x32_bf16 v[64:67], a[72:75], v[216:219], v[64:67]
 v_mfma_f32_16x16x32_bf16 v[64:67], a[88:91], v[220:223], v[64:67]
 buffer_load_dwordx4 a[4:7], v230, s[52:55], s81 offen offset:0 sc1
 v_mfma_f32_16x16x32_bf16 v[96:99], a[92:95], v[220:223], v[96:99]
 s_waitcnt lgkmcnt(4)
 v_mfma_f32_16x16x32_bf16 v[96:99], a[76:79], v[216:219], v[96:99]
 v_mfma_f32_16x16x32_bf16 v[4:7], a[64:67], v[200:203], v[4:7]
 ds_read_b64_tr_b16 v[216:217], v195 offset:256
 ds_read_b64_tr_b16 v[218:219], v195 offset:1280
 v_mfma_f32_16x16x32_bf16 v[4:7], a[80:83], v[204:207], v[4:7]
 v_mfma_f32_16x16x32_bf16 v[36:39], a[84:87], v[204:207], v[36:39]
 buffer_load_dwordx4 v225, s[20:23], s75 offen offset:1024 lds
 v_mfma_f32_16x16x32_bf16 v[36:39], a[68:71], v[200:203], v[36:39]
 ds_read_b64_tr_b16 v[220:221], v195 offset:8448
 ds_read_b64_tr_b16 v[222:223], v195 offset:9472
 v_mfma_f32_16x16x32_bf16 v[68:71], a[72:75], v[200:203], v[68:71]
 v_mfma_f32_16x16x32_bf16 v[68:71], a[88:91], v[204:207], v[68:71]
 v_mfma_f32_16x16x32_bf16 v[100:103], a[92:95], v[204:207], v[100:103]
 s_waitcnt lgkmcnt(4)
 v_mfma_f32_16x16x32_bf16 v[100:103], a[76:79], v[200:203], v[100:103]
 buffer_load_dwordx4 a[8:11], v229, s[52:55], s80 offen offset:0 sc1
 v_mfma_f32_16x16x32_bf16 v[8:11], a[64:67], v[208:211], v[8:11]
 ds_read_b64_tr_b16 v[200:201], v194 offset:512
 ds_read_b64_tr_b16 v[202:203], v194 offset:1536
 v_mfma_f32_16x16x32_bf16 v[8:11], a[80:83], v[212:215], v[8:11]
 v_mfma_f32_16x16x32_bf16 v[40:43], a[84:87], v[212:215], v[40:43]
 v_mfma_f32_16x16x32_bf16 v[40:43], a[68:71], v[208:211], v[40:43]
 ds_read_b64_tr_b16 v[204:205], v194 offset:8704
 ds_read_b64_tr_b16 v[206:207], v194 offset:9728
 v_mfma_f32_16x16x32_bf16 v[72:75], a[72:75], v[208:211], v[72:75]
 v_mfma_f32_16x16x32_bf16 v[72:75], a[88:91], v[212:215], v[72:75]
 buffer_load_dwordx4 v226, s[20:23], s75 offen offset:2048 lds
 v_mfma_f32_16x16x32_bf16 v[104:107], a[92:95], v[212:215], v[104:107]
 s_waitcnt lgkmcnt(4)
 v_mfma_f32_16x16x32_bf16 v[104:107], a[76:79], v[208:211], v[104:107]
 v_mfma_f32_16x16x32_bf16 v[12:15], a[64:67], v[216:219], v[12:15]
 ds_read_b64_tr_b16 v[208:209], v195 offset:512
 ds_read_b64_tr_b16 v[210:211], v195 offset:1536
 v_mfma_f32_16x16x32_bf16 v[12:15], a[80:83], v[220:223], v[12:15]
 v_mfma_f32_16x16x32_bf16 v[44:47], a[84:87], v[220:223], v[44:47]
 buffer_load_dwordx4 a[12:15], v230, s[52:55], s80 offen offset:0 sc1
 v_mfma_f32_16x16x32_bf16 v[44:47], a[68:71], v[216:219], v[44:47]
 ds_read_b64_tr_b16 v[212:213], v195 offset:8704
 ds_read_b64_tr_b16 v[214:215], v195 offset:9728
 v_mfma_f32_16x16x32_bf16 v[76:79], a[72:75], v[216:219], v[76:79]
 v_mfma_f32_16x16x32_bf16 v[76:79], a[88:91], v[220:223], v[76:79]
 v_mfma_f32_16x16x32_bf16 v[108:111], a[92:95], v[220:223], v[108:111]
 s_waitcnt lgkmcnt(4)
 v_mfma_f32_16x16x32_bf16 v[108:111], a[76:79], v[216:219], v[108:111]
 s_add_u32 s82, s79, 12288
 v_mfma_f32_16x16x32_bf16 v[16:19], a[64:67], v[200:203], v[16:19]
 buffer_store_dwordx4 v[176:179], v251, s[52:55], s82 offen sc1
 v_mfma_f32_16x16x32_bf16 v[16:19], a[80:83], v[204:207], v[16:19]
 ds_read_b64_tr_b16 v[216:217], v194 offset:768
 ds_read_b64_tr_b16 v[218:219], v194 offset:1792
 v_mfma_f32_16x16x32_bf16 v[48:51], a[84:87], v[204:207], v[48:51]
 v_mfma_f32_16x16x32_bf16 v[48:51], a[68:71], v[200:203], v[48:51]
 ds_read_b64_tr_b16 v[220:221], v194 offset:8960
 ds_read_b64_tr_b16 v[222:223], v194 offset:9984
 v_mfma_f32_16x16x32_bf16 v[80:83], a[72:75], v[200:203], v[80:83]
 buffer_load_dwordx4 v227, s[20:23], s75 offen offset:3072 lds
 v_mfma_f32_16x16x32_bf16 v[80:83], a[88:91], v[204:207], v[80:83]
 v_mfma_f32_16x16x32_bf16 v[112:115], a[92:95], v[204:207], v[112:115]
 s_waitcnt lgkmcnt(4)
 v_mfma_f32_16x16x32_bf16 v[112:115], a[76:79], v[200:203], v[112:115]
 v_mfma_f32_16x16x32_bf16 v[20:23], a[64:67], v[208:211], v[20:23]
 s_add_u32 s75, s75, 524288
 ds_read_b64_tr_b16 v[200:201], v195 offset:768
 ds_read_b64_tr_b16 v[202:203], v195 offset:1792
 v_mfma_f32_16x16x32_bf16 v[20:23], a[80:83], v[212:215], v[20:23]
 s_bitset0_b32 s75, 22
 v_mfma_f32_16x16x32_bf16 v[52:55], a[84:87], v[212:215], v[52:55]
 buffer_load_dwordx4 a[16:19], v229, s[52:55], s81 offen offset:1024 sc1
 v_mfma_f32_16x16x32_bf16 v[52:55], a[68:71], v[208:211], v[52:55]
 ds_read_b64_tr_b16 v[204:205], v195 offset:8960
 ds_read_b64_tr_b16 v[206:207], v195 offset:9984
 v_mfma_f32_16x16x32_bf16 v[84:87], a[72:75], v[208:211], v[84:87]
 v_mfma_f32_16x16x32_bf16 v[84:87], a[88:91], v[212:215], v[84:87]
 v_mfma_f32_16x16x32_bf16 v[116:119], a[92:95], v[212:215], v[116:119]
 s_waitcnt lgkmcnt(4)
 v_mfma_f32_16x16x32_bf16 v[116:119], a[76:79], v[208:211], v[116:119]
 s_waitcnt vmcnt(11)
 v_mfma_f32_16x16x32_bf16 v[24:27], a[64:67], v[216:219], v[24:27]
 s_barrier
 ds_read_b64_tr_b16 v[208:209], v194 offset:16384
 ds_read_b64_tr_b16 v[210:211], v194 offset:17408
 v_mfma_f32_16x16x32_bf16 v[24:27], a[80:83], v[220:223], v[24:27]
 buffer_load_dwordx4 a[20:23], v230, s[52:55], s81 offen offset:1024 sc1
 v_mfma_f32_16x16x32_bf16 v[56:59], a[84:87], v[220:223], v[56:59]
 v_mfma_f32_16x16x32_bf16 v[56:59], a[68:71], v[216:219], v[56:59]
 ds_read_b64_tr_b16 v[212:213], v194 offset:24576
 ds_read_b64_tr_b16 v[214:215], v194 offset:25600
 v_mfma_f32_16x16x32_bf16 v[88:91], a[72:75], v[216:219], v[88:91]
 v_mfma_f32_16x16x32_bf16 v[88:91], a[88:91], v[220:223], v[88:91]
 s_add_u32 m0, s73, 16384
 v_mfma_f32_16x16x32_bf16 v[120:123], a[92:95], v[220:223], v[120:123]
 buffer_load_dwordx4 v224, s[20:23], s75 offen offset:0 lds
 v_mfma_f32_16x16x32_bf16 v[120:123], a[76:79], v[216:219], v[120:123]
 s_waitcnt lgkmcnt(4)
 v_mfma_f32_16x16x32_bf16 v[28:31], a[64:67], v[200:203], v[28:31]
 ds_read_b64_tr_b16 v[216:217], v195 offset:16384
 ds_read_b64_tr_b16 v[218:219], v195 offset:17408
 v_mfma_f32_16x16x32_bf16 v[28:31], a[80:83], v[204:207], v[28:31]
 v_mfma_f32_16x16x32_bf16 v[60:63], a[84:87], v[204:207], v[60:63]
 s_add_u32 s82, s79, 1024
 v_mfma_f32_16x16x32_bf16 v[60:63], a[68:71], v[200:203], v[60:63]
 buffer_store_dwordx4 v[132:135], v251, s[52:55], s82 offen sc1
 v_mfma_f32_16x16x32_bf16 v[92:95], a[72:75], v[200:203], v[92:95]
 ds_read_b64_tr_b16 v[220:221], v195 offset:24576
 ds_read_b64_tr_b16 v[222:223], v195 offset:25600
 v_mfma_f32_16x16x32_bf16 v[92:95], a[88:91], v[204:207], v[92:95]
 v_mfma_f32_16x16x32_bf16 v[124:127], a[92:95], v[204:207], v[124:127]
 s_waitcnt lgkmcnt(4)
 v_mfma_f32_16x16x32_bf16 v[124:127], a[76:79], v[200:203], v[124:127]
 v_mfma_f32_16x16x32_bf16 v[0:3], a[96:99], v[208:211], v[0:3]
 ds_read_b64_tr_b16 v[200:201], v194 offset:16640
 ds_read_b64_tr_b16 v[202:203], v194 offset:17664
 v_mfma_f32_16x16x32_bf16 v[0:3], a[112:115], v[212:215], v[0:3]
 buffer_load_dwordx4 a[24:27], v229, s[52:55], s80 offen offset:1024 sc1
 v_mfma_f32_16x16x32_bf16 v[32:35], a[116:119], v[212:215], v[32:35]
 v_mfma_f32_16x16x32_bf16 v[32:35], a[100:103], v[208:211], v[32:35]
 ds_read_b64_tr_b16 v[204:205], v194 offset:24832
 ds_read_b64_tr_b16 v[206:207], v194 offset:25856
 v_mfma_f32_16x16x32_bf16 v[64:67], a[104:107], v[208:211], v[64:67]
 v_mfma_f32_16x16x32_bf16 v[64:67], a[120:123], v[212:215], v[64:67]
 buffer_load_dwordx4 v225, s[20:23], s75 offen offset:1024 lds
 v_mfma_f32_16x16x32_bf16 v[96:99], a[124:127], v[212:215], v[96:99]
 s_waitcnt lgkmcnt(4)
 v_mfma_f32_16x16x32_bf16 v[96:99], a[108:111], v[208:211], v[96:99]
 v_mfma_f32_16x16x32_bf16 v[4:7], a[96:99], v[216:219], v[4:7]
 ds_read_b64_tr_b16 v[208:209], v195 offset:16640
 ds_read_b64_tr_b16 v[210:211], v195 offset:17664
 v_mfma_f32_16x16x32_bf16 v[4:7], a[112:115], v[220:223], v[4:7]
 v_mfma_f32_16x16x32_bf16 v[36:39], a[116:119], v[220:223], v[36:39]
 buffer_load_dwordx4 a[28:31], v230, s[52:55], s80 offen offset:1024 sc1
 v_mfma_f32_16x16x32_bf16 v[36:39], a[100:103], v[216:219], v[36:39]
 ds_read_b64_tr_b16 v[212:213], v195 offset:24832
 ds_read_b64_tr_b16 v[214:215], v195 offset:25856
 v_mfma_f32_16x16x32_bf16 v[68:71], a[104:107], v[216:219], v[68:71]
 v_mfma_f32_16x16x32_bf16 v[68:71], a[120:123], v[220:223], v[68:71]
 v_mfma_f32_16x16x32_bf16 v[100:103], a[124:127], v[220:223], v[100:103]
 s_waitcnt lgkmcnt(4)
 v_mfma_f32_16x16x32_bf16 v[100:103], a[108:111], v[216:219], v[100:103]
 buffer_load_dwordx4 a[32:35], v229, s[52:55], s81 offen offset:2048 sc1
 v_mfma_f32_16x16x32_bf16 v[8:11], a[96:99], v[200:203], v[8:11]
 ds_read_b64_tr_b16 v[216:217], v194 offset:16896
 ds_read_b64_tr_b16 v[218:219], v194 offset:17920
 v_mfma_f32_16x16x32_bf16 v[8:11], a[112:115], v[204:207], v[8:11]
 v_mfma_f32_16x16x32_bf16 v[40:43], a[116:119], v[204:207], v[40:43]
 v_mfma_f32_16x16x32_bf16 v[40:43], a[100:103], v[200:203], v[40:43]
 ds_read_b64_tr_b16 v[220:221], v194 offset:25088
 ds_read_b64_tr_b16 v[222:223], v194 offset:26112
 v_mfma_f32_16x16x32_bf16 v[72:75], a[104:107], v[200:203], v[72:75]
 v_mfma_f32_16x16x32_bf16 v[72:75], a[120:123], v[204:207], v[72:75]
 buffer_load_dwordx4 v226, s[20:23], s75 offen offset:2048 lds
 v_mfma_f32_16x16x32_bf16 v[104:107], a[124:127], v[204:207], v[104:107]
 s_waitcnt lgkmcnt(4)
 v_mfma_f32_16x16x32_bf16 v[104:107], a[108:111], v[200:203], v[104:107]
 v_mfma_f32_16x16x32_bf16 v[12:15], a[96:99], v[208:211], v[12:15]
 ds_read_b64_tr_b16 v[200:201], v195 offset:16896
 ds_read_b64_tr_b16 v[202:203], v195 offset:17920
 v_mfma_f32_16x16x32_bf16 v[12:15], a[112:115], v[212:215], v[12:15]
 s_add_u32 s82, s79, 5120
 v_mfma_f32_16x16x32_bf16 v[44:47], a[116:119], v[212:215], v[44:47]
 buffer_store_dwordx4 v[148:151], v251, s[52:55], s82 offen sc1
 v_mfma_f32_16x16x32_bf16 v[44:47], a[100:103], v[208:211], v[44:47]
 ds_read_b64_tr_b16 v[204:205], v195 offset:25088
 ds_read_b64_tr_b16 v[206:207], v195 offset:26112
 v_mfma_f32_16x16x32_bf16 v[76:79], a[104:107], v[208:211], v[76:79]
 v_mfma_f32_16x16x32_bf16 v[76:79], a[120:123], v[212:215], v[76:79]
 v_mfma_f32_16x16x32_bf16 v[108:111], a[124:127], v[212:215], v[108:111]
 s_waitcnt lgkmcnt(4)
 v_mfma_f32_16x16x32_bf16 v[108:111], a[108:111], v[208:211], v[108:111]
 buffer_load_dwordx4 a[36:39], v230, s[52:55], s81 offen offset:2048 sc1
 v_mfma_f32_16x16x32_bf16 v[16:19], a[96:99], v[216:219], v[16:19]
 ds_read_b64_tr_b16 v[208:209], v194 offset:17152
 ds_read_b64_tr_b16 v[210:211], v194 offset:18176
 v_mfma_f32_16x16x32_bf16 v[16:19], a[112:115], v[220:223], v[16:19]
 v_mfma_f32_16x16x32_bf16 v[48:51], a[116:119], v[220:223], v[48:51]
 v_mfma_f32_16x16x32_bf16 v[48:51], a[100:103], v[216:219], v[48:51]
 ds_read_b64_tr_b16 v[212:213], v194 offset:25344
 ds_read_b64_tr_b16 v[214:215], v194 offset:26368
 v_mfma_f32_16x16x32_bf16 v[80:83], a[104:107], v[216:219], v[80:83]
 buffer_load_dwordx4 v227, s[20:23], s75 offen offset:3072 lds
 v_mfma_f32_16x16x32_bf16 v[80:83], a[120:123], v[220:223], v[80:83]
 v_mfma_f32_16x16x32_bf16 v[112:115], a[124:127], v[220:223], v[112:115]
 s_waitcnt lgkmcnt(4)
 v_mfma_f32_16x16x32_bf16 v[112:115], a[108:111], v[216:219], v[112:115]
 v_mfma_f32_16x16x32_bf16 v[20:23], a[96:99], v[200:203], v[20:23]
 s_add_u32 s75, s75, 524288
 ds_read_b64_tr_b16 v[216:217], v195 offset:17152
 ds_read_b64_tr_b16 v[218:219], v195 offset:18176
 v_mfma_f32_16x16x32_bf16 v[20:23], a[112:115], v[204:207], v[20:23]
 s_bitset0_b32 s75, 22
 v_mfma_f32_16x16x32_bf16 v[52:55], a[116:119], v[204:207], v[52:55]
 buffer_load_dwordx4 a[40:43], v229, s[52:55], s80 offen offset:2048 sc1
 v_mfma_f32_16x16x32_bf16 v[52:55], a[100:103], v[200:203], v[52:55]
 ds_read_b64_tr_b16 v[220:221], v195 offset:25344
 ds_read_b64_tr_b16 v[222:223], v195 offset:26368
 v_mfma_f32_16x16x32_bf16 v[84:87], a[104:107], v[200:203], v[84:87]
 v_mfma_f32_16x16x32_bf16 v[84:87], a[120:123], v[204:207], v[84:87]
 v_mfma_f32_16x16x32_bf16 v[116:119], a[124:127], v[204:207], v[116:119]
 s_waitcnt lgkmcnt(4)
 v_mfma_f32_16x16x32_bf16 v[116:119], a[108:111], v[200:203], v[116:119]
 s_waitcnt vmcnt(13)
 v_mfma_f32_16x16x32_bf16 v[24:27], a[96:99], v[208:211], v[24:27]
 s_barrier
 ds_read_b64_tr_b16 v[200:201], v192 offset:0
 ds_read_b64_tr_b16 v[202:203], v192 offset:1024
 v_mfma_f32_16x16x32_bf16 v[24:27], a[112:115], v[212:215], v[24:27]
 buffer_load_dwordx4 a[44:47], v230, s[52:55], s80 offen offset:2048 sc1
 v_mfma_f32_16x16x32_bf16 v[56:59], a[116:119], v[212:215], v[56:59]
 v_mfma_f32_16x16x32_bf16 v[56:59], a[100:103], v[208:211], v[56:59]
 ds_read_b64_tr_b16 v[204:205], v192 offset:8192
 ds_read_b64_tr_b16 v[206:207], v192 offset:9216
 v_mfma_f32_16x16x32_bf16 v[88:91], a[104:107], v[208:211], v[88:91]
 s_add_u32 m0, s73, 98304
 v_mfma_f32_16x16x32_bf16 v[88:91], a[120:123], v[212:215], v[88:91]
 buffer_load_dwordx4 v224, s[20:23], s75 offen offset:0 lds
 v_mfma_f32_16x16x32_bf16 v[120:123], a[124:127], v[212:215], v[120:123]
 s_waitcnt lgkmcnt(4)
 v_mfma_f32_16x16x32_bf16 v[120:123], a[108:111], v[208:211], v[120:123]
 v_mfma_f32_16x16x32_bf16 v[28:31], a[96:99], v[216:219], v[28:31]
 ds_read_b64_tr_b16 v[208:209], v193 offset:0
 ds_read_b64_tr_b16 v[210:211], v193 offset:1024
 v_mfma_f32_16x16x32_bf16 v[28:31], a[112:115], v[220:223], v[28:31]
 s_add_u32 s82, s79, 9216
 v_mfma_f32_16x16x32_bf16 v[60:63], a[116:119], v[220:223], v[60:63]
 buffer_store_dwordx4 v[164:167], v251, s[52:55], s82 offen sc1
 v_mfma_f32_16x16x32_bf16 v[60:63], a[100:103], v[216:219], v[60:63]
 ds_read_b64_tr_b16 v[212:213], v193 offset:8192
 ds_read_b64_tr_b16 v[214:215], v193 offset:9216
 v_mfma_f32_16x16x32_bf16 v[92:95], a[104:107], v[216:219], v[92:95]
 v_mfma_f32_16x16x32_bf16 v[92:95], a[120:123], v[220:223], v[92:95]
 v_mfma_f32_16x16x32_bf16 v[124:127], a[124:127], v[220:223], v[124:127]
 s_waitcnt lgkmcnt(4)
 v_mfma_f32_16x16x32_bf16 v[124:127], a[108:111], v[216:219], v[124:127]
 buffer_load_dwordx4 a[48:51], v229, s[52:55], s81 offen offset:3072 sc1
 v_mfma_f32_16x16x32_bf16 v[0:3], a[128:131], v[200:203], v[0:3]
 ds_read_b64_tr_b16 v[216:217], v192 offset:256
 ds_read_b64_tr_b16 v[218:219], v192 offset:1280
 v_mfma_f32_16x16x32_bf16 v[0:3], a[144:147], v[204:207], v[0:3]
 v_mfma_f32_16x16x32_bf16 v[32:35], a[148:151], v[204:207], v[32:35]
 v_mfma_f32_16x16x32_bf16 v[32:35], a[132:135], v[200:203], v[32:35]
 ds_read_b64_tr_b16 v[220:221], v192 offset:8448
 ds_read_b64_tr_b16 v[222:223], v192 offset:9472
 v_mfma_f32_16x16x32_bf16 v[64:67], a[136:139], v[200:203], v[64:67]
 buffer_load_dwordx4 v225, s[20:23], s75 offen offset:1024 lds
 v_mfma_f32_16x16x32_bf16 v[64:67], a[152:155], v[204:207], v[64:67]
 v_mfma_f32_16x16x32_bf16 v[96:99], a[156:159], v[204:207], v[96:99]
 s_waitcnt lgkmcnt(4)
 v_mfma_f32_16x16x32_bf16 v[96:99], a[140:143], v[200:203], v[96:99]
 v_mfma_f32_16x16x32_bf16 v[4:7], a[128:131], v[208:211], v[4:7]
 ds_read_b64_tr_b16 v[200:201], v193 offset:256
 ds_read_b64_tr_b16 v[202:203], v193 offset:1280
 v_mfma_f32_16x16x32_bf16 v[4:7], a[144:147], v[212:215], v[4:7]
 buffer_load_dwordx4 a[52:55], v230, s[52:55], s81 offen offset:3072 sc1
 v_mfma_f32_16x16x32_bf16 v[36:39], a[148:151], v[212:215], v[36:39]
 v_mfma_f32_16x16x32_bf16 v[36:39], a[132:135], v[208:211], v[36:39]
 ds_read_b64_tr_b16 v[204:205], v193 offset:8448
 ds_read_b64_tr_b16 v[206:207], v193 offset:9472
 v_mfma_f32_16x16x32_bf16 v[68:71], a[136:139], v[208:211], v[68:71]
 s_add_u32 s82, s79, 13312
 v_mfma_f32_16x16x32_bf16 v[68:71], a[152:155], v[212:215], v[68:71]
 buffer_store_dwordx4 v[180:183], v251, s[52:55], s82 offen sc1
 v_mfma_f32_16x16x32_bf16 v[100:103], a[156:159], v[212:215], v[100:103]
 s_waitcnt lgkmcnt(4)
 v_mfma_f32_16x16x32_bf16 v[100:103], a[140:143], v[208:211], v[100:103]
 v_mfma_f32_16x16x32_bf16 v[8:11], a[128:131], v[216:219], v[8:11]
 ds_read_b64_tr_b16 v[208:209], v192 offset:512
 ds_read_b64_tr_b16 v[210:211], v192 offset:1536
 v_mfma_f32_16x16x32_bf16 v[8:11], a[144:147], v[220:223], v[8:11]
 v_mfma_f32_16x16x32_bf16 v[40:43], a[148:151], v[220:223], v[40:43]
 buffer_load_dwordx4 a[56:59], v229, s[52:55], s80 offen offset:3072 sc1
 v_mfma_f32_16x16x32_bf16 v[40:43], a[132:135], v[216:219], v[40:43]
 ds_read_b64_tr_b16 v[212:213], v192 offset:8704
 ds_read_b64_tr_b16 v[214:215], v192 offset:9728
 v_mfma_f32_16x16x32_bf16 v[72:75], a[136:139], v[216:219], v[72:75]
 v_mfma_f32_16x16x32_bf16 v[72:75], a[152:155], v[220:223], v[72:75]
 v_mfma_f32_16x16x32_bf16 v[104:107], a[156:159], v[220:223], v[104:107]
 s_waitcnt lgkmcnt(4)
 v_mfma_f32_16x16x32_bf16 v[104:107], a[140:143], v[216:219], v[104:107]
 buffer_load_dwordx4 v226, s[20:23], s75 offen offset:2048 lds
 v_mfma_f32_16x16x32_bf16 v[12:15], a[128:131], v[200:203], v[12:15]
 ds_read_b64_tr_b16 v[216:217], v193 offset:512
 ds_read_b64_tr_b16 v[218:219], v193 offset:1536
 v_mfma_f32_16x16x32_bf16 v[12:15], a[144:147], v[204:207], v[12:15]
 v_mfma_f32_16x16x32_bf16 v[44:47], a[148:151], v[204:207], v[44:47]
 v_mfma_f32_16x16x32_bf16 v[44:47], a[132:135], v[200:203], v[44:47]
 buffer_load_dwordx4 a[60:63], v230, s[52:55], s80 offen offset:3072 sc1
 v_mfma_f32_16x16x32_bf16 v[76:79], a[136:139], v[200:203], v[76:79]
 ds_read_b64_tr_b16 v[220:221], v193 offset:8704
 ds_read_b64_tr_b16 v[222:223], v193 offset:9728
 v_mfma_f32_16x16x32_bf16 v[76:79], a[152:155], v[204:207], v[76:79]
 v_mfma_f32_16x16x32_bf16 v[108:111], a[156:159], v[204:207], v[108:111]
 s_waitcnt lgkmcnt(4)
 v_mfma_f32_16x16x32_bf16 v[108:111], a[140:143], v[200:203], v[108:111]
 s_add_u32 s80, s80, 4096
 v_mfma_f32_16x16x32_bf16 v[16:19], a[128:131], v[208:211], v[16:19]
 s_add_u32 s81, s81, 4096
 ds_read_b64_tr_b16 v[200:201], v192 offset:768
 ds_read_b64_tr_b16 v[202:203], v192 offset:1792
 v_mfma_f32_16x16x32_bf16 v[16:19], a[144:147], v[212:215], v[16:19]
 s_bitset0_b32 s80, 14
 v_mfma_f32_16x16x32_bf16 v[48:51], a[148:151], v[212:215], v[48:51]
 s_bitset0_b32 s81, 14
 v_mfma_f32_16x16x32_bf16 v[48:51], a[132:135], v[208:211], v[48:51]
 s_add_u32 s82, s79, 2048
 ds_read_b64_tr_b16 v[204:205], v192 offset:8960
 ds_read_b64_tr_b16 v[206:207], v192 offset:9984
 buffer_store_dwordx4 v[136:139], v251, s[52:55], s82 offen sc1
 v_mfma_f32_16x16x32_bf16 v[80:83], a[136:139], v[208:211], v[80:83]
 v_mfma_f32_16x16x32_bf16 v[80:83], a[152:155], v[212:215], v[80:83]
 buffer_load_dwordx4 v227, s[20:23], s75 offen offset:3072 lds
 v_mfma_f32_16x16x32_bf16 v[112:115], a[156:159], v[212:215], v[112:115]
 s_waitcnt lgkmcnt(4)
 v_mfma_f32_16x16x32_bf16 v[112:115], a[140:143], v[208:211], v[112:115]
 v_mfma_f32_16x16x32_bf16 v[20:23], a[128:131], v[216:219], v[20:23]
 ds_read_b64_tr_b16 v[208:209], v193 offset:768
 ds_read_b64_tr_b16 v[210:211], v193 offset:1792
 v_mfma_f32_16x16x32_bf16 v[20:23], a[144:147], v[220:223], v[20:23]
 s_add_u32 s75, s75, 524288
 v_mfma_f32_16x16x32_bf16 v[52:55], a[148:151], v[220:223], v[52:55]
 s_bitset0_b32 s75, 22
 v_mfma_f32_16x16x32_bf16 v[52:55], a[132:135], v[216:219], v[52:55]
 buffer_load_dwordx4 a[64:67], v229, s[52:55], s81 offen offset:0 sc1
 v_mfma_f32_16x16x32_bf16 v[84:87], a[136:139], v[216:219], v[84:87]
 ds_read_b64_tr_b16 v[212:213], v193 offset:8960
 ds_read_b64_tr_b16 v[214:215], v193 offset:9984
 v_mfma_f32_16x16x32_bf16 v[84:87], a[152:155], v[220:223], v[84:87]
 v_mfma_f32_16x16x32_bf16 v[116:119], a[156:159], v[220:223], v[116:119]
 s_waitcnt lgkmcnt(4)
 v_mfma_f32_16x16x32_bf16 v[116:119], a[140:143], v[216:219], v[116:119]
 s_waitcnt vmcnt(14)
 v_mfma_f32_16x16x32_bf16 v[24:27], a[128:131], v[200:203], v[24:27]
 s_barrier
 ds_read_b64_tr_b16 v[216:217], v192 offset:16384
 ds_read_b64_tr_b16 v[218:219], v192 offset:17408
 v_mfma_f32_16x16x32_bf16 v[24:27], a[144:147], v[204:207], v[24:27]
 buffer_load_dwordx4 a[68:71], v230, s[52:55], s81 offen offset:0 sc1
 v_mfma_f32_16x16x32_bf16 v[56:59], a[148:151], v[204:207], v[56:59]
 v_mfma_f32_16x16x32_bf16 v[56:59], a[132:135], v[200:203], v[56:59]
 ds_read_b64_tr_b16 v[220:221], v192 offset:24576
 ds_read_b64_tr_b16 v[222:223], v192 offset:25600
 v_mfma_f32_16x16x32_bf16 v[88:91], a[136:139], v[200:203], v[88:91]
 v_mfma_f32_16x16x32_bf16 v[88:91], a[152:155], v[204:207], v[88:91]
 s_add_u32 m0, s73, 114688
 v_mfma_f32_16x16x32_bf16 v[120:123], a[156:159], v[204:207], v[120:123]
 buffer_load_dwordx4 v224, s[20:23], s75 offen offset:0 lds
 v_mfma_f32_16x16x32_bf16 v[120:123], a[140:143], v[200:203], v[120:123]
 s_waitcnt lgkmcnt(4)
 v_mfma_f32_16x16x32_bf16 v[28:31], a[128:131], v[208:211], v[28:31]
 ds_read_b64_tr_b16 v[200:201], v193 offset:16384
 ds_read_b64_tr_b16 v[202:203], v193 offset:17408
 v_mfma_f32_16x16x32_bf16 v[28:31], a[144:147], v[212:215], v[28:31]
 v_mfma_f32_16x16x32_bf16 v[60:63], a[148:151], v[212:215], v[60:63]
 s_add_u32 s82, s79, 6144
 v_mfma_f32_16x16x32_bf16 v[60:63], a[132:135], v[208:211], v[60:63]
 buffer_store_dwordx4 v[152:155], v251, s[52:55], s82 offen sc1
 v_mfma_f32_16x16x32_bf16 v[92:95], a[136:139], v[208:211], v[92:95]
 ds_read_b64_tr_b16 v[204:205], v193 offset:24576
 ds_read_b64_tr_b16 v[206:207], v193 offset:25600
 v_mfma_f32_16x16x32_bf16 v[92:95], a[152:155], v[212:215], v[92:95]
 v_mfma_f32_16x16x32_bf16 v[124:127], a[156:159], v[212:215], v[124:127]
 s_waitcnt lgkmcnt(4)
 v_mfma_f32_16x16x32_bf16 v[124:127], a[140:143], v[208:211], v[124:127]
 v_mfma_f32_16x16x32_bf16 v[0:3], a[160:163], v[216:219], v[0:3]
 ds_read_b64_tr_b16 v[208:209], v192 offset:16640
 ds_read_b64_tr_b16 v[210:211], v192 offset:17664
 v_mfma_f32_16x16x32_bf16 v[0:3], a[176:179], v[220:223], v[0:3]
 buffer_load_dwordx4 a[72:75], v229, s[52:55], s80 offen offset:0 sc1
 v_mfma_f32_16x16x32_bf16 v[32:35], a[180:183], v[220:223], v[32:35]
 v_mfma_f32_16x16x32_bf16 v[32:35], a[164:167], v[216:219], v[32:35]
 ds_read_b64_tr_b16 v[212:213], v192 offset:24832
 ds_read_b64_tr_b16 v[214:215], v192 offset:25856
 v_mfma_f32_16x16x32_bf16 v[64:67], a[168:171], v[216:219], v[64:67]
 v_mfma_f32_16x16x32_bf16 v[64:67], a[184:187], v[220:223], v[64:67]
 buffer_load_dwordx4 v225, s[20:23], s75 offen offset:1024 lds
 v_mfma_f32_16x16x32_bf16 v[96:99], a[188:191], v[220:223], v[96:99]
 s_waitcnt lgkmcnt(4)
 v_mfma_f32_16x16x32_bf16 v[96:99], a[172:175], v[216:219], v[96:99]
 v_mfma_f32_16x16x32_bf16 v[4:7], a[160:163], v[200:203], v[4:7]
 ds_read_b64_tr_b16 v[216:217], v193 offset:16640
 ds_read_b64_tr_b16 v[218:219], v193 offset:17664
 v_mfma_f32_16x16x32_bf16 v[4:7], a[176:179], v[204:207], v[4:7]
 v_mfma_f32_16x16x32_bf16 v[36:39], a[180:183], v[204:207], v[36:39]
 buffer_load_dwordx4 a[76:79], v230, s[52:55], s80 offen offset:0 sc1
 v_mfma_f32_16x16x32_bf16 v[36:39], a[164:167], v[200:203], v[36:39]
 ds_read_b64_tr_b16 v[220:221], v193 offset:24832
 ds_read_b64_tr_b16 v[222:223], v193 offset:25856
 v_mfma_f32_16x16x32_bf16 v[68:71], a[168:171], v[200:203], v[68:71]
 v_mfma_f32_16x16x32_bf16 v[68:71], a[184:187], v[204:207], v[68:71]
 v_mfma_f32_16x16x32_bf16 v[100:103], a[188:191], v[204:207], v[100:103]
 s_waitcnt lgkmcnt(4)
 v_mfma_f32_16x16x32_bf16 v[100:103], a[172:175], v[200:203], v[100:103]
 buffer_load_dwordx4 a[80:83], v229, s[52:55], s81 offen offset:1024 sc1
 v_mfma_f32_16x16x32_bf16 v[8:11], a[160:163], v[208:211], v[8:11]
 ds_read_b64_tr_b16 v[200:201], v192 offset:16896
 ds_read_b64_tr_b16 v[202:203], v192 offset:17920
 v_mfma_f32_16x16x32_bf16 v[8:11], a[176:179], v[212:215], v[8:11]
 v_mfma_f32_16x16x32_bf16 v[40:43], a[180:183], v[212:215], v[40:43]
 v_mfma_f32_16x16x32_bf16 v[40:43], a[164:167], v[208:211], v[40:43]
 ds_read_b64_tr_b16 v[204:205], v192 offset:25088
 ds_read_b64_tr_b16 v[206:207], v192 offset:26112
 v_mfma_f32_16x16x32_bf16 v[72:75], a[168:171], v[208:211], v[72:75]
 v_mfma_f32_16x16x32_bf16 v[72:75], a[184:187], v[212:215], v[72:75]
 buffer_load_dwordx4 v226, s[20:23], s75 offen offset:2048 lds
 v_mfma_f32_16x16x32_bf16 v[104:107], a[188:191], v[212:215], v[104:107]
 s_waitcnt lgkmcnt(4)
 v_mfma_f32_16x16x32_bf16 v[104:107], a[172:175], v[208:211], v[104:107]
 v_mfma_f32_16x16x32_bf16 v[12:15], a[160:163], v[216:219], v[12:15]
 ds_read_b64_tr_b16 v[208:209], v193 offset:16896
 ds_read_b64_tr_b16 v[210:211], v193 offset:17920
 v_mfma_f32_16x16x32_bf16 v[12:15], a[176:179], v[220:223], v[12:15]
 s_add_u32 s82, s79, 10240
 v_mfma_f32_16x16x32_bf16 v[44:47], a[180:183], v[220:223], v[44:47]
 buffer_store_dwordx4 v[168:171], v251, s[52:55], s82 offen sc1
 v_mfma_f32_16x16x32_bf16 v[44:47], a[164:167], v[216:219], v[44:47]
 ds_read_b64_tr_b16 v[212:213], v193 offset:25088
 ds_read_b64_tr_b16 v[214:215], v193 offset:26112
 v_mfma_f32_16x16x32_bf16 v[76:79], a[168:171], v[216:219], v[76:79]
 v_mfma_f32_16x16x32_bf16 v[76:79], a[184:187], v[220:223], v[76:79]
 v_mfma_f32_16x16x32_bf16 v[108:111], a[188:191], v[220:223], v[108:111]
 s_waitcnt lgkmcnt(4)
 v_mfma_f32_16x16x32_bf16 v[108:111], a[172:175], v[216:219], v[108:111]
 buffer_load_dwordx4 a[84:87], v230, s[52:55], s81 offen offset:1024 sc1
 v_mfma_f32_16x16x32_bf16 v[16:19], a[160:163], v[200:203], v[16:19]
 ds_read_b64_tr_b16 v[216:217], v192 offset:17152
 ds_read_b64_tr_b16 v[218:219], v192 offset:18176
 v_mfma_f32_16x16x32_bf16 v[16:19], a[176:179], v[204:207], v[16:19]
 v_mfma_f32_16x16x32_bf16 v[48:51], a[180:183], v[204:207], v[48:51]
 v_mfma_f32_16x16x32_bf16 v[48:51], a[164:167], v[200:203], v[48:51]
 ds_read_b64_tr_b16 v[220:221], v192 offset:25344
 ds_read_b64_tr_b16 v[222:223], v192 offset:26368
 v_mfma_f32_16x16x32_bf16 v[80:83], a[168:171], v[200:203], v[80:83]
 buffer_load_dwordx4 v227, s[20:23], s75 offen offset:3072 lds
 v_mfma_f32_16x16x32_bf16 v[80:83], a[184:187], v[204:207], v[80:83]
 v_mfma_f32_16x16x32_bf16 v[112:115], a[188:191], v[204:207], v[112:115]
 s_waitcnt lgkmcnt(4)
 v_mfma_f32_16x16x32_bf16 v[112:115], a[172:175], v[200:203], v[112:115]
 v_mfma_f32_16x16x32_bf16 v[20:23], a[160:163], v[208:211], v[20:23]
 s_add_u32 s75, s75, 524288
 ds_read_b64_tr_b16 v[200:201], v193 offset:17152
 ds_read_b64_tr_b16 v[202:203], v193 offset:18176
 v_mfma_f32_16x16x32_bf16 v[20:23], a[176:179], v[212:215], v[20:23]
 s_bitset0_b32 s75, 22
 v_mfma_f32_16x16x32_bf16 v[52:55], a[180:183], v[212:215], v[52:55]
 buffer_load_dwordx4 a[88:91], v229, s[52:55], s80 offen offset:1024 sc1
 v_mfma_f32_16x16x32_bf16 v[52:55], a[164:167], v[208:211], v[52:55]
 ds_read_b64_tr_b16 v[204:205], v193 offset:25344
 ds_read_b64_tr_b16 v[206:207], v193 offset:26368
 v_mfma_f32_16x16x32_bf16 v[84:87], a[168:171], v[208:211], v[84:87]
 v_mfma_f32_16x16x32_bf16 v[84:87], a[184:187], v[212:215], v[84:87]
 v_mfma_f32_16x16x32_bf16 v[116:119], a[188:191], v[212:215], v[116:119]
 s_waitcnt lgkmcnt(4)
 v_mfma_f32_16x16x32_bf16 v[116:119], a[172:175], v[208:211], v[116:119]
 s_waitcnt vmcnt(13)
 v_mfma_f32_16x16x32_bf16 v[24:27], a[160:163], v[216:219], v[24:27]
 s_barrier
 ds_read_b64_tr_b16 v[208:209], v194 offset:0
 ds_read_b64_tr_b16 v[210:211], v194 offset:1024
 v_mfma_f32_16x16x32_bf16 v[24:27], a[176:179], v[220:223], v[24:27]
 buffer_load_dwordx4 a[92:95], v230, s[52:55], s80 offen offset:1024 sc1
 v_mfma_f32_16x16x32_bf16 v[56:59], a[180:183], v[220:223], v[56:59]
 v_mfma_f32_16x16x32_bf16 v[56:59], a[164:167], v[216:219], v[56:59]
 ds_read_b64_tr_b16 v[212:213], v194 offset:8192
 ds_read_b64_tr_b16 v[214:215], v194 offset:9216
 v_mfma_f32_16x16x32_bf16 v[88:91], a[168:171], v[216:219], v[88:91]
 v_mfma_f32_16x16x32_bf16 v[88:91], a[184:187], v[220:223], v[88:91]
 s_add_u32 m0, s73, 0
 v_mfma_f32_16x16x32_bf16 v[120:123], a[188:191], v[220:223], v[120:123]
 buffer_load_dwordx4 v224, s[12:15], s75 offen offset:0 lds
 v_mfma_f32_16x16x32_bf16 v[120:123], a[172:175], v[216:219], v[120:123]
 s_waitcnt lgkmcnt(4)
 v_mfma_f32_16x16x32_bf16 v[28:31], a[160:163], v[200:203], v[28:31]
 ds_read_b64_tr_b16 v[216:217], v195 offset:0
 ds_read_b64_tr_b16 v[218:219], v195 offset:1024
 v_mfma_f32_16x16x32_bf16 v[28:31], a[176:179], v[204:207], v[28:31]
 v_mfma_f32_16x16x32_bf16 v[60:63], a[180:183], v[204:207], v[60:63]
 s_add_u32 s82, s79, 14336
 v_mfma_f32_16x16x32_bf16 v[60:63], a[164:167], v[200:203], v[60:63]
 buffer_store_dwordx4 v[184:187], v251, s[52:55], s82 offen sc1
 v_mfma_f32_16x16x32_bf16 v[92:95], a[168:171], v[200:203], v[92:95]
 ds_read_b64_tr_b16 v[220:221], v195 offset:8192
 ds_read_b64_tr_b16 v[222:223], v195 offset:9216
 v_mfma_f32_16x16x32_bf16 v[92:95], a[184:187], v[204:207], v[92:95]
 v_mfma_f32_16x16x32_bf16 v[124:127], a[188:191], v[204:207], v[124:127]
 s_waitcnt lgkmcnt(4)
 v_mfma_f32_16x16x32_bf16 v[124:127], a[172:175], v[200:203], v[124:127]
 v_mfma_f32_16x16x32_bf16 v[0:3], a[192:195], v[208:211], v[0:3]
 ds_read_b64_tr_b16 v[200:201], v194 offset:256
 ds_read_b64_tr_b16 v[202:203], v194 offset:1280
 v_mfma_f32_16x16x32_bf16 v[0:3], a[208:211], v[212:215], v[0:3]
 buffer_load_dwordx4 a[96:99], v229, s[52:55], s81 offen offset:2048 sc1
 v_mfma_f32_16x16x32_bf16 v[32:35], a[212:215], v[212:215], v[32:35]
 v_mfma_f32_16x16x32_bf16 v[32:35], a[196:199], v[208:211], v[32:35]
 ds_read_b64_tr_b16 v[204:205], v194 offset:8448
 ds_read_b64_tr_b16 v[206:207], v194 offset:9472
 v_mfma_f32_16x16x32_bf16 v[64:67], a[200:203], v[208:211], v[64:67]
 v_mfma_f32_16x16x32_bf16 v[64:67], a[216:219], v[212:215], v[64:67]
 buffer_load_dwordx4 v225, s[12:15], s75 offen offset:1024 lds
 v_mfma_f32_16x16x32_bf16 v[96:99], a[220:223], v[212:215], v[96:99]
 s_waitcnt lgkmcnt(4)
 v_mfma_f32_16x16x32_bf16 v[96:99], a[204:207], v[208:211], v[96:99]
 v_mfma_f32_16x16x32_bf16 v[4:7], a[192:195], v[216:219], v[4:7]
 ds_read_b64_tr_b16 v[208:209], v195 offset:256
 ds_read_b64_tr_b16 v[210:211], v195 offset:1280
 v_mfma_f32_16x16x32_bf16 v[4:7], a[208:211], v[220:223], v[4:7]
 v_mfma_f32_16x16x32_bf16 v[36:39], a[212:215], v[220:223], v[36:39]
 buffer_load_dwordx4 a[100:103], v230, s[52:55], s81 offen offset:2048 sc1
 v_mfma_f32_16x16x32_bf16 v[36:39], a[196:199], v[216:219], v[36:39]
 ds_read_b64_tr_b16 v[212:213], v195 offset:8448
 ds_read_b64_tr_b16 v[214:215], v195 offset:9472
 v_mfma_f32_16x16x32_bf16 v[68:71], a[200:203], v[216:219], v[68:71]
 v_mfma_f32_16x16x32_bf16 v[68:71], a[216:219], v[220:223], v[68:71]
 v_mfma_f32_16x16x32_bf16 v[100:103], a[220:223], v[220:223], v[100:103]
 s_waitcnt lgkmcnt(4)
 v_mfma_f32_16x16x32_bf16 v[100:103], a[204:207], v[216:219], v[100:103]
 buffer_load_dwordx4 a[104:107], v229, s[52:55], s80 offen offset:2048 sc1
 v_mfma_f32_16x16x32_bf16 v[8:11], a[192:195], v[200:203], v[8:11]
 ds_read_b64_tr_b16 v[216:217], v194 offset:512
 ds_read_b64_tr_b16 v[218:219], v194 offset:1536
 v_mfma_f32_16x16x32_bf16 v[8:11], a[208:211], v[204:207], v[8:11]
 v_mfma_f32_16x16x32_bf16 v[40:43], a[212:215], v[204:207], v[40:43]
 v_mfma_f32_16x16x32_bf16 v[40:43], a[196:199], v[200:203], v[40:43]
 ds_read_b64_tr_b16 v[220:221], v194 offset:8704
 ds_read_b64_tr_b16 v[222:223], v194 offset:9728
 v_mfma_f32_16x16x32_bf16 v[72:75], a[200:203], v[200:203], v[72:75]
 v_mfma_f32_16x16x32_bf16 v[72:75], a[216:219], v[204:207], v[72:75]
 buffer_load_dwordx4 v226, s[12:15], s75 offen offset:2048 lds
 v_mfma_f32_16x16x32_bf16 v[104:107], a[220:223], v[204:207], v[104:107]
 s_waitcnt lgkmcnt(4)
 v_mfma_f32_16x16x32_bf16 v[104:107], a[204:207], v[200:203], v[104:107]
 v_mfma_f32_16x16x32_bf16 v[12:15], a[192:195], v[208:211], v[12:15]
 ds_read_b64_tr_b16 v[200:201], v195 offset:512
 ds_read_b64_tr_b16 v[202:203], v195 offset:1536
 v_mfma_f32_16x16x32_bf16 v[12:15], a[208:211], v[212:215], v[12:15]
 s_add_u32 s82, s79, 3072
 v_mfma_f32_16x16x32_bf16 v[44:47], a[212:215], v[212:215], v[44:47]
 buffer_store_dwordx4 v[140:143], v251, s[52:55], s82 offen sc1
 v_mfma_f32_16x16x32_bf16 v[44:47], a[196:199], v[208:211], v[44:47]
 ds_read_b64_tr_b16 v[204:205], v195 offset:8704
 ds_read_b64_tr_b16 v[206:207], v195 offset:9728
 v_mfma_f32_16x16x32_bf16 v[76:79], a[200:203], v[208:211], v[76:79]
 v_mfma_f32_16x16x32_bf16 v[76:79], a[216:219], v[212:215], v[76:79]
 v_mfma_f32_16x16x32_bf16 v[108:111], a[220:223], v[212:215], v[108:111]
 s_waitcnt lgkmcnt(4)
 v_mfma_f32_16x16x32_bf16 v[108:111], a[204:207], v[208:211], v[108:111]
 buffer_load_dwordx4 a[108:111], v230, s[52:55], s80 offen offset:2048 sc1
 v_mfma_f32_16x16x32_bf16 v[16:19], a[192:195], v[216:219], v[16:19]
 ds_read_b64_tr_b16 v[208:209], v194 offset:768
 ds_read_b64_tr_b16 v[210:211], v194 offset:1792
 v_mfma_f32_16x16x32_bf16 v[16:19], a[208:211], v[220:223], v[16:19]
 v_mfma_f32_16x16x32_bf16 v[48:51], a[212:215], v[220:223], v[48:51]
 v_mfma_f32_16x16x32_bf16 v[48:51], a[196:199], v[216:219], v[48:51]
 ds_read_b64_tr_b16 v[212:213], v194 offset:8960
 ds_read_b64_tr_b16 v[214:215], v194 offset:9984
 v_mfma_f32_16x16x32_bf16 v[80:83], a[200:203], v[216:219], v[80:83]
 buffer_load_dwordx4 v227, s[12:15], s75 offen offset:3072 lds
 v_mfma_f32_16x16x32_bf16 v[80:83], a[216:219], v[220:223], v[80:83]
 v_mfma_f32_16x16x32_bf16 v[112:115], a[220:223], v[220:223], v[112:115]
 s_waitcnt lgkmcnt(4)
 v_mfma_f32_16x16x32_bf16 v[112:115], a[204:207], v[216:219], v[112:115]
 v_mfma_f32_16x16x32_bf16 v[20:23], a[192:195], v[200:203], v[20:23]
 s_add_u32 s75, s75, 524288
 ds_read_b64_tr_b16 v[216:217], v195 offset:768
 ds_read_b64_tr_b16 v[218:219], v195 offset:1792
 v_mfma_f32_16x16x32_bf16 v[20:23], a[208:211], v[204:207], v[20:23]
 s_bitset0_b32 s75, 22
 v_mfma_f32_16x16x32_bf16 v[52:55], a[212:215], v[204:207], v[52:55]
 buffer_load_dwordx4 a[112:115], v229, s[52:55], s81 offen offset:3072 sc1
 v_mfma_f32_16x16x32_bf16 v[52:55], a[196:199], v[200:203], v[52:55]
 ds_read_b64_tr_b16 v[220:221], v195 offset:8960
 ds_read_b64_tr_b16 v[222:223], v195 offset:9984
 v_mfma_f32_16x16x32_bf16 v[84:87], a[200:203], v[200:203], v[84:87]
 v_mfma_f32_16x16x32_bf16 v[84:87], a[216:219], v[204:207], v[84:87]
 v_mfma_f32_16x16x32_bf16 v[116:119], a[220:223], v[204:207], v[116:119]
 s_waitcnt lgkmcnt(4)
 v_mfma_f32_16x16x32_bf16 v[116:119], a[204:207], v[200:203], v[116:119]
 s_waitcnt vmcnt(13)
 v_mfma_f32_16x16x32_bf16 v[24:27], a[192:195], v[208:211], v[24:27]
 s_barrier
 ds_read_b64_tr_b16 v[200:201], v194 offset:16384
 ds_read_b64_tr_b16 v[202:203], v194 offset:17408
 v_mfma_f32_16x16x32_bf16 v[24:27], a[208:211], v[212:215], v[24:27]
 buffer_load_dwordx4 a[116:119], v230, s[52:55], s81 offen offset:3072 sc1
 v_mfma_f32_16x16x32_bf16 v[56:59], a[212:215], v[212:215], v[56:59]
 v_mfma_f32_16x16x32_bf16 v[56:59], a[196:199], v[208:211], v[56:59]
 ds_read_b64_tr_b16 v[204:205], v194 offset:24576
 ds_read_b64_tr_b16 v[206:207], v194 offset:25600
 v_mfma_f32_16x16x32_bf16 v[88:91], a[200:203], v[208:211], v[88:91]
 v_mfma_f32_16x16x32_bf16 v[88:91], a[216:219], v[212:215], v[88:91]
 s_add_u32 m0, s73, 16384
 v_mfma_f32_16x16x32_bf16 v[120:123], a[220:223], v[212:215], v[120:123]
 buffer_load_dwordx4 v224, s[12:15], s75 offen offset:0 lds
 v_mfma_f32_16x16x32_bf16 v[120:123], a[204:207], v[208:211], v[120:123]
 s_waitcnt lgkmcnt(4)
 v_mfma_f32_16x16x32_bf16 v[28:31], a[192:195], v[216:219], v[28:31]
 ds_read_b64_tr_b16 v[208:209], v195 offset:16384
 ds_read_b64_tr_b16 v[210:211], v195 offset:17408
 v_mfma_f32_16x16x32_bf16 v[28:31], a[208:211], v[220:223], v[28:31]
 v_mfma_f32_16x16x32_bf16 v[60:63], a[212:215], v[220:223], v[60:63]
 s_add_u32 s82, s79, 7168
 v_mfma_f32_16x16x32_bf16 v[60:63], a[196:199], v[216:219], v[60:63]
 buffer_store_dwordx4 v[156:159], v251, s[52:55], s82 offen sc1
 v_mfma_f32_16x16x32_bf16 v[92:95], a[200:203], v[216:219], v[92:95]
 ds_read_b64_tr_b16 v[212:213], v195 offset:24576
 ds_read_b64_tr_b16 v[214:215], v195 offset:25600
 v_mfma_f32_16x16x32_bf16 v[92:95], a[216:219], v[220:223], v[92:95]
 v_mfma_f32_16x16x32_bf16 v[124:127], a[220:223], v[220:223], v[124:127]
 s_waitcnt lgkmcnt(4)
 v_mfma_f32_16x16x32_bf16 v[124:127], a[204:207], v[216:219], v[124:127]
 v_mfma_f32_16x16x32_bf16 v[0:3], a[224:227], v[200:203], v[0:3]
 ds_read_b64_tr_b16 v[216:217], v194 offset:16640
 ds_read_b64_tr_b16 v[218:219], v194 offset:17664
 v_mfma_f32_16x16x32_bf16 v[0:3], a[240:243], v[204:207], v[0:3]
 buffer_load_dwordx4 a[120:123], v229, s[52:55], s80 offen offset:3072 sc1
 v_mfma_f32_16x16x32_bf16 v[32:35], a[244:247], v[204:207], v[32:35]
 v_mfma_f32_16x16x32_bf16 v[32:35], a[228:231], v[200:203], v[32:35]
 ds_read_b64_tr_b16 v[220:221], v194 offset:24832
 ds_read_b64_tr_b16 v[222:223], v194 offset:25856
 v_mfma_f32_16x16x32_bf16 v[64:67], a[232:235], v[200:203], v[64:67]
 v_mfma_f32_16x16x32_bf16 v[64:67], a[248:251], v[204:207], v[64:67]
 buffer_load_dwordx4 v225, s[12:15], s75 offen offset:1024 lds
 v_mfma_f32_16x16x32_bf16 v[96:99], a[252:255], v[204:207], v[96:99]
 s_waitcnt lgkmcnt(4)
 v_mfma_f32_16x16x32_bf16 v[96:99], a[236:239], v[200:203], v[96:99]
 v_mfma_f32_16x16x32_bf16 v[4:7], a[224:227], v[208:211], v[4:7]
 ds_read_b64_tr_b16 v[200:201], v195 offset:16640
 ds_read_b64_tr_b16 v[202:203], v195 offset:17664
 v_mfma_f32_16x16x32_bf16 v[4:7], a[240:243], v[212:215], v[4:7]
 s_add_u32 s82, s79, 11264
 v_mfma_f32_16x16x32_bf16 v[36:39], a[244:247], v[212:215], v[36:39]
 buffer_store_dwordx4 v[172:175], v251, s[52:55], s82 offen sc1
 v_mfma_f32_16x16x32_bf16 v[36:39], a[228:231], v[208:211], v[36:39]
 ds_read_b64_tr_b16 v[204:205], v195 offset:24832
 ds_read_b64_tr_b16 v[206:207], v195 offset:25856
 v_mfma_f32_16x16x32_bf16 v[68:71], a[232:235], v[208:211], v[68:71]
 v_mfma_f32_16x16x32_bf16 v[68:71], a[248:251], v[212:215], v[68:71]
 v_mfma_f32_16x16x32_bf16 v[100:103], a[252:255], v[212:215], v[100:103]
 s_waitcnt lgkmcnt(4)
 v_mfma_f32_16x16x32_bf16 v[100:103], a[236:239], v[208:211], v[100:103]
 buffer_load_dwordx4 a[124:127], v230, s[52:55], s80 offen offset:3072 sc1
 v_mfma_f32_16x16x32_bf16 v[8:11], a[224:227], v[216:219], v[8:11]
 ds_read_b64_tr_b16 v[208:209], v194 offset:16896
 ds_read_b64_tr_b16 v[210:211], v194 offset:17920
 v_mfma_f32_16x16x32_bf16 v[8:11], a[240:243], v[220:223], v[8:11]
 v_mfma_f32_16x16x32_bf16 v[40:43], a[244:247], v[220:223], v[40:43]
 v_mfma_f32_16x16x32_bf16 v[40:43], a[228:231], v[216:219], v[40:43]
 ds_read_b64_tr_b16 v[212:213], v194 offset:25088
 ds_read_b64_tr_b16 v[214:215], v194 offset:26112
 v_mfma_f32_16x16x32_bf16 v[72:75], a[232:235], v[216:219], v[72:75]
 s_add_u32 s80, s80, 4096
 v_mfma_f32_16x16x32_bf16 v[72:75], a[248:251], v[220:223], v[72:75]
 s_add_u32 s81, s81, 4096
 v_mfma_f32_16x16x32_bf16 v[104:107], a[252:255], v[220:223], v[104:107]
 s_bitset0_b32 s80, 14
 v_mfma_f32_16x16x32_bf16 v[104:107], a[236:239], v[216:219], v[104:107]
 s_waitcnt lgkmcnt(4)
 v_mfma_f32_16x16x32_bf16 v[12:15], a[224:227], v[200:203], v[12:15]
 s_bitset0_b32 s81, 14
 ds_read_b64_tr_b16 v[216:217], v195 offset:16896
 ds_read_b64_tr_b16 v[218:219], v195 offset:17920
 buffer_load_dwordx4 v226, s[12:15], s75 offen offset:2048 lds
 v_mfma_f32_16x16x32_bf16 v[12:15], a[240:243], v[204:207], v[12:15]
 v_mfma_f32_16x16x32_bf16 v[44:47], a[244:247], v[204:207], v[44:47]
 buffer_load_dwordx4 a[128:131], v229, s[52:55], s81 offen offset:0 sc1
 v_mfma_f32_16x16x32_bf16 v[44:47], a[228:231], v[200:203], v[44:47]
 ds_read_b64_tr_b16 v[220:221], v195 offset:25088
 ds_read_b64_tr_b16 v[222:223], v195 offset:26112
 v_mfma_f32_16x16x32_bf16 v[76:79], a[232:235], v[200:203], v[76:79]
 v_mfma_f32_16x16x32_bf16 v[76:79], a[248:251], v[204:207], v[76:79]
 v_mfma_f32_16x16x32_bf16 v[108:111], a[252:255], v[204:207], v[108:111]
 s_waitcnt lgkmcnt(4)
 v_mfma_f32_16x16x32_bf16 v[108:111], a[236:239], v[200:203], v[108:111]
 s_add_u32 s82, s79, 15360
 v_mfma_f32_16x16x32_bf16 v[16:19], a[224:227], v[208:211], v[16:19]
 buffer_store_dwordx4 v[188:191], v251, s[52:55], s82 offen sc1
 v_mfma_f32_16x16x32_bf16 v[16:19], a[240:243], v[212:215], v[16:19]
 ds_read_b64_tr_b16 v[200:201], v194 offset:17152
 ds_read_b64_tr_b16 v[202:203], v194 offset:18176
 v_mfma_f32_16x16x32_bf16 v[48:51], a[244:247], v[212:215], v[48:51]
 v_mfma_f32_16x16x32_bf16 v[48:51], a[228:231], v[208:211], v[48:51]
 ds_read_b64_tr_b16 v[204:205], v194 offset:25344
 ds_read_b64_tr_b16 v[206:207], v194 offset:26368
 v_mfma_f32_16x16x32_bf16 v[80:83], a[232:235], v[208:211], v[80:83]
 buffer_load_dwordx4 v227, s[12:15], s75 offen offset:3072 lds
 v_mfma_f32_16x16x32_bf16 v[80:83], a[248:251], v[212:215], v[80:83]
 v_mfma_f32_16x16x32_bf16 v[112:115], a[252:255], v[212:215], v[112:115]
 s_waitcnt lgkmcnt(4)
 v_mfma_f32_16x16x32_bf16 v[112:115], a[236:239], v[208:211], v[112:115]
 v_mfma_f32_16x16x32_bf16 v[20:23], a[224:227], v[216:219], v[20:23]
 s_add_u32 s75, s75, 524288
 ds_read_b64_tr_b16 v[208:209], v195 offset:17152
 ds_read_b64_tr_b16 v[210:211], v195 offset:18176
 v_mfma_f32_16x16x32_bf16 v[20:23], a[240:243], v[220:223], v[20:23]
 s_bitset0_b32 s75, 22
 v_mfma_f32_16x16x32_bf16 v[52:55], a[244:247], v[220:223], v[52:55]
 buffer_load_dwordx4 a[132:135], v230, s[52:55], s81 offen offset:0 sc1
 v_mfma_f32_16x16x32_bf16 v[52:55], a[228:231], v[216:219], v[52:55]
 ds_read_b64_tr_b16 v[212:213], v195 offset:25344
 ds_read_b64_tr_b16 v[214:215], v195 offset:26368
 v_mfma_f32_16x16x32_bf16 v[84:87], a[232:235], v[216:219], v[84:87]
 v_mfma_f32_16x16x32_bf16 v[84:87], a[248:251], v[220:223], v[84:87]
 v_mfma_f32_16x16x32_bf16 v[116:119], a[252:255], v[220:223], v[116:119]
 s_waitcnt lgkmcnt(4)
 v_mfma_f32_16x16x32_bf16 v[116:119], a[236:239], v[216:219], v[116:119]
 s_waitcnt vmcnt(13)
 v_mfma_f32_16x16x32_bf16 v[24:27], a[224:227], v[200:203], v[24:27]
 s_barrier
 ds_read_b64_tr_b16 v[216:217], v192 offset:0
 ds_read_b64_tr_b16 v[218:219], v192 offset:1024
 v_mfma_f32_16x16x32_bf16 v[24:27], a[240:243], v[204:207], v[24:27]
 buffer_load_dwordx4 a[136:139], v229, s[52:55], s80 offen offset:0 sc1
 v_mfma_f32_16x16x32_bf16 v[56:59], a[244:247], v[204:207], v[56:59]
 v_cvt_pk_bf16_f32 v128, v0, v1
 v_cvt_pk_bf16_f32 v129, v2, v3
 v_mfma_f32_16x16x32_bf16 v[56:59], a[228:231], v[200:203], v[56:59]
 v_cvt_pk_bf16_f32 v130, v32, v33
 v_cvt_pk_bf16_f32 v131, v34, v35
 v_mfma_f32_16x16x32_bf16 v[88:91], a[232:235], v[200:203], v[88:91]
 ds_read_b64_tr_b16 v[220:221], v192 offset:8192
 v_cvt_pk_bf16_f32 v160, v64, v65
 v_mfma_f32_16x16x32_bf16 v[88:91], a[248:251], v[204:207], v[88:91]
 ds_read_b64_tr_b16 v[222:223], v192 offset:9216
 v_cvt_pk_bf16_f32 v161, v66, v67
 v_mfma_f32_16x16x32_bf16 v[120:123], a[252:255], v[204:207], v[120:123]
 s_waitcnt lgkmcnt(4)
 v_cvt_pk_bf16_f32 v162, v96, v97
 v_cvt_pk_bf16_f32 v163, v98, v99
 v_mfma_f32_16x16x32_bf16 v[120:123], a[236:239], v[200:203], v[120:123]
 s_add_u32 m0, s73, 98304
 v_mfma_f32_16x16x32_bf16 v[28:31], a[224:227], v[208:211], v[28:31]
 buffer_load_dwordx4 v224, s[12:15], s75 offen offset:0 lds
 v_mfma_f32_16x16x32_bf16 v[28:31], a[240:243], v[212:215], v[28:31]
 ds_read_b64_tr_b16 v[200:201], v193 offset:0
 v_cvt_pk_bf16_f32 v132, v4, v5
 v_mfma_f32_16x16x32_bf16 v[60:63], a[244:247], v[212:215], v[60:63]
 ds_read_b64_tr_b16 v[202:203], v193 offset:1024
 v_cvt_pk_bf16_f32 v133, v6, v7
 v_mfma_f32_16x16x32_bf16 v[60:63], a[228:231], v[208:211], v[60:63]
 v_cvt_pk_bf16_f32 v134, v36, v37
 v_cvt_pk_bf16_f32 v135, v38, v39
 v_mfma_f32_16x16x32_bf16 v[92:95], a[232:235], v[208:211], v[92:95]
 ds_read_b64_tr_b16 v[204:205], v193 offset:8192
 v_cvt_pk_bf16_f32 v164, v68, v69
 v_mfma_f32_16x16x32_bf16 v[92:95], a[248:251], v[212:215], v[92:95]
 ds_read_b64_tr_b16 v[206:207], v193 offset:9216
 v_cvt_pk_bf16_f32 v165, v70, v71
 v_mfma_f32_16x16x32_bf16 v[124:127], a[252:255], v[212:215], v[124:127]
 buffer_load_dwordx4 a[140:143], v230, s[52:55], s80 offen offset:0 sc1
 v_mfma_f32_16x16x32_bf16 v[124:127], a[236:239], v[208:211], v[124:127]
 s_waitcnt lgkmcnt(4) vmcnt(58)
 v_cvt_pk_bf16_f32 v166, v100, v101
 v_cvt_pk_bf16_f32 v167, v102, v103
 v_mfma_f32_16x16x32_bf16 v[0:3], v[216:219], a[0:3], 0
 ds_read_b64_tr_b16 v[208:209], v192 offset:256
 v_cvt_pk_bf16_f32 v136, v8, v9
 v_mfma_f32_16x16x32_bf16 v[0:3], v[220:223], a[16:19], v[0:3]
 ds_read_b64_tr_b16 v[210:211], v192 offset:1280
 v_cvt_pk_bf16_f32 v137, v10, v11
 v_mfma_f32_16x16x32_bf16 v[32:35], v[220:223], a[20:23], 0
 v_cvt_pk_bf16_f32 v138, v40, v41
 v_cvt_pk_bf16_f32 v139, v42, v43
 v_mfma_f32_16x16x32_bf16 v[32:35], v[216:219], a[4:7], v[32:35]
 buffer_load_dwordx4 v225, s[12:15], s75 offen offset:1024 lds
 v_mfma_f32_16x16x32_bf16 v[64:67], v[216:219], a[8:11], 0
 ds_read_b64_tr_b16 v[212:213], v192 offset:8448
 v_cvt_pk_bf16_f32 v168, v72, v73
 v_mfma_f32_16x16x32_bf16 v[64:67], v[220:223], a[24:27], v[64:67]
 v_cvt_pk_bf16_f32 v169, v74, v75
 v_cvt_pk_bf16_f32 v170, v104, v105
 v_mfma_f32_16x16x32_bf16 v[96:99], v[220:223], a[28:31], 0
 s_waitcnt lgkmcnt(3)
 ds_read_b64_tr_b16 v[214:215], v192 offset:9472
 v_cvt_pk_bf16_f32 v171, v106, v107
 v_mfma_f32_16x16x32_bf16 v[96:99], v[216:219], a[12:15], v[96:99]
 v_cvt_pk_bf16_f32 v140, v12, v13
 v_cvt_pk_bf16_f32 v141, v14, v15
 v_mfma_f32_16x16x32_bf16 v[4:7], v[200:203], a[0:3], 0
 ds_read_b64_tr_b16 v[216:217], v193 offset:256
 v_cvt_pk_bf16_f32 v142, v44, v45
 v_mfma_f32_16x16x32_bf16 v[4:7], v[204:207], a[16:19], v[4:7]
 buffer_load_dwordx4 a[144:147], v229, s[52:55], s81 offen offset:1024 sc1
 v_mfma_f32_16x16x32_bf16 v[36:39], v[204:207], a[20:23], 0
 ds_read_b64_tr_b16 v[218:219], v193 offset:1280
 v_cvt_pk_bf16_f32 v143, v46, v47
 v_mfma_f32_16x16x32_bf16 v[36:39], v[200:203], a[4:7], v[36:39]
 ds_read_b64_tr_b16 v[220:221], v193 offset:8448
 v_cvt_pk_bf16_f32 v172, v76, v77
 v_mfma_f32_16x16x32_bf16 v[68:71], v[200:203], a[8:11], 0
 v_cvt_pk_bf16_f32 v173, v78, v79
 v_cvt_pk_bf16_f32 v174, v108, v109
 v_mfma_f32_16x16x32_bf16 v[68:71], v[204:207], a[24:27], v[68:71]
 ds_read_b64_tr_b16 v[222:223], v193 offset:9472
 v_cvt_pk_bf16_f32 v175, v110, v111
 v_mfma_f32_16x16x32_bf16 v[100:103], v[204:207], a[28:31], 0
 s_waitcnt lgkmcnt(4)
 v_mfma_f32_16x16x32_bf16 v[100:103], v[200:203], a[12:15], v[100:103]
 v_cvt_pk_bf16_f32 v144, v16, v17
 v_cvt_pk_bf16_f32 v145, v18, v19
 v_mfma_f32_16x16x32_bf16 v[8:11], v[208:211], a[0:3], 0
 ds_read_b64_tr_b16 v[200:201], v192 offset:512
 v_cvt_pk_bf16_f32 v146, v48, v49
 v_mfma_f32_16x16x32_bf16 v[8:11], v[212:215], a[16:19], v[8:11]
 buffer_load_dwordx4 a[148:151], v230, s[52:55], s81 offen offset:1024 sc1
 v_mfma_f32_16x16x32_bf16 v[40:43], v[212:215], a[20:23], 0
 ds_read_b64_tr_b16 v[202:203], v192 offset:1536
 v_cvt_pk_bf16_f32 v147, v50, v51
 v_mfma_f32_16x16x32_bf16 v[40:43], v[208:211], a[4:7], v[40:43]
 ds_read_b64_tr_b16 v[204:205], v192 offset:8704
 v_cvt_pk_bf16_f32 v176, v80, v81
 v_mfma_f32_16x16x32_bf16 v[72:75], v[208:211], a[8:11], 0
 v_cvt_pk_bf16_f32 v177, v82, v83
 v_cvt_pk_bf16_f32 v178, v112, v113
 v_mfma_f32_16x16x32_bf16 v[72:75], v[212:215], a[24:27], v[72:75]
 ds_read_b64_tr_b16 v[206:207], v192 offset:9728
 v_cvt_pk_bf16_f32 v179, v114, v115
 v_mfma_f32_16x16x32_bf16 v[104:107], v[212:215], a[28:31], 0
 buffer_load_dwordx4 v226, s[12:15], s75 offen offset:2048 lds
 v_mfma_f32_16x16x32_bf16 v[104:107], v[208:211], a[12:15], v[104:107]
 s_waitcnt lgkmcnt(4)
 v_cvt_pk_bf16_f32 v148, v20, v21
 v_cvt_pk_bf16_f32 v149, v22, v23
 v_mfma_f32_16x16x32_bf16 v[12:15], v[216:219], a[0:3], 0
 ds_read_b64_tr_b16 v[208:209], v193 offset:512
 v_cvt_pk_bf16_f32 v150, v52, v53
 v_mfma_f32_16x16x32_bf16 v[12:15], v[220:223], a[16:19], v[12:15]
 ds_read_b64_tr_b16 v[210:211], v193 offset:1536
 v_cvt_pk_bf16_f32 v151, v54, v55
 v_mfma_f32_16x16x32_bf16 v[44:47], v[220:223], a[20:23], 0
 v_cvt_pk_bf16_f32 v180, v84, v85
 v_cvt_pk_bf16_f32 v181, v86, v87
 v_mfma_f32_16x16x32_bf16 v[44:47], v[216:219], a[4:7], v[44:47]
 ds_read_b64_tr_b16 v[212:213], v193 offset:8704
 v_cvt_pk_bf16_f32 v182, v116, v117
 v_mfma_f32_16x16x32_bf16 v[76:79], v[216:219], a[8:11], 0
 buffer_load_dwordx4 a[152:155], v229, s[52:55], s80 offen offset:1024 sc1
 v_mfma_f32_16x16x32_bf16 v[76:79], v[220:223], a[24:27], v[76:79]
 ds_read_b64_tr_b16 v[214:215], v193 offset:9728
 v_cvt_pk_bf16_f32 v183, v118, v119
 v_mfma_f32_16x16x32_bf16 v[108:111], v[220:223], a[28:31], 0
 s_waitcnt lgkmcnt(4)
 v_cvt_pk_bf16_f32 v152, v24, v25
 v_cvt_pk_bf16_f32 v153, v26, v27
 v_mfma_f32_16x16x32_bf16 v[108:111], v[216:219], a[12:15], v[108:111]
 v_mfma_f32_16x16x32_bf16 v[16:19], v[200:203], a[0:3], 0
 ds_read_b64_tr_b16 v[216:217], v192 offset:768
 v_cvt_pk_bf16_f32 v154, v56, v57
 v_mfma_f32_16x16x32_bf16 v[16:19], v[204:207], a[16:19], v[16:19]
 ds_read_b64_tr_b16 v[218:219], v192 offset:1792
 v_cvt_pk_bf16_f32 v155, v58, v59
 v_mfma_f32_16x16x32_bf16 v[48:51], v[204:207], a[20:23], 0
 v_cvt_pk_bf16_f32 v184, v88, v89
 v_cvt_pk_bf16_f32 v185, v90, v91
 v_mfma_f32_16x16x32_bf16 v[48:51], v[200:203], a[4:7], v[48:51]
 buffer_load_dwordx4 v227, s[12:15], s75 offen offset:3072 lds
 v_mfma_f32_16x16x32_bf16 v[80:83], v[200:203], a[8:11], 0
 ds_read_b64_tr_b16 v[220:221], v192 offset:8960
 v_cvt_pk_bf16_f32 v186, v120, v121
 v_mfma_f32_16x16x32_bf16 v[80:83], v[204:207], a[24:27], v[80:83]
 ds_read_b64_tr_b16 v[222:223], v192 offset:9984
 v_cvt_pk_bf16_f32 v187, v122, v123
 v_mfma_f32_16x16x32_bf16 v[112:115], v[204:207], a[28:31], 0
 s_waitcnt lgkmcnt(4)
 v_cvt_pk_bf16_f32 v156, v28, v29
 v_cvt_pk_bf16_f32 v157, v30, v31
 v_mfma_f32_16x16x32_bf16 v[112:115], v[200:203], a[12:15], v[112:115]
 s_add_u32 s75, s75, 524288
 v_mfma_f32_16x16x32_bf16 v[20:23], v[208:211], a[0:3], 0
 s_bitset0_b32 s75, 22
 ds_read_b64_tr_b16 v[200:201], v193 offset:768
 v_cvt_pk_bf16_f32 v158, v60, v61
 v_mfma_f32_16x16x32_bf16 v[20:23], v[212:215], a[16:19], v[20:23]
 buffer_load_dwordx4 a[156:159], v230, s[52:55], s80 offen offset:1024 sc1
 v_mfma_f32_16x16x32_bf16 v[52:55], v[212:215], a[20:23], 0
 ds_read_b64_tr_b16 v[202:203], v193 offset:1792
 v_cvt_pk_bf16_f32 v159, v62, v63
 v_mfma_f32_16x16x32_bf16 v[52:55], v[208:211], a[4:7], v[52:55]
 v_cvt_pk_bf16_f32 v188, v92, v93
 v_cvt_pk_bf16_f32 v189, v94, v95
 v_mfma_f32_16x16x32_bf16 v[84:87], v[208:211], a[8:11], 0
 ds_read_b64_tr_b16 v[204:205], v193 offset:8960
 v_cvt_pk_bf16_f32 v190, v124, v125
 v_mfma_f32_16x16x32_bf16 v[84:87], v[212:215], a[24:27], v[84:87]
 ds_read_b64_tr_b16 v[206:207], v193 offset:9984
 v_cvt_pk_bf16_f32 v191, v126, v127
 v_mfma_f32_16x16x32_bf16 v[116:119], v[212:215], a[28:31], 0
 s_waitcnt lgkmcnt(4)
 v_mfma_f32_16x16x32_bf16 v[116:119], v[208:211], a[12:15], v[116:119]
 s_waitcnt vmcnt(11)
 v_mfma_f32_16x16x32_bf16 v[24:27], v[216:219], a[0:3], 0
 s_barrier
 ds_read_b64_tr_b16 v[208:209], v192 offset:16384
 ds_read_b64_tr_b16 v[210:211], v192 offset:17408
 v_mfma_f32_16x16x32_bf16 v[24:27], v[220:223], a[16:19], v[24:27]
 buffer_load_dwordx4 a[160:163], v229, s[52:55], s81 offen offset:2048 sc1
 v_mfma_f32_16x16x32_bf16 v[56:59], v[220:223], a[20:23], 0
 v_mfma_f32_16x16x32_bf16 v[56:59], v[216:219], a[4:7], v[56:59]
 ds_read_b64_tr_b16 v[212:213], v192 offset:24576
 ds_read_b64_tr_b16 v[214:215], v192 offset:25600
 v_mfma_f32_16x16x32_bf16 v[88:91], v[216:219], a[8:11], 0
 v_mfma_f32_16x16x32_bf16 v[88:91], v[220:223], a[24:27], v[88:91]
 s_add_u32 m0, s73, 114688
 v_mfma_f32_16x16x32_bf16 v[120:123], v[220:223], a[28:31], 0
 buffer_load_dwordx4 v224, s[12:15], s75 offen offset:0 lds
 v_mfma_f32_16x16x32_bf16 v[120:123], v[216:219], a[12:15], v[120:123]
 s_waitcnt lgkmcnt(4)
 v_mfma_f32_16x16x32_bf16 v[28:31], v[200:203], a[0:3], 0
 ds_read_b64_tr_b16 v[216:217], v193 offset:16384
 ds_read_b64_tr_b16 v[218:219], v193 offset:17408
 v_mfma_f32_16x16x32_bf16 v[28:31], v[204:207], a[16:19], v[28:31]
 v_mfma_f32_16x16x32_bf16 v[60:63], v[204:207], a[20:23], 0
 s_add_u32 s82, s79, 16384
 v_mfma_f32_16x16x32_bf16 v[60:63], v[200:203], a[4:7], v[60:63]
 buffer_store_dwordx4 v[128:131], v251, s[52:55], s82 offen sc1
 v_mfma_f32_16x16x32_bf16 v[92:95], v[200:203], a[8:11], 0
 ds_read_b64_tr_b16 v[220:221], v193 offset:24576
 ds_read_b64_tr_b16 v[222:223], v193 offset:25600
 v_mfma_f32_16x16x32_bf16 v[92:95], v[204:207], a[24:27], v[92:95]
 v_mfma_f32_16x16x32_bf16 v[124:127], v[204:207], a[28:31], 0
 s_waitcnt lgkmcnt(4) vmcnt(52)
 v_mfma_f32_16x16x32_bf16 v[124:127], v[200:203], a[12:15], v[124:127]
 v_mfma_f32_16x16x32_bf16 v[0:3], v[208:211], a[32:35], v[0:3]
 ds_read_b64_tr_b16 v[200:201], v192 offset:16640
 ds_read_b64_tr_b16 v[202:203], v192 offset:17664
 v_mfma_f32_16x16x32_bf16 v[0:3], v[212:215], a[48:51], v[0:3]
 buffer_load_dwordx4 a[164:167], v230, s[52:55], s81 offen offset:2048 sc1
 v_mfma_f32_16x16x32_bf16 v[32:35], v[212:215], a[52:55], v[32:35]
 v_mfma_f32_16x16x32_bf16 v[32:35], v[208:211], a[36:39], v[32:35]
 ds_read_b64_tr_b16 v[204:205], v192 offset:24832
 ds_read_b64_tr_b16 v[206:207], v192 offset:25856
 v_mfma_f32_16x16x32_bf16 v[64:67], v[208:211], a[40:43], v[64:67]
 v_mfma_f32_16x16x32_bf16 v[64:67], v[212:215], a[56:59], v[64:67]
 buffer_load_dwordx4 v225, s[12:15], s75 offen offset:1024 lds
 v_mfma_f32_16x16x32_bf16 v[96:99], v[212:215], a[60:63], v[96:99]
 s_waitcnt lgkmcnt(4)
 v_mfma_f32_16x16x32_bf16 v[96:99], v[208:211], a[44:47], v[96:99]
 v_mfma_f32_16x16x32_bf16 v[4:7], v[216:219], a[32:35], v[4:7]
 ds_read_b64_tr_b16 v[208:209], v193 offset:16640
 ds_read_b64_tr_b16 v[210:211], v193 offset:17664
 v_mfma_f32_16x16x32_bf16 v[4:7], v[220:223], a[48:51], v[4:7]
 v_mfma_f32_16x16x32_bf16 v[36:39], v[220:223], a[52:55], v[36:39]
 buffer_load_dwordx4 a[168:171], v229, s[52:55], s80 offen offset:2048 sc1
 v_mfma_f32_16x16x32_bf16 v[36:39], v[216:219], a[36:39], v[36:39]
 ds_read_b64_tr_b16 v[212:213], v193 offset:24832
 ds_read_b64_tr_b16 v[214:215], v193 offset:25856
 v_mfma_f32_16x16x32_bf16 v[68:71], v[216:219], a[40:43], v[68:71]
 v_mfma_f32_16x16x32_bf16 v[68:71], v[220:223], a[56:59], v[68:71]
 v_mfma_f32_16x16x32_bf16 v[100:103], v[220:223], a[60:63], v[100:103]
 s_waitcnt lgkmcnt(4)
 v_mfma_f32_16x16x32_bf16 v[100:103], v[216:219], a[44:47], v[100:103]
 buffer_load_dwordx4 a[172:175], v230, s[52:55], s80 offen offset:2048 sc1
 v_mfma_f32_16x16x32_bf16 v[8:11], v[200:203], a[32:35], v[8:11]
 ds_read_b64_tr_b16 v[216:217], v192 offset:16896
 ds_read_b64_tr_b16 v[218:219], v192 offset:17920
 v_mfma_f32_16x16x32_bf16 v[8:11], v[204:207], a[48:51], v[8:11]
 v_mfma_f32_16x16x32_bf16 v[40:43], v[204:207], a[52:55], v[40:43]
 v_mfma_f32_16x16x32_bf16 v[40:43], v[200:203], a[36:39], v[40:43]
 ds_read_b64_tr_b16 v[220:221], v192 offset:25088
 ds_read_b64_tr_b16 v[222:223], v192 offset:26112
 v_mfma_f32_16x16x32_bf16 v[72:75], v[200:203], a[40:43], v[72:75]
 v_mfma_f32_16x16x32_bf16 v[72:75], v[204:207], a[56:59], v[72:75]
 buffer_load_dwordx4 v226, s[12:15], s75 offen offset:2048 lds
 v_mfma_f32_16x16x32_bf16 v[104:107], v[204:207], a[60:63], v[104:107]
 s_waitcnt lgkmcnt(4)
 v_mfma_f32_16x16x32_bf16 v[104:107], v[200:203], a[44:47], v[104:107]
 v_mfma_f32_16x16x32_bf16 v[12:15], v[208:211], a[32:35], v[12:15]
 ds_read_b64_tr_b16 v[200:201], v193 offset:16896
 ds_read_b64_tr_b16 v[202:203], v193 offset:17920
 v_mfma_f32_16x16x32_bf16 v[12:15], v[212:215], a[48:51], v[12:15]
 s_add_u32 s82, s79, 24576
 v_mfma_f32_16x16x32_bf16 v[44:47], v[212:215], a[52:55], v[44:47]
 buffer_store_dwordx4 v[160:163], v251, s[52:55], s82 offen sc1
 v_mfma_f32_16x16x32_bf16 v[44:47], v[208:211], a[36:39], v[44:47]
 ds_read_b64_tr_b16 v[204:205], v193 offset:25088
 ds_read_b64_tr_b16 v[206:207], v193 offset:26112
 v_mfma_f32_16x16x32_bf16 v[76:79], v[208:211], a[40:43], v[76:79]
 v_mfma_f32_16x16x32_bf16 v[76:79], v[212:215], a[56:59], v[76:79]
 v_mfma_f32_16x16x32_bf16 v[108:111], v[212:215], a[60:63], v[108:111]
 s_waitcnt lgkmcnt(4)
 v_mfma_f32_16x16x32_bf16 v[108:111], v[208:211], a[44:47], v[108:111]
 buffer_load_dwordx4 a[176:179], v229, s[52:55], s81 offen offset:3072 sc1
 v_mfma_f32_16x16x32_bf16 v[16:19], v[216:219], a[32:35], v[16:19]
 ds_read_b64_tr_b16 v[208:209], v192 offset:17152
 ds_read_b64_tr_b16 v[210:211], v192 offset:18176
 v_mfma_f32_16x16x32_bf16 v[16:19], v[220:223], a[48:51], v[16:19]
 v_mfma_f32_16x16x32_bf16 v[48:51], v[220:223], a[52:55], v[48:51]
 v_mfma_f32_16x16x32_bf16 v[48:51], v[216:219], a[36:39], v[48:51]
 ds_read_b64_tr_b16 v[212:213], v192 offset:25344
 ds_read_b64_tr_b16 v[214:215], v192 offset:26368
 v_mfma_f32_16x16x32_bf16 v[80:83], v[216:219], a[40:43], v[80:83]
 buffer_load_dwordx4 v227, s[12:15], s75 offen offset:3072 lds
 v_mfma_f32_16x16x32_bf16 v[80:83], v[220:223], a[56:59], v[80:83]
 v_mfma_f32_16x16x32_bf16 v[112:115], v[220:223], a[60:63], v[112:115]
 s_waitcnt lgkmcnt(4)
 v_mfma_f32_16x16x32_bf16 v[112:115], v[216:219], a[44:47], v[112:115]
 v_mfma_f32_16x16x32_bf16 v[20:23], v[200:203], a[32:35], v[20:23]
 s_add_u32 s75, s75, 524288
 ds_read_b64_tr_b16 v[216:217], v193 offset:17152
 ds_read_b64_tr_b16 v[218:219], v193 offset:18176
 v_mfma_f32_16x16x32_bf16 v[20:23], v[204:207], a[48:51], v[20:23]
 s_bitset0_b32 s75, 22
 v_mfma_f32_16x16x32_bf16 v[52:55], v[204:207], a[52:55], v[52:55]
 buffer_load_dwordx4 a[180:183], v230, s[52:55], s81 offen offset:3072 sc1
 v_mfma_f32_16x16x32_bf16 v[52:55], v[200:203], a[36:39], v[52:55]
 ds_read_b64_tr_b16 v[220:221], v193 offset:25344
 ds_read_b64_tr_b16 v[222:223], v193 offset:26368
 v_mfma_f32_16x16x32_bf16 v[84:87], v[200:203], a[40:43], v[84:87]
 v_mfma_f32_16x16x32_bf16 v[84:87], v[204:207], a[56:59], v[84:87]
 v_mfma_f32_16x16x32_bf16 v[116:119], v[204:207], a[60:63], v[116:119]
 s_waitcnt lgkmcnt(4)
 v_mfma_f32_16x16x32_bf16 v[116:119], v[200:203], a[44:47], v[116:119]
 s_waitcnt vmcnt(13)
 v_mfma_f32_16x16x32_bf16 v[24:27], v[208:211], a[32:35], v[24:27]
 s_barrier
 ds_read_b64_tr_b16 v[200:201], v194 offset:0
 ds_read_b64_tr_b16 v[202:203], v194 offset:1024
 v_mfma_f32_16x16x32_bf16 v[24:27], v[212:215], a[48:51], v[24:27]
 s_lshl_b32 s72, s61, 7
 v_mfma_f32_16x16x32_bf16 v[56:59], v[212:215], a[52:55], v[56:59]
 s_add_u32 s72, s72, 71318528
 v_mfma_f32_16x16x32_bf16 v[56:59], v[208:211], a[36:39], v[56:59]
 buffer_atomic_add v249, v248, s[52:55], s72 offen sc1
 v_mfma_f32_16x16x32_bf16 v[88:91], v[208:211], a[40:43], v[88:91]
 ds_read_b64_tr_b16 v[204:205], v194 offset:8192
 ds_read_b64_tr_b16 v[206:207], v194 offset:9216
 v_mfma_f32_16x16x32_bf16 v[88:91], v[212:215], a[56:59], v[88:91]
 buffer_load_dwordx4 a[184:187], v229, s[52:55], s80 offen offset:3072 sc1
 v_mfma_f32_16x16x32_bf16 v[120:123], v[212:215], a[60:63], v[120:123]
 s_waitcnt lgkmcnt(4)
 v_mfma_f32_16x16x32_bf16 v[120:123], v[208:211], a[44:47], v[120:123]
 v_mfma_f32_16x16x32_bf16 v[28:31], v[216:219], a[32:35], v[28:31]
 s_add_u32 m0, s73, 0
 ds_read_b64_tr_b16 v[208:209], v195 offset:0
 ds_read_b64_tr_b16 v[210:211], v195 offset:1024
 v_mfma_f32_16x16x32_bf16 v[28:31], v[220:223], a[48:51], v[28:31]
 buffer_load_dwordx4 v224, s[12:15], s75 offen offset:0 lds
 v_mfma_f32_16x16x32_bf16 v[60:63], v[220:223], a[52:55], v[60:63]
 v_mfma_f32_16x16x32_bf16 v[60:63], v[216:219], a[36:39], v[60:63]
 ds_read_b64_tr_b16 v[212:213], v195 offset:8192
 ds_read_b64_tr_b16 v[214:215], v195 offset:9216
 v_mfma_f32_16x16x32_bf16 v[92:95], v[216:219], a[40:43], v[92:95]
 v_mfma_f32_16x16x32_bf16 v[92:95], v[220:223], a[56:59], v[92:95]
 s_add_u32 s82, s79, 17408
 v_mfma_f32_16x16x32_bf16 v[124:127], v[220:223], a[60:63], v[124:127]
 buffer_store_dwordx4 v[132:135], v251, s[52:55], s82 offen sc1
 v_mfma_f32_16x16x32_bf16 v[124:127], v[216:219], a[44:47], v[124:127]
 s_waitcnt lgkmcnt(4) vmcnt(49)
 v_mfma_f32_16x16x32_bf16 v[0:3], v[200:203], a[64:67], v[0:3]
 ds_read_b64_tr_b16 v[216:217], v194 offset:256
 ds_read_b64_tr_b16 v[218:219], v194 offset:1280
 v_mfma_f32_16x16x32_bf16 v[0:3], v[204:207], a[80:83], v[0:3]
 v_mfma_f32_16x16x32_bf16 v[32:35], v[204:207], a[84:87], v[32:35]
 buffer_load_dwordx4 a[188:191], v230, s[52:55], s80 offen offset:3072 sc1
 v_mfma_f32_16x16x32_bf16 v[32:35], v[200:203], a[68:71], v[32:35]
 ds_read_b64_tr_b16 v[220:221], v194 offset:8448
 ds_read_b64_tr_b16 v[222:223], v194 offset:9472
 v_mfma_f32_16x16x32_bf16 v[64:67], v[200:203], a[72:75], v[64:67]
 v_mfma_f32_16x16x32_bf16 v[64:67], v[204:207], a[88:91], v[64:67]
 v_mfma_f32_16x16x32_bf16 v[96:99], v[204:207], a[92:95], v[96:99]
 s_waitcnt lgkmcnt(4)
 v_mfma_f32_16x16x32_bf16 v[96:99], v[200:203], a[76:79], v[96:99]
 s_add_u32 s80, s80, 4096
 v_mfma_f32_16x16x32_bf16 v[4:7], v[208:211], a[64:67], v[4:7]
 s_add_u32 s81, s81, 4096
 ds_read_b64_tr_b16 v[200:201], v195 offset:256
 ds_read_b64_tr_b16 v[202:203], v195 offset:1280
 v_mfma_f32_16x16x32_bf16 v[4:7], v[212:215], a[80:83], v[4:7]
 s_bitset0_b32 s80, 14
 v_mfma_f32_16x16x32_bf16 v[36:39], v[212:215], a[84:87], v[36:39]
 s_bitset0_b32 s81, 14
 buffer_load_dwordx4 v225, s[12:15], s75 offen offset:1024 lds
 v_mfma_f32_16x16x32_bf16 v[36:39], v[208:211], a[68:71], v[36:39]
 buffer_load_dwordx4 a[192:195], v229, s[52:55], s81 offen offset:0 sc1
 v_mfma_f32_16x16x32_bf16 v[68:71], v[208:211], a[72:75], v[68:71]
 ds_read_b64_tr_b16 v[204:205], v195 offset:8448
 ds_read_b64_tr_b16 v[206:207], v195 offset:9472
 v_mfma_f32_16x16x32_bf16 v[68:71], v[212:215], a[88:91], v[68:71]
 v_mfma_f32_16x16x32_bf16 v[100:103], v[212:215], a[92:95], v[100:103]
 s_waitcnt lgkmcnt(4)
 v_mfma_f32_16x16x32_bf16 v[100:103], v[208:211], a[76:79], v[100:103]
 s_add_u32 s82, s79, 25600
 v_mfma_f32_16x16x32_bf16 v[8:11], v[216:219], a[64:67], v[8:11]
 ds_read_b64_tr_b16 v[208:209], v194 offset:512
 ds_read_b64_tr_b16 v[210:211], v194 offset:1536
 v_mfma_f32_16x16x32_bf16 v[8:11], v[220:223], a[80:83], v[8:11]
 buffer_store_dwordx4 v[164:167], v251, s[52:55], s82 offen sc1
 v_mfma_f32_16x16x32_bf16 v[40:43], v[220:223], a[84:87], v[40:43]
 v_mfma_f32_16x16x32_bf16 v[40:43], v[216:219], a[68:71], v[40:43]
 ds_read_b64_tr_b16 v[212:213], v194 offset:8704
 ds_read_b64_tr_b16 v[214:215], v194 offset:9728
 v_mfma_f32_16x16x32_bf16 v[72:75], v[216:219], a[72:75], v[72:75]
 buffer_load_dwordx4 a[196:199], v230, s[52:55], s81 offen offset:0 sc1
 v_mfma_f32_16x16x32_bf16 v[72:75], v[220:223], a[88:91], v[72:75]
 v_mfma_f32_16x16x32_bf16 v[104:107], v[220:223], a[92:95], v[104:107]
 s_waitcnt lgkmcnt(4)
 v_mfma_f32_16x16x32_bf16 v[104:107], v[216:219], a[76:79], v[104:107]
 v_mfma_f32_16x16x32_bf16 v[12:15], v[200:203], a[64:67], v[12:15]
 ds_read_b64_tr_b16 v[216:217], v195 offset:512
 ds_read_b64_tr_b16 v[218:219], v195 offset:1536
 v_mfma_f32_16x16x32_bf16 v[12:15], v[204:207], a[80:83], v[12:15]
 buffer_load_dwordx4 v226, s[12:15], s75 offen offset:2048 lds
 v_mfma_f32_16x16x32_bf16 v[44:47], v[204:207], a[84:87], v[44:47]
 v_mfma_f32_16x16x32_bf16 v[44:47], v[200:203], a[68:71], v[44:47]
 ds_read_b64_tr_b16 v[220:221], v195 offset:8704
 ds_read_b64_tr_b16 v[222:223], v195 offset:9728
 v_mfma_f32_16x16x32_bf16 v[76:79], v[200:203], a[72:75], v[76:79]
 v_mfma_f32_16x16x32_bf16 v[76:79], v[204:207], a[88:91], v[76:79]
 buffer_load_dwordx4 a[200:203], v229, s[52:55], s80 offen offset:0 sc1
 v_mfma_f32_16x16x32_bf16 v[108:111], v[204:207], a[92:95], v[108:111]
 s_waitcnt lgkmcnt(4)
 v_mfma_f32_16x16x32_bf16 v[108:111], v[200:203], a[76:79], v[108:111]
 v_mfma_f32_16x16x32_bf16 v[16:19], v[208:211], a[64:67], v[16:19]
 s_add_u32 s82, s79, 18432
 ds_read_b64_tr_b16 v[200:201], v194 offset:768
 ds_read_b64_tr_b16 v[202:203], v194 offset:1792
 v_mfma_f32_16x16x32_bf16 v[16:19], v[212:215], a[80:83], v[16:19]
 buffer_store_dwordx4 v[136:139], v251, s[52:55], s82 offen sc1
 v_mfma_f32_16x16x32_bf16 v[48:51], v[212:215], a[84:87], v[48:51]
 v_mfma_f32_16x16x32_bf16 v[48:51], v[208:211], a[68:71], v[48:51]
 ds_read_b64_tr_b16 v[204:205], v194 offset:8960
 ds_read_b64_tr_b16 v[206:207], v194 offset:9984
 v_mfma_f32_16x16x32_bf16 v[80:83], v[208:211], a[72:75], v[80:83]
 v_mfma_f32_16x16x32_bf16 v[80:83], v[212:215], a[88:91], v[80:83]
 v_mfma_f32_16x16x32_bf16 v[112:115], v[212:215], a[92:95], v[112:115]
 buffer_load_dwordx4 v227, s[12:15], s75 offen offset:3072 lds
 v_mfma_f32_16x16x32_bf16 v[112:115], v[208:211], a[76:79], v[112:115]
 s_waitcnt lgkmcnt(4)
 v_mfma_f32_16x16x32_bf16 v[20:23], v[216:219], a[64:67], v[20:23]
 ds_read_b64_tr_b16 v[208:209], v195 offset:768
 ds_read_b64_tr_b16 v[210:211], v195 offset:1792
 v_mfma_f32_16x16x32_bf16 v[20:23], v[220:223], a[80:83], v[20:23]
 s_add_u32 s75, s75, 524288
 v_mfma_f32_16x16x32_bf16 v[52:55], v[220:223], a[84:87], v[52:55]
 s_bitset0_b32 s75, 22
 v_mfma_f32_16x16x32_bf16 v[52:55], v[216:219], a[68:71], v[52:55]
 buffer_load_dwordx4 a[204:207], v230, s[52:55], s80 offen offset:0 sc1
 v_mfma_f32_16x16x32_bf16 v[84:87], v[216:219], a[72:75], v[84:87]
 ds_read_b64_tr_b16 v[212:213], v195 offset:8960
 ds_read_b64_tr_b16 v[214:215], v195 offset:9984
 v_mfma_f32_16x16x32_bf16 v[84:87], v[220:223], a[88:91], v[84:87]
 v_mfma_f32_16x16x32_bf16 v[116:119], v[220:223], a[92:95], v[116:119]
 s_waitcnt lgkmcnt(4)
 v_mfma_f32_16x16x32_bf16 v[116:119], v[216:219], a[76:79], v[116:119]
 s_waitcnt vmcnt(15)
 v_mfma_f32_16x16x32_bf16 v[24:27], v[200:203], a[64:67], v[24:27]
 s_barrier
 ds_read_b64_tr_b16 v[216:217], v194 offset:16384
 ds_read_b64_tr_b16 v[218:219], v194 offset:17408
 v_mfma_f32_16x16x32_bf16 v[24:27], v[204:207], a[80:83], v[24:27]
 buffer_load_dwordx4 a[208:211], v229, s[52:55], s81 offen offset:1024 sc1
 v_mfma_f32_16x16x32_bf16 v[56:59], v[204:207], a[84:87], v[56:59]
 v_mfma_f32_16x16x32_bf16 v[56:59], v[200:203], a[68:71], v[56:59]
 ds_read_b64_tr_b16 v[220:221], v194 offset:24576
 ds_read_b64_tr_b16 v[222:223], v194 offset:25600
 v_mfma_f32_16x16x32_bf16 v[88:91], v[200:203], a[72:75], v[88:91]
 s_add_u32 m0, s73, 16384
 v_mfma_f32_16x16x32_bf16 v[88:91], v[204:207], a[88:91], v[88:91]
 buffer_load_dwordx4 v224, s[12:15], s75 offen offset:0 lds
 v_mfma_f32_16x16x32_bf16 v[120:123], v[204:207], a[92:95], v[120:123]
 s_waitcnt lgkmcnt(4)
 v_mfma_f32_16x16x32_bf16 v[120:123], v[200:203], a[76:79], v[120:123]
 v_mfma_f32_16x16x32_bf16 v[28:31], v[208:211], a[64:67], v[28:31]
 ds_read_b64_tr_b16 v[200:201], v195 offset:16384
 ds_read_b64_tr_b16 v[202:203], v195 offset:17408
 v_mfma_f32_16x16x32_bf16 v[28:31], v[212:215], a[80:83], v[28:31]
 s_add_u32 s82, s79, 26624
 v_mfma_f32_16x16x32_bf16 v[60:63], v[212:215], a[84:87], v[60:63]
 buffer_store_dwordx4 v[168:171], v251, s[52:55], s82 offen sc1
 v_mfma_f32_16x16x32_bf16 v[60:63], v[208:211], a[68:71], v[60:63]
 ds_read_b64_tr_b16 v[204:205], v195 offset:24576
 ds_read_b64_tr_b16 v[206:207], v195 offset:25600
 v_mfma_f32_16x16x32_bf16 v[92:95], v[208:211], a[72:75], v[92:95]
 v_mfma_f32_16x16x32_bf16 v[92:95], v[212:215], a[88:91], v[92:95]
 v_mfma_f32_16x16x32_bf16 v[124:127], v[212:215], a[92:95], v[124:127]
 s_waitcnt lgkmcnt(4) vmcnt(44)
 v_mfma_f32_16x16x32_bf16 v[124:127], v[208:211], a[76:79], v[124:127]
 buffer_load_dwordx4 a[212:215], v230, s[52:55], s81 offen offset:1024 sc1
 v_mfma_f32_16x16x32_bf16 v[0:3], v[216:219], a[96:99], v[0:3]
 ds_read_b64_tr_b16 v[208:209], v194 offset:16640
 ds_read_b64_tr_b16 v[210:211], v194 offset:17664
 v_mfma_f32_16x16x32_bf16 v[0:3], v[220:223], a[112:115], v[0:3]
 v_mfma_f32_16x16x32_bf16 v[32:35], v[220:223], a[116:119], v[32:35]
 v_mfma_f32_16x16x32_bf16 v[32:35], v[216:219], a[100:103], v[32:35]
 ds_read_b64_tr_b16 v[212:213], v194 offset:24832
 ds_read_b64_tr_b16 v[214:215], v194 offset:25856
 v_mfma_f32_16x16x32_bf16 v[64:67], v[216:219], a[104:107], v[64:67]
 buffer_load_dwordx4 v225, s[12:15], s75 offen offset:1024 lds
 v_mfma_f32_16x16x32_bf16 v[64:67], v[220:223], a[120:123], v[64:67]
 v_mfma_f32_16x16x32_bf16 v[96:99], v[220:223], a[124:127], v[96:99]
 s_waitcnt lgkmcnt(4)
 v_mfma_f32_16x16x32_bf16 v[96:99], v[216:219], a[108:111], v[96:99]
 v_mfma_f32_16x16x32_bf16 v[4:7], v[200:203], a[96:99], v[4:7]
 ds_read_b64_tr_b16 v[216:217], v195 offset:16640
 ds_read_b64_tr_b16 v[218:219], v195 offset:17664
 v_mfma_f32_16x16x32_bf16 v[4:7], v[204:207], a[112:115], v[4:7]
 buffer_load_dwordx4 a[216:219], v229, s[52:55], s80 offen offset:1024 sc1
 v_mfma_f32_16x16x32_bf16 v[36:39], v[204:207], a[116:119], v[36:39]
 v_mfma_f32_16x16x32_bf16 v[36:39], v[200:203], a[100:103], v[36:39]
 ds_read_b64_tr_b16 v[220:221], v195 offset:24832
 ds_read_b64_tr_b16 v[222:223], v195 offset:25856
 v_mfma_f32_16x16x32_bf16 v[68:71], v[200:203], a[104:107], v[68:71]
 s_add_u32 s82, s79, 19456
 v_mfma_f32_16x16x32_bf16 v[68:71], v[204:207], a[120:123], v[68:71]
 buffer_store_dwordx4 v[140:143], v251, s[52:55], s82 offen sc1
 v_mfma_f32_16x16x32_bf16 v[100:103], v[204:207], a[124:127], v[100:103]
 s_waitcnt lgkmcnt(4)
 v_mfma_f32_16x16x32_bf16 v[100:103], v[200:203], a[108:111], v[100:103]
 v_mfma_f32_16x16x32_bf16 v[8:11], v[208:211], a[96:99], v[8:11]
 ds_read_b64_tr_b16 v[200:201], v194 offset:16896
 ds_read_b64_tr_b16 v[202:203], v194 offset:17920
 v_mfma_f32_16x16x32_bf16 v[8:11], v[212:215], a[112:115], v[8:11]
 v_mfma_f32_16x16x32_bf16 v[40:43], v[212:215], a[116:119], v[40:43]
 buffer_load_dwordx4 a[220:223], v230, s[52:55], s80 offen offset:1024 sc1
 v_mfma_f32_16x16x32_bf16 v[40:43], v[208:211], a[100:103], v[40:43]
 ds_read_b64_tr_b16 v[204:205], v194 offset:25088
 ds_read_b64_tr_b16 v[206:207], v194 offset:26112
 v_mfma_f32_16x16x32_bf16 v[72:75], v[208:211], a[104:107], v[72:75]
 v_mfma_f32_16x16x32_bf16 v[72:75], v[212:215], a[120:123], v[72:75]
 v_mfma_f32_16x16x32_bf16 v[104:107], v[212:215], a[124:127], v[104:107]
 s_waitcnt lgkmcnt(4)
 v_mfma_f32_16x16x32_bf16 v[104:107], v[208:211], a[108:111], v[104:107]
 buffer_load_dwordx4 v226, s[12:15], s75 offen offset:2048 lds
 v_mfma_f32_16x16x32_bf16 v[12:15], v[216:219], a[96:99], v[12:15]
 ds_read_b64_tr_b16 v[208:209], v195 offset:16896
 ds_read_b64_tr_b16 v[210:211], v195 offset:17920
 v_mfma_f32_16x16x32_bf16 v[12:15], v[220:223], a[112:115], v[12:15]
 v_mfma_f32_16x16x32_bf16 v[44:47], v[220:223], a[116:119], v[44:47]
 v_mfma_f32_16x16x32_bf16 v[44:47], v[216:219], a[100:103], v[44:47]
 buffer_load_dwordx4 a[224:227], v229, s[52:55], s81 offen offset:2048 sc1
 v_mfma_f32_16x16x32_bf16 v[76:79], v[216:219], a[104:107], v[76:79]
 ds_read_b64_tr_b16 v[212:213], v195 offset:25088
 ds_read_b64_tr_b16 v[214:215], v195 offset:26112
 v_mfma_f32_16x16x32_bf16 v[76:79], v[220:223], a[120:123], v[76:79]
 v_mfma_f32_16x16x32_bf16 v[108:111], v[220:223], a[124:127], v[108:111]
 s_waitcnt lgkmcnt(4)
 v_mfma_f32_16x16x32_bf16 v[108:111], v[216:219], a[108:111], v[108:111]
 s_add_u32 s82, s79, 27648
 v_mfma_f32_16x16x32_bf16 v[16:19], v[200:203], a[96:99], v[16:19]
 ds_read_b64_tr_b16 v[216:217], v194 offset:17152
 ds_read_b64_tr_b16 v[218:219], v194 offset:18176
 v_mfma_f32_16x16x32_bf16 v[16:19], v[204:207], a[112:115], v[16:19]
 buffer_store_dwordx4 v[172:175], v251, s[52:55], s82 offen sc1
 v_mfma_f32_16x16x32_bf16 v[48:51], v[204:207], a[116:119], v[48:51]
 v_mfma_f32_16x16x32_bf16 v[48:51], v[200:203], a[100:103], v[48:51]
 ds_read_b64_tr_b16 v[220:221], v194 offset:25344
 ds_read_b64_tr_b16 v[222:223], v194 offset:26368
 v_mfma_f32_16x16x32_bf16 v[80:83], v[200:203], a[104:107], v[80:83]
 v_mfma_f32_16x16x32_bf16 v[80:83], v[204:207], a[120:123], v[80:83]
 buffer_load_dwordx4 v227, s[12:15], s75 offen offset:3072 lds
 v_mfma_f32_16x16x32_bf16 v[112:115], v[204:207], a[124:127], v[112:115]
 s_waitcnt lgkmcnt(4)
 v_mfma_f32_16x16x32_bf16 v[112:115], v[200:203], a[108:111], v[112:115]
 v_mfma_f32_16x16x32_bf16 v[20:23], v[208:211], a[96:99], v[20:23]
 ds_read_b64_tr_b16 v[200:201], v195 offset:17152
 ds_read_b64_tr_b16 v[202:203], v195 offset:18176
 v_mfma_f32_16x16x32_bf16 v[20:23], v[212:215], a[112:115], v[20:23]
 s_add_u32 s75, s75, 524288
 v_mfma_f32_16x16x32_bf16 v[52:55], v[212:215], a[116:119], v[52:55]
 s_bitset0_b32 s75, 22
 v_mfma_f32_16x16x32_bf16 v[52:55], v[208:211], a[100:103], v[52:55]
 buffer_load_dwordx4 a[228:231], v230, s[52:55], s81 offen offset:2048 sc1
 v_mfma_f32_16x16x32_bf16 v[84:87], v[208:211], a[104:107], v[84:87]
 ds_read_b64_tr_b16 v[204:205], v195 offset:25344
 ds_read_b64_tr_b16 v[206:207], v195 offset:26368
 v_mfma_f32_16x16x32_bf16 v[84:87], v[212:215], a[120:123], v[84:87]
 v_mfma_f32_16x16x32_bf16 v[116:119], v[212:215], a[124:127], v[116:119]
 s_waitcnt lgkmcnt(4)
 v_mfma_f32_16x16x32_bf16 v[116:119], v[208:211], a[108:111], v[116:119]
 s_waitcnt vmcnt(14)
 v_mfma_f32_16x16x32_bf16 v[24:27], v[216:219], a[96:99], v[24:27]
 s_barrier
 ds_read_b64_tr_b16 v[208:209], v192 offset:0
 ds_read_b64_tr_b16 v[210:211], v192 offset:1024
 v_mfma_f32_16x16x32_bf16 v[24:27], v[220:223], a[112:115], v[24:27]
 buffer_load_dwordx4 a[232:235], v229, s[52:55], s80 offen offset:2048 sc1
 v_mfma_f32_16x16x32_bf16 v[56:59], v[220:223], a[116:119], v[56:59]
 v_mfma_f32_16x16x32_bf16 v[56:59], v[216:219], a[100:103], v[56:59]
 ds_read_b64_tr_b16 v[212:213], v192 offset:8192
 ds_read_b64_tr_b16 v[214:215], v192 offset:9216
 v_mfma_f32_16x16x32_bf16 v[88:91], v[216:219], a[104:107], v[88:91]
 v_mfma_f32_16x16x32_bf16 v[88:91], v[220:223], a[120:123], v[88:91]
 s_add_u32 m0, s73, 98304
 v_mfma_f32_16x16x32_bf16 v[120:123], v[220:223], a[124:127], v[120:123]
 buffer_load_dwordx4 v224, s[12:15], s75 offen offset:0 lds
 v_mfma_f32_16x16x32_bf16 v[120:123], v[216:219], a[108:111], v[120:123]
 s_waitcnt lgkmcnt(4)
 v_mfma_f32_16x16x32_bf16 v[28:31], v[200:203], a[96:99], v[28:31]
 ds_read_b64_tr_b16 v[216:217], v193 offset:0
 ds_read_b64_tr_b16 v[218:219], v193 offset:1024
 v_mfma_f32_16x16x32_bf16 v[28:31], v[204:207], a[112:115], v[28:31]
 v_mfma_f32_16x16x32_bf16 v[60:63], v[204:207], a[116:119], v[60:63]
 s_add_u32 s82, s79, 20480
 v_mfma_f32_16x16x32_bf16 v[60:63], v[200:203], a[100:103], v[60:63]
 buffer_store_dwordx4 v[144:147], v251, s[52:55], s82 offen sc1
 v_mfma_f32_16x16x32_bf16 v[92:95], v[200:203], a[104:107], v[92:95]
 ds_read_b64_tr_b16 v[220:221], v193 offset:8192
 ds_read_b64_tr_b16 v[222:223], v193 offset:9216
 v_mfma_f32_16x16x32_bf16 v[92:95], v[204:207], a[120:123], v[92:95]
 v_mfma_f32_16x16x32_bf16 v[124:127], v[204:207], a[124:127], v[124:127]
 s_waitcnt lgkmcnt(4) vmcnt(42)
 v_mfma_f32_16x16x32_bf16 v[124:127], v[200:203], a[108:111], v[124:127]
 v_mfma_f32_16x16x32_bf16 v[0:3], v[208:211], a[128:131], v[0:3]
 ds_read_b64_tr_b16 v[200:201], v192 offset:256
 ds_read_b64_tr_b16 v[202:203], v192 offset:1280
 v_mfma_f32_16x16x32_bf16 v[0:3], v[212:215], a[144:147], v[0:3]
 buffer_load_dwordx4 a[236:239], v230, s[52:55], s80 offen offset:2048 sc1
 v_mfma_f32_16x16x32_bf16 v[32:35], v[212:215], a[148:151], v[32:35]
 v_accvgpr_write_b32 a0, 0
 v_accvgpr_write_b32 a1, 0
 v_mfma_f32_16x16x32_bf16 v[32:35], v[208:211], a[132:135], v[32:35]
 ds_read_b64_tr_b16 v[204:205], v192 offset:8448
 v_accvgpr_write_b32 a2, 0
 v_mfma_f32_16x16x32_bf16 v[64:67], v[208:211], a[136:139], v[64:67]
 v_mfma_f32_16x16x32_bf16 v[64:67], v[212:215], a[152:155], v[64:67]
 buffer_load_dwordx4 v225, s[12:15], s75 offen offset:1024 lds
 v_mfma_f32_16x16x32_bf16 v[96:99], v[212:215], a[156:159], v[96:99]
 s_waitcnt lgkmcnt(3)
 ds_read_b64_tr_b16 v[206:207], v192 offset:9472
 v_accvgpr_write_b32 a3, 0
 v_mfma_f32_16x16x32_bf16 v[96:99], v[208:211], a[140:143], v[96:99]
 v_accvgpr_write_b32 a4, 0
 v_accvgpr_write_b32 a5, 0
 v_mfma_f32_16x16x32_bf16 v[4:7], v[216:219], a[128:131], v[4:7]
 ds_read_b64_tr_b16 v[208:209], v193 offset:256
 ds_read_b64_tr_b16 v[210:211], v193 offset:1280
 v_mfma_f32_16x16x32_bf16 v[4:7], v[220:223], a[144:147], v[4:7]
 v_mfma_f32_16x16x32_bf16 v[36:39], v[220:223], a[148:151], v[36:39]
 buffer_load_dwordx4 a[240:243], v229, s[52:55], s81 offen offset:3072 sc1
 v_mfma_f32_16x16x32_bf16 v[36:39], v[216:219], a[132:135], v[36:39]
 ds_read_b64_tr_b16 v[212:213], v193 offset:8448
 v_accvgpr_write_b32 a6, 0
 v_mfma_f32_16x16x32_bf16 v[68:71], v[216:219], a[136:139], v[68:71]
 v_accvgpr_write_b32 a7, 0
 v_accvgpr_write_b32 a8, 0
 v_mfma_f32_16x16x32_bf16 v[68:71], v[220:223], a[152:155], v[68:71]
 ds_read_b64_tr_b16 v[214:215], v193 offset:9472
 v_accvgpr_write_b32 a9, 0
 v_mfma_f32_16x16x32_bf16 v[100:103], v[220:223], a[156:159], v[100:103]
 s_waitcnt lgkmcnt(4)
 v_mfma_f32_16x16x32_bf16 v[100:103], v[216:219], a[140:143], v[100:103]
 buffer_load_dwordx4 a[244:247], v230, s[52:55], s81 offen offset:3072 sc1
 v_mfma_f32_16x16x32_bf16 v[8:11], v[200:203], a[128:131], v[8:11]
 ds_read_b64_tr_b16 v[216:217], v192 offset:512
 v_accvgpr_write_b32 a10, 0
 v_mfma_f32_16x16x32_bf16 v[8:11], v[204:207], a[144:147], v[8:11]
 ds_read_b64_tr_b16 v[218:219], v192 offset:1536
 v_accvgpr_write_b32 a11, 0
 v_mfma_f32_16x16x32_bf16 v[40:43], v[204:207], a[148:151], v[40:43]
 v_mfma_f32_16x16x32_bf16 v[40:43], v[200:203], a[132:135], v[40:43]
 ds_read_b64_tr_b16 v[220:221], v192 offset:8704
 v_accvgpr_write_b32 a12, 0
 v_mfma_f32_16x16x32_bf16 v[72:75], v[200:203], a[136:139], v[72:75]
 v_mfma_f32_16x16x32_bf16 v[72:75], v[204:207], a[152:155], v[72:75]
 buffer_load_dwordx4 v226, s[12:15], s75 offen offset:2048 lds
 v_mfma_f32_16x16x32_bf16 v[104:107], v[204:207], a[156:159], v[104:107]
 s_waitcnt lgkmcnt(3)
 ds_read_b64_tr_b16 v[222:223], v192 offset:9728
 v_accvgpr_write_b32 a13, 0
 v_mfma_f32_16x16x32_bf16 v[104:107], v[200:203], a[140:143], v[104:107]
 v_accvgpr_write_b32 a14, 0
 v_accvgpr_write_b32 a15, 0
 v_mfma_f32_16x16x32_bf16 v[12:15], v[208:211], a[128:131], v[12:15]
 ds_read_b64_tr_b16 v[200:201], v193 offset:512
 v_accvgpr_write_b32 a16, 0
 v_mfma_f32_16x16x32_bf16 v[12:15], v[212:215], a[144:147], v[12:15]
 s_add_u32 s82, s79, 28672
 ds_read_b64_tr_b16 v[202:203], v193 offset:1536
 v_accvgpr_write_b32 a17, 0
 v_mfma_f32_16x16x32_bf16 v[44:47], v[212:215], a[148:151], v[44:47]
 buffer_store_dwordx4 v[176:179], v251, s[52:55], s82 offen sc1
 v_mfma_f32_16x16x32_bf16 v[44:47], v[208:211], a[132:135], v[44:47]
 ds_read_b64_tr_b16 v[204:205], v193 offset:8704
 v_accvgpr_write_b32 a18, 0
 v_mfma_f32_16x16x32_bf16 v[76:79], v[208:211], a[136:139], v[76:79]
 v_mfma_f32_16x16x32_bf16 v[76:79], v[212:215], a[152:155], v[76:79]
 ds_read_b64_tr_b16 v[206:207], v193 offset:9728
 v_accvgpr_write_b32 a19, 0
 v_mfma_f32_16x16x32_bf16 v[108:111], v[212:215], a[156:159], v[108:111]
 s_waitcnt lgkmcnt(4)
 v_mfma_f32_16x16x32_bf16 v[108:111], v[208:211], a[140:143], v[108:111]
 buffer_load_dwordx4 a[248:251], v229, s[52:55], s80 offen offset:3072 sc1
 v_mfma_f32_16x16x32_bf16 v[16:19], v[216:219], a[128:131], v[16:19]
 ds_read_b64_tr_b16 v[208:209], v192 offset:768
 v_accvgpr_write_b32 a20, 0
 v_mfma_f32_16x16x32_bf16 v[16:19], v[220:223], a[144:147], v[16:19]
 ds_read_b64_tr_b16 v[210:211], v192 offset:1792
 v_accvgpr_write_b32 a21, 0
 v_mfma_f32_16x16x32_bf16 v[48:51], v[220:223], a[148:151], v[48:51]
 ds_read_b64_tr_b16 v[212:213], v192 offset:8960
 v_accvgpr_write_b32 a22, 0
 v_mfma_f32_16x16x32_bf16 v[48:51], v[216:219], a[132:135], v[48:51]
 v_mfma_f32_16x16x32_bf16 v[80:83], v[216:219], a[136:139], v[80:83]
 v_accvgpr_write_b32 a23, 0
 v_accvgpr_write_b32 a24, 0
 v_mfma_f32_16x16x32_bf16 v[80:83], v[220:223], a[152:155], v[80:83]
 buffer_load_dwordx4 v227, s[12:15], s75 offen offset:3072 lds
 v_mfma_f32_16x16x32_bf16 v[112:115], v[220:223], a[156:159], v[112:115]
 s_waitcnt lgkmcnt(3)
 ds_read_b64_tr_b16 v[214:215], v192 offset:9984
 v_accvgpr_write_b32 a25, 0
 v_mfma_f32_16x16x32_bf16 v[112:115], v[216:219], a[140:143], v[112:115]
 v_mfma_f32_16x16x32_bf16 v[20:23], v[200:203], a[128:131], v[20:23]
 s_add_u32 s75, s75, 524288
 ds_read_b64_tr_b16 v[216:217], v193 offset:768
 v_accvgpr_write_b32 a26, 0
 v_mfma_f32_16x16x32_bf16 v[20:23], v[204:207], a[144:147], v[20:23]
 s_bitset0_b32 s75, 22
 ds_read_b64_tr_b16 v[218:219], v193 offset:1792
 v_accvgpr_write_b32 a27, 0
 v_mfma_f32_16x16x32_bf16 v[52:55], v[204:207], a[148:151], v[52:55]
 buffer_load_dwordx4 a[252:255], v230, s[52:55], s80 offen offset:3072 sc1
 v_mfma_f32_16x16x32_bf16 v[52:55], v[200:203], a[132:135], v[52:55]
 ds_read_b64_tr_b16 v[220:221], v193 offset:8960
 v_accvgpr_write_b32 a28, 0
 v_mfma_f32_16x16x32_bf16 v[84:87], v[200:203], a[136:139], v[84:87]
 v_mfma_f32_16x16x32_bf16 v[84:87], v[204:207], a[152:155], v[84:87]
 s_add_u32 s80, s80, 4096
 ds_read_b64_tr_b16 v[222:223], v193 offset:9984
 v_accvgpr_write_b32 a29, 0
 v_mfma_f32_16x16x32_bf16 v[116:119], v[204:207], a[156:159], v[116:119]
 s_add_u32 s81, s81, 4096
 s_bitset0_b32 s80, 14
 s_bitset0_b32 s81, 14
 v_mfma_f32_16x16x32_bf16 v[116:119], v[200:203], a[140:143], v[116:119]
 s_waitcnt vmcnt(13)
 s_waitcnt lgkmcnt(4)
 v_accvgpr_write_b32 a30, 0
 v_mfma_f32_16x16x32_bf16 v[24:27], v[208:211], a[128:131], v[24:27]
 s_barrier
 ds_read_b64_tr_b16 v[200:201], v192 offset:16384
 v_accvgpr_write_b32 a31, 0
 v_mfma_f32_16x16x32_bf16 v[24:27], v[212:215], a[144:147], v[24:27]
 s_add_u32 m0, s73, 114688
 ds_read_b64_tr_b16 v[202:203], v192 offset:17408
 v_accvgpr_write_b32 a32, 0
 v_mfma_f32_16x16x32_bf16 v[56:59], v[212:215], a[148:151], v[56:59]
 buffer_load_dwordx4 v224, s[12:15], s75 offen offset:0 lds
 v_mfma_f32_16x16x32_bf16 v[56:59], v[208:211], a[132:135], v[56:59]
 ds_read_b64_tr_b16 v[204:205], v192 offset:24576
 v_accvgpr_write_b32 a33, 0
 v_mfma_f32_16x16x32_bf16 v[88:91], v[208:211], a[136:139], v[88:91]
 v_accvgpr_write_b32 a34, 0
 v_accvgpr_write_b32 a35, 0
 v_mfma_f32_16x16x32_bf16 v[88:91], v[212:215], a[152:155], v[88:91]
 ds_read_b64_tr_b16 v[206:207], v192 offset:25600
 v_accvgpr_write_b32 a36, 0
 v_mfma_f32_16x16x32_bf16 v[120:123], v[212:215], a[156:159], v[120:123]
 s_waitcnt lgkmcnt(4)
 v_mfma_f32_16x16x32_bf16 v[120:123], v[208:211], a[140:143], v[120:123]
 v_mfma_f32_16x16x32_bf16 v[28:31], v[216:219], a[128:131], v[28:31]
 s_add_u32 s82, s79, 21504
 ds_read_b64_tr_b16 v[208:209], v193 offset:16384
 v_accvgpr_write_b32 a37, 0
 v_mfma_f32_16x16x32_bf16 v[28:31], v[220:223], a[144:147], v[28:31]
 buffer_store_dwordx4 v[148:151], v251, s[52:55], s82 offen sc1
 v_mfma_f32_16x16x32_bf16 v[60:63], v[220:223], a[148:151], v[60:63]
 ds_read_b64_tr_b16 v[210:211], v193 offset:17408
 v_accvgpr_write_b32 a38, 0
 v_mfma_f32_16x16x32_bf16 v[60:63], v[216:219], a[132:135], v[60:63]
 ds_read_b64_tr_b16 v[212:213], v193 offset:24576
 v_accvgpr_write_b32 a39, 0
 v_mfma_f32_16x16x32_bf16 v[92:95], v[216:219], a[136:139], v[92:95]
 v_mfma_f32_16x16x32_bf16 v[92:95], v[220:223], a[152:155], v[92:95]
 ds_read_b64_tr_b16 v[214:215], v193 offset:25600
 v_accvgpr_write_b32 a40, 0
 v_mfma_f32_16x16x32_bf16 v[124:127], v[220:223], a[156:159], v[124:127]
 s_waitcnt lgkmcnt(4) vmcnt(36)
 v_accvgpr_write_b32 a41, 0
 v_accvgpr_write_b32 a42, 0
 v_mfma_f32_16x16x32_bf16 v[124:127], v[216:219], a[140:143], v[124:127]
 v_mfma_f32_16x16x32_bf16 v[0:3], v[200:203], a[160:163], v[0:3]
 ds_read_b64_tr_b16 v[216:217], v192 offset:16640
 v_accvgpr_write_b32 a43, 0
 v_mfma_f32_16x16x32_bf16 v[0:3], v[204:207], a[176:179], v[0:3]
 ds_read_b64_tr_b16 v[218:219], v192 offset:17664
 v_accvgpr_write_b32 a44, 0
 v_mfma_f32_16x16x32_bf16 v[32:35], v[204:207], a[180:183], v[32:35]
 buffer_load_dwordx4 v225, s[12:15], s75 offen offset:1024 lds
 v_mfma_f32_16x16x32_bf16 v[32:35], v[200:203], a[164:167], v[32:35]
 ds_read_b64_tr_b16 v[220:221], v192 offset:24832
 v_accvgpr_write_b32 a45, 0
 v_mfma_f32_16x16x32_bf16 v[64:67], v[200:203], a[168:171], v[64:67]
 v_mfma_f32_16x16x32_bf16 v[64:67], v[204:207], a[184:187], v[64:67]
 ds_read_b64_tr_b16 v[222:223], v192 offset:25856
 v_accvgpr_write_b32 a46, 0
 v_mfma_f32_16x16x32_bf16 v[96:99], v[204:207], a[188:191], v[96:99]
 s_waitcnt lgkmcnt(4)
 v_mfma_f32_16x16x32_bf16 v[96:99], v[200:203], a[172:175], v[96:99]
 v_accvgpr_write_b32 a47, 0
 v_accvgpr_write_b32 a48, 0
 v_mfma_f32_16x16x32_bf16 v[4:7], v[208:211], a[160:163], v[4:7]
 ds_read_b64_tr_b16 v[200:201], v193 offset:16640
 ds_read_b64_tr_b16 v[202:203], v193 offset:17664
 v_mfma_f32_16x16x32_bf16 v[4:7], v[212:215], a[176:179], v[4:7]
 v_mfma_f32_16x16x32_bf16 v[36:39], v[212:215], a[180:183], v[36:39]
 s_add_u32 s82, s79, 29696
 ds_read_b64_tr_b16 v[204:205], v193 offset:24832
 v_accvgpr_write_b32 a49, 0
 v_mfma_f32_16x16x32_bf16 v[36:39], v[208:211], a[164:167], v[36:39]
 buffer_store_dwordx4 v[180:183], v251, s[52:55], s82 offen sc1
 v_mfma_f32_16x16x32_bf16 v[68:71], v[208:211], a[168:171], v[68:71]
 v_accvgpr_write_b32 a50, 0
 v_accvgpr_write_b32 a51, 0
 v_mfma_f32_16x16x32_bf16 v[68:71], v[212:215], a[184:187], v[68:71]
 ds_read_b64_tr_b16 v[206:207], v193 offset:25856
 v_accvgpr_write_b32 a52, 0
 v_mfma_f32_16x16x32_bf16 v[100:103], v[212:215], a[188:191], v[100:103]
 s_waitcnt lgkmcnt(4)
 v_mfma_f32_16x16x32_bf16 v[100:103], v[208:211], a[172:175], v[100:103]
 v_mfma_f32_16x16x32_bf16 v[8:11], v[216:219], a[160:163], v[8:11]
 ds_read_b64_tr_b16 v[208:209], v192 offset:16896
 v_accvgpr_write_b32 a53, 0
 v_mfma_f32_16x16x32_bf16 v[8:11], v[220:223], a[176:179], v[8:11]
 ds_read_b64_tr_b16 v[210:211], v192 offset:17920
 v_accvgpr_write_b32 a54, 0
 v_mfma_f32_16x16x32_bf16 v[40:43], v[220:223], a[180:183], v[40:43]
 v_mfma_f32_16x16x32_bf16 v[40:43], v[216:219], a[164:167], v[40:43]
 ds_read_b64_tr_b16 v[212:213], v192 offset:25088
 v_accvgpr_write_b32 a55, 0
 v_mfma_f32_16x16x32_bf16 v[72:75], v[216:219], a[168:171], v[72:75]
 buffer_load_dwordx4 v226, s[12:15], s75 offen offset:2048 lds
 v_mfma_f32_16x16x32_bf16 v[72:75], v[220:223], a[184:187], v[72:75]
 ds_read_b64_tr_b16 v[214:215], v192 offset:26112
 v_accvgpr_write_b32 a56, 0
 v_mfma_f32_16x16x32_bf16 v[104:107], v[220:223], a[188:191], v[104:107]
 s_waitcnt lgkmcnt(4)
 v_accvgpr_write_b32 a57, 0
 v_accvgpr_write_b32 a58, 0
 v_mfma_f32_16x16x32_bf16 v[104:107], v[216:219], a[172:175], v[104:107]
 v_mfma_f32_16x16x32_bf16 v[12:15], v[200:203], a[160:163], v[12:15]
 ds_read_b64_tr_b16 v[216:217], v193 offset:16896
 v_accvgpr_write_b32 a59, 0
 v_mfma_f32_16x16x32_bf16 v[12:15], v[204:207], a[176:179], v[12:15]
 ds_read_b64_tr_b16 v[218:219], v193 offset:17920
 v_accvgpr_write_b32 a60, 0
 v_mfma_f32_16x16x32_bf16 v[44:47], v[204:207], a[180:183], v[44:47]
 v_mfma_f32_16x16x32_bf16 v[44:47], v[200:203], a[164:167], v[44:47]
 ds_read_b64_tr_b16 v[220:221], v193 offset:25088
 v_accvgpr_write_b32 a61, 0
 v_mfma_f32_16x16x32_bf16 v[76:79], v[200:203], a[168:171], v[76:79]
 s_add_u32 s82, s79, 22528
 v_mfma_f32_16x16x32_bf16 v[76:79], v[204:207], a[184:187], v[76:79]
 buffer_store_dwordx4 v[152:155], v251, s[52:55], s82 offen sc1
 v_mfma_f32_16x16x32_bf16 v[108:111], v[204:207], a[188:191], v[108:111]
 s_waitcnt lgkmcnt(3)
 ds_read_b64_tr_b16 v[222:223], v193 offset:26112
 v_accvgpr_write_b32 a62, 0
 v_mfma_f32_16x16x32_bf16 v[108:111], v[200:203], a[172:175], v[108:111]
 v_accvgpr_write_b32 a63, 0
 v_accvgpr_write_b32 a64, 0
 v_mfma_f32_16x16x32_bf16 v[16:19], v[208:211], a[160:163], v[16:19]
 ds_read_b64_tr_b16 v[200:201], v192 offset:17152
 ds_read_b64_tr_b16 v[202:203], v192 offset:18176
 v_mfma_f32_16x16x32_bf16 v[16:19], v[212:215], a[176:179], v[16:19]
 v_mfma_f32_16x16x32_bf16 v[48:51], v[212:215], a[180:183], v[48:51]
 v_accvgpr_write_b32 a65, 0
 v_accvgpr_write_b32 a66, 0
 v_mfma_f32_16x16x32_bf16 v[48:51], v[208:211], a[164:167], v[48:51]
 ds_read_b64_tr_b16 v[204:205], v192 offset:25344
 v_accvgpr_write_b32 a67, 0
 v_mfma_f32_16x16x32_bf16 v[80:83], v[208:211], a[168:171], v[80:83]
 v_mfma_f32_16x16x32_bf16 v[80:83], v[212:215], a[184:187], v[80:83]
 ds_read_b64_tr_b16 v[206:207], v192 offset:26368
 v_accvgpr_write_b32 a68, 0
 v_mfma_f32_16x16x32_bf16 v[112:115], v[212:215], a[188:191], v[112:115]
 buffer_load_dwordx4 v227, s[12:15], s75 offen offset:3072 lds
 v_mfma_f32_16x16x32_bf16 v[112:115], v[208:211], a[172:175], v[112:115]
 s_waitcnt lgkmcnt(4)
 v_mfma_f32_16x16x32_bf16 v[20:23], v[216:219], a[160:163], v[20:23]
 ds_read_b64_tr_b16 v[208:209], v193 offset:17152
 v_accvgpr_write_b32 a69, 0
 v_mfma_f32_16x16x32_bf16 v[20:23], v[220:223], a[176:179], v[20:23]
 ds_read_b64_tr_b16 v[210:211], v193 offset:18176
 v_accvgpr_write_b32 a70, 0
 v_mfma_f32_16x16x32_bf16 v[52:55], v[220:223], a[180:183], v[52:55]
 v_mfma_f32_16x16x32_bf16 v[52:55], v[216:219], a[164:167], v[52:55]
 ds_read_b64_tr_b16 v[212:213], v193 offset:25344
 v_accvgpr_write_b32 a71, 0
 v_mfma_f32_16x16x32_bf16 v[84:87], v[216:219], a[168:171], v[84:87]
 ds_read_b64_tr_b16 v[214:215], v193 offset:26368
 v_accvgpr_write_b32 a72, 0
 v_mfma_f32_16x16x32_bf16 v[84:87], v[220:223], a[184:187], v[84:87]
 s_add_u32 s75, s75, 524288
 v_mfma_f32_16x16x32_bf16 v[116:119], v[220:223], a[188:191], v[116:119]
 s_bitset0_b32 s75, 22
 v_accvgpr_write_b32 a73, 0
 v_accvgpr_write_b32 a74, 0
 v_mfma_f32_16x16x32_bf16 v[116:119], v[216:219], a[172:175], v[116:119]
 s_waitcnt vmcnt(8)
 s_waitcnt lgkmcnt(4)
 v_accvgpr_write_b32 a75, 0
 v_mfma_f32_16x16x32_bf16 v[24:27], v[200:203], a[160:163], v[24:27]
 s_barrier
 ds_read_b64_tr_b16 v[216:217], v194 offset:0
 ds_read_b64_tr_b16 v[218:219], v194 offset:1024
 v_mfma_f32_16x16x32_bf16 v[24:27], v[204:207], a[176:179], v[24:27]
 buffer_load_dword v239, v238, s[52:55], s72 offen sc1
 v_mfma_f32_16x16x32_bf16 v[56:59], v[204:207], a[180:183], v[56:59]
 ds_read_b64_tr_b16 v[220:221], v194 offset:8192
 v_accvgpr_write_b32 a76, 0
 v_mfma_f32_16x16x32_bf16 v[56:59], v[200:203], a[164:167], v[56:59]
 v_mfma_f32_16x16x32_bf16 v[88:91], v[200:203], a[168:171], v[88:91]
 v_accvgpr_write_b32 a77, 0
 v_accvgpr_write_b32 a78, 0
 v_mfma_f32_16x16x32_bf16 v[88:91], v[204:207], a[184:187], v[88:91]
 ds_read_b64_tr_b16 v[222:223], v194 offset:9216
 v_accvgpr_write_b32 a79, 0
 v_mfma_f32_16x16x32_bf16 v[120:123], v[204:207], a[188:191], v[120:123]
 s_waitcnt lgkmcnt(4)
 v_mfma_f32_16x16x32_bf16 v[120:123], v[200:203], a[172:175], v[120:123]
 v_mfma_f32_16x16x32_bf16 v[28:31], v[208:211], a[160:163], v[28:31]
 ds_read_b64_tr_b16 v[200:201], v195 offset:0
 v_accvgpr_write_b32 a80, 0
 v_mfma_f32_16x16x32_bf16 v[28:31], v[212:215], a[176:179], v[28:31]
 ds_read_b64_tr_b16 v[202:203], v195 offset:1024
 v_accvgpr_write_b32 a81, 0
 v_mfma_f32_16x16x32_bf16 v[60:63], v[212:215], a[180:183], v[60:63]
 v_mfma_f32_16x16x32_bf16 v[60:63], v[208:211], a[164:167], v[60:63]
 ds_read_b64_tr_b16 v[204:205], v195 offset:8192
 v_accvgpr_write_b32 a82, 0
 v_mfma_f32_16x16x32_bf16 v[92:95], v[208:211], a[168:171], v[92:95]
 v_mfma_f32_16x16x32_bf16 v[92:95], v[212:215], a[184:187], v[92:95]
 ds_read_b64_tr_b16 v[206:207], v195 offset:9216
 v_accvgpr_write_b32 a83, 0
 v_mfma_f32_16x16x32_bf16 v[124:127], v[212:215], a[188:191], v[124:127]
 s_waitcnt lgkmcnt(4) vmcnt(25)
 v_accvgpr_write_b32 a84, 0
 v_accvgpr_write_b32 a85, 0
 v_mfma_f32_16x16x32_bf16 v[124:127], v[208:211], a[172:175], v[124:127]
 s_add_u32 s82, s79, 30720
 v_mfma_f32_16x16x32_bf16 v[0:3], v[216:219], a[192:195], v[0:3]
 ds_read_b64_tr_b16 v[208:209], v194 offset:256
 v_accvgpr_write_b32 a86, 0
 v_mfma_f32_16x16x32_bf16 v[0:3], v[220:223], a[208:211], v[0:3]
 buffer_store_dwordx4 v[184:187], v251, s[52:55], s82 offen sc1
 v_mfma_f32_16x16x32_bf16 v[32:35], v[220:223], a[212:215], v[32:35]
 ds_read_b64_tr_b16 v[210:211], v194 offset:1280
 v_accvgpr_write_b32 a87, 0
 v_mfma_f32_16x16x32_bf16 v[32:35], v[216:219], a[196:199], v[32:35]
 ds_read_b64_tr_b16 v[212:213], v194 offset:8448
 v_accvgpr_write_b32 a88, 0
 v_mfma_f32_16x16x32_bf16 v[64:67], v[216:219], a[200:203], v[64:67]
 v_mfma_f32_16x16x32_bf16 v[64:67], v[220:223], a[216:219], v[64:67]
 ds_read_b64_tr_b16 v[214:215], v194 offset:9472
 v_accvgpr_write_b32 a89, 0
 v_mfma_f32_16x16x32_bf16 v[96:99], v[220:223], a[220:223], v[96:99]
 s_waitcnt lgkmcnt(4)
 v_mfma_f32_16x16x32_bf16 v[96:99], v[216:219], a[204:207], v[96:99]
 v_accvgpr_write_b32 a90, 0
 v_accvgpr_write_b32 a91, 0
 v_mfma_f32_16x16x32_bf16 v[4:7], v[200:203], a[192:195], v[4:7]
 ds_read_b64_tr_b16 v[216:217], v195 offset:256
 ds_read_b64_tr_b16 v[218:219], v195 offset:1280
 v_mfma_f32_16x16x32_bf16 v[4:7], v[204:207], a[208:211], v[4:7]
 v_mfma_f32_16x16x32_bf16 v[36:39], v[204:207], a[212:215], v[36:39]
 ds_read_b64_tr_b16 v[220:221], v195 offset:8448
 v_accvgpr_write_b32 a92, 0
 v_mfma_f32_16x16x32_bf16 v[36:39], v[200:203], a[196:199], v[36:39]
 v_mfma_f32_16x16x32_bf16 v[68:71], v[200:203], a[200:203], v[68:71]
 v_accvgpr_write_b32 a93, 0
 v_accvgpr_write_b32 a94, 0
 v_mfma_f32_16x16x32_bf16 v[68:71], v[204:207], a[216:219], v[68:71]
 ds_read_b64_tr_b16 v[222:223], v195 offset:9472
 v_accvgpr_write_b32 a95, 0
 v_mfma_f32_16x16x32_bf16 v[100:103], v[204:207], a[220:223], v[100:103]
 s_waitcnt lgkmcnt(4)
 v_mfma_f32_16x16x32_bf16 v[100:103], v[200:203], a[204:207], v[100:103]
 s_add_u32 s82, s79, 23552
 v_mfma_f32_16x16x32_bf16 v[8:11], v[208:211], a[192:195], v[8:11]
 ds_read_b64_tr_b16 v[200:201], v194 offset:512
 v_accvgpr_write_b32 a96, 0
 v_mfma_f32_16x16x32_bf16 v[8:11], v[212:215], a[208:211], v[8:11]
 buffer_store_dwordx4 v[156:159], v251, s[52:55], s82 offen sc1
 v_mfma_f32_16x16x32_bf16 v[40:43], v[212:215], a[212:215], v[40:43]
 ds_read_b64_tr_b16 v[202:203], v194 offset:1536
 v_accvgpr_write_b32 a97, 0
 v_mfma_f32_16x16x32_bf16 v[40:43], v[208:211], a[196:199], v[40:43]
 ds_read_b64_tr_b16 v[204:205], v194 offset:8704
 v_accvgpr_write_b32 a98, 0
 v_mfma_f32_16x16x32_bf16 v[72:75], v[208:211], a[200:203], v[72:75]
 ds_read_b64_tr_b16 v[206:207], v194 offset:9728
 v_accvgpr_write_b32 a99, 0
 v_mfma_f32_16x16x32_bf16 v[72:75], v[212:215], a[216:219], v[72:75]
 v_mfma_f32_16x16x32_bf16 v[104:107], v[212:215], a[220:223], v[104:107]
 s_waitcnt lgkmcnt(4)
 v_accvgpr_write_b32 a100, 0
 v_accvgpr_write_b32 a101, 0
 v_mfma_f32_16x16x32_bf16 v[104:107], v[208:211], a[204:207], v[104:107]
 v_mfma_f32_16x16x32_bf16 v[12:15], v[216:219], a[192:195], v[12:15]
 ds_read_b64_tr_b16 v[208:209], v195 offset:512
 v_accvgpr_write_b32 a102, 0
 v_mfma_f32_16x16x32_bf16 v[12:15], v[220:223], a[208:211], v[12:15]
 ds_read_b64_tr_b16 v[210:211], v195 offset:1536
 v_accvgpr_write_b32 a103, 0
 v_mfma_f32_16x16x32_bf16 v[44:47], v[220:223], a[212:215], v[44:47]
 v_mfma_f32_16x16x32_bf16 v[44:47], v[216:219], a[196:199], v[44:47]
 ds_read_b64_tr_b16 v[212:213], v195 offset:8704
 v_accvgpr_write_b32 a104, 0
 v_mfma_f32_16x16x32_bf16 v[76:79], v[216:219], a[200:203], v[76:79]
 v_mfma_f32_16x16x32_bf16 v[76:79], v[220:223], a[216:219], v[76:79]
 ds_read_b64_tr_b16 v[214:215], v195 offset:9728
 v_accvgpr_write_b32 a105, 0
 v_mfma_f32_16x16x32_bf16 v[108:111], v[220:223], a[220:223], v[108:111]
 s_waitcnt lgkmcnt(4)
 v_mfma_f32_16x16x32_bf16 v[108:111], v[216:219], a[204:207], v[108:111]
 s_add_u32 s82, s79, 31744
 v_accvgpr_write_b32 a106, 0
 v_accvgpr_write_b32 a107, 0
 v_mfma_f32_16x16x32_bf16 v[16:19], v[200:203], a[192:195], v[16:19]
 buffer_store_dwordx4 v[188:191], v251, s[52:55], s82 offen sc1
 v_mfma_f32_16x16x32_bf16 v[16:19], v[204:207], a[208:211], v[16:19]
 ds_read_b64_tr_b16 v[216:217], v194 offset:768
 ds_read_b64_tr_b16 v[218:219], v194 offset:1792
 v_mfma_f32_16x16x32_bf16 v[48:51], v[204:207], a[212:215], v[48:51]
 v_accvgpr_write_b32 a108, 0
 v_accvgpr_write_b32 a109, 0
 v_mfma_f32_16x16x32_bf16 v[48:51], v[200:203], a[196:199], v[48:51]
 ds_read_b64_tr_b16 v[220:221], v194 offset:8960
 v_accvgpr_write_b32 a110, 0
 v_mfma_f32_16x16x32_bf16 v[80:83], v[200:203], a[200:203], v[80:83]
 v_mfma_f32_16x16x32_bf16 v[80:83], v[204:207], a[216:219], v[80:83]
 ds_read_b64_tr_b16 v[222:223], v194 offset:9984
 v_accvgpr_write_b32 a111, 0
 v_mfma_f32_16x16x32_bf16 v[112:115], v[204:207], a[220:223], v[112:115]
 s_waitcnt lgkmcnt(4)
 v_mfma_f32_16x16x32_bf16 v[112:115], v[200:203], a[204:207], v[112:115]
 v_mfma_f32_16x16x32_bf16 v[20:23], v[208:211], a[192:195], v[20:23]
 ds_read_b64_tr_b16 v[200:201], v195 offset:768
 v_accvgpr_write_b32 a112, 0
 v_mfma_f32_16x16x32_bf16 v[20:23], v[212:215], a[208:211], v[20:23]
 ds_read_b64_tr_b16 v[202:203], v195 offset:1792
 v_accvgpr_write_b32 a113, 0
 v_mfma_f32_16x16x32_bf16 v[52:55], v[212:215], a[212:215], v[52:55]
 v_mfma_f32_16x16x32_bf16 v[52:55], v[208:211], a[196:199], v[52:55]
 ds_read_b64_tr_b16 v[204:205], v195 offset:8960
 v_accvgpr_write_b32 a114, 0
 v_mfma_f32_16x16x32_bf16 v[84:87], v[208:211], a[200:203], v[84:87]
 ds_read_b64_tr_b16 v[206:207], v195 offset:9984
 v_accvgpr_write_b32 a115, 0
 v_mfma_f32_16x16x32_bf16 v[84:87], v[212:215], a[216:219], v[84:87]
 v_mfma_f32_16x16x32_bf16 v[116:119], v[212:215], a[220:223], v[116:119]
 s_waitcnt lgkmcnt(4)
 v_accvgpr_write_b32 a116, 0
 v_accvgpr_write_b32 a117, 0
 v_mfma_f32_16x16x32_bf16 v[116:119], v[208:211], a[204:207], v[116:119]
 s_waitcnt vmcnt(4)
 v_mfma_f32_16x16x32_bf16 v[24:27], v[216:219], a[192:195], v[24:27]
 s_barrier
 ds_read_b64_tr_b16 v[208:209], v194 offset:16384
 v_accvgpr_write_b32 a118, 0
 v_mfma_f32_16x16x32_bf16 v[24:27], v[220:223], a[208:211], v[24:27]
 s_waitcnt vmcnt(3)
 ds_read_b64_tr_b16 v[210:211], v194 offset:17408
 v_accvgpr_write_b32 a119, 0
 v_mfma_f32_16x16x32_bf16 v[56:59], v[220:223], a[212:215], v[56:59]
 ds_read_b64_tr_b16 v[212:213], v194 offset:24576
 v_cmp_gt_u32 vcc, 8, v239
 v_mfma_f32_16x16x32_bf16 v[56:59], v[216:219], a[196:199], v[56:59]
 s_cbranch_vccnz Lfs7
Lfb8:
 v_mfma_f32_16x16x32_bf16 v[88:91], v[216:219], a[200:203], v[88:91]
 s_add_u32 m0, s73, 147456
 v_accvgpr_write_b32 a120, 0
 v_accvgpr_write_b32 a121, 0
 v_mfma_f32_16x16x32_bf16 v[88:91], v[220:223], a[216:219], v[88:91]
 s_add_u32 s77, s73, 0
 ds_read_b64_tr_b16 v[214:215], v194 offset:25600
 v_accvgpr_write_b32 a122, 0
 v_mfma_f32_16x16x32_bf16 v[120:123], v[220:223], a[220:223], v[120:123]
 buffer_load_dwordx4 v251, s[56:59], s77 offen offset:0 sc1 lds
 v_mfma_f32_16x16x32_bf16 v[120:123], v[216:219], a[204:207], v[120:123]
 s_waitcnt lgkmcnt(4)
 v_mfma_f32_16x16x32_bf16 v[28:31], v[200:203], a[192:195], v[28:31]
 ds_read_b64_tr_b16 v[216:217], v195 offset:16384
 v_accvgpr_write_b32 a123, 0
 v_mfma_f32_16x16x32_bf16 v[28:31], v[204:207], a[208:211], v[28:31]
 buffer_load_dwordx4 v251, s[56:59], s77 offen offset:1024 sc1 lds
 v_mfma_f32_16x16x32_bf16 v[60:63], v[204:207], a[212:215], v[60:63]
 ds_read_b64_tr_b16 v[218:219], v195 offset:17408
 v_accvgpr_write_b32 a124, 0
 v_mfma_f32_16x16x32_bf16 v[60:63], v[200:203], a[196:199], v[60:63]
 ds_read_b64_tr_b16 v[220:221], v195 offset:24576
 v_accvgpr_write_b32 a125, 0
 v_mfma_f32_16x16x32_bf16 v[92:95], v[200:203], a[200:203], v[92:95]
 v_mfma_f32_16x16x32_bf16 v[92:95], v[204:207], a[216:219], v[92:95]
 ds_read_b64_tr_b16 v[222:223], v195 offset:25600
 v_accvgpr_write_b32 a126, 0
 v_mfma_f32_16x16x32_bf16 v[124:127], v[204:207], a[220:223], v[124:127]
 s_waitcnt lgkmcnt(4) vmcnt(13)
 v_accvgpr_write_b32 a127, 0
 v_mfma_f32_16x16x32_bf16 v[124:127], v[200:203], a[204:207], v[124:127]
 buffer_load_dwordx4 v251, s[56:59], s77 offen offset:2048 sc1 lds
 v_mfma_f32_16x16x32_bf16 v[0:3], v[208:211], a[224:227], v[0:3]
 ds_read_b64_tr_b16 v[200:201], v194 offset:16640
 ds_read_b64_tr_b16 v[202:203], v194 offset:17664
 v_mfma_f32_16x16x32_bf16 v[0:3], v[212:215], a[240:243], v[0:3]
 v_mfma_f32_16x16x32_bf16 v[32:35], v[212:215], a[244:247], v[32:35]
 v_mfma_f32_16x16x32_bf16 v[32:35], v[208:211], a[228:231], v[32:35]
 ds_read_b64_tr_b16 v[204:205], v194 offset:24832
 ds_read_b64_tr_b16 v[206:207], v194 offset:25856
 v_mfma_f32_16x16x32_bf16 v[64:67], v[208:211], a[232:235], v[64:67]
 v_mfma_f32_16x16x32_bf16 v[64:67], v[212:215], a[248:251], v[64:67]
 s_nop 1
 v_cvt_pk_bf16_f32 v128, v0, v1
 v_cvt_pk_bf16_f32 v129, v2, v3
 v_mfma_f32_16x16x32_bf16 v[96:99], v[212:215], a[252:255], v[96:99]
 buffer_load_dwordx4 v251, s[56:59], s77 offen offset:3072 sc1 lds
 v_mfma_f32_16x16x32_bf16 v[96:99], v[208:211], a[236:239], v[96:99]
 s_waitcnt lgkmcnt(4)
 v_cvt_pk_bf16_f32 v130, v32, v33
 v_cvt_pk_bf16_f32 v131, v34, v35
 v_mfma_f32_16x16x32_bf16 v[4:7], v[216:219], a[224:227], v[4:7]
 ds_read_b64_tr_b16 v[208:209], v195 offset:16640
 v_accvgpr_write_b32 a160, v128
 v_mfma_f32_16x16x32_bf16 v[4:7], v[220:223], a[240:243], v[4:7]
 v_accvgpr_write_b32 a161, v129
 v_cvt_pk_bf16_f32 v132, v64, v65
 v_mfma_f32_16x16x32_bf16 v[36:39], v[220:223], a[244:247], v[36:39]
 s_add_u32 m0, s73, 49152
 v_cvt_pk_bf16_f32 v133, v66, v67
 v_accvgpr_write_b32 a164, v130
 v_mfma_f32_16x16x32_bf16 v[36:39], v[216:219], a[228:231], v[36:39]
 s_add_u32 s77, s73, 32768
 ds_read_b64_tr_b16 v[210:211], v195 offset:17664
 v_accvgpr_write_b32 a165, v131
 v_mfma_f32_16x16x32_bf16 v[68:71], v[216:219], a[232:235], v[68:71]
 v_cvt_pk_bf16_f32 v134, v96, v97
 v_cvt_pk_bf16_f32 v135, v98, v99
 v_mfma_f32_16x16x32_bf16 v[68:71], v[220:223], a[248:251], v[68:71]
 buffer_load_dwordx4 v251, s[56:59], s77 offen offset:0 sc1 lds
 v_mfma_f32_16x16x32_bf16 v[100:103], v[220:223], a[252:255], v[100:103]
 s_waitcnt lgkmcnt(2)
 ds_read_b64_tr_b16 v[212:213], v195 offset:24832
 v_accvgpr_write_b32 a128, v132
 v_mfma_f32_16x16x32_bf16 v[100:103], v[216:219], a[236:239], v[100:103]
 v_accvgpr_write_b32 a129, v133
 v_cvt_pk_bf16_f32 v128, v4, v5
 v_mfma_f32_16x16x32_bf16 v[8:11], v[200:203], a[224:227], v[8:11]
 ds_read_b64_tr_b16 v[214:215], v195 offset:25856
 v_cvt_pk_bf16_f32 v129, v6, v7
 v_mfma_f32_16x16x32_bf16 v[8:11], v[204:207], a[240:243], v[8:11]
 v_accvgpr_write_b32 a132, v134
 v_accvgpr_write_b32 a133, v135
 v_mfma_f32_16x16x32_bf16 v[40:43], v[204:207], a[244:247], v[40:43]
 ds_read_b64_tr_b16 v[216:217], v194 offset:16896
 v_cvt_pk_bf16_f32 v130, v36, v37
 v_mfma_f32_16x16x32_bf16 v[40:43], v[200:203], a[228:231], v[40:43]
 v_cvt_pk_bf16_f32 v131, v38, v39
 v_accvgpr_write_b32 a162, v128
 v_mfma_f32_16x16x32_bf16 v[72:75], v[200:203], a[232:235], v[72:75]
 buffer_load_dwordx4 v251, s[56:59], s77 offen offset:1024 sc1 lds
 v_accvgpr_write_b32 a163, v129
 v_mfma_f32_16x16x32_bf16 v[72:75], v[204:207], a[248:251], v[72:75]
 ds_read_b64_tr_b16 v[218:219], v194 offset:17920
 v_cvt_pk_bf16_f32 v132, v68, v69
 v_mfma_f32_16x16x32_bf16 v[104:107], v[204:207], a[252:255], v[104:107]
 s_waitcnt lgkmcnt(2)
 v_cvt_pk_bf16_f32 v133, v70, v71
 v_accvgpr_write_b32 a166, v130
 v_mfma_f32_16x16x32_bf16 v[104:107], v[200:203], a[236:239], v[104:107]
 ds_read_b64_tr_b16 v[220:221], v194 offset:25088
 v_accvgpr_write_b32 a167, v131
 v_cvt_pk_bf16_f32 v134, v100, v101
 v_mfma_f32_16x16x32_bf16 v[12:15], v[208:211], a[224:227], v[12:15]
 ds_read_b64_tr_b16 v[222:223], v194 offset:26112
 v_cvt_pk_bf16_f32 v135, v102, v103
 v_mfma_f32_16x16x32_bf16 v[12:15], v[212:215], a[240:243], v[12:15]
 buffer_load_dwordx4 v251, s[56:59], s77 offen offset:2048 sc1 lds
 v_accvgpr_write_b32 a130, v132
 v_accvgpr_write_b32 a131, v133
 v_mfma_f32_16x16x32_bf16 v[44:47], v[212:215], a[244:247], v[44:47]
 ds_read_b64_tr_b16 v[200:201], v195 offset:16896
 v_cvt_pk_bf16_f32 v128, v8, v9
 v_mfma_f32_16x16x32_bf16 v[44:47], v[208:211], a[228:231], v[44:47]
 v_cvt_pk_bf16_f32 v129, v10, v11
 v_accvgpr_write_b32 a134, v134
 v_mfma_f32_16x16x32_bf16 v[76:79], v[208:211], a[232:235], v[76:79]
 v_accvgpr_write_b32 a135, v135
 v_cvt_pk_bf16_f32 v130, v40, v41
 v_mfma_f32_16x16x32_bf16 v[76:79], v[212:215], a[248:251], v[76:79]
 ds_read_b64_tr_b16 v[202:203], v195 offset:17920
 v_cvt_pk_bf16_f32 v131, v42, v43
 v_mfma_f32_16x16x32_bf16 v[108:111], v[212:215], a[252:255], v[108:111]
 s_waitcnt lgkmcnt(2)
 v_accvgpr_write_b32 a168, v128
 v_accvgpr_write_b32 a169, v129
 v_mfma_f32_16x16x32_bf16 v[108:111], v[208:211], a[236:239], v[108:111]
 ds_read_b64_tr_b16 v[204:205], v195 offset:25088
 buffer_load_dwordx4 v251, s[56:59], s77 offen offset:3072 sc1 lds
 v_cvt_pk_bf16_f32 v132, v72, v73
 v_cvt_pk_bf16_f32 v133, v74, v75
 v_mfma_f32_16x16x32_bf16 v[16:19], v[216:219], a[224:227], v[16:19]
 ds_read_b64_tr_b16 v[206:207], v195 offset:26112
 v_accvgpr_write_b32 a172, v130
 v_mfma_f32_16x16x32_bf16 v[16:19], v[220:223], a[240:243], v[16:19]
 s_add_u32 m0, s73, 81920
 v_accvgpr_write_b32 a173, v131
 v_cvt_pk_bf16_f32 v134, v104, v105
 v_mfma_f32_16x16x32_bf16 v[48:51], v[220:223], a[244:247], v[48:51]
 s_add_u32 s77, s73, 65536
 ds_read_b64_tr_b16 v[208:209], v194 offset:17152
 v_cvt_pk_bf16_f32 v135, v106, v107
 v_mfma_f32_16x16x32_bf16 v[48:51], v[216:219], a[228:231], v[48:51]
 v_accvgpr_write_b32 a136, v132
 v_accvgpr_write_b32 a137, v133
 v_mfma_f32_16x16x32_bf16 v[80:83], v[216:219], a[232:235], v[80:83]
 v_cvt_pk_bf16_f32 v128, v12, v13
 v_cvt_pk_bf16_f32 v129, v14, v15
 v_mfma_f32_16x16x32_bf16 v[80:83], v[220:223], a[248:251], v[80:83]
 ds_read_b64_tr_b16 v[210:211], v194 offset:18176
 buffer_load_dwordx4 v251, s[56:59], s77 offen offset:0 sc1 lds
 v_accvgpr_write_b32 a140, v134
 v_mfma_f32_16x16x32_bf16 v[112:115], v[220:223], a[252:255], v[112:115]
 s_waitcnt lgkmcnt(2)
 v_accvgpr_write_b32 a141, v135
 v_cvt_pk_bf16_f32 v130, v44, v45
 v_mfma_f32_16x16x32_bf16 v[112:115], v[216:219], a[236:239], v[112:115]
 ds_read_b64_tr_b16 v[212:213], v194 offset:25344
 v_cvt_pk_bf16_f32 v131, v46, v47
 v_accvgpr_write_b32 a170, v128
 v_mfma_f32_16x16x32_bf16 v[20:23], v[200:203], a[224:227], v[20:23]
 ds_read_b64_tr_b16 v[214:215], v194 offset:26368
 v_accvgpr_write_b32 a171, v129
 v_mfma_f32_16x16x32_bf16 v[20:23], v[204:207], a[240:243], v[20:23]
 v_cvt_pk_bf16_f32 v132, v76, v77
 v_cvt_pk_bf16_f32 v133, v78, v79
 v_mfma_f32_16x16x32_bf16 v[52:55], v[204:207], a[244:247], v[52:55]
 ds_read_b64_tr_b16 v[216:217], v195 offset:17152
 v_accvgpr_write_b32 a174, v130
 v_mfma_f32_16x16x32_bf16 v[52:55], v[200:203], a[228:231], v[52:55]
 buffer_load_dwordx4 v251, s[56:59], s77 offen offset:1024 sc1 lds
 v_accvgpr_write_b32 a175, v131
 v_cvt_pk_bf16_f32 v134, v108, v109
 v_mfma_f32_16x16x32_bf16 v[84:87], v[200:203], a[232:235], v[84:87]
 v_cvt_pk_bf16_f32 v135, v110, v111
 v_accvgpr_write_b32 a138, v132
 v_mfma_f32_16x16x32_bf16 v[84:87], v[204:207], a[248:251], v[84:87]
 ds_read_b64_tr_b16 v[218:219], v195 offset:18176
 v_accvgpr_write_b32 a139, v133
 v_mfma_f32_16x16x32_bf16 v[116:119], v[204:207], a[252:255], v[116:119]
 s_waitcnt lgkmcnt(2)
 v_cvt_pk_bf16_f32 v128, v16, v17
 v_cvt_pk_bf16_f32 v129, v18, v19
 v_mfma_f32_16x16x32_bf16 v[116:119], v[200:203], a[236:239], v[116:119]
 ds_read_b64_tr_b16 v[220:221], v195 offset:25344
 v_accvgpr_write_b32 a142, v134
 v_accvgpr_write_b32 a143, v135
 v_mfma_f32_16x16x32_bf16 v[24:27], v[208:211], a[224:227], v[24:27]
 ds_read_b64_tr_b16 v[222:223], v195 offset:26368
 v_cvt_pk_bf16_f32 v130, v48, v49
 v_mfma_f32_16x16x32_bf16 v[24:27], v[212:215], a[240:243], v[24:27]
 buffer_load_dwordx4 v251, s[56:59], s77 offen offset:2048 sc1 lds
 v_cvt_pk_bf16_f32 v131, v50, v51
 v_accvgpr_write_b32 a176, v128
 v_mfma_f32_16x16x32_bf16 v[56:59], v[212:215], a[244:247], v[56:59]
 v_accvgpr_write_b32 a177, v129
 v_cvt_pk_bf16_f32 v132, v80, v81
 v_mfma_f32_16x16x32_bf16 v[56:59], v[208:211], a[228:231], v[56:59]
 v_cvt_pk_bf16_f32 v133, v82, v83
 v_accvgpr_write_b32 a180, v130
 v_mfma_f32_16x16x32_bf16 v[88:91], v[208:211], a[232:235], v[88:91]
 v_accvgpr_write_b32 a181, v131
 v_cvt_pk_bf16_f32 v134, v112, v113
 v_mfma_f32_16x16x32_bf16 v[88:91], v[212:215], a[248:251], v[88:91]
 v_cvt_pk_bf16_f32 v135, v114, v115
 v_accvgpr_write_b32 a144, v132
 v_mfma_f32_16x16x32_bf16 v[120:123], v[212:215], a[252:255], v[120:123]
 buffer_load_dwordx4 v251, s[56:59], s77 offen offset:3072 sc1 lds
 v_mfma_f32_16x16x32_bf16 v[120:123], v[208:211], a[236:239], v[120:123]
 s_waitcnt lgkmcnt(0)
 v_accvgpr_write_b32 a145, v133
 v_cvt_pk_bf16_f32 v128, v20, v21
 v_mfma_f32_16x16x32_bf16 v[28:31], v[216:219], a[224:227], v[28:31]
 s_add_u32 s67, s76, 0x18000
 v_cvt_pk_bf16_f32 v129, v22, v23
 v_accvgpr_write_b32 a148, v134
 v_mfma_f32_16x16x32_bf16 v[28:31], v[220:223], a[240:243], v[28:31]
 s_mov_b32 s66, 81920
 s_add_u32 s72, s72, 4294951936
 v_accvgpr_write_b32 a149, v135
 v_mfma_f32_16x16x32_bf16 v[60:63], v[220:223], a[244:247], v[60:63]
 v_cvt_pk_bf16_f32 v130, v52, v53
 v_cvt_pk_bf16_f32 v131, v54, v55
 v_mfma_f32_16x16x32_bf16 v[60:63], v[216:219], a[228:231], v[60:63]
 v_accvgpr_write_b32 a178, v128
 v_accvgpr_write_b32 a179, v129
 v_mfma_f32_16x16x32_bf16 v[92:95], v[216:219], a[232:235], v[92:95]
 v_cvt_pk_bf16_f32 v132, v84, v85
 v_cvt_pk_bf16_f32 v133, v86, v87
 v_mfma_f32_16x16x32_bf16 v[92:95], v[220:223], a[248:251], v[92:95]
 v_accvgpr_write_b32 a182, v130
 v_accvgpr_write_b32 a183, v131
 v_mfma_f32_16x16x32_bf16 v[124:127], v[220:223], a[252:255], v[124:127]
 v_cvt_pk_bf16_f32 v134, v116, v117
 v_cvt_pk_bf16_f32 v135, v118, v119
 v_mfma_f32_16x16x32_bf16 v[124:127], v[216:219], a[236:239], v[124:127]
 v_accvgpr_write_b32 a146, v132
 v_accvgpr_write_b32 a147, v133
 v_cvt_pk_bf16_f32 v128, v24, v25
 v_cvt_pk_bf16_f32 v129, v26, v27
Latt:
 v_add_u32 v217, 0x18000, v251
 s_mov_b32 s75, 0x53800000
 s_mov_b32 s74, 0
 s_waitcnt vmcnt(8)
 s_barrier
 ds_read_b128 a[192:195], v217 offset:49152
 ds_read_b128 a[196:199], v217 offset:50176
 ds_read_b128 a[200:203], v217 offset:51200
 ds_read_b128 a[204:207], v217 offset:52224
 ds_read_b128 a[208:211], v217 offset:53248
 ds_read_b128 a[212:215], v217 offset:54272
 ds_read_b128 a[216:219], v217 offset:55296
 ds_read_b128 a[220:223], v217 offset:56320
 s_cmp_lg_u32 s60, 0
 s_cbranch_scc1 Lna16
 v_mov_b32 v250, 1
 v_mov_b32 v249, 0
 s_mov_b64 exec, 1
 buffer_atomic_add v250, v249, s[52:55], s72 offen sc1
 s_mov_b64 exec, -1
Lna16:
 s_getpc_b64 s[80:81]
Lpc17:
 s_lshr_b32 s78, s2, 3
 s_lshl_b32 s78, s78, 12
 v_and_b32 v249, 7, v253
 v_lshl_add_u32 v249, v252, 3, v249
 v_lshl_add_u32 v249, v249, 7, s78
 v_min_u32 v249, sequential_preLN__compressed_kv_cla__mixer_gmlp__prompt_kernel_last-Lpc17, v249
 global_load_dword v221, v249, s[80:81]
 v_mov_b32 v220, 0xff800000
 v_bfe_u32 v216, v253, 2, 2
 v_lshlrev_b32 v216, 3, v216
 v_and_b32 v248, 3, v253
 v_add_u32 v216, v216, v248
 v_and_b32 v248, 1, v252
 v_lshl_add_u32 v216, v248, 2, v216
 v_lshrrev_b32 v248, 1, v252
 v_lshl_add_u32 v216, v248, 5, v216
 v_lshrrev_b32 v248, 4, v253
 v_lshlrev_b32 v248, 2, v248
 v_sub_u32 v216, v216, v248
 v_cmp_le_i32 s[8:9], 0, v216
 v_cmp_le_i32 s[10:11], 1, v216
 v_cmp_le_i32 s[12:13], 2, v216
 v_cmp_le_i32 s[14:15], 3, v216
 v_cmp_le_i32 s[16:17], 16, v216
 v_cmp_le_i32 s[18:19], 17, v216
 v_cmp_le_i32 s[20:21], 18, v216
 v_cmp_le_i32 s[22:23], 19, v216
 v_cmp_le_i32 s[48:49], 32, v216
 v_cmp_le_i32 s[50:51], 33, v216
 v_cmp_le_i32 s[82:83], 34, v216
 v_cmp_le_i32 s[84:85], 35, v216
 v_cmp_le_i32 s[86:87], 48, v216
 v_cmp_le_i32 s[88:89], 49, v216
 v_cmp_le_i32 s[90:91], 50, v216
 v_cmp_le_i32 s[92:93], 51, v216
 v_accvgpr_write_b32 a150, v134
 v_accvgpr_write_b32 a151, v135
 v_cvt_pk_bf16_f32 v130, v56, v57
 v_cvt_pk_bf16_f32 v131, v58, v59
 v_accvgpr_write_b32 a184, v128
 v_accvgpr_write_b32 a185, v129
 v_cvt_pk_bf16_f32 v132, v88, v89
 v_cvt_pk_bf16_f32 v133, v90, v91
 v_accvgpr_write_b32 a188, v130
 v_accvgpr_write_b32 a189, v131
 v_cvt_pk_bf16_f32 v134, v120, v121
 v_cvt_pk_bf16_f32 v135, v122, v123
 v_accvgpr_write_b32 a152, v132
 v_accvgpr_write_b32 a153, v133
 v_cvt_pk_bf16_f32 v128, v28, v29
 v_cvt_pk_bf16_f32 v129, v30, v31
 v_accvgpr_write_b32 a156, v134
 v_accvgpr_write_b32 a157, v135
 v_cvt_pk_bf16_f32 v130, v60, v61
 v_cvt_pk_bf16_f32 v131, v62, v63
 v_accvgpr_write_b32 a186, v128
 v_accvgpr_write_b32 a187, v129
 v_cvt_pk_bf16_f32 v132, v92, v93
 v_cvt_pk_bf16_f32 v133, v94, v95
 v_accvgpr_write_b32 a190, v130
 v_accvgpr_write_b32 a191, v131
 v_cvt_pk_bf16_f32 v134, v124, v125
 v_cvt_pk_bf16_f32 v135, v126, v127
 v_accvgpr_write_b32 a154, v132
 v_accvgpr_write_b32 a155, v133
 v_accvgpr_write_b32 a158, v134
 v_accvgpr_write_b32 a159, v135
 s_cmp_eq_u32 s62, 0
 s_cbranch_scc1 Li0m9
 s_waitcnt lgkmcnt(4)
 v_mfma_f32_16x16x32_bf16 v[8:11], a[192:195], a[164:167], 0
 ds_read_b128 a[224:227], v217 offset:57344
 v_mov_b32 v208, 0x3f803f80
 v_mfma_f32_16x16x32_bf16 v[8:11], a[196:199], a[172:175], v[8:11]
 ds_read_b128 a[228:231], v217 offset:58368
 v_mov_b32 v209, 0x3f803f80
 v_mfma_f32_16x16x32_bf16 v[8:11], a[200:203], a[180:183], v[8:11]
 v_mov_b32 v210, 0x3f803f80
 v_mov_b32 v211, 0x3f803f80
 v_mfma_f32_16x16x32_bf16 v[8:11], a[204:207], a[188:191], v[8:11]
 ds_read_b128 a[232:235], v217 offset:59392
 v_mov_b32 v214, 0
 v_mfma_f32_16x16x32_bf16 v[0:3], a[204:207], a[184:187], 0
 v_mfma_f32_16x16x32_bf16 v[0:3], a[200:203], a[176:179], v[0:3]
 ds_read_b128 a[236:239], v217 offset:60416
 v_mov_b32 v215, 0
 v_mfma_f32_16x16x32_bf16 v[0:3], a[196:199], a[168:171], v[0:3]
 s_waitcnt lgkmcnt(4)
 v_mov_b32 v212, 0
 v_mov_b32 v213, 0
 v_mfma_f32_16x16x32_bf16 v[0:3], a[192:195], a[160:163], v[0:3]
 ds_read_b128 a[240:243], v217 offset:61440
 v_lshl_add_u32 v218, v252, 13, v251
 v_mfma_f32_16x16x32_bf16 v[12:15], a[208:211], a[164:167], 0
 v_mfma_f32_16x16x32_bf16 v[12:15], a[212:215], a[172:175], v[12:15]
 v_add_u32 v219, 4096, v218
 v_mov_b32 v224, v231
 v_mfma_f32_16x16x32_bf16 v[12:15], a[216:219], a[180:183], v[12:15]
 v_mfma_f32_16x16x32_bf16 v[12:15], a[220:223], a[188:191], v[12:15]
 ds_read_b128 a[244:247], v217 offset:62464
 v_add_u32 v225, s68, v224
 v_mfma_f32_16x16x32_bf16 v[4:7], a[220:223], a[184:187], 0
 v_mfma_f32_16x16x32_bf16 v[4:7], a[216:219], a[176:179], v[4:7]
 v_add_u32 v226, s69, v225
 v_add_u32 v227, s68, v226
 v_mfma_f32_16x16x32_bf16 v[4:7], a[212:215], a[168:171], v[4:7]
 v_mfma_f32_16x16x32_bf16 v[4:7], a[208:211], a[160:163], v[4:7]
 ds_read_b128 a[248:251], v217 offset:63488
 v_add_u32 v228, 128, v224
 v_mfma_f32_16x16x32_bf16 v[72:75], a[192:195], a[132:135], 0
 v_add_u32 v229, 128, v225
 v_add_u32 v230, 128, v226
 v_mfma_f32_16x16x32_bf16 v[72:75], a[196:199], a[140:143], v[72:75]
 v_mfma_f32_16x16x32_bf16 v[72:75], a[200:203], a[148:151], v[72:75]
 ds_read_b128 a[252:255], v217 offset:64512
 v_add_u32 v231, 128, v227
 v_mfma_f32_16x16x32_bf16 v[72:75], a[204:207], a[156:159], v[72:75]
 v_max3_f32 v250, v0, v1, v2
 v_max3_f32 v249, v8, v9, v10
 v_mfma_f32_16x16x32_bf16 v[64:67], a[204:207], a[152:155], 0
 v_max3_f32 v250, v250, v3, v4
 v_max3_f32 v249, v249, v11, v12
 v_mfma_f32_16x16x32_bf16 v[64:67], a[200:203], a[144:147], v[64:67]
 v_max3_f32 v250, v250, v5, v6
 v_max3_f32 v249, v249, v13, v14
 v_mfma_f32_16x16x32_bf16 v[64:67], a[196:199], a[136:139], v[64:67]
 v_max_f32 v250, v250, v7
 v_max_f32 v249, v249, v15
 v_mfma_f32_16x16x32_bf16 v[64:67], a[192:195], a[128:131], v[64:67]
 v_mov_b32 v188, v250
 v_mov_b32 v189, v249
 v_mfma_f32_16x16x32_bf16 v[76:79], a[208:211], a[132:135], 0
 v_permlane16_swap_b32 v188, v250
 v_permlane16_swap_b32 v189, v249
 v_mfma_f32_16x16x32_bf16 v[76:79], a[212:215], a[140:143], v[76:79]
 v_max_f32 v250, v250, v188
 v_max_f32 v249, v249, v189
 v_mfma_f32_16x16x32_bf16 v[76:79], a[216:219], a[148:151], v[76:79]
 v_mov_b32 v188, v250
 v_mov_b32 v189, v249
 v_mfma_f32_16x16x32_bf16 v[76:79], a[220:223], a[156:159], v[76:79]
 v_permlane32_swap_b32 v188, v250
 v_permlane32_swap_b32 v189, v249
 v_mfma_f32_16x16x32_bf16 v[68:71], a[220:223], a[152:155], 0
 v_max_f32 v250, v250, v188
 v_max_f32 v249, v249, v189
 v_mfma_f32_16x16x32_bf16 v[68:71], a[216:219], a[144:147], v[68:71]
 v_sub_f32 v168, 0, v250
 v_sub_f32 v169, 0, v250
 v_mfma_f32_16x16x32_bf16 v[68:71], a[212:215], a[136:139], v[68:71]
 s_waitcnt lgkmcnt(4)
 v_xor_b32 v217, 0x10000, v217
 v_sub_f32 v170, 0, v250
 v_mfma_f32_16x16x32_bf16 v[68:71], a[208:211], a[128:131], v[68:71]
 s_waitcnt vmcnt(5)
 v_sub_f32 v171, 0, v250
 v_sub_f32 v172, 0, v249
 v_sub_f32 v173, 0, v249
 v_sub_f32 v174, 0, v249
 v_sub_f32 v175, 0, v249
 s_nop 1
 v_mfma_f32_16x16x32_bf16 v[24:27], a[224:227], a[164:167], v[172:175]
 s_barrier
 ds_read_b128 a[192:195], v217 offset:16384
 v_add_f32 v8, v8, v172
 v_mfma_f32_16x16x32_bf16 v[24:27], a[228:231], a[172:175], v[24:27]
 v_add_f32 v9, v9, v172
 v_add_f32 v10, v10, v172
 v_mfma_f32_16x16x32_bf16 v[24:27], a[232:235], a[180:183], v[24:27]
 v_add_f32 v11, v11, v172
 v_add_f32 v12, v12, v172
 v_add_f32 v13, v13, v172
 v_mfma_f32_16x16x32_bf16 v[24:27], a[236:239], a[188:191], v[24:27]
 ds_read_b128 a[196:199], v217 offset:17408
 v_max3_f32 v250, v64, v65, v66
 v_mfma_f32_16x16x32_bf16 v[16:19], a[236:239], a[184:187], v[168:171]
 v_max3_f32 v249, v72, v73, v74
 v_max3_f32 v250, v250, v67, v68
 v_mfma_f32_16x16x32_bf16 v[16:19], a[232:235], a[176:179], v[16:19]
 ds_read_b128 a[200:203], v217 offset:18432
 v_max3_f32 v249, v249, v75, v76
 v_mfma_f32_16x16x32_bf16 v[16:19], a[228:231], a[168:171], v[16:19]
 s_waitcnt lgkmcnt(3)
 v_max3_f32 v250, v250, v69, v70
 v_max3_f32 v249, v249, v77, v78
 v_mfma_f32_16x16x32_bf16 v[16:19], a[224:227], a[160:163], v[16:19]
 ds_read_b128 a[204:207], v217 offset:19456
 v_max_f32 v250, v250, v71
 v_mfma_f32_16x16x32_bf16 v[28:31], a[240:243], a[164:167], v[172:175]
 v_max_f32 v249, v249, v79
 v_mov_b32 v188, v250
 v_mfma_f32_16x16x32_bf16 v[28:31], a[244:247], a[172:175], v[28:31]
 v_mov_b32 v189, v249
 v_permlane16_swap_b32 v188, v250
 v_mfma_f32_16x16x32_bf16 v[28:31], a[248:251], a[180:183], v[28:31]
 ds_read_b128 a[208:211], v217 offset:20480
 v_permlane16_swap_b32 v189, v249
 v_mfma_f32_16x16x32_bf16 v[28:31], a[252:255], a[188:191], v[28:31]
 v_max_f32 v250, v250, v188
 v_max_f32 v249, v249, v189
 v_mfma_f32_16x16x32_bf16 v[20:23], a[252:255], a[184:187], v[168:171]
 v_mov_b32 v188, v250
 v_mov_b32 v189, v249
 v_mfma_f32_16x16x32_bf16 v[20:23], a[248:251], a[176:179], v[20:23]
 v_permlane32_swap_b32 v188, v250
 v_permlane32_swap_b32 v189, v249
 v_mfma_f32_16x16x32_bf16 v[20:23], a[244:247], a[168:171], v[20:23]
 v_max_f32 v250, v250, v188
 v_max_f32 v249, v249, v189
 v_mfma_f32_16x16x32_bf16 v[20:23], a[240:243], a[160:163], v[20:23]
 ds_read_b128 a[212:215], v217 offset:21504
 v_sub_f32 v176, 0, v250
 v_sub_f32 v177, 0, v250
 v_sub_f32 v178, 0, v250
 v_sub_f32 v179, 0, v250
 v_sub_f32 v180, 0, v249
 v_sub_f32 v181, 0, v249
 v_sub_f32 v182, 0, v249
 v_sub_f32 v183, 0, v249
 s_nop 1
 v_mfma_f32_16x16x32_bf16 v[88:91], a[224:227], a[132:135], v[180:183]
 ds_read_b128 a[216:219], v217 offset:22528
 v_add_f32 v14, v14, v172
 v_mfma_f32_16x16x32_bf16 v[88:91], a[228:231], a[140:143], v[88:91]
 buffer_load_dword v239, v238, s[52:55], s72 offen sc1
 v_mfma_f32_16x16x32_bf16 v[88:91], a[232:235], a[148:151], v[88:91]
 v_add_f32 v15, v15, v172
 v_add_f32 v0, v0, v168
 v_mfma_f32_16x16x32_bf16 v[88:91], a[236:239], a[156:159], v[88:91]
 v_add_f32 v1, v1, v168
 v_add_f32 v2, v2, v168
 v_mfma_f32_16x16x32_bf16 v[80:83], a[236:239], a[152:155], v[176:179]
 v_add_f32 v3, v3, v168
 v_add_f32 v4, v4, v168
 v_mfma_f32_16x16x32_bf16 v[80:83], a[232:235], a[144:147], v[80:83]
 v_add_f32 v5, v5, v168
 v_add_f32 v6, v6, v168
 v_mfma_f32_16x16x32_bf16 v[80:83], a[228:231], a[136:139], v[80:83]
 ds_read_b128 a[220:223], v217 offset:23552
 v_add_f32 v7, v7, v168
 v_mfma_f32_16x16x32_bf16 v[80:83], a[224:227], a[128:131], v[80:83]
 v_exp_f32 v184, v8
 v_mfma_f32_16x16x32_bf16 v[92:95], a[240:243], a[132:135], v[180:183]
 v_exp_f32 v185, v9
 v_mfma_f32_16x16x32_bf16 v[92:95], a[244:247], a[140:143], v[92:95]
 v_exp_f32 v186, v10
 v_mfma_f32_16x16x32_bf16 v[92:95], a[248:251], a[148:151], v[92:95]
 v_exp_f32 v187, v11
 v_mfma_f32_16x16x32_bf16 v[92:95], a[252:255], a[156:159], v[92:95]
 v_add_f32 v72, v72, v180
 v_add_f32 v73, v73, v180
 v_mfma_f32_16x16x32_bf16 v[84:87], a[252:255], a[152:155], v[176:179]
 v_add_f32 v74, v74, v180
 v_add_f32 v75, v75, v180
 v_mfma_f32_16x16x32_bf16 v[84:87], a[248:251], a[144:147], v[84:87]
 s_waitcnt lgkmcnt(4)
 v_add_f32 v76, v76, v180
 v_add_f32 v77, v77, v180
 v_mfma_f32_16x16x32_bf16 v[84:87], a[244:247], a[136:139], v[84:87]
 v_add_f32 v78, v78, v180
 v_add_f32 v79, v79, v180
 v_mfma_f32_16x16x32_bf16 v[84:87], a[240:243], a[128:131], v[84:87]
 v_add_f32 v64, v64, v176
 v_add_f32 v65, v65, v176
 v_add_f32 v66, v66, v176
 v_add_f32 v67, v67, v176
 v_add_f32 v68, v68, v176
 v_add_f32 v69, v69, v176
 v_add_f32 v70, v70, v176
 v_add_f32 v71, v71, v176
 s_waitcnt vmcnt(0)
 v_cmp_gt_u32 vcc, 8, v239
 s_cbranch_vccnz Lvs18
Lvb19:
 s_add_u32 m0, s73, 32768
 s_add_u32 s76, s73, 16384
 v_mfma_f32_16x16x32_bf16 v[40:43], a[192:195], a[164:167], v[172:175]
 ds_read_b128 a[224:227], v217 offset:24576
 v_cvt_pk_bf16_f32 v132, v184, v185
 v_mfma_f32_16x16x32_bf16 v[40:43], a[196:199], a[172:175], v[40:43]
 buffer_load_dwordx4 v251, s[56:59], s76 offen offset:0 sc1 lds
 v_mfma_f32_16x16x32_bf16 v[40:43], a[200:203], a[180:183], v[40:43]
 v_exp_f32 v188, v12
 v_mfma_f32_16x16x32_bf16 v[40:43], a[204:207], a[188:191], v[40:43]
 ds_read_b128 a[228:231], v217 offset:25600
 v_cvt_pk_bf16_f32 v133, v186, v187
 v_mfma_f32_16x16x32_bf16 v[32:35], a[204:207], a[184:187], v[168:171]
 buffer_load_dwordx4 v251, s[56:59], s76 offen offset:1024 sc1 lds
 buffer_load_dwordx4 v251, s[56:59], s76 offen offset:2048 sc1 lds
 buffer_load_dwordx4 v251, s[56:59], s76 offen offset:3072 sc1 lds
 v_exp_f32 v189, v13
 v_mfma_f32_16x16x32_bf16 v[32:35], a[200:203], a[176:179], v[32:35]
 s_add_u32 m0, s73, 65536
 v_exp_f32 v190, v14
 v_mfma_f32_16x16x32_bf16 v[32:35], a[196:199], a[168:171], v[32:35]
 s_add_u32 s76, s73, 49152
 ds_read_b128 a[232:235], v217 offset:26624
 v_cvt_pk_bf16_f32 v134, v188, v189
 v_exp_f32 v191, v15
 v_mfma_f32_16x16x32_bf16 v[32:35], a[192:195], a[160:163], v[32:35]
 v_exp_f32 v184, v0
 v_cvt_pk_bf16_f32 v135, v190, v191
 v_mfma_f32_16x16x32_bf16 v[104:107], a[192:195], a[132:135], v[180:183]
 buffer_load_dwordx4 v251, s[56:59], s76 offen offset:0 sc1 lds
 v_exp_f32 v185, v1
 v_mfma_f32_16x16x32_bf16 v[104:107], a[196:199], a[140:143], v[104:107]
 buffer_load_dwordx4 v251, s[56:59], s76 offen offset:1024 sc1 lds
 v_mfma_f32_16x16x32_bf16 v[196:199], v[208:211], v[132:135], 0
 v_exp_f32 v186, v2
 v_cvt_pk_bf16_f32 v128, v184, v185
 v_mfma_f32_16x16x32_bf16 v[104:107], a[200:203], a[148:151], v[104:107]
 v_exp_f32 v187, v3
 v_mfma_f32_16x16x32_bf16 v[104:107], a[204:207], a[156:159], v[104:107]
 v_exp_f32 v188, v4
 v_cvt_pk_bf16_f32 v129, v186, v187
 v_mfma_f32_16x16x32_bf16 v[96:99], a[204:207], a[152:155], v[176:179]
 v_exp_f32 v189, v5
 v_exp_f32 v190, v6
 v_mfma_f32_16x16x32_bf16 v[96:99], a[200:203], a[144:147], v[96:99]
 ds_read_b128 a[236:239], v217 offset:27648
 buffer_load_dwordx4 v251, s[56:59], s76 offen offset:2048 sc1 lds
 v_cvt_pk_bf16_f32 v130, v188, v189
 v_mfma_f32_16x16x32_bf16 v[96:99], a[196:199], a[136:139], v[96:99]
 s_waitcnt lgkmcnt(4)
 v_exp_f32 v191, v7
 v_exp_f32 v184, v72
 v_mfma_f32_16x16x32_bf16 v[96:99], a[192:195], a[128:131], v[96:99]
 ds_read_b128 a[240:243], v217 offset:28672
 v_cvt_pk_bf16_f32 v131, v190, v191
 v_exp_f32 v185, v73
 v_mfma_f32_16x16x32_bf16 v[44:47], a[208:211], a[164:167], v[172:175]
 buffer_load_dwordx4 v251, s[56:59], s76 offen offset:3072 sc1 lds
 v_mfma_f32_16x16x32_bf16 v[192:195], v[208:211], v[128:131], 0
 s_add_u32 m0, s67, 0
 v_exp_f32 v186, v74
 v_mfma_f32_16x16x32_bf16 v[44:47], a[212:215], a[172:175], v[44:47]
 ds_read_b128 a[244:247], v217 offset:29696
 v_cvt_pk_bf16_f32 v156, v184, v185
 v_exp_f32 v187, v75
 v_mfma_f32_16x16x32_bf16 v[44:47], a[216:219], a[180:183], v[44:47]
 v_exp_f32 v188, v76
 v_mfma_f32_16x16x32_bf16 v[44:47], a[220:223], a[188:191], v[44:47]
 buffer_load_dwordx4 v218, s[56:59], s66 offen offset:0 sc1 lds
 v_cvt_pk_bf16_f32 v157, v186, v187
 v_exp_f32 v189, v77
 v_mfma_f32_16x16x32_bf16 v[36:39], a[220:223], a[184:187], v[168:171]
 v_exp_f32 v190, v78
 v_mfma_f32_16x16x32_bf16 v[36:39], a[216:219], a[176:179], v[36:39]
 ds_read_b128 a[248:251], v217 offset:30720
 v_cvt_pk_bf16_f32 v158, v188, v189
 v_exp_f32 v191, v79
 v_mfma_f32_16x16x32_bf16 v[36:39], a[212:215], a[168:171], v[36:39]
 buffer_load_dwordx4 v218, s[56:59], s66 offen offset:1024 sc1 lds
 v_exp_f32 v184, v64
 v_mfma_f32_16x16x32_bf16 v[36:39], a[208:211], a[160:163], v[36:39]
 v_cvt_pk_bf16_f32 v159, v190, v191
 v_exp_f32 v185, v65
 v_mfma_f32_16x16x32_bf16 v[108:111], a[208:211], a[132:135], v[180:183]
 buffer_load_dwordx4 v218, s[56:59], s66 offen offset:2048 sc1 lds
 v_mfma_f32_16x16x32_bf16 v[204:207], v[208:211], v[156:159], 0
 v_exp_f32 v186, v66
 v_mfma_f32_16x16x32_bf16 v[108:111], a[212:215], a[140:143], v[108:111]
 ds_read_b128 a[252:255], v217 offset:31744
 v_cvt_pk_bf16_f32 v152, v184, v185
 v_exp_f32 v187, v67
 v_mfma_f32_16x16x32_bf16 v[108:111], a[216:219], a[148:151], v[108:111]
 v_exp_f32 v188, v68
 v_mfma_f32_16x16x32_bf16 v[108:111], a[220:223], a[156:159], v[108:111]
 buffer_load_dwordx4 v218, s[56:59], s66 offen offset:3072 sc1 lds
 v_cvt_pk_bf16_f32 v153, v186, v187
 v_exp_f32 v189, v69
 v_mfma_f32_16x16x32_bf16 v[100:103], a[220:223], a[152:155], v[176:179]
 s_add_u32 m0, s67, 4096
 v_exp_f32 v190, v70
 v_cvt_pk_bf16_f32 v154, v188, v189
 v_mfma_f32_16x16x32_bf16 v[100:103], a[216:219], a[144:147], v[100:103]
 v_exp_f32 v191, v71
 v_mfma_f32_16x16x32_bf16 v[100:103], a[212:215], a[136:139], v[100:103]
 buffer_load_dwordx4 v219, s[56:59], s66 offen offset:0 sc1 lds
 v_exp_f32 v184, v24
 v_cvt_pk_bf16_f32 v155, v190, v191
 v_mfma_f32_16x16x32_bf16 v[100:103], a[208:211], a[128:131], v[100:103]
 s_waitcnt lgkmcnt(4)
 v_exp_f32 v185, v25
 v_mfma_f32_16x16x32_bf16 v[56:59], a[224:227], a[164:167], v[172:175]
 buffer_load_dwordx4 v219, s[56:59], s66 offen offset:1024 sc1 lds
 v_mfma_f32_16x16x32_bf16 v[200:203], v[208:211], v[152:155], 0
 v_exp_f32 v186, v26
 v_cvt_pk_bf16_f32 v148, v184, v185
 v_mfma_f32_16x16x32_bf16 v[56:59], a[228:231], a[172:175], v[56:59]
 v_exp_f32 v187, v27
 v_exp_f32 v188, v28
 v_mfma_f32_16x16x32_bf16 v[56:59], a[232:235], a[180:183], v[56:59]
 v_cvt_pk_bf16_f32 v149, v186, v187
 v_mfma_f32_16x16x32_bf16 v[56:59], a[236:239], a[188:191], v[56:59]
 v_exp_f32 v189, v29
 v_exp_f32 v190, v30
 v_mfma_f32_16x16x32_bf16 v[48:51], a[236:239], a[184:187], v[168:171]
 buffer_load_dwordx4 v219, s[56:59], s66 offen offset:2048 sc1 lds
 v_cvt_pk_bf16_f32 v150, v188, v189
 v_exp_f32 v191, v31
 v_mfma_f32_16x16x32_bf16 v[48:51], a[232:235], a[176:179], v[48:51]
 v_exp_f32 v184, v16
 v_mfma_f32_16x16x32_bf16 v[48:51], a[228:231], a[168:171], v[48:51]
 v_cvt_pk_bf16_f32 v151, v190, v191
 v_exp_f32 v185, v17
 v_mfma_f32_16x16x32_bf16 v[48:51], a[224:227], a[160:163], v[48:51]
 buffer_load_dwordx4 v219, s[56:59], s66 offen offset:3072 sc1 lds
 v_mfma_f32_16x16x32_bf16 v[196:199], v[208:211], v[148:151], v[196:199]
 s_add_u32 s66, s66, 32768
 v_exp_f32 v186, v18
 v_mfma_f32_16x16x32_bf16 v[120:123], a[224:227], a[132:135], v[180:183]
 s_add_u32 m0, s41, 0
 v_cvt_pk_bf16_f32 v144, v184, v185
 v_exp_f32 v187, v19
 v_mfma_f32_16x16x32_bf16 v[120:123], a[228:231], a[140:143], v[120:123]
 v_exp_f32 v188, v20
 v_mfma_f32_16x16x32_bf16 v[120:123], a[232:235], a[148:151], v[120:123]
 buffer_load_dwordx4 v224, s[24:27], s30 offen offset:0 lds
 v_cvt_pk_bf16_f32 v145, v186, v187
 v_exp_f32 v189, v21
 v_mfma_f32_16x16x32_bf16 v[120:123], a[236:239], a[156:159], v[120:123]
 v_exp_f32 v190, v22
 v_mfma_f32_16x16x32_bf16 v[112:115], a[236:239], a[152:155], v[176:179]
 v_cvt_pk_bf16_f32 v146, v188, v189
 v_exp_f32 v191, v23
 v_mfma_f32_16x16x32_bf16 v[112:115], a[232:235], a[144:147], v[112:115]
 buffer_load_dwordx4 v225, s[24:27], s30 offen offset:1024 lds
 v_exp_f32 v184, v88
 v_mfma_f32_16x16x32_bf16 v[112:115], a[228:231], a[136:139], v[112:115]
 s_waitcnt lgkmcnt(0)
 v_cvt_pk_bf16_f32 v147, v190, v191
 v_exp_f32 v185, v89
 v_mfma_f32_16x16x32_bf16 v[112:115], a[224:227], a[128:131], v[112:115]
 s_waitcnt vmcnt(14)
 buffer_load_dwordx4 v226, s[24:27], s30 offen offset:2048 lds
 v_mfma_f32_16x16x32_bf16 v[192:195], v[208:211], v[144:147], v[192:195]
 v_exp_f32 v186, v90
 v_cvt_pk_bf16_f32 v164, v184, v185
 v_mfma_f32_16x16x32_bf16 v[60:63], a[240:243], a[164:167], v[172:175]
 s_barrier
 v_exp_f32 v187, v91
 v_mfma_f32_16x16x32_bf16 v[60:63], a[244:247], a[172:175], v[60:63]
 v_exp_f32 v188, v92
 v_cvt_pk_bf16_f32 v165, v186, v187
 v_mfma_f32_16x16x32_bf16 v[60:63], a[248:251], a[180:183], v[60:63]
 buffer_load_dwordx4 v227, s[24:27], s30 offen offset:3072 lds
 v_exp_f32 v189, v93
 v_mfma_f32_16x16x32_bf16 v[60:63], a[252:255], a[188:191], v[60:63]
 s_add_u32 m0, s41, 4096
 ds_read_b128 a[192:195], v217 offset:0
 ds_read_b128 a[196:199], v217 offset:1024
 v_exp_f32 v190, v94
 v_cvt_pk_bf16_f32 v166, v188, v189
 v_mfma_f32_16x16x32_bf16 v[52:55], a[252:255], a[184:187], v[168:171]
 v_exp_f32 v191, v95
 v_exp_f32 v184, v80
 v_mfma_f32_16x16x32_bf16 v[52:55], a[248:251], a[176:179], v[52:55]
 buffer_load_dwordx4 v228, s[24:27], s30 offen offset:0 lds
 v_cvt_pk_bf16_f32 v167, v190, v191
 v_mfma_f32_16x16x32_bf16 v[52:55], a[244:247], a[168:171], v[52:55]
 ds_read_b128 a[200:203], v217 offset:2048
 ds_read_b128 a[204:207], v217 offset:3072
 v_exp_f32 v185, v81
 v_mfma_f32_16x16x32_bf16 v[52:55], a[240:243], a[160:163], v[52:55]
 buffer_load_dwordx4 v229, s[24:27], s30 offen offset:1024 lds
 v_mfma_f32_16x16x32_bf16 v[204:207], v[208:211], v[164:167], v[204:207]
 v_exp_f32 v186, v82
 v_cvt_pk_bf16_f32 v160, v184, v185
 v_exp_f32 v187, v83
 v_mfma_f32_16x16x32_bf16 v[124:127], a[240:243], a[132:135], v[180:183]
 v_exp_f32 v188, v84
 v_mfma_f32_16x16x32_bf16 v[124:127], a[244:247], a[140:143], v[124:127]
 ds_read_b128 a[208:211], v217 offset:4096
 v_cvt_pk_bf16_f32 v161, v186, v187
 v_exp_f32 v189, v85
 v_mfma_f32_16x16x32_bf16 v[124:127], a[248:251], a[148:151], v[124:127]
 ds_read_b128 a[212:215], v217 offset:5120
 v_exp_f32 v190, v86
 v_cvt_pk_bf16_f32 v162, v188, v189
 v_exp_f32 v191, v87
 v_exp_f32 v184, v40
 v_cvt_pk_bf16_f32 v163, v190, v191
 v_exp_f32 v185, v41
 v_mfma_f32_16x16x32_bf16 v[124:127], a[252:255], a[156:159], v[124:127]
 buffer_load_dwordx4 v230, s[24:27], s30 offen offset:2048 lds
 v_mfma_f32_16x16x32_bf16 v[200:203], v[208:211], v[160:163], v[200:203]
 ds_read_b128 a[216:219], v217 offset:6144
 ds_read_b128 a[220:223], v217 offset:7168
 v_mfma_f32_16x16x32_bf16 v[116:119], a[252:255], a[152:155], v[176:179]
 v_exp_f32 v186, v42
 v_exp_f32 v187, v43
 v_mfma_f32_16x16x32_bf16 v[116:119], a[248:251], a[144:147], v[116:119]
 buffer_load_dwordx4 v231, s[24:27], s30 offen offset:3072 lds
 v_mfma_f32_16x16x32_bf16 v[116:119], a[244:247], a[136:139], v[116:119]
 s_waitcnt lgkmcnt(4)
 v_max3_f32 v250, v196, v192, v204
 v_max_f32 v250, v250, v200
 v_cmp_lt_f32 vcc, s75, v250
 v_mfma_f32_16x16x32_bf16 v[116:119], a[240:243], a[128:131], v[116:119]
 s_cbranch_vccnz Lrare20
Lback21:
 v_add_f32 v213, v213, v196
 v_add_f32 v212, v212, v192
 v_add_f32 v215, v215, v204
 v_add_f32 v214, v214, v200
 s_sub_u32 s74, s62, 1
 s_cmp_eq_u32 s74, 0
 s_cbranch_scc1 Lm114
.p2align 3
Lp113:
 v_mfma_f32_16x16x32_bf16 a[68:71], a[192:195], v[132:135], a[68:71]
 ds_read_b128 a[224:227], v217 offset:8192
 v_cvt_pk_bf16_f32 v140, v184, v185
 v_mfma_f32_16x16x32_bf16 a[64:67], a[192:195], v[128:131], a[64:67]
 v_exp_f32 v188, v44
 v_mfma_f32_16x16x32_bf16 a[4:7], a[192:195], v[156:159], a[4:7]
 ds_read_b128 a[228:231], v217 offset:9216
 v_cvt_pk_bf16_f32 v141, v186, v187
 v_mfma_f32_16x16x32_bf16 a[0:3], a[192:195], v[152:155], a[0:3]
 v_exp_f32 v189, v45
 v_mfma_f32_16x16x32_bf16 a[76:79], a[196:199], v[132:135], a[76:79]
 v_exp_f32 v190, v46
 v_mfma_f32_16x16x32_bf16 a[72:75], a[196:199], v[128:131], a[72:75]
 v_mfma_f32_16x16x32_bf16 a[12:15], a[196:199], v[156:159], a[12:15]
 ds_read_b128 a[232:235], v217 offset:10240
 v_cvt_pk_bf16_f32 v142, v188, v189
 v_mfma_f32_16x16x32_bf16 a[8:11], a[196:199], v[152:155], a[8:11]
 v_exp_f32 v191, v47
 v_mfma_f32_16x16x32_bf16 a[84:87], a[200:203], v[132:135], a[84:87]
 v_exp_f32 v184, v32
 v_mfma_f32_16x16x32_bf16 a[80:83], a[200:203], v[128:131], a[80:83]
 v_mfma_f32_16x16x32_bf16 a[20:23], a[200:203], v[156:159], a[20:23]
 ds_read_b128 a[236:239], v217 offset:11264
 v_cvt_pk_bf16_f32 v143, v190, v191
 v_mfma_f32_16x16x32_bf16 a[16:19], a[200:203], v[152:155], a[16:19]
 v_exp_f32 v185, v33
 v_mfma_f32_16x16x32_bf16 a[92:95], a[204:207], v[132:135], a[92:95]
 v_mfma_f32_16x16x32_bf16 v[196:199], v[208:211], v[140:143], 0
 v_exp_f32 v186, v34
 v_mfma_f32_16x16x32_bf16 a[88:91], a[204:207], v[128:131], a[88:91]
 v_mfma_f32_16x16x32_bf16 a[28:31], a[204:207], v[156:159], a[28:31]
 s_waitcnt lgkmcnt(4)
 ds_read_b128 a[240:243], v217 offset:12288
 v_cvt_pk_bf16_f32 v136, v184, v185
 v_mfma_f32_16x16x32_bf16 a[24:27], a[204:207], v[152:155], a[24:27]
 v_exp_f32 v187, v35
 v_mfma_f32_16x16x32_bf16 a[100:103], a[208:211], v[132:135], a[100:103]
 v_exp_f32 v188, v36
 v_mfma_f32_16x16x32_bf16 a[96:99], a[208:211], v[128:131], a[96:99]
 v_mfma_f32_16x16x32_bf16 a[36:39], a[208:211], v[156:159], a[36:39]
 ds_read_b128 a[244:247], v217 offset:13312
 v_cvt_pk_bf16_f32 v137, v186, v187
 v_mfma_f32_16x16x32_bf16 a[32:35], a[208:211], v[152:155], a[32:35]
 v_exp_f32 v189, v37
 v_mfma_f32_16x16x32_bf16 a[108:111], a[212:215], v[132:135], a[108:111]
 v_exp_f32 v190, v38
 v_mfma_f32_16x16x32_bf16 a[104:107], a[212:215], v[128:131], a[104:107]
 v_mfma_f32_16x16x32_bf16 a[44:47], a[212:215], v[156:159], a[44:47]
 ds_read_b128 a[248:251], v217 offset:14336
 v_cvt_pk_bf16_f32 v138, v188, v189
 v_mfma_f32_16x16x32_bf16 a[40:43], a[212:215], v[152:155], a[40:43]
 v_exp_f32 v191, v39
 v_mfma_f32_16x16x32_bf16 a[116:119], a[216:219], v[132:135], a[116:119]
 v_exp_f32 v184, v104
 v_mfma_f32_16x16x32_bf16 a[112:115], a[216:219], v[128:131], a[112:115]
 v_mfma_f32_16x16x32_bf16 a[52:55], a[216:219], v[156:159], a[52:55]
 ds_read_b128 a[252:255], v217 offset:15360
 v_cvt_pk_bf16_f32 v139, v190, v191
 v_mfma_f32_16x16x32_bf16 a[48:51], a[216:219], v[152:155], a[48:51]
 v_exp_f32 v185, v105
 v_mfma_f32_16x16x32_bf16 a[124:127], a[220:223], v[132:135], a[124:127]
 v_mfma_f32_16x16x32_bf16 v[192:195], v[208:211], v[136:139], 0
 v_exp_f32 v186, v106
 v_mfma_f32_16x16x32_bf16 a[120:123], a[220:223], v[128:131], a[120:123]
 v_mfma_f32_16x16x32_bf16 a[60:63], a[220:223], v[156:159], a[60:63]
 s_waitcnt lgkmcnt(4)
 v_cvt_pk_bf16_f32 v156, v184, v185
 v_mfma_f32_16x16x32_bf16 a[56:59], a[220:223], v[152:155], a[56:59]
 s_waitcnt vmcnt(8)
 v_exp_f32 v187, v107
 v_mfma_f32_16x16x32_bf16 a[68:71], a[224:227], v[148:151], a[68:71]
 s_barrier
 ds_read_b128 a[192:195], v217 offset:49152
 ds_read_b128 a[196:199], v217 offset:50176
 v_mfma_f32_16x16x32_bf16 a[64:67], a[224:227], v[144:147], a[64:67]
 s_add_u32 m0, s67, 32768
 v_exp_f32 v188, v108
 v_mfma_f32_16x16x32_bf16 a[4:7], a[224:227], v[164:167], a[4:7]
 buffer_load_dwordx4 v218, s[56:59], s66 offen offset:0 sc1 lds
 v_mfma_f32_16x16x32_bf16 a[0:3], a[224:227], v[160:163], a[0:3]
 v_cvt_pk_bf16_f32 v157, v186, v187
 v_mfma_f32_16x16x32_bf16 a[76:79], a[228:231], v[148:151], a[76:79]
 v_exp_f32 v189, v109
 v_mfma_f32_16x16x32_bf16 a[72:75], a[228:231], v[144:147], a[72:75]
 v_exp_f32 v190, v110
 v_mfma_f32_16x16x32_bf16 a[12:15], a[228:231], v[164:167], a[12:15]
 ds_read_b128 a[200:203], v217 offset:51200
 v_cvt_pk_bf16_f32 v158, v188, v189
 v_mfma_f32_16x16x32_bf16 a[8:11], a[228:231], v[160:163], a[8:11]
 v_exp_f32 v191, v111
 v_mfma_f32_16x16x32_bf16 a[84:87], a[232:235], v[148:151], a[84:87]
 buffer_load_dwordx4 v218, s[56:59], s66 offen offset:1024 sc1 lds
 v_mfma_f32_16x16x32_bf16 a[80:83], a[232:235], v[144:147], a[80:83]
 v_exp_f32 v184, v96
 v_mfma_f32_16x16x32_bf16 a[20:23], a[232:235], v[164:167], a[20:23]
 ds_read_b128 a[204:207], v217 offset:52224
 v_cvt_pk_bf16_f32 v159, v190, v191
 v_mfma_f32_16x16x32_bf16 a[16:19], a[232:235], v[160:163], a[16:19]
 v_exp_f32 v185, v97
 v_mfma_f32_16x16x32_bf16 a[92:95], a[236:239], v[148:151], a[92:95]
 buffer_load_dwordx4 v218, s[56:59], s66 offen offset:2048 sc1 lds
 v_mfma_f32_16x16x32_bf16 v[204:207], v[208:211], v[156:159], 0
 v_exp_f32 v186, v98
 v_mfma_f32_16x16x32_bf16 a[88:91], a[236:239], v[144:147], a[88:91]
 ds_read_b128 a[208:211], v217 offset:53248
 v_cvt_pk_bf16_f32 v152, v184, v185
 v_mfma_f32_16x16x32_bf16 a[28:31], a[236:239], v[164:167], a[28:31]
 s_waitcnt lgkmcnt(5)
 v_exp_f32 v187, v99
 v_mfma_f32_16x16x32_bf16 a[24:27], a[236:239], v[160:163], a[24:27]
 v_exp_f32 v188, v100
 v_mfma_f32_16x16x32_bf16 a[100:103], a[240:243], v[148:151], a[100:103]
 v_mfma_f32_16x16x32_bf16 a[96:99], a[240:243], v[144:147], a[96:99]
 ds_read_b128 a[212:215], v217 offset:54272
 v_cvt_pk_bf16_f32 v153, v186, v187
 v_mfma_f32_16x16x32_bf16 a[36:39], a[240:243], v[164:167], a[36:39]
 v_exp_f32 v189, v101
 v_mfma_f32_16x16x32_bf16 a[32:35], a[240:243], v[160:163], a[32:35]
 buffer_load_dwordx4 v218, s[56:59], s66 offen offset:3072 sc1 lds
 v_mfma_f32_16x16x32_bf16 a[108:111], a[244:247], v[148:151], a[108:111]
 v_exp_f32 v190, v102
 v_mfma_f32_16x16x32_bf16 a[104:107], a[244:247], v[144:147], a[104:107]
 ds_read_b128 a[216:219], v217 offset:55296
 v_cvt_pk_bf16_f32 v154, v188, v189
 v_mfma_f32_16x16x32_bf16 a[44:47], a[244:247], v[164:167], a[44:47]
 s_add_u32 m0, s67, 36864
 v_exp_f32 v191, v103
 v_mfma_f32_16x16x32_bf16 a[40:43], a[244:247], v[160:163], a[40:43]
 v_exp_f32 v184, v56
 v_mfma_f32_16x16x32_bf16 a[116:119], a[248:251], v[148:151], a[116:119]
 buffer_load_dwordx4 v219, s[56:59], s66 offen offset:0 sc1 lds
 v_mfma_f32_16x16x32_bf16 a[112:115], a[248:251], v[144:147], a[112:115]
 ds_read_b128 a[220:223], v217 offset:56320
 v_cvt_pk_bf16_f32 v155, v190, v191
 v_mfma_f32_16x16x32_bf16 a[52:55], a[248:251], v[164:167], a[52:55]
 v_exp_f32 v185, v57
 v_mfma_f32_16x16x32_bf16 a[48:51], a[248:251], v[160:163], a[48:51]
 v_mfma_f32_16x16x32_bf16 v[200:203], v[208:211], v[152:155], 0
 v_exp_f32 v186, v58
 v_mfma_f32_16x16x32_bf16 a[124:127], a[252:255], v[148:151], a[124:127]
 v_mfma_f32_16x16x32_bf16 a[120:123], a[252:255], v[144:147], a[120:123]
 ds_read_b128 a[224:227], v217 offset:57344
 v_cvt_pk_bf16_f32 v148, v184, v185
 v_mfma_f32_16x16x32_bf16 a[60:63], a[252:255], v[164:167], a[60:63]
 buffer_load_dwordx4 v219, s[56:59], s66 offen offset:1024 sc1 lds
 v_mfma_f32_16x16x32_bf16 a[56:59], a[252:255], v[160:163], a[56:59]
 s_waitcnt lgkmcnt(5)
 v_exp_f32 v187, v59
 v_mfma_f32_16x16x32_bf16 v[8:11], a[192:195], a[164:167], v[172:175]
 v_exp_f32 v188, v60
 v_mfma_f32_16x16x32_bf16 v[8:11], a[196:199], a[172:175], v[8:11]
 ds_read_b128 a[228:231], v217 offset:58368
 v_cvt_pk_bf16_f32 v149, v186, v187
 v_mfma_f32_16x16x32_bf16 v[8:11], a[200:203], a[180:183], v[8:11]
 v_exp_f32 v189, v61
 v_mfma_f32_16x16x32_bf16 v[8:11], a[204:207], a[188:191], v[8:11]
 v_exp_f32 v190, v62
 v_mfma_f32_16x16x32_bf16 v[0:3], a[204:207], a[184:187], v[168:171]
 buffer_load_dwordx4 v219, s[56:59], s66 offen offset:2048 sc1 lds
 v_mfma_f32_16x16x32_bf16 v[0:3], a[200:203], a[176:179], v[0:3]
 ds_read_b128 a[232:235], v217 offset:59392
 v_cvt_pk_bf16_f32 v150, v188, v189
 v_mfma_f32_16x16x32_bf16 v[0:3], a[196:199], a[168:171], v[0:3]
 v_exp_f32 v191, v63
 v_mfma_f32_16x16x32_bf16 v[0:3], a[192:195], a[160:163], v[0:3]
 v_exp_f32 v184, v48
 v_mfma_f32_16x16x32_bf16 v[72:75], a[192:195], a[132:135], v[180:183]
 ds_read_b128 a[236:239], v217 offset:60416
 v_cvt_pk_bf16_f32 v151, v190, v191
 v_mfma_f32_16x16x32_bf16 v[72:75], a[196:199], a[140:143], v[72:75]
 buffer_load_dwordx4 v219, s[56:59], s66 offen offset:3072 sc1 lds
 v_mfma_f32_16x16x32_bf16 v[72:75], a[200:203], a[148:151], v[72:75]
 v_exp_f32 v185, v49
 v_mfma_f32_16x16x32_bf16 v[72:75], a[204:207], a[156:159], v[72:75]
 v_mfma_f32_16x16x32_bf16 v[196:199], v[208:211], v[148:151], v[196:199]
 v_exp_f32 v186, v50
 v_mfma_f32_16x16x32_bf16 v[64:67], a[204:207], a[152:155], v[176:179]
 ds_read_b128 a[240:243], v217 offset:61440
 v_cvt_pk_bf16_f32 v144, v184, v185
 v_mfma_f32_16x16x32_bf16 v[64:67], a[200:203], a[144:147], v[64:67]
 s_add_u32 s66, s66, 32768
 v_exp_f32 v187, v51
 v_mfma_f32_16x16x32_bf16 v[64:67], a[196:199], a[136:139], v[64:67]
 s_xor_b32 s67, s67, 0x10000
 v_mfma_f32_16x16x32_bf16 v[64:67], a[192:195], a[128:131], v[64:67]
 s_waitcnt lgkmcnt(5)
 v_exp_f32 v188, v52
 v_mfma_f32_16x16x32_bf16 v[12:15], a[208:211], a[164:167], v[172:175]
 ds_read_b128 a[244:247], v217 offset:62464
 v_cvt_pk_bf16_f32 v145, v186, v187
 v_mfma_f32_16x16x32_bf16 v[12:15], a[212:215], a[172:175], v[12:15]
 v_exp_f32 v189, v53
 v_mfma_f32_16x16x32_bf16 v[12:15], a[216:219], a[180:183], v[12:15]
 v_exp_f32 v190, v54
 v_mfma_f32_16x16x32_bf16 v[12:15], a[220:223], a[188:191], v[12:15]
 v_mfma_f32_16x16x32_bf16 v[4:7], a[220:223], a[184:187], v[168:171]
 ds_read_b128 a[248:251], v217 offset:63488
 v_cvt_pk_bf16_f32 v146, v188, v189
 v_mfma_f32_16x16x32_bf16 v[4:7], a[216:219], a[176:179], v[4:7]
 v_exp_f32 v191, v55
 v_mfma_f32_16x16x32_bf16 v[4:7], a[212:215], a[168:171], v[4:7]
 v_exp_f32 v184, v120
 v_mfma_f32_16x16x32_bf16 v[4:7], a[208:211], a[160:163], v[4:7]
 v_mfma_f32_16x16x32_bf16 v[76:79], a[208:211], a[132:135], v[180:183]
 ds_read_b128 a[252:255], v217 offset:64512
 v_cvt_pk_bf16_f32 v147, v190, v191
 v_mfma_f32_16x16x32_bf16 v[76:79], a[212:215], a[140:143], v[76:79]
 v_exp_f32 v185, v121
 v_mfma_f32_16x16x32_bf16 v[76:79], a[216:219], a[148:151], v[76:79]
 v_mfma_f32_16x16x32_bf16 v[192:195], v[208:211], v[144:147], v[192:195]
 v_exp_f32 v186, v122
 v_mfma_f32_16x16x32_bf16 v[76:79], a[220:223], a[156:159], v[76:79]
 v_mfma_f32_16x16x32_bf16 v[68:71], a[220:223], a[152:155], v[176:179]
 ds_read_b128 a[192:195], v217 offset:32768
 v_cvt_pk_bf16_f32 v164, v184, v185
 v_mfma_f32_16x16x32_bf16 v[68:71], a[216:219], a[144:147], v[68:71]
 v_exp_f32 v187, v123
 v_mfma_f32_16x16x32_bf16 v[68:71], a[212:215], a[136:139], v[68:71]
 s_waitcnt lgkmcnt(5)
 v_exp_f32 v188, v124
 v_mfma_f32_16x16x32_bf16 v[68:71], a[208:211], a[128:131], v[68:71]
 v_mfma_f32_16x16x32_bf16 v[24:27], a[224:227], a[164:167], v[172:175]
 ds_read_b128 a[196:199], v217 offset:33792
 v_cvt_pk_bf16_f32 v165, v186, v187
 v_mfma_f32_16x16x32_bf16 v[24:27], a[228:231], a[172:175], v[24:27]
 v_exp_f32 v189, v125
 v_mfma_f32_16x16x32_bf16 v[24:27], a[232:235], a[180:183], v[24:27]
 v_exp_f32 v190, v126
 v_mfma_f32_16x16x32_bf16 v[24:27], a[236:239], a[188:191], v[24:27]
 v_mfma_f32_16x16x32_bf16 v[16:19], a[236:239], a[184:187], v[168:171]
 ds_read_b128 a[200:203], v217 offset:34816
 v_cvt_pk_bf16_f32 v166, v188, v189
 v_mfma_f32_16x16x32_bf16 v[16:19], a[232:235], a[176:179], v[16:19]
 v_exp_f32 v191, v127
 v_mfma_f32_16x16x32_bf16 v[16:19], a[228:231], a[168:171], v[16:19]
 v_exp_f32 v184, v112
 v_mfma_f32_16x16x32_bf16 v[16:19], a[224:227], a[160:163], v[16:19]
 v_cvt_pk_bf16_f32 v167, v190, v191
 v_mfma_f32_16x16x32_bf16 v[88:91], a[224:227], a[132:135], v[180:183]
 v_exp_f32 v185, v113
 v_mfma_f32_16x16x32_bf16 v[88:91], a[228:231], a[140:143], v[88:91]
 v_mfma_f32_16x16x32_bf16 v[204:207], v[208:211], v[164:167], v[204:207]
 v_mfma_f32_16x16x32_bf16 v[88:91], a[232:235], a[148:151], v[88:91]
 v_exp_f32 v186, v114
 v_mfma_f32_16x16x32_bf16 v[88:91], a[236:239], a[156:159], v[88:91]
 ds_read_b128 a[204:207], v217 offset:35840
 v_cvt_pk_bf16_f32 v160, v184, v185
 v_mfma_f32_16x16x32_bf16 v[80:83], a[236:239], a[152:155], v[176:179]
 v_exp_f32 v187, v115
 v_mfma_f32_16x16x32_bf16 v[80:83], a[232:235], a[144:147], v[80:83]
 v_mfma_f32_16x16x32_bf16 v[80:83], a[228:231], a[136:139], v[80:83]
 s_waitcnt lgkmcnt(4)
 v_exp_f32 v188, v116
 v_mfma_f32_16x16x32_bf16 v[80:83], a[224:227], a[128:131], v[80:83]
 ds_read_b128 a[208:211], v217 offset:36864
 v_cvt_pk_bf16_f32 v161, v186, v187
 v_mfma_f32_16x16x32_bf16 v[28:31], a[240:243], a[164:167], v[172:175]
 v_exp_f32 v189, v117
 v_mfma_f32_16x16x32_bf16 v[28:31], a[244:247], a[172:175], v[28:31]
 v_mfma_f32_16x16x32_bf16 v[28:31], a[248:251], a[180:183], v[28:31]
 v_exp_f32 v190, v118
 v_mfma_f32_16x16x32_bf16 v[28:31], a[252:255], a[188:191], v[28:31]
 ds_read_b128 a[212:215], v217 offset:37888
 v_cvt_pk_bf16_f32 v162, v188, v189
 v_mfma_f32_16x16x32_bf16 v[20:23], a[252:255], a[184:187], v[168:171]
 v_exp_f32 v191, v119
 v_mfma_f32_16x16x32_bf16 v[20:23], a[248:251], a[176:179], v[20:23]
 v_exp_f32 v184, v8
 v_mfma_f32_16x16x32_bf16 v[20:23], a[244:247], a[168:171], v[20:23]
 v_mfma_f32_16x16x32_bf16 v[20:23], a[240:243], a[160:163], v[20:23]
 ds_read_b128 a[216:219], v217 offset:38912
 v_cvt_pk_bf16_f32 v163, v190, v191
 v_mfma_f32_16x16x32_bf16 v[92:95], a[240:243], a[132:135], v[180:183]
 v_exp_f32 v185, v9
 v_mfma_f32_16x16x32_bf16 v[92:95], a[244:247], a[140:143], v[92:95]
 v_mfma_f32_16x16x32_bf16 v[200:203], v[208:211], v[160:163], v[200:203]
 v_exp_f32 v186, v10
 v_mfma_f32_16x16x32_bf16 v[92:95], a[248:251], a[148:151], v[92:95]
 v_mfma_f32_16x16x32_bf16 v[92:95], a[252:255], a[156:159], v[92:95]
 v_exp_f32 v187, v11
 v_mfma_f32_16x16x32_bf16 v[84:87], a[252:255], a[152:155], v[176:179]
 ds_read_b128 a[220:223], v217 offset:39936
 v_mfma_f32_16x16x32_bf16 v[84:87], a[248:251], a[144:147], v[84:87]
 s_waitcnt lgkmcnt(4)
 v_max3_f32 v250, v196, v192, v204
 v_max_f32 v250, v250, v200
 v_mfma_f32_16x16x32_bf16 v[84:87], a[244:247], a[136:139], v[84:87]
 v_cmp_lt_f32 vcc, s75, v250
 v_mfma_f32_16x16x32_bf16 v[84:87], a[240:243], a[128:131], v[84:87]
 s_cbranch_vccnz Lrare22
Lback23:
 v_add_f32 v213, v213, v196
 v_add_f32 v212, v212, v192
 v_add_f32 v215, v215, v204
 v_add_f32 v214, v214, v200
 v_mfma_f32_16x16x32_bf16 a[68:71], a[192:195], v[140:143], a[68:71]
 ds_read_b128 a[224:227], v217 offset:40960
 v_cvt_pk_bf16_f32 v132, v184, v185
 v_mfma_f32_16x16x32_bf16 a[64:67], a[192:195], v[136:139], a[64:67]
 s_sub_u32 s74, s74, 1
 v_exp_f32 v188, v12
 v_mfma_f32_16x16x32_bf16 a[4:7], a[192:195], v[156:159], a[4:7]
 ds_read_b128 a[228:231], v217 offset:41984
 v_cvt_pk_bf16_f32 v133, v186, v187
 v_mfma_f32_16x16x32_bf16 a[0:3], a[192:195], v[152:155], a[0:3]
 v_exp_f32 v189, v13
 v_mfma_f32_16x16x32_bf16 a[76:79], a[196:199], v[140:143], a[76:79]
 v_exp_f32 v190, v14
 v_mfma_f32_16x16x32_bf16 a[72:75], a[196:199], v[136:139], a[72:75]
 v_mfma_f32_16x16x32_bf16 a[12:15], a[196:199], v[156:159], a[12:15]
 ds_read_b128 a[232:235], v217 offset:43008
 v_cvt_pk_bf16_f32 v134, v188, v189
 v_mfma_f32_16x16x32_bf16 a[8:11], a[196:199], v[152:155], a[8:11]
 v_exp_f32 v191, v15
 v_mfma_f32_16x16x32_bf16 a[84:87], a[200:203], v[140:143], a[84:87]
 v_exp_f32 v184, v0
 v_mfma_f32_16x16x32_bf16 a[80:83], a[200:203], v[136:139], a[80:83]
 v_mfma_f32_16x16x32_bf16 a[20:23], a[200:203], v[156:159], a[20:23]
 ds_read_b128 a[236:239], v217 offset:44032
 v_cvt_pk_bf16_f32 v135, v190, v191
 v_mfma_f32_16x16x32_bf16 a[16:19], a[200:203], v[152:155], a[16:19]
 v_exp_f32 v185, v1
 v_mfma_f32_16x16x32_bf16 a[92:95], a[204:207], v[140:143], a[92:95]
 v_mfma_f32_16x16x32_bf16 v[196:199], v[208:211], v[132:135], 0
 v_exp_f32 v186, v2
 v_mfma_f32_16x16x32_bf16 a[88:91], a[204:207], v[136:139], a[88:91]
 v_mfma_f32_16x16x32_bf16 a[28:31], a[204:207], v[156:159], a[28:31]
 s_waitcnt lgkmcnt(4)
 ds_read_b128 a[240:243], v217 offset:45056
 v_cvt_pk_bf16_f32 v128, v184, v185
 v_mfma_f32_16x16x32_bf16 a[24:27], a[204:207], v[152:155], a[24:27]
 v_exp_f32 v187, v3
 v_mfma_f32_16x16x32_bf16 a[100:103], a[208:211], v[140:143], a[100:103]
 v_exp_f32 v188, v4
 v_mfma_f32_16x16x32_bf16 a[96:99], a[208:211], v[136:139], a[96:99]
 v_mfma_f32_16x16x32_bf16 a[36:39], a[208:211], v[156:159], a[36:39]
 ds_read_b128 a[244:247], v217 offset:46080
 v_cvt_pk_bf16_f32 v129, v186, v187
 v_mfma_f32_16x16x32_bf16 a[32:35], a[208:211], v[152:155], a[32:35]
 v_exp_f32 v189, v5
 v_mfma_f32_16x16x32_bf16 a[108:111], a[212:215], v[140:143], a[108:111]
 v_exp_f32 v190, v6
 v_mfma_f32_16x16x32_bf16 a[104:107], a[212:215], v[136:139], a[104:107]
 v_mfma_f32_16x16x32_bf16 a[44:47], a[212:215], v[156:159], a[44:47]
 ds_read_b128 a[248:251], v217 offset:47104
 v_cvt_pk_bf16_f32 v130, v188, v189
 v_mfma_f32_16x16x32_bf16 a[40:43], a[212:215], v[152:155], a[40:43]
 v_exp_f32 v191, v7
 v_mfma_f32_16x16x32_bf16 a[116:119], a[216:219], v[140:143], a[116:119]
 v_exp_f32 v184, v72
 v_mfma_f32_16x16x32_bf16 a[112:115], a[216:219], v[136:139], a[112:115]
 v_mfma_f32_16x16x32_bf16 a[52:55], a[216:219], v[156:159], a[52:55]
 ds_read_b128 a[252:255], v217 offset:48128
 v_cvt_pk_bf16_f32 v131, v190, v191
 v_mfma_f32_16x16x32_bf16 a[48:51], a[216:219], v[152:155], a[48:51]
 v_exp_f32 v185, v73
 v_mfma_f32_16x16x32_bf16 a[124:127], a[220:223], v[140:143], a[124:127]
 v_mfma_f32_16x16x32_bf16 v[192:195], v[208:211], v[128:131], 0
 v_exp_f32 v186, v74
 v_mfma_f32_16x16x32_bf16 a[120:123], a[220:223], v[136:139], a[120:123]
 v_xor_b32 v217, 0x10000, v217
 v_mfma_f32_16x16x32_bf16 a[60:63], a[220:223], v[156:159], a[60:63]
 s_waitcnt lgkmcnt(4)
 v_cvt_pk_bf16_f32 v156, v184, v185
 v_mfma_f32_16x16x32_bf16 a[56:59], a[220:223], v[152:155], a[56:59]
 s_waitcnt vmcnt(8)
 v_exp_f32 v187, v75
 v_mfma_f32_16x16x32_bf16 a[68:71], a[224:227], v[148:151], a[68:71]
 s_barrier
 ds_read_b128 a[192:195], v217 offset:16384
 ds_read_b128 a[196:199], v217 offset:17408
 v_mfma_f32_16x16x32_bf16 a[64:67], a[224:227], v[144:147], a[64:67]
 s_add_u32 m0, s67, 0
 v_exp_f32 v188, v76
 v_mfma_f32_16x16x32_bf16 a[4:7], a[224:227], v[164:167], a[4:7]
 buffer_load_dwordx4 v218, s[56:59], s66 offen offset:0 sc1 lds
 v_mfma_f32_16x16x32_bf16 a[0:3], a[224:227], v[160:163], a[0:3]
 v_cvt_pk_bf16_f32 v157, v186, v187
 v_mfma_f32_16x16x32_bf16 a[76:79], a[228:231], v[148:151], a[76:79]
 v_exp_f32 v189, v77
 v_mfma_f32_16x16x32_bf16 a[72:75], a[228:231], v[144:147], a[72:75]
 v_exp_f32 v190, v78
 v_mfma_f32_16x16x32_bf16 a[12:15], a[228:231], v[164:167], a[12:15]
 ds_read_b128 a[200:203], v217 offset:18432
 v_cvt_pk_bf16_f32 v158, v188, v189
 v_mfma_f32_16x16x32_bf16 a[8:11], a[228:231], v[160:163], a[8:11]
 v_exp_f32 v191, v79
 v_mfma_f32_16x16x32_bf16 a[84:87], a[232:235], v[148:151], a[84:87]
 buffer_load_dwordx4 v218, s[56:59], s66 offen offset:1024 sc1 lds
 v_mfma_f32_16x16x32_bf16 a[80:83], a[232:235], v[144:147], a[80:83]
 v_exp_f32 v184, v64
 v_mfma_f32_16x16x32_bf16 a[20:23], a[232:235], v[164:167], a[20:23]
 ds_read_b128 a[204:207], v217 offset:19456
 v_cvt_pk_bf16_f32 v159, v190, v191
 v_mfma_f32_16x16x32_bf16 a[16:19], a[232:235], v[160:163], a[16:19]
 v_exp_f32 v185, v65
 v_mfma_f32_16x16x32_bf16 a[92:95], a[236:239], v[148:151], a[92:95]
 buffer_load_dwordx4 v218, s[56:59], s66 offen offset:2048 sc1 lds
 v_mfma_f32_16x16x32_bf16 v[204:207], v[208:211], v[156:159], 0
 v_exp_f32 v186, v66
 v_mfma_f32_16x16x32_bf16 a[88:91], a[236:239], v[144:147], a[88:91]
 ds_read_b128 a[208:211], v217 offset:20480
 v_cvt_pk_bf16_f32 v152, v184, v185
 v_mfma_f32_16x16x32_bf16 a[28:31], a[236:239], v[164:167], a[28:31]
 s_waitcnt lgkmcnt(5)
 v_exp_f32 v187, v67
 v_mfma_f32_16x16x32_bf16 a[24:27], a[236:239], v[160:163], a[24:27]
 v_exp_f32 v188, v68
 v_mfma_f32_16x16x32_bf16 a[100:103], a[240:243], v[148:151], a[100:103]
 v_mfma_f32_16x16x32_bf16 a[96:99], a[240:243], v[144:147], a[96:99]
 ds_read_b128 a[212:215], v217 offset:21504
 v_cvt_pk_bf16_f32 v153, v186, v187
 v_mfma_f32_16x16x32_bf16 a[36:39], a[240:243], v[164:167], a[36:39]
 v_exp_f32 v189, v69
 v_mfma_f32_16x16x32_bf16 a[32:35], a[240:243], v[160:163], a[32:35]
 buffer_load_dwordx4 v218, s[56:59], s66 offen offset:3072 sc1 lds
 v_mfma_f32_16x16x32_bf16 a[108:111], a[244:247], v[148:151], a[108:111]
 v_exp_f32 v190, v70
 v_mfma_f32_16x16x32_bf16 a[104:107], a[244:247], v[144:147], a[104:107]
 ds_read_b128 a[216:219], v217 offset:22528
 v_cvt_pk_bf16_f32 v154, v188, v189
 v_mfma_f32_16x16x32_bf16 a[44:47], a[244:247], v[164:167], a[44:47]
 s_add_u32 m0, s67, 4096
 v_exp_f32 v191, v71
 v_mfma_f32_16x16x32_bf16 a[40:43], a[244:247], v[160:163], a[40:43]
 v_exp_f32 v184, v24
 v_mfma_f32_16x16x32_bf16 a[116:119], a[248:251], v[148:151], a[116:119]
 buffer_load_dwordx4 v219, s[56:59], s66 offen offset:0 sc1 lds
 v_mfma_f32_16x16x32_bf16 a[112:115], a[248:251], v[144:147], a[112:115]
 ds_read_b128 a[220:223], v217 offset:23552
 v_cvt_pk_bf16_f32 v155, v190, v191
 v_mfma_f32_16x16x32_bf16 a[52:55], a[248:251], v[164:167], a[52:55]
 v_exp_f32 v185, v25
 v_mfma_f32_16x16x32_bf16 a[48:51], a[248:251], v[160:163], a[48:51]
 v_mfma_f32_16x16x32_bf16 v[200:203], v[208:211], v[152:155], 0
 v_exp_f32 v186, v26
 v_mfma_f32_16x16x32_bf16 a[124:127], a[252:255], v[148:151], a[124:127]
 v_mfma_f32_16x16x32_bf16 a[120:123], a[252:255], v[144:147], a[120:123]
 ds_read_b128 a[224:227], v217 offset:24576
 v_cvt_pk_bf16_f32 v148, v184, v185
 v_mfma_f32_16x16x32_bf16 a[60:63], a[252:255], v[164:167], a[60:63]
 buffer_load_dwordx4 v219, s[56:59], s66 offen offset:1024 sc1 lds
 v_mfma_f32_16x16x32_bf16 a[56:59], a[252:255], v[160:163], a[56:59]
 s_waitcnt lgkmcnt(5)
 v_exp_f32 v187, v27
 v_mfma_f32_16x16x32_bf16 v[40:43], a[192:195], a[164:167], v[172:175]
 v_exp_f32 v188, v28
 v_mfma_f32_16x16x32_bf16 v[40:43], a[196:199], a[172:175], v[40:43]
 ds_read_b128 a[228:231], v217 offset:25600
 v_cvt_pk_bf16_f32 v149, v186, v187
 v_mfma_f32_16x16x32_bf16 v[40:43], a[200:203], a[180:183], v[40:43]
 v_exp_f32 v189, v29
 v_mfma_f32_16x16x32_bf16 v[40:43], a[204:207], a[188:191], v[40:43]
 v_exp_f32 v190, v30
 v_mfma_f32_16x16x32_bf16 v[32:35], a[204:207], a[184:187], v[168:171]
 buffer_load_dwordx4 v219, s[56:59], s66 offen offset:2048 sc1 lds
 v_mfma_f32_16x16x32_bf16 v[32:35], a[200:203], a[176:179], v[32:35]
 ds_read_b128 a[232:235], v217 offset:26624
 v_cvt_pk_bf16_f32 v150, v188, v189
 v_mfma_f32_16x16x32_bf16 v[32:35], a[196:199], a[168:171], v[32:35]
 v_exp_f32 v191, v31
 v_mfma_f32_16x16x32_bf16 v[32:35], a[192:195], a[160:163], v[32:35]
 v_exp_f32 v184, v16
 v_mfma_f32_16x16x32_bf16 v[104:107], a[192:195], a[132:135], v[180:183]
 ds_read_b128 a[236:239], v217 offset:27648
 v_cvt_pk_bf16_f32 v151, v190, v191
 v_mfma_f32_16x16x32_bf16 v[104:107], a[196:199], a[140:143], v[104:107]
 buffer_load_dwordx4 v219, s[56:59], s66 offen offset:3072 sc1 lds
 v_mfma_f32_16x16x32_bf16 v[104:107], a[200:203], a[148:151], v[104:107]
 v_exp_f32 v185, v17
 v_mfma_f32_16x16x32_bf16 v[104:107], a[204:207], a[156:159], v[104:107]
 v_mfma_f32_16x16x32_bf16 v[196:199], v[208:211], v[148:151], v[196:199]
 v_exp_f32 v186, v18
 v_mfma_f32_16x16x32_bf16 v[96:99], a[204:207], a[152:155], v[176:179]
 ds_read_b128 a[240:243], v217 offset:28672
 v_cvt_pk_bf16_f32 v144, v184, v185
 v_mfma_f32_16x16x32_bf16 v[96:99], a[200:203], a[144:147], v[96:99]
 s_add_u32 s66, s66, 32768
 v_exp_f32 v187, v19
 v_mfma_f32_16x16x32_bf16 v[96:99], a[196:199], a[136:139], v[96:99]
 s_waitcnt lgkmcnt(5)
 v_mfma_f32_16x16x32_bf16 v[96:99], a[192:195], a[128:131], v[96:99]
 v_exp_f32 v188, v20
 v_mfma_f32_16x16x32_bf16 v[44:47], a[208:211], a[164:167], v[172:175]
 ds_read_b128 a[244:247], v217 offset:29696
 v_cvt_pk_bf16_f32 v145, v186, v187
 v_mfma_f32_16x16x32_bf16 v[44:47], a[212:215], a[172:175], v[44:47]
 v_exp_f32 v189, v21
 v_mfma_f32_16x16x32_bf16 v[44:47], a[216:219], a[180:183], v[44:47]
 v_exp_f32 v190, v22
 v_mfma_f32_16x16x32_bf16 v[44:47], a[220:223], a[188:191], v[44:47]
 v_mfma_f32_16x16x32_bf16 v[36:39], a[220:223], a[184:187], v[168:171]
 ds_read_b128 a[248:251], v217 offset:30720
 v_cvt_pk_bf16_f32 v146, v188, v189
 v_mfma_f32_16x16x32_bf16 v[36:39], a[216:219], a[176:179], v[36:39]
 v_exp_f32 v191, v23
 v_mfma_f32_16x16x32_bf16 v[36:39], a[212:215], a[168:171], v[36:39]
 v_exp_f32 v184, v88
 v_mfma_f32_16x16x32_bf16 v[36:39], a[208:211], a[160:163], v[36:39]
 v_mfma_f32_16x16x32_bf16 v[108:111], a[208:211], a[132:135], v[180:183]
 ds_read_b128 a[252:255], v217 offset:31744
 v_cvt_pk_bf16_f32 v147, v190, v191
 v_mfma_f32_16x16x32_bf16 v[108:111], a[212:215], a[140:143], v[108:111]
 v_exp_f32 v185, v89
 v_mfma_f32_16x16x32_bf16 v[108:111], a[216:219], a[148:151], v[108:111]
 v_mfma_f32_16x16x32_bf16 v[192:195], v[208:211], v[144:147], v[192:195]
 v_exp_f32 v186, v90
 v_mfma_f32_16x16x32_bf16 v[108:111], a[220:223], a[156:159], v[108:111]
 v_mfma_f32_16x16x32_bf16 v[100:103], a[220:223], a[152:155], v[176:179]
 ds_read_b128 a[192:195], v217 offset:0
 v_cvt_pk_bf16_f32 v164, v184, v185
 v_mfma_f32_16x16x32_bf16 v[100:103], a[216:219], a[144:147], v[100:103]
 v_exp_f32 v187, v91
 v_mfma_f32_16x16x32_bf16 v[100:103], a[212:215], a[136:139], v[100:103]
 s_waitcnt lgkmcnt(5)
 v_exp_f32 v188, v92
 v_mfma_f32_16x16x32_bf16 v[100:103], a[208:211], a[128:131], v[100:103]
 v_mfma_f32_16x16x32_bf16 v[56:59], a[224:227], a[164:167], v[172:175]
 ds_read_b128 a[196:199], v217 offset:1024
 v_cvt_pk_bf16_f32 v165, v186, v187
 v_mfma_f32_16x16x32_bf16 v[56:59], a[228:231], a[172:175], v[56:59]
 v_exp_f32 v189, v93
 v_mfma_f32_16x16x32_bf16 v[56:59], a[232:235], a[180:183], v[56:59]
 v_exp_f32 v190, v94
 v_mfma_f32_16x16x32_bf16 v[56:59], a[236:239], a[188:191], v[56:59]
 v_mfma_f32_16x16x32_bf16 v[48:51], a[236:239], a[184:187], v[168:171]
 ds_read_b128 a[200:203], v217 offset:2048
 v_cvt_pk_bf16_f32 v166, v188, v189
 v_mfma_f32_16x16x32_bf16 v[48:51], a[232:235], a[176:179], v[48:51]
 v_exp_f32 v191, v95
 v_mfma_f32_16x16x32_bf16 v[48:51], a[228:231], a[168:171], v[48:51]
 v_exp_f32 v184, v80
 v_mfma_f32_16x16x32_bf16 v[48:51], a[224:227], a[160:163], v[48:51]
 v_cvt_pk_bf16_f32 v167, v190, v191
 v_mfma_f32_16x16x32_bf16 v[120:123], a[224:227], a[132:135], v[180:183]
 v_exp_f32 v185, v81
 v_mfma_f32_16x16x32_bf16 v[120:123], a[228:231], a[140:143], v[120:123]
 v_mfma_f32_16x16x32_bf16 v[204:207], v[208:211], v[164:167], v[204:207]
 v_mfma_f32_16x16x32_bf16 v[120:123], a[232:235], a[148:151], v[120:123]
 v_exp_f32 v186, v82
 v_mfma_f32_16x16x32_bf16 v[120:123], a[236:239], a[156:159], v[120:123]
 ds_read_b128 a[204:207], v217 offset:3072
 v_cvt_pk_bf16_f32 v160, v184, v185
 v_mfma_f32_16x16x32_bf16 v[112:115], a[236:239], a[152:155], v[176:179]
 v_exp_f32 v187, v83
 v_mfma_f32_16x16x32_bf16 v[112:115], a[232:235], a[144:147], v[112:115]
 v_mfma_f32_16x16x32_bf16 v[112:115], a[228:231], a[136:139], v[112:115]
 s_waitcnt lgkmcnt(4)
 v_exp_f32 v188, v84
 v_mfma_f32_16x16x32_bf16 v[112:115], a[224:227], a[128:131], v[112:115]
 ds_read_b128 a[208:211], v217 offset:4096
 v_cvt_pk_bf16_f32 v161, v186, v187
 v_mfma_f32_16x16x32_bf16 v[60:63], a[240:243], a[164:167], v[172:175]
 v_exp_f32 v189, v85
 v_mfma_f32_16x16x32_bf16 v[60:63], a[244:247], a[172:175], v[60:63]
 v_mfma_f32_16x16x32_bf16 v[60:63], a[248:251], a[180:183], v[60:63]
 v_exp_f32 v190, v86
 v_mfma_f32_16x16x32_bf16 v[60:63], a[252:255], a[188:191], v[60:63]
 ds_read_b128 a[212:215], v217 offset:5120
 v_cvt_pk_bf16_f32 v162, v188, v189
 v_mfma_f32_16x16x32_bf16 v[52:55], a[252:255], a[184:187], v[168:171]
 v_exp_f32 v191, v87
 v_mfma_f32_16x16x32_bf16 v[52:55], a[248:251], a[176:179], v[52:55]
 v_exp_f32 v184, v40
 v_mfma_f32_16x16x32_bf16 v[52:55], a[244:247], a[168:171], v[52:55]
 v_mfma_f32_16x16x32_bf16 v[52:55], a[240:243], a[160:163], v[52:55]
 ds_read_b128 a[216:219], v217 offset:6144
 v_cvt_pk_bf16_f32 v163, v190, v191
 v_mfma_f32_16x16x32_bf16 v[124:127], a[240:243], a[132:135], v[180:183]
 v_exp_f32 v185, v41
 v_mfma_f32_16x16x32_bf16 v[124:127], a[244:247], a[140:143], v[124:127]
 v_mfma_f32_16x16x32_bf16 v[200:203], v[208:211], v[160:163], v[200:203]
 v_exp_f32 v186, v42
 v_mfma_f32_16x16x32_bf16 v[124:127], a[248:251], a[148:151], v[124:127]
 v_mfma_f32_16x16x32_bf16 v[124:127], a[252:255], a[156:159], v[124:127]
 v_exp_f32 v187, v43
 v_mfma_f32_16x16x32_bf16 v[116:119], a[252:255], a[152:155], v[176:179]
 ds_read_b128 a[220:223], v217 offset:7168
 v_mfma_f32_16x16x32_bf16 v[116:119], a[248:251], a[144:147], v[116:119]
 s_cmp_lg_u32 s74, 0
 v_max3_f32 v250, v196, v192, v204
 v_max_f32 v250, v250, v200
 v_mfma_f32_16x16x32_bf16 v[116:119], a[244:247], a[136:139], v[116:119]
 s_waitcnt lgkmcnt(4)
 v_cmp_lt_f32 vcc, s75, v250
 v_mfma_f32_16x16x32_bf16 v[116:119], a[240:243], a[128:131], v[116:119]
 s_cbranch_vccnz Lrare24
Lback25:
 v_add_f32 v213, v213, v196
 v_add_f32 v212, v212, v192
 v_add_f32 v215, v215, v204
 v_add_f32 v214, v214, v200
 s_cbranch_scc1 Lp113
Lm114:
 v_mfma_f32_16x16x32_bf16 a[68:71], a[192:195], v[132:135], a[68:71]
 ds_read_b128 a[224:227], v217 offset:8192
 v_cndmask_b32 v64, v220, v176, s[8:9]
 v_mfma_f32_16x16x32_bf16 a[64:67], a[192:195], v[128:131], a[64:67]
 ds_read_b128 a[228:231], v217 offset:9216
 v_cvt_pk_bf16_f32 v140, v184, v185
 v_mfma_f32_16x16x32_bf16 a[4:7], a[192:195], v[156:159], a[4:7]
 v_exp_f32 v188, v44
 v_mfma_f32_16x16x32_bf16 a[0:3], a[192:195], v[152:155], a[0:3]
 v_cvt_pk_bf16_f32 v141, v186, v187
 v_mfma_f32_16x16x32_bf16 a[76:79], a[196:199], v[132:135], a[76:79]
 v_exp_f32 v189, v45
 v_mfma_f32_16x16x32_bf16 a[72:75], a[196:199], v[128:131], a[72:75]
 v_exp_f32 v190, v46
 v_mfma_f32_16x16x32_bf16 a[12:15], a[196:199], v[156:159], a[12:15]
 v_cvt_pk_bf16_f32 v142, v188, v189
 v_cndmask_b32 v65, v220, v176, s[10:11]
 v_mfma_f32_16x16x32_bf16 a[8:11], a[196:199], v[152:155], a[8:11]
 v_exp_f32 v191, v47
 v_mfma_f32_16x16x32_bf16 a[84:87], a[200:203], v[132:135], a[84:87]
 ds_read_b128 a[232:235], v217 offset:10240
 ds_read_b128 a[236:239], v217 offset:11264
 v_mfma_f32_16x16x32_bf16 a[80:83], a[200:203], v[128:131], a[80:83]
 v_exp_f32 v184, v32
 v_mfma_f32_16x16x32_bf16 a[20:23], a[200:203], v[156:159], a[20:23]
 v_cvt_pk_bf16_f32 v143, v190, v191
 v_mfma_f32_16x16x32_bf16 a[16:19], a[200:203], v[152:155], a[16:19]
 v_exp_f32 v185, v33
 v_mfma_f32_16x16x32_bf16 a[92:95], a[204:207], v[132:135], a[92:95]
 v_mfma_f32_16x16x32_bf16 v[196:199], v[208:211], v[140:143], 0
 v_exp_f32 v186, v34
 v_mfma_f32_16x16x32_bf16 a[88:91], a[204:207], v[128:131], a[88:91]
 v_mfma_f32_16x16x32_bf16 a[28:31], a[204:207], v[156:159], a[28:31]
 s_waitcnt lgkmcnt(4)
 v_cvt_pk_bf16_f32 v136, v184, v185
 v_cndmask_b32 v66, v220, v176, s[12:13]
 v_mfma_f32_16x16x32_bf16 a[24:27], a[204:207], v[152:155], a[24:27]
 v_exp_f32 v187, v35
 v_mfma_f32_16x16x32_bf16 a[100:103], a[208:211], v[132:135], a[100:103]
 ds_read_b128 a[240:243], v217 offset:12288
 ds_read_b128 a[244:247], v217 offset:13312
 v_mfma_f32_16x16x32_bf16 a[96:99], a[208:211], v[128:131], a[96:99]
 v_exp_f32 v188, v36
 v_mfma_f32_16x16x32_bf16 a[36:39], a[208:211], v[156:159], a[36:39]
 v_cvt_pk_bf16_f32 v137, v186, v187
 v_mfma_f32_16x16x32_bf16 a[32:35], a[208:211], v[152:155], a[32:35]
 v_exp_f32 v189, v37
 v_mfma_f32_16x16x32_bf16 a[108:111], a[212:215], v[132:135], a[108:111]
 v_exp_f32 v190, v38
 v_mfma_f32_16x16x32_bf16 a[104:107], a[212:215], v[128:131], a[104:107]
 v_mfma_f32_16x16x32_bf16 a[44:47], a[212:215], v[156:159], a[44:47]
 v_cvt_pk_bf16_f32 v138, v188, v189
 v_cndmask_b32 v67, v220, v176, s[14:15]
 v_mfma_f32_16x16x32_bf16 a[40:43], a[212:215], v[152:155], a[40:43]
 v_exp_f32 v191, v39
 v_mfma_f32_16x16x32_bf16 a[116:119], a[216:219], v[132:135], a[116:119]
 ds_read_b128 a[248:251], v217 offset:14336
 ds_read_b128 a[252:255], v217 offset:15360
 v_mfma_f32_16x16x32_bf16 a[112:115], a[216:219], v[128:131], a[112:115]
 v_exp_f32 v184, v104
 v_mfma_f32_16x16x32_bf16 a[52:55], a[216:219], v[156:159], a[52:55]
 v_cvt_pk_bf16_f32 v139, v190, v191
 v_mfma_f32_16x16x32_bf16 a[48:51], a[216:219], v[152:155], a[48:51]
 v_exp_f32 v185, v105
 v_mfma_f32_16x16x32_bf16 a[124:127], a[220:223], v[132:135], a[124:127]
 v_mfma_f32_16x16x32_bf16 v[192:195], v[208:211], v[136:139], 0
 v_exp_f32 v186, v106
 v_mfma_f32_16x16x32_bf16 a[120:123], a[220:223], v[128:131], a[120:123]
 v_mfma_f32_16x16x32_bf16 a[60:63], a[220:223], v[156:159], a[60:63]
 s_waitcnt lgkmcnt(4)
 v_cvt_pk_bf16_f32 v156, v184, v185
 v_cndmask_b32 v68, v220, v176, s[16:17]
 v_mfma_f32_16x16x32_bf16 a[56:59], a[220:223], v[152:155], a[56:59]
 s_waitcnt vmcnt(8)
 v_exp_f32 v187, v107
 v_mfma_f32_16x16x32_bf16 a[68:71], a[224:227], v[148:151], a[68:71]
 s_barrier
 ds_read_b128 a[192:195], v217 offset:49152
 ds_read_b128 a[196:199], v217 offset:50176
 v_mfma_f32_16x16x32_bf16 a[64:67], a[224:227], v[144:147], a[64:67]
 s_add_u32 m0, s67, 32768
 v_exp_f32 v188, v108
 v_mfma_f32_16x16x32_bf16 a[4:7], a[224:227], v[164:167], a[4:7]
 buffer_load_dwordx4 v218, s[56:59], s66 offen offset:0 sc1 lds
 v_mfma_f32_16x16x32_bf16 a[0:3], a[224:227], v[160:163], a[0:3]
 v_cvt_pk_bf16_f32 v157, v186, v187
 v_mfma_f32_16x16x32_bf16 a[76:79], a[228:231], v[148:151], a[76:79]
 v_exp_f32 v189, v109
 v_mfma_f32_16x16x32_bf16 a[72:75], a[228:231], v[144:147], a[72:75]
 v_exp_f32 v190, v110
 v_mfma_f32_16x16x32_bf16 a[12:15], a[228:231], v[164:167], a[12:15]
 v_cvt_pk_bf16_f32 v158, v188, v189
 v_cndmask_b32 v69, v220, v176, s[18:19]
 v_mfma_f32_16x16x32_bf16 a[8:11], a[228:231], v[160:163], a[8:11]
 v_exp_f32 v191, v111
 v_mfma_f32_16x16x32_bf16 a[84:87], a[232:235], v[148:151], a[84:87]
 buffer_load_dwordx4 v218, s[56:59], s66 offen offset:1024 sc1 lds
 v_mfma_f32_16x16x32_bf16 a[80:83], a[232:235], v[144:147], a[80:83]
 ds_read_b128 a[200:203], v217 offset:51200
 ds_read_b128 a[204:207], v217 offset:52224
 v_mfma_f32_16x16x32_bf16 a[20:23], a[232:235], v[164:167], a[20:23]
 v_exp_f32 v184, v96
 v_mfma_f32_16x16x32_bf16 a[16:19], a[232:235], v[160:163], a[16:19]
 v_cvt_pk_bf16_f32 v159, v190, v191
 v_cndmask_b32 v70, v220, v176, s[20:21]
 v_mfma_f32_16x16x32_bf16 a[92:95], a[236:239], v[148:151], a[92:95]
 v_exp_f32 v185, v97
 v_mfma_f32_16x16x32_bf16 a[88:91], a[236:239], v[144:147], a[88:91]
 buffer_load_dwordx4 v218, s[56:59], s66 offen offset:2048 sc1 lds
 v_mfma_f32_16x16x32_bf16 v[204:207], v[208:211], v[156:159], 0
 v_exp_f32 v186, v98
 v_mfma_f32_16x16x32_bf16 a[28:31], a[236:239], v[164:167], a[28:31]
 s_waitcnt lgkmcnt(4)
 ds_read_b128 a[208:211], v217 offset:53248
 v_cvt_pk_bf16_f32 v152, v184, v185
 v_mfma_f32_16x16x32_bf16 a[24:27], a[236:239], v[160:163], a[24:27]
 v_exp_f32 v187, v99
 v_mfma_f32_16x16x32_bf16 a[100:103], a[240:243], v[148:151], a[100:103]
 v_exp_f32 v188, v100
 v_mfma_f32_16x16x32_bf16 a[96:99], a[240:243], v[144:147], a[96:99]
 ds_read_b128 a[212:215], v217 offset:54272
 v_cvt_pk_bf16_f32 v153, v186, v187
 v_mfma_f32_16x16x32_bf16 a[36:39], a[240:243], v[164:167], a[36:39]
 v_exp_f32 v189, v101
 v_mfma_f32_16x16x32_bf16 a[32:35], a[240:243], v[160:163], a[32:35]
 buffer_load_dwordx4 v218, s[56:59], s66 offen offset:3072 sc1 lds
 v_mfma_f32_16x16x32_bf16 a[108:111], a[244:247], v[148:151], a[108:111]
 v_exp_f32 v190, v102
 v_mfma_f32_16x16x32_bf16 a[104:107], a[244:247], v[144:147], a[104:107]
 v_cvt_pk_bf16_f32 v154, v188, v189
 v_cndmask_b32 v71, v220, v176, s[22:23]
 v_mfma_f32_16x16x32_bf16 a[44:47], a[244:247], v[164:167], a[44:47]
 s_add_u32 m0, s67, 36864
 v_exp_f32 v191, v103
 v_mfma_f32_16x16x32_bf16 a[40:43], a[244:247], v[160:163], a[40:43]
 v_exp_f32 v184, v56
 v_mfma_f32_16x16x32_bf16 a[116:119], a[248:251], v[148:151], a[116:119]
 ds_read_b128 a[216:219], v217 offset:55296
 v_cvt_pk_bf16_f32 v155, v190, v191
 v_mfma_f32_16x16x32_bf16 a[112:115], a[248:251], v[144:147], a[112:115]
 buffer_load_dwordx4 v219, s[56:59], s66 offen offset:0 sc1 lds
 v_mfma_f32_16x16x32_bf16 a[52:55], a[248:251], v[164:167], a[52:55]
 v_exp_f32 v185, v57
 v_mfma_f32_16x16x32_bf16 a[48:51], a[248:251], v[160:163], a[48:51]
 ds_read_b128 a[220:223], v217 offset:56320
 v_cndmask_b32 v80, v220, v176, s[48:49]
 v_mfma_f32_16x16x32_bf16 v[200:203], v[208:211], v[152:155], 0
 v_exp_f32 v186, v58
 v_mfma_f32_16x16x32_bf16 a[124:127], a[252:255], v[148:151], a[124:127]
 v_mfma_f32_16x16x32_bf16 a[120:123], a[252:255], v[144:147], a[120:123]
 ds_read_b128 a[224:227], v217 offset:57344
 v_cvt_pk_bf16_f32 v148, v184, v185
 v_mfma_f32_16x16x32_bf16 a[60:63], a[252:255], v[164:167], a[60:63]
 buffer_load_dwordx4 v219, s[56:59], s66 offen offset:1024 sc1 lds
 v_mfma_f32_16x16x32_bf16 a[56:59], a[252:255], v[160:163], a[56:59]
 s_waitcnt lgkmcnt(5)
 v_exp_f32 v187, v59
 v_mfma_f32_16x16x32_bf16 v[8:11], a[192:195], a[164:167], v[172:175]
 v_exp_f32 v188, v60
 v_mfma_f32_16x16x32_bf16 v[8:11], a[196:199], a[172:175], v[8:11]
 ds_read_b128 a[228:231], v217 offset:58368
 v_cvt_pk_bf16_f32 v149, v186, v187
 v_mfma_f32_16x16x32_bf16 v[8:11], a[200:203], a[180:183], v[8:11]
 v_exp_f32 v189, v61
 v_mfma_f32_16x16x32_bf16 v[8:11], a[204:207], a[188:191], v[8:11]
 v_exp_f32 v190, v62
 v_mfma_f32_16x16x32_bf16 v[0:3], a[204:207], a[184:187], v[168:171]
 buffer_load_dwordx4 v219, s[56:59], s66 offen offset:2048 sc1 lds
 v_mfma_f32_16x16x32_bf16 v[0:3], a[200:203], a[176:179], v[0:3]
 v_cndmask_b32 v81, v220, v176, s[50:51]
 v_cvt_pk_bf16_f32 v150, v188, v189
 v_mfma_f32_16x16x32_bf16 v[0:3], a[196:199], a[168:171], v[0:3]
 v_exp_f32 v191, v63
 v_mfma_f32_16x16x32_bf16 v[0:3], a[192:195], a[160:163], v[0:3]
 v_exp_f32 v184, v48
 v_mfma_f32_16x16x32_bf16 v[72:75], a[192:195], a[132:135], v[180:183]
 ds_read_b128 a[232:235], v217 offset:59392
 v_cvt_pk_bf16_f32 v151, v190, v191
 v_mfma_f32_16x16x32_bf16 v[72:75], a[196:199], a[140:143], v[72:75]
 buffer_load_dwordx4 v219, s[56:59], s66 offen offset:3072 sc1 lds
 v_mfma_f32_16x16x32_bf16 v[72:75], a[200:203], a[148:151], v[72:75]
 v_exp_f32 v185, v49
 v_mfma_f32_16x16x32_bf16 v[72:75], a[204:207], a[156:159], v[72:75]
 ds_read_b128 a[236:239], v217 offset:60416
 v_cndmask_b32 v82, v220, v176, s[82:83]
 v_mfma_f32_16x16x32_bf16 v[196:199], v[208:211], v[148:151], v[196:199]
 v_exp_f32 v186, v50
 v_mfma_f32_16x16x32_bf16 v[64:67], a[204:207], a[152:155], v[64:67]
 ds_read_b128 a[240:243], v217 offset:61440
 v_cvt_pk_bf16_f32 v144, v184, v185
 v_mfma_f32_16x16x32_bf16 v[64:67], a[200:203], a[144:147], v[64:67]
 s_add_u32 s66, s66, 32768
 v_exp_f32 v187, v51
 v_mfma_f32_16x16x32_bf16 v[64:67], a[196:199], a[136:139], v[64:67]
 s_xor_b32 s67, s67, 0x10000
 v_mfma_f32_16x16x32_bf16 v[64:67], a[192:195], a[128:131], v[64:67]
 s_waitcnt lgkmcnt(5)
 v_exp_f32 v188, v52
 v_mfma_f32_16x16x32_bf16 v[12:15], a[208:211], a[164:167], v[172:175]
 ds_read_b128 a[244:247], v217 offset:62464
 v_cvt_pk_bf16_f32 v145, v186, v187
 v_mfma_f32_16x16x32_bf16 v[12:15], a[212:215], a[172:175], v[12:15]
 v_exp_f32 v189, v53
 v_mfma_f32_16x16x32_bf16 v[12:15], a[216:219], a[180:183], v[12:15]
 v_exp_f32 v190, v54
 v_mfma_f32_16x16x32_bf16 v[12:15], a[220:223], a[188:191], v[12:15]
 v_cndmask_b32 v83, v220, v176, s[84:85]
 v_cvt_pk_bf16_f32 v146, v188, v189
 v_mfma_f32_16x16x32_bf16 v[4:7], a[220:223], a[184:187], v[168:171]
 v_mfma_f32_16x16x32_bf16 v[4:7], a[216:219], a[176:179], v[4:7]
 v_exp_f32 v191, v55
 v_mfma_f32_16x16x32_bf16 v[4:7], a[212:215], a[168:171], v[4:7]
 v_exp_f32 v184, v120
 v_mfma_f32_16x16x32_bf16 v[4:7], a[208:211], a[160:163], v[4:7]
 ds_read_b128 a[248:251], v217 offset:63488
 v_cvt_pk_bf16_f32 v147, v190, v191
 v_mfma_f32_16x16x32_bf16 v[76:79], a[208:211], a[132:135], v[180:183]
 v_mfma_f32_16x16x32_bf16 v[76:79], a[212:215], a[140:143], v[76:79]
 v_exp_f32 v185, v121
 v_mfma_f32_16x16x32_bf16 v[76:79], a[216:219], a[148:151], v[76:79]
 v_mfma_f32_16x16x32_bf16 v[192:195], v[208:211], v[144:147], v[192:195]
 v_exp_f32 v186, v122
 v_mfma_f32_16x16x32_bf16 v[76:79], a[220:223], a[156:159], v[76:79]
 ds_read_b128 a[252:255], v217 offset:64512
 v_cndmask_b32 v84, v220, v176, s[86:87]
 v_mfma_f32_16x16x32_bf16 v[68:71], a[220:223], a[152:155], v[68:71]
 ds_read_b128 a[192:195], v217 offset:32768
 v_cvt_pk_bf16_f32 v164, v184, v185
 v_mfma_f32_16x16x32_bf16 v[68:71], a[216:219], a[144:147], v[68:71]
 v_exp_f32 v187, v123
 v_mfma_f32_16x16x32_bf16 v[68:71], a[212:215], a[136:139], v[68:71]
 s_waitcnt lgkmcnt(5)
 v_exp_f32 v188, v124
 v_mfma_f32_16x16x32_bf16 v[68:71], a[208:211], a[128:131], v[68:71]
 v_mfma_f32_16x16x32_bf16 v[24:27], a[224:227], a[164:167], v[172:175]
 ds_read_b128 a[196:199], v217 offset:33792
 v_cvt_pk_bf16_f32 v165, v186, v187
 v_mfma_f32_16x16x32_bf16 v[24:27], a[228:231], a[172:175], v[24:27]
 v_exp_f32 v189, v125
 v_mfma_f32_16x16x32_bf16 v[24:27], a[232:235], a[180:183], v[24:27]
 v_exp_f32 v190, v126
 v_mfma_f32_16x16x32_bf16 v[24:27], a[236:239], a[188:191], v[24:27]
 v_cndmask_b32 v85, v220, v176, s[88:89]
 v_cvt_pk_bf16_f32 v166, v188, v189
 v_mfma_f32_16x16x32_bf16 v[16:19], a[236:239], a[184:187], v[168:171]
 v_exp_f32 v191, v127
 v_mfma_f32_16x16x32_bf16 v[16:19], a[232:235], a[176:179], v[16:19]
 v_mfma_f32_16x16x32_bf16 v[16:19], a[228:231], a[168:171], v[16:19]
 v_exp_f32 v184, v112
 v_mfma_f32_16x16x32_bf16 v[16:19], a[224:227], a[160:163], v[16:19]
 ds_read_b128 a[200:203], v217 offset:34816
 v_cvt_pk_bf16_f32 v167, v190, v191
 v_mfma_f32_16x16x32_bf16 v[88:91], a[224:227], a[132:135], v[180:183]
 v_exp_f32 v185, v113
 v_mfma_f32_16x16x32_bf16 v[88:91], a[228:231], a[140:143], v[88:91]
 v_mfma_f32_16x16x32_bf16 v[204:207], v[208:211], v[164:167], v[204:207]
 v_mfma_f32_16x16x32_bf16 v[88:91], a[232:235], a[148:151], v[88:91]
 v_exp_f32 v186, v114
 v_mfma_f32_16x16x32_bf16 v[88:91], a[236:239], a[156:159], v[88:91]
 v_cndmask_b32 v86, v220, v176, s[90:91]
 v_cvt_pk_bf16_f32 v160, v184, v185
 v_mfma_f32_16x16x32_bf16 v[80:83], a[236:239], a[152:155], v[80:83]
 ds_read_b128 a[204:207], v217 offset:35840
 ds_read_b128 a[208:211], v217 offset:36864
 v_mfma_f32_16x16x32_bf16 v[80:83], a[232:235], a[144:147], v[80:83]
 v_exp_f32 v187, v115
 v_mfma_f32_16x16x32_bf16 v[80:83], a[228:231], a[136:139], v[80:83]
 s_waitcnt lgkmcnt(5)
 v_exp_f32 v188, v116
 v_mfma_f32_16x16x32_bf16 v[80:83], a[224:227], a[128:131], v[80:83]
 v_cvt_pk_bf16_f32 v161, v186, v187
 v_mfma_f32_16x16x32_bf16 v[28:31], a[240:243], a[164:167], v[172:175]
 v_exp_f32 v189, v117
 v_mfma_f32_16x16x32_bf16 v[28:31], a[244:247], a[172:175], v[28:31]
 v_mfma_f32_16x16x32_bf16 v[28:31], a[248:251], a[180:183], v[28:31]
 v_exp_f32 v190, v118
 v_mfma_f32_16x16x32_bf16 v[28:31], a[252:255], a[188:191], v[28:31]
 v_cndmask_b32 v87, v220, v176, s[92:93]
 v_cvt_pk_bf16_f32 v162, v188, v189
 v_mfma_f32_16x16x32_bf16 v[20:23], a[252:255], a[184:187], v[168:171]
 ds_read_b128 a[212:215], v217 offset:37888
 ds_read_b128 a[216:219], v217 offset:38912
 v_mfma_f32_16x16x32_bf16 v[20:23], a[248:251], a[176:179], v[20:23]
 v_exp_f32 v191, v119
 v_mfma_f32_16x16x32_bf16 v[20:23], a[244:247], a[168:171], v[20:23]
 v_exp_f32 v184, v8
 v_mfma_f32_16x16x32_bf16 v[20:23], a[240:243], a[160:163], v[20:23]
 v_cvt_pk_bf16_f32 v163, v190, v191
 v_mfma_f32_16x16x32_bf16 v[92:95], a[240:243], a[132:135], v[180:183]
 v_exp_f32 v185, v9
 v_mfma_f32_16x16x32_bf16 v[92:95], a[244:247], a[140:143], v[92:95]
 v_mfma_f32_16x16x32_bf16 v[200:203], v[208:211], v[160:163], v[200:203]
 v_exp_f32 v186, v10
 v_mfma_f32_16x16x32_bf16 v[92:95], a[248:251], a[148:151], v[92:95]
 v_mfma_f32_16x16x32_bf16 v[92:95], a[252:255], a[156:159], v[92:95]
 v_exp_f32 v187, v11
 v_mfma_f32_16x16x32_bf16 v[84:87], a[252:255], a[152:155], v[84:87]
 ds_read_b128 a[220:223], v217 offset:39936
 v_mfma_f32_16x16x32_bf16 v[84:87], a[248:251], a[144:147], v[84:87]
 s_waitcnt lgkmcnt(4)
 v_max3_f32 v250, v196, v192, v204
 v_max_f32 v250, v250, v200
 v_mfma_f32_16x16x32_bf16 v[84:87], a[244:247], a[136:139], v[84:87]
 v_cmp_lt_f32 vcc, s75, v250
 v_mfma_f32_16x16x32_bf16 v[84:87], a[240:243], a[128:131], v[84:87]
 s_cbranch_vccnz Lrare26
Lback27:
 v_add_f32 v213, v213, v196
 v_add_f32 v212, v212, v192
 v_add_f32 v215, v215, v204
 v_add_f32 v214, v214, v200
 v_mfma_f32_16x16x32_bf16 a[68:71], a[192:195], v[140:143], a[68:71]
 s_waitcnt vmcnt(8)
 ds_read_b128 a[224:227], v217 offset:40960
 v_cndmask_b32 v104, v220, v180, s[8:9]
 v_mfma_f32_16x16x32_bf16 a[64:67], a[192:195], v[136:139], a[64:67]
 ds_read_b64_tr_b16 v[224:225], v232 offset:0
 v_cvt_pk_bf16_f32 v132, v184, v185
 v_mfma_f32_16x16x32_bf16 a[4:7], a[192:195], v[156:159], a[4:7]
 v_exp_f32 v188, v12
 v_mfma_f32_16x16x32_bf16 a[0:3], a[192:195], v[152:155], a[0:3]
 ds_read_b64_tr_b16 v[226:227], v234 offset:0
 v_cvt_pk_bf16_f32 v133, v186, v187
 v_mfma_f32_16x16x32_bf16 a[76:79], a[196:199], v[140:143], a[76:79]
 v_exp_f32 v189, v13
 v_mfma_f32_16x16x32_bf16 a[72:75], a[196:199], v[136:139], a[72:75]
 ds_read_b64_tr_b16 v[228:229], v233 offset:0
 ds_read_b128 a[228:231], v217 offset:41984
 v_mfma_f32_16x16x32_bf16 a[12:15], a[196:199], v[156:159], a[12:15]
 v_exp_f32 v190, v14
 v_mfma_f32_16x16x32_bf16 a[8:11], a[196:199], v[152:155], a[8:11]
 ds_read_b64_tr_b16 v[230:231], v235 offset:0
 v_cvt_pk_bf16_f32 v134, v188, v189
 v_mfma_f32_16x16x32_bf16 a[84:87], a[200:203], v[140:143], a[84:87]
 ds_read_b128 a[232:235], v217 offset:43008
 v_cndmask_b32 v105, v220, v180, s[10:11]
 v_mfma_f32_16x16x32_bf16 a[80:83], a[200:203], v[136:139], a[80:83]
 v_exp_f32 v191, v15
 v_mfma_f32_16x16x32_bf16 a[20:23], a[200:203], v[156:159], a[20:23]
 v_exp_f32 v184, v0
 v_mfma_f32_16x16x32_bf16 a[16:19], a[200:203], v[152:155], a[16:19]
 ds_read_b128 a[236:239], v217 offset:44032
 v_cvt_pk_bf16_f32 v135, v190, v191
 v_mfma_f32_16x16x32_bf16 a[92:95], a[204:207], v[140:143], a[92:95]
 s_waitcnt lgkmcnt(2)
 buffer_store_dwordx4 v[224:227], v251, s[52:55], s31 offen offset:0 sc1
 v_exp_f32 v185, v1
 v_mfma_f32_16x16x32_bf16 a[88:91], a[204:207], v[136:139], a[88:91]
 buffer_store_dwordx4 v[228:231], v251, s[52:55], s31 offen offset:1024 sc1
 v_mfma_f32_16x16x32_bf16 v[196:199], v[208:211], v[132:135], 0
 v_exp_f32 v186, v2
 v_mfma_f32_16x16x32_bf16 a[28:31], a[204:207], v[156:159], a[28:31]
 s_waitcnt lgkmcnt(8)
 v_cndmask_b32 v106, v220, v180, s[12:13]
 v_cvt_pk_bf16_f32 v128, v184, v185
 v_mfma_f32_16x16x32_bf16 a[24:27], a[204:207], v[152:155], a[24:27]
 v_exp_f32 v187, v3
 v_mfma_f32_16x16x32_bf16 a[100:103], a[208:211], v[140:143], a[100:103]
 ds_read_b64_tr_b16 v[224:225], v232 offset:256
 ds_read_b128 a[240:243], v217 offset:45056
 v_mfma_f32_16x16x32_bf16 a[96:99], a[208:211], v[136:139], a[96:99]
 v_exp_f32 v188, v4
 v_mfma_f32_16x16x32_bf16 a[36:39], a[208:211], v[156:159], a[36:39]
 ds_read_b64_tr_b16 v[226:227], v234 offset:256
 v_cvt_pk_bf16_f32 v129, v186, v187
 v_mfma_f32_16x16x32_bf16 a[32:35], a[208:211], v[152:155], a[32:35]
 v_exp_f32 v189, v5
 v_mfma_f32_16x16x32_bf16 a[108:111], a[212:215], v[140:143], a[108:111]
 ds_read_b64_tr_b16 v[228:229], v233 offset:256
 v_cndmask_b32 v107, v220, v180, s[14:15]
 v_mfma_f32_16x16x32_bf16 a[104:107], a[212:215], v[136:139], a[104:107]
 ds_read_b128 a[244:247], v217 offset:46080
 ds_read_b64_tr_b16 v[230:231], v235 offset:256
 v_mfma_f32_16x16x32_bf16 a[44:47], a[212:215], v[156:159], a[44:47]
 v_exp_f32 v190, v6
 v_mfma_f32_16x16x32_bf16 a[40:43], a[212:215], v[152:155], a[40:43]
 ds_read_b128 a[248:251], v217 offset:47104
 v_cvt_pk_bf16_f32 v130, v188, v189
 v_mfma_f32_16x16x32_bf16 a[116:119], a[216:219], v[140:143], a[116:119]
 v_exp_f32 v191, v7
 v_mfma_f32_16x16x32_bf16 a[112:115], a[216:219], v[136:139], a[112:115]
 v_exp_f32 v184, v72
 v_mfma_f32_16x16x32_bf16 a[52:55], a[216:219], v[156:159], a[52:55]
 s_waitcnt lgkmcnt(1)
 buffer_store_dwordx4 v[224:227], v251, s[52:55], s31 offen offset:2048 sc1
 v_cvt_pk_bf16_f32 v131, v190, v191
 v_cndmask_b32 v108, v220, v180, s[16:17]
 v_mfma_f32_16x16x32_bf16 a[48:51], a[216:219], v[152:155], a[48:51]
 v_exp_f32 v185, v73
 v_mfma_f32_16x16x32_bf16 a[124:127], a[220:223], v[140:143], a[124:127]
 buffer_store_dwordx4 v[228:231], v251, s[52:55], s31 offen offset:3072 sc1
 v_mfma_f32_16x16x32_bf16 v[192:195], v[208:211], v[128:131], 0
 ds_read_b128 a[252:255], v217 offset:48128
 v_xor_b32 v217, 0x10000, v217
 v_mfma_f32_16x16x32_bf16 a[120:123], a[220:223], v[136:139], a[120:123]
 v_exp_f32 v186, v74
 v_mfma_f32_16x16x32_bf16 a[60:63], a[220:223], v[156:159], a[60:63]
 s_waitcnt lgkmcnt(8)
 v_cvt_pk_bf16_f32 v156, v184, v185
 v_mfma_f32_16x16x32_bf16 a[56:59], a[220:223], v[152:155], a[56:59]
 s_waitcnt vmcnt(12)
 v_exp_f32 v187, v75
 v_mfma_f32_16x16x32_bf16 a[68:71], a[224:227], v[148:151], a[68:71]
 s_barrier
 ds_read_b128 a[192:195], v217 offset:16384
 v_cndmask_b32 v109, v220, v180, s[18:19]
 v_mfma_f32_16x16x32_bf16 a[64:67], a[224:227], v[144:147], a[64:67]
 s_add_u32 m0, s67, 0
 v_exp_f32 v188, v76
 v_mfma_f32_16x16x32_bf16 a[4:7], a[224:227], v[164:167], a[4:7]
 buffer_load_dwordx4 v218, s[56:59], s66 offen offset:0 sc1 lds
 v_mfma_f32_16x16x32_bf16 a[0:3], a[224:227], v[160:163], a[0:3]
 ds_read_b128 a[196:199], v217 offset:17408
 v_cvt_pk_bf16_f32 v157, v186, v187
 v_mfma_f32_16x16x32_bf16 a[76:79], a[228:231], v[148:151], a[76:79]
 v_exp_f32 v189, v77
 v_mfma_f32_16x16x32_bf16 a[72:75], a[228:231], v[144:147], a[72:75]
 v_exp_f32 v190, v78
 v_mfma_f32_16x16x32_bf16 a[12:15], a[228:231], v[164:167], a[12:15]
 v_cvt_pk_bf16_f32 v158, v188, v189
 v_cndmask_b32 v110, v220, v180, s[20:21]
 v_mfma_f32_16x16x32_bf16 a[8:11], a[228:231], v[160:163], a[8:11]
 v_exp_f32 v191, v79
 v_mfma_f32_16x16x32_bf16 a[84:87], a[232:235], v[148:151], a[84:87]
 buffer_load_dwordx4 v218, s[56:59], s66 offen offset:1024 sc1 lds
 v_mfma_f32_16x16x32_bf16 a[80:83], a[232:235], v[144:147], a[80:83]
 v_exp_f32 v184, v64
 v_mfma_f32_16x16x32_bf16 a[20:23], a[232:235], v[164:167], a[20:23]
 ds_read_b128 a[200:203], v217 offset:18432
 v_cvt_pk_bf16_f32 v159, v190, v191
 v_mfma_f32_16x16x32_bf16 a[16:19], a[232:235], v[160:163], a[16:19]
 v_exp_f32 v185, v65
 v_mfma_f32_16x16x32_bf16 a[92:95], a[236:239], v[148:151], a[92:95]
 ds_read_b128 a[204:207], v217 offset:19456
 v_cndmask_b32 v111, v220, v180, s[22:23]
 v_mfma_f32_16x16x32_bf16 v[204:207], v[208:211], v[156:159], 0
 v_exp_f32 v186, v66
 v_mfma_f32_16x16x32_bf16 a[88:91], a[236:239], v[144:147], a[88:91]
 buffer_load_dwordx4 v218, s[56:59], s66 offen offset:2048 sc1 lds
 v_mfma_f32_16x16x32_bf16 a[28:31], a[236:239], v[164:167], a[28:31]
 s_waitcnt lgkmcnt(4)
 ds_read_b128 a[208:211], v217 offset:20480
 v_cvt_pk_bf16_f32 v152, v184, v185
 v_mfma_f32_16x16x32_bf16 a[24:27], a[236:239], v[160:163], a[24:27]
 v_exp_f32 v187, v67
 v_mfma_f32_16x16x32_bf16 a[100:103], a[240:243], v[148:151], a[100:103]
 v_exp_f32 v188, v68
 v_mfma_f32_16x16x32_bf16 a[96:99], a[240:243], v[144:147], a[96:99]
 ds_read_b128 a[212:215], v217 offset:21504
 v_cvt_pk_bf16_f32 v153, v186, v187
 v_mfma_f32_16x16x32_bf16 a[36:39], a[240:243], v[164:167], a[36:39]
 v_exp_f32 v189, v69
 v_mfma_f32_16x16x32_bf16 a[32:35], a[240:243], v[160:163], a[32:35]
 buffer_load_dwordx4 v218, s[56:59], s66 offen offset:3072 sc1 lds
 v_mfma_f32_16x16x32_bf16 a[108:111], a[244:247], v[148:151], a[108:111]
 v_exp_f32 v190, v70
 v_mfma_f32_16x16x32_bf16 a[104:107], a[244:247], v[144:147], a[104:107]
 v_cvt_pk_bf16_f32 v154, v188, v189
 v_cndmask_b32 v120, v220, v180, s[48:49]
 v_mfma_f32_16x16x32_bf16 a[44:47], a[244:247], v[164:167], a[44:47]
 s_add_u32 m0, s67, 4096
 v_exp_f32 v191, v71
 v_mfma_f32_16x16x32_bf16 a[40:43], a[244:247], v[160:163], a[40:43]
 v_exp_f32 v184, v24
 v_mfma_f32_16x16x32_bf16 a[116:119], a[248:251], v[148:151], a[116:119]
 ds_read_b128 a[216:219], v217 offset:22528
 v_cvt_pk_bf16_f32 v155, v190, v191
 v_mfma_f32_16x16x32_bf16 a[112:115], a[248:251], v[144:147], a[112:115]
 buffer_load_dwordx4 v219, s[56:59], s66 offen offset:0 sc1 lds
 v_mfma_f32_16x16x32_bf16 a[52:55], a[248:251], v[164:167], a[52:55]
 v_exp_f32 v185, v25
 v_mfma_f32_16x16x32_bf16 a[48:51], a[248:251], v[160:163], a[48:51]
 ds_read_b128 a[220:223], v217 offset:23552
 v_cndmask_b32 v121, v220, v180, s[50:51]
 v_mfma_f32_16x16x32_bf16 v[200:203], v[208:211], v[152:155], 0
 v_exp_f32 v186, v26
 v_mfma_f32_16x16x32_bf16 a[124:127], a[252:255], v[148:151], a[124:127]
 ds_read_b128 a[224:227], v217 offset:24576
 v_cvt_pk_bf16_f32 v148, v184, v185
 v_mfma_f32_16x16x32_bf16 a[120:123], a[252:255], v[144:147], a[120:123]
 v_exp_f32 v187, v27
 v_mfma_f32_16x16x32_bf16 a[60:63], a[252:255], v[164:167], a[60:63]
 buffer_load_dwordx4 v219, s[56:59], s66 offen offset:1024 sc1 lds
 v_mfma_f32_16x16x32_bf16 a[56:59], a[252:255], v[160:163], a[56:59]
 s_waitcnt lgkmcnt(5)
 v_exp_f32 v188, v28
 v_mfma_f32_16x16x32_bf16 v[40:43], a[192:195], a[164:167], v[172:175]
 v_cvt_pk_bf16_f32 v149, v186, v187
 v_cndmask_b32 v122, v220, v180, s[82:83]
 v_mfma_f32_16x16x32_bf16 v[40:43], a[196:199], a[172:175], v[40:43]
 v_exp_f32 v189, v29
 v_mfma_f32_16x16x32_bf16 v[40:43], a[200:203], a[180:183], v[40:43]
 v_exp_f32 v190, v30
 v_mfma_f32_16x16x32_bf16 v[40:43], a[204:207], a[188:191], v[40:43]
 ds_read_b128 a[228:231], v217 offset:25600
 v_cvt_pk_bf16_f32 v150, v188, v189
 v_mfma_f32_16x16x32_bf16 v[32:35], a[204:207], a[184:187], v[168:171]
 v_exp_f32 v191, v31
 v_mfma_f32_16x16x32_bf16 v[32:35], a[200:203], a[176:179], v[32:35]
 buffer_load_dwordx4 v219, s[56:59], s66 offen offset:2048 sc1 lds
 v_mfma_f32_16x16x32_bf16 v[32:35], a[196:199], a[168:171], v[32:35]
 v_exp_f32 v184, v16
 v_mfma_f32_16x16x32_bf16 v[32:35], a[192:195], a[160:163], v[32:35]
 ds_read_b128 a[232:235], v217 offset:26624
 v_cvt_pk_bf16_f32 v151, v190, v191
 v_mfma_f32_16x16x32_bf16 v[104:107], a[192:195], a[132:135], v[104:107]
 v_exp_f32 v185, v17
 v_mfma_f32_16x16x32_bf16 v[104:107], a[196:199], a[140:143], v[104:107]
 ds_read_b128 a[236:239], v217 offset:27648
 v_cndmask_b32 v123, v220, v180, s[84:85]
 v_mfma_f32_16x16x32_bf16 v[196:199], v[208:211], v[148:151], v[196:199]
 v_exp_f32 v186, v18
 v_mfma_f32_16x16x32_bf16 v[104:107], a[200:203], a[148:151], v[104:107]
 s_waitcnt lgkmcnt(4)
 ds_read_b128 a[240:243], v217 offset:28672
 v_cvt_pk_bf16_f32 v144, v184, v185
 v_mfma_f32_16x16x32_bf16 v[104:107], a[204:207], a[156:159], v[104:107]
 v_exp_f32 v187, v19
 v_mfma_f32_16x16x32_bf16 v[44:47], a[208:211], a[164:167], v[172:175]
 buffer_load_dwordx4 v219, s[56:59], s66 offen offset:3072 sc1 lds
 v_exp_f32 v188, v20
 v_mfma_f32_16x16x32_bf16 v[44:47], a[212:215], a[172:175], v[44:47]
 s_add_u32 s66, s66, 32768
 ds_read_b128 a[244:247], v217 offset:29696
 v_cvt_pk_bf16_f32 v145, v186, v187
 v_mfma_f32_16x16x32_bf16 v[44:47], a[216:219], a[180:183], v[44:47]
 v_exp_f32 v189, v21
 v_mfma_f32_16x16x32_bf16 v[44:47], a[220:223], a[188:191], v[44:47]
 s_add_u32 m0, s41, 0
 v_exp_f32 v190, v22
 v_mfma_f32_16x16x32_bf16 v[36:39], a[220:223], a[184:187], v[168:171]
 v_cvt_pk_bf16_f32 v146, v188, v189
 v_cndmask_b32 v124, v220, v180, s[86:87]
 v_mfma_f32_16x16x32_bf16 v[36:39], a[216:219], a[176:179], v[36:39]
 v_exp_f32 v191, v23
 v_mfma_f32_16x16x32_bf16 v[36:39], a[212:215], a[168:171], v[36:39]
 buffer_load_dwordx4 v240, s[32:35], s28 offen offset:0 lds
 v_exp_f32 v184, v88
 v_mfma_f32_16x16x32_bf16 v[36:39], a[208:211], a[160:163], v[36:39]
 ds_read_b128 a[248:251], v217 offset:30720
 v_cvt_pk_bf16_f32 v147, v190, v191
 v_mfma_f32_16x16x32_bf16 v[108:111], a[208:211], a[132:135], v[108:111]
 buffer_load_dwordx4 v241, s[32:35], s28 offen offset:1024 lds
 v_exp_f32 v185, v89
 v_mfma_f32_16x16x32_bf16 v[108:111], a[212:215], a[140:143], v[108:111]
 buffer_load_dwordx4 v242, s[32:35], s28 offen offset:2048 lds
 v_mfma_f32_16x16x32_bf16 v[192:195], v[208:211], v[144:147], v[192:195]
 v_exp_f32 v186, v90
 v_mfma_f32_16x16x32_bf16 v[108:111], a[216:219], a[148:151], v[108:111]
 s_waitcnt lgkmcnt(3)
 ds_read_b128 a[252:255], v217 offset:31744
 v_cvt_pk_bf16_f32 v164, v184, v185
 v_mfma_f32_16x16x32_bf16 v[108:111], a[220:223], a[156:159], v[108:111]
 v_exp_f32 v187, v91
 v_mfma_f32_16x16x32_bf16 v[56:59], a[224:227], a[164:167], v[172:175]
 v_exp_f32 v188, v92
 v_mfma_f32_16x16x32_bf16 v[56:59], a[228:231], a[172:175], v[56:59]
 buffer_load_dwordx4 v243, s[32:35], s28 offen offset:3072 lds
 v_cndmask_b32 v125, v220, v180, s[88:89]
 v_cvt_pk_bf16_f32 v165, v186, v187
 v_mfma_f32_16x16x32_bf16 v[56:59], a[232:235], a[180:183], v[56:59]
 v_exp_f32 v189, v93
 v_mfma_f32_16x16x32_bf16 v[56:59], a[236:239], a[188:191], v[56:59]
 ds_read_b128 a[192:195], v217 offset:0
 ds_read_b64_tr_b16 v[224:225], v232 offset:4096
 v_exp_f32 v190, v94
 v_mfma_f32_16x16x32_bf16 v[48:51], a[236:239], a[184:187], v[168:171]
 ds_read_b64_tr_b16 v[226:227], v234 offset:4096
 v_cvt_pk_bf16_f32 v166, v188, v189
 v_mfma_f32_16x16x32_bf16 v[48:51], a[232:235], a[176:179], v[48:51]
 v_exp_f32 v191, v95
 v_mfma_f32_16x16x32_bf16 v[48:51], a[228:231], a[168:171], v[48:51]
 ds_read_b128 a[196:199], v217 offset:1024
 ds_read_b64_tr_b16 v[228:229], v233 offset:4096
 v_exp_f32 v184, v80
 v_mfma_f32_16x16x32_bf16 v[48:51], a[224:227], a[160:163], v[48:51]
 v_cndmask_b32 v126, v220, v180, s[90:91]
 v_cvt_pk_bf16_f32 v167, v190, v191
 v_mfma_f32_16x16x32_bf16 v[120:123], a[224:227], a[132:135], v[120:123]
 ds_read_b64_tr_b16 v[230:231], v235 offset:4096
 ds_read_b128 a[200:203], v217 offset:2048
 v_exp_f32 v185, v81
 v_mfma_f32_16x16x32_bf16 v[120:123], a[228:231], a[140:143], v[120:123]
 ds_read_b128 a[204:207], v217 offset:3072
 v_cndmask_b32 v127, v220, v180, s[92:93]
 v_mfma_f32_16x16x32_bf16 v[204:207], v[208:211], v[164:167], v[204:207]
 v_exp_f32 v186, v82
 v_mfma_f32_16x16x32_bf16 v[120:123], a[232:235], a[148:151], v[120:123]
 s_waitcnt lgkmcnt(8)
 ds_read_b128 a[208:211], v217 offset:4096
 v_cvt_pk_bf16_f32 v160, v184, v185
 v_mfma_f32_16x16x32_bf16 v[120:123], a[236:239], a[156:159], v[120:123]
 v_exp_f32 v187, v83
 v_mfma_f32_16x16x32_bf16 v[60:63], a[240:243], a[164:167], v[172:175]
 v_exp_f32 v188, v84
 v_mfma_f32_16x16x32_bf16 v[60:63], a[244:247], a[172:175], v[60:63]
 s_waitcnt lgkmcnt(3)
 ds_read_b128 a[212:215], v217 offset:5120
 buffer_store_dwordx4 v[224:227], v251, s[52:55], s42 offen offset:0 sc1
 buffer_store_dwordx4 v[228:231], v251, s[52:55], s42 offen offset:1024 sc1
 v_cvt_pk_bf16_f32 v161, v186, v187
 v_mfma_f32_16x16x32_bf16 v[60:63], a[248:251], a[180:183], v[60:63]
 ds_read_b64_tr_b16 v[224:225], v232 offset:4352
 v_exp_f32 v189, v85
 v_mfma_f32_16x16x32_bf16 v[60:63], a[252:255], a[188:191], v[60:63]
 ds_read_b64_tr_b16 v[226:227], v234 offset:4352
 v_exp_f32 v190, v86
 v_mfma_f32_16x16x32_bf16 v[52:55], a[252:255], a[184:187], v[168:171]
 ds_read_b64_tr_b16 v[228:229], v233 offset:4352
 v_cvt_pk_bf16_f32 v162, v188, v189
 v_mfma_f32_16x16x32_bf16 v[52:55], a[248:251], a[176:179], v[52:55]
 ds_read_b64_tr_b16 v[230:231], v235 offset:4352
 ds_read_b128 a[216:219], v217 offset:6144
 v_exp_f32 v191, v87
 v_mfma_f32_16x16x32_bf16 v[52:55], a[244:247], a[168:171], v[52:55]
 v_exp_f32 v184, v40
 v_cvt_pk_bf16_f32 v163, v190, v191
 v_exp_f32 v185, v41
 v_mfma_f32_16x16x32_bf16 v[52:55], a[240:243], a[160:163], v[52:55]
 v_mfma_f32_16x16x32_bf16 v[200:203], v[208:211], v[160:163], v[200:203]
 v_exp_f32 v186, v42
 v_mfma_f32_16x16x32_bf16 v[124:127], a[240:243], a[132:135], v[124:127]
 v_exp_f32 v187, v43
 v_mfma_f32_16x16x32_bf16 v[124:127], a[244:247], a[140:143], v[124:127]
 s_waitcnt lgkmcnt(1)
 buffer_store_dwordx4 v[224:227], v251, s[52:55], s42 offen offset:2048 sc1
 buffer_store_dwordx4 v[228:231], v251, s[52:55], s42 offen offset:3072 sc1
 v_mfma_f32_16x16x32_bf16 v[124:127], a[248:251], a[148:151], v[124:127]
 s_waitcnt lgkmcnt(7)
 ds_read_b128 a[220:223], v217 offset:7168
 v_max3_f32 v250, v196, v192, v204
 v_max_f32 v250, v250, v200
 v_cmp_lt_f32 vcc, s75, v250
 v_mfma_f32_16x16x32_bf16 v[124:127], a[252:255], a[156:159], v[124:127]
 s_cbranch_vccnz Lrare28
Lback29:
 v_add_f32 v213, v213, v196
 v_add_f32 v212, v212, v192
 v_add_f32 v215, v215, v204
 v_add_f32 v214, v214, v200
 s_cmp_eq_u32 s62, 7
 s_cbranch_scc1 LdrA711
LdrA10:
 v_mfma_f32_16x16x32_bf16 a[68:71], a[192:195], v[132:135], a[68:71]
 ds_read_b128 a[224:227], v217 offset:8192
 v_cvt_pk_bf16_f32 v140, v184, v185
 v_mfma_f32_16x16x32_bf16 a[64:67], a[192:195], v[128:131], a[64:67]
 v_exp_f32 v188, v44
 v_mfma_f32_16x16x32_bf16 a[4:7], a[192:195], v[156:159], a[4:7]
 ds_read_b128 a[228:231], v217 offset:9216
 v_cvt_pk_bf16_f32 v141, v186, v187
 v_mfma_f32_16x16x32_bf16 a[0:3], a[192:195], v[152:155], a[0:3]
 v_exp_f32 v189, v45
 v_mfma_f32_16x16x32_bf16 a[76:79], a[196:199], v[132:135], a[76:79]
 v_exp_f32 v190, v46
 v_mfma_f32_16x16x32_bf16 a[72:75], a[196:199], v[128:131], a[72:75]
 v_mfma_f32_16x16x32_bf16 a[12:15], a[196:199], v[156:159], a[12:15]
 ds_read_b128 a[232:235], v217 offset:10240
 v_cvt_pk_bf16_f32 v142, v188, v189
 v_mfma_f32_16x16x32_bf16 a[8:11], a[196:199], v[152:155], a[8:11]
 v_exp_f32 v191, v47
 v_mfma_f32_16x16x32_bf16 a[84:87], a[200:203], v[132:135], a[84:87]
 v_exp_f32 v184, v32
 v_mfma_f32_16x16x32_bf16 a[80:83], a[200:203], v[128:131], a[80:83]
 v_mfma_f32_16x16x32_bf16 a[20:23], a[200:203], v[156:159], a[20:23]
 ds_read_b128 a[236:239], v217 offset:11264
 v_cvt_pk_bf16_f32 v143, v190, v191
 v_mfma_f32_16x16x32_bf16 a[16:19], a[200:203], v[152:155], a[16:19]
 v_exp_f32 v185, v33
 v_mfma_f32_16x16x32_bf16 a[92:95], a[204:207], v[132:135], a[92:95]
 v_mfma_f32_16x16x32_bf16 v[196:199], v[208:211], v[140:143], 0
 v_exp_f32 v186, v34
 v_mfma_f32_16x16x32_bf16 a[88:91], a[204:207], v[128:131], a[88:91]
 v_mfma_f32_16x16x32_bf16 a[28:31], a[204:207], v[156:159], a[28:31]
 s_waitcnt lgkmcnt(4)
 ds_read_b128 a[240:243], v217 offset:12288
 v_cvt_pk_bf16_f32 v136, v184, v185
 v_mfma_f32_16x16x32_bf16 a[24:27], a[204:207], v[152:155], a[24:27]
 v_exp_f32 v187, v35
 v_mfma_f32_16x16x32_bf16 a[100:103], a[208:211], v[132:135], a[100:103]
 v_exp_f32 v188, v36
 v_mfma_f32_16x16x32_bf16 a[96:99], a[208:211], v[128:131], a[96:99]
 v_mfma_f32_16x16x32_bf16 a[36:39], a[208:211], v[156:159], a[36:39]
 ds_read_b128 a[244:247], v217 offset:13312
 v_cvt_pk_bf16_f32 v137, v186, v187
 v_mfma_f32_16x16x32_bf16 a[32:35], a[208:211], v[152:155], a[32:35]
 v_exp_f32 v189, v37
 v_mfma_f32_16x16x32_bf16 a[108:111], a[212:215], v[132:135], a[108:111]
 v_exp_f32 v190, v38
 v_mfma_f32_16x16x32_bf16 a[104:107], a[212:215], v[128:131], a[104:107]
 v_mfma_f32_16x16x32_bf16 a[44:47], a[212:215], v[156:159], a[44:47]
 ds_read_b128 a[248:251], v217 offset:14336
 v_cvt_pk_bf16_f32 v138, v188, v189
 v_mfma_f32_16x16x32_bf16 a[40:43], a[212:215], v[152:155], a[40:43]
 v_exp_f32 v191, v39
 v_mfma_f32_16x16x32_bf16 a[116:119], a[216:219], v[132:135], a[116:119]
 v_exp_f32 v184, v104
 v_mfma_f32_16x16x32_bf16 a[112:115], a[216:219], v[128:131], a[112:115]
 v_mfma_f32_16x16x32_bf16 a[52:55], a[216:219], v[156:159], a[52:55]
 ds_read_b128 a[252:255], v217 offset:15360
 v_cvt_pk_bf16_f32 v139, v190, v191
 v_mfma_f32_16x16x32_bf16 a[48:51], a[216:219], v[152:155], a[48:51]
 v_exp_f32 v185, v105
 v_mfma_f32_16x16x32_bf16 a[124:127], a[220:223], v[132:135], a[124:127]
 v_mfma_f32_16x16x32_bf16 v[192:195], v[208:211], v[136:139], 0
 v_exp_f32 v186, v106
 v_mfma_f32_16x16x32_bf16 a[120:123], a[220:223], v[128:131], a[120:123]
 v_mfma_f32_16x16x32_bf16 a[60:63], a[220:223], v[156:159], a[60:63]
 s_waitcnt lgkmcnt(4)
 v_cvt_pk_bf16_f32 v156, v184, v185
 v_mfma_f32_16x16x32_bf16 a[56:59], a[220:223], v[152:155], a[56:59]
 s_waitcnt vmcnt(12)
 v_exp_f32 v187, v107
 v_mfma_f32_16x16x32_bf16 a[68:71], a[224:227], v[148:151], a[68:71]
 s_barrier
 ds_read_b128 a[192:195], v217 offset:49152
 ds_read_b128 a[196:199], v217 offset:50176
 v_mfma_f32_16x16x32_bf16 a[64:67], a[224:227], v[144:147], a[64:67]
 s_add_u32 m0, s67, 32768
 v_mfma_f32_16x16x32_bf16 a[4:7], a[224:227], v[164:167], a[4:7]
 buffer_load_dwordx4 v218, s[56:59], s66 offen offset:0 sc1 lds
 v_mfma_f32_16x16x32_bf16 a[0:3], a[224:227], v[160:163], a[0:3]
 v_exp_f32 v188, v108
 v_mfma_f32_16x16x32_bf16 a[76:79], a[228:231], v[148:151], a[76:79]
 v_mfma_f32_16x16x32_bf16 a[72:75], a[228:231], v[144:147], a[72:75]
 ds_read_b128 a[200:203], v217 offset:51200
 v_cvt_pk_bf16_f32 v157, v186, v187
 v_mfma_f32_16x16x32_bf16 a[12:15], a[228:231], v[164:167], a[12:15]
 buffer_load_dwordx4 v218, s[56:59], s66 offen offset:1024 sc1 lds
 v_mfma_f32_16x16x32_bf16 a[8:11], a[228:231], v[160:163], a[8:11]
 v_exp_f32 v189, v109
 v_mfma_f32_16x16x32_bf16 a[84:87], a[232:235], v[148:151], a[84:87]
 v_mfma_f32_16x16x32_bf16 a[80:83], a[232:235], v[144:147], a[80:83]
 v_exp_f32 v190, v110
 v_mfma_f32_16x16x32_bf16 a[20:23], a[232:235], v[164:167], a[20:23]
 v_mfma_f32_16x16x32_bf16 a[16:19], a[232:235], v[160:163], a[16:19]
 ds_read_b128 a[204:207], v217 offset:52224
 v_cvt_pk_bf16_f32 v158, v188, v189
 v_mfma_f32_16x16x32_bf16 a[92:95], a[236:239], v[148:151], a[92:95]
 buffer_load_dwordx4 v218, s[56:59], s66 offen offset:2048 sc1 lds
 v_mfma_f32_16x16x32_bf16 a[88:91], a[236:239], v[144:147], a[88:91]
 v_mfma_f32_16x16x32_bf16 a[28:31], a[236:239], v[164:167], a[28:31]
 s_waitcnt lgkmcnt(4)
 v_exp_f32 v191, v111
 v_mfma_f32_16x16x32_bf16 a[24:27], a[236:239], v[160:163], a[24:27]
 ds_read_b128 a[208:211], v217 offset:53248
 v_mfma_f32_16x16x32_bf16 a[100:103], a[240:243], v[148:151], a[100:103]
 v_mfma_f32_16x16x32_bf16 a[96:99], a[240:243], v[144:147], a[96:99]
 v_exp_f32 v184, v56
 v_mfma_f32_16x16x32_bf16 a[36:39], a[240:243], v[164:167], a[36:39]
 buffer_load_dwordx4 v218, s[56:59], s66 offen offset:3072 sc1 lds
 v_mfma_f32_16x16x32_bf16 a[32:35], a[240:243], v[160:163], a[32:35]
 ds_read_b128 a[212:215], v217 offset:54272
 v_cvt_pk_bf16_f32 v159, v190, v191
 v_mfma_f32_16x16x32_bf16 a[108:111], a[244:247], v[148:151], a[108:111]
 v_mfma_f32_16x16x32_bf16 a[104:107], a[244:247], v[144:147], a[104:107]
 v_exp_f32 v185, v57
 v_mfma_f32_16x16x32_bf16 a[44:47], a[244:247], v[164:167], a[44:47]
 s_add_u32 m0, s67, 36864
 v_mfma_f32_16x16x32_bf16 v[204:207], v[208:211], v[156:159], 0
 v_mfma_f32_16x16x32_bf16 a[40:43], a[244:247], v[160:163], a[40:43]
 ds_read_b128 a[216:219], v217 offset:55296
 v_mfma_f32_16x16x32_bf16 a[116:119], a[248:251], v[148:151], a[116:119]
 buffer_load_dwordx4 v219, s[56:59], s66 offen offset:0 sc1 lds
 v_mfma_f32_16x16x32_bf16 a[112:115], a[248:251], v[144:147], a[112:115]
 v_exp_f32 v186, v58
 v_mfma_f32_16x16x32_bf16 a[52:55], a[248:251], v[164:167], a[52:55]
 v_mfma_f32_16x16x32_bf16 a[48:51], a[248:251], v[160:163], a[48:51]
 ds_read_b128 a[220:223], v217 offset:56320
 v_mfma_f32_16x16x32_bf16 a[124:127], a[252:255], v[148:151], a[124:127]
 ds_read_b128 a[224:227], v217 offset:57344
 v_cvt_pk_bf16_f32 v148, v184, v185
 v_mfma_f32_16x16x32_bf16 a[120:123], a[252:255], v[144:147], a[120:123]
 v_exp_f32 v187, v59
 v_mfma_f32_16x16x32_bf16 a[60:63], a[252:255], v[164:167], a[60:63]
 s_waitcnt lgkmcnt(5)
 v_exp_f32 v188, v60
 v_mfma_f32_16x16x32_bf16 a[56:59], a[252:255], v[160:163], a[56:59]
 buffer_load_dwordx4 v219, s[56:59], s66 offen offset:1024 sc1 lds
 v_mfma_f32_16x16x32_bf16 v[8:11], a[192:195], a[164:167], v[172:175]
 ds_read_b128 a[228:231], v217 offset:58368
 v_cvt_pk_bf16_f32 v149, v186, v187
 v_mfma_f32_16x16x32_bf16 v[8:11], a[196:199], a[172:175], v[8:11]
 v_exp_f32 v189, v61
 v_mfma_f32_16x16x32_bf16 v[8:11], a[200:203], a[180:183], v[8:11]
 v_exp_f32 v190, v62
 v_mfma_f32_16x16x32_bf16 v[8:11], a[204:207], a[188:191], v[8:11]
 ds_read_b128 a[232:235], v217 offset:59392
 v_cvt_pk_bf16_f32 v150, v188, v189
 v_mfma_f32_16x16x32_bf16 v[0:3], a[204:207], a[184:187], v[168:171]
 v_exp_f32 v191, v63
 v_mfma_f32_16x16x32_bf16 v[0:3], a[200:203], a[176:179], v[0:3]
 v_exp_f32 v184, v48
 v_mfma_f32_16x16x32_bf16 v[0:3], a[196:199], a[168:171], v[0:3]
 buffer_load_dwordx4 v219, s[56:59], s66 offen offset:2048 sc1 lds
 v_cvt_pk_bf16_f32 v151, v190, v191
 v_mfma_f32_16x16x32_bf16 v[0:3], a[192:195], a[160:163], v[0:3]
 s_waitcnt lgkmcnt(3)
 ds_read_b128 a[236:239], v217 offset:60416
 ds_read_b128 a[240:243], v217 offset:61440
 v_exp_f32 v185, v49
 v_mfma_f32_16x16x32_bf16 v[12:15], a[208:211], a[164:167], v[172:175]
 v_mfma_f32_16x16x32_bf16 v[196:199], v[208:211], v[148:151], v[196:199]
 v_exp_f32 v186, v50
 v_mfma_f32_16x16x32_bf16 v[12:15], a[212:215], a[172:175], v[12:15]
 ds_read_b128 a[244:247], v217 offset:62464
 v_cvt_pk_bf16_f32 v144, v184, v185
 v_mfma_f32_16x16x32_bf16 v[12:15], a[216:219], a[180:183], v[12:15]
 v_exp_f32 v187, v51
 v_mfma_f32_16x16x32_bf16 v[12:15], a[220:223], a[188:191], v[12:15]
 v_exp_f32 v188, v52
 v_mfma_f32_16x16x32_bf16 v[4:7], a[220:223], a[184:187], v[168:171]
 buffer_load_dwordx4 v219, s[56:59], s66 offen offset:3072 sc1 lds
 v_cvt_pk_bf16_f32 v145, v186, v187
 v_exp_f32 v189, v53
 v_mfma_f32_16x16x32_bf16 v[4:7], a[216:219], a[176:179], v[4:7]
 s_add_u32 s66, s66, 32768
 v_exp_f32 v190, v54
 v_mfma_f32_16x16x32_bf16 v[4:7], a[212:215], a[168:171], v[4:7]
 s_xor_b32 s67, s67, 0x10000
 ds_read_b128 a[248:251], v217 offset:63488
 v_cvt_pk_bf16_f32 v146, v188, v189
 v_mfma_f32_16x16x32_bf16 v[4:7], a[208:211], a[160:163], v[4:7]
 s_waitcnt lgkmcnt(3)
 ds_read_b128 a[252:255], v217 offset:64512
 ds_read_b128 a[192:195], v217 offset:32768
 v_exp_f32 v191, v55
 v_mfma_f32_16x16x32_bf16 v[24:27], a[224:227], a[164:167], v[172:175]
 s_add_u32 m0, s41, 4096
 v_exp_f32 v184, v120
 v_mfma_f32_16x16x32_bf16 v[24:27], a[228:231], a[172:175], v[24:27]
 ds_read_b128 a[196:199], v217 offset:40960
 v_cvt_pk_bf16_f32 v147, v190, v191
 v_mfma_f32_16x16x32_bf16 v[24:27], a[232:235], a[180:183], v[24:27]
 buffer_load_dwordx4 v244, s[32:35], s28 offen offset:0 lds
 v_exp_f32 v185, v121
 v_mfma_f32_16x16x32_bf16 v[24:27], a[236:239], a[188:191], v[24:27]
 buffer_load_dwordx4 v245, s[32:35], s28 offen offset:1024 lds
 v_mfma_f32_16x16x32_bf16 v[192:195], v[208:211], v[144:147], v[192:195]
 v_exp_f32 v186, v122
 v_mfma_f32_16x16x32_bf16 v[16:19], a[236:239], a[184:187], v[168:171]
 ds_read_b128 a[200:203], v217 offset:33792
 v_cvt_pk_bf16_f32 v164, v184, v185
 v_exp_f32 v187, v123
 v_mfma_f32_16x16x32_bf16 v[16:19], a[232:235], a[176:179], v[16:19]
 v_exp_f32 v188, v124
 v_mfma_f32_16x16x32_bf16 v[16:19], a[228:231], a[168:171], v[16:19]
 s_waitcnt lgkmcnt(3)
 ds_read_b128 a[204:207], v217 offset:41984
 v_cvt_pk_bf16_f32 v165, v186, v187
 v_mfma_f32_16x16x32_bf16 v[16:19], a[224:227], a[160:163], v[16:19]
 v_exp_f32 v189, v125
 v_mfma_f32_16x16x32_bf16 v[28:31], a[240:243], a[164:167], v[172:175]
 v_exp_f32 v190, v126
 v_mfma_f32_16x16x32_bf16 v[28:31], a[244:247], a[172:175], v[28:31]
 buffer_load_dwordx4 v246, s[32:35], s28 offen offset:2048 lds
 v_cvt_pk_bf16_f32 v166, v188, v189
 v_mfma_f32_16x16x32_bf16 v[28:31], a[248:251], a[180:183], v[28:31]
 v_exp_f32 v191, v127
 v_exp_f32 v184, v8
 v_cvt_pk_bf16_f32 v167, v190, v191
 v_exp_f32 v185, v9
 v_mfma_f32_16x16x32_bf16 v[28:31], a[252:255], a[188:191], v[28:31]
 ds_read_b128 a[208:211], v217 offset:34816
 ds_read_b128 a[212:215], v217 offset:43008
 v_mfma_f32_16x16x32_bf16 v[204:207], v[208:211], v[164:167], v[204:207]
 buffer_load_dwordx4 v247, s[32:35], s28 offen offset:3072 lds
 v_mfma_f32_16x16x32_bf16 v[20:23], a[252:255], a[184:187], v[168:171]
 v_exp_f32 v186, v10
 v_exp_f32 v187, v11
 v_mfma_f32_16x16x32_bf16 v[20:23], a[248:251], a[176:179], v[20:23]
 s_waitcnt lgkmcnt(2)
 ds_read_b128 a[216:219], v217 offset:35840
 s_nop 0
 v_max3_f32 v250, v196, v192, v204
 v_mfma_f32_16x16x32_bf16 v[20:23], a[244:247], a[168:171], v[20:23]
 ds_read_b128 a[220:223], v217 offset:44032
 v_cmp_lt_f32 vcc, s75, v250
 v_mfma_f32_16x16x32_bf16 v[20:23], a[240:243], a[160:163], v[20:23]
 s_cbranch_vccnz Lrare30
Lback31:
 v_add_f32 v213, v213, v196
 v_add_f32 v212, v212, v192
 v_add_f32 v215, v215, v204
 v_mfma_f32_16x16x32_bf16 a[4:7], a[192:195], v[156:159], a[4:7]
 ds_read_b128 a[224:227], v217 offset:36864
 ds_read_b128 a[228:231], v217 offset:45056
 v_mfma_f32_16x16x32_bf16 a[4:7], a[196:199], v[164:167], a[4:7]
 ds_read_b128 a[232:235], v217 offset:37888
 ds_read_b128 a[236:239], v217 offset:46080
 v_mfma_f32_16x16x32_bf16 a[12:15], a[200:203], v[156:159], a[12:15]
 s_waitcnt lgkmcnt(4)
 ds_read_b128 a[240:243], v217 offset:38912
 ds_read_b128 a[244:247], v217 offset:47104
 v_mfma_f32_16x16x32_bf16 a[12:15], a[204:207], v[164:167], a[12:15]
 ds_read_b128 a[248:251], v217 offset:39936
 ds_read_b128 a[252:255], v217 offset:48128
 v_rcp_f32 v214, v214
 v_cvt_pk_bf16_f32 v132, v184, v185
 v_mfma_f32_16x16x32_bf16 a[20:23], a[208:211], v[156:159], a[20:23]
 s_lshl_b32 s76, s64, 17
 s_lshl_b32 s77, s61, 12
 s_add_u32 s76, s76, s77
 s_add_u32 s76, s76, 37748736
 s_add_u32 s77, s76, 524288
 v_exp_f32 v188, v12
 v_accvgpr_read_b32 v112, a0
 v_accvgpr_read_b32 v113, a1
 v_accvgpr_read_b32 v114, a2
 v_accvgpr_read_b32 v115, a3
 v_accvgpr_read_b32 v116, a8
 v_mfma_f32_16x16x32_bf16 a[20:23], a[212:215], v[164:167], a[20:23]
 v_accvgpr_read_b32 v117, a9
 v_accvgpr_read_b32 v118, a10
 v_accvgpr_read_b32 v119, a11
 v_mfma_f32_16x16x32_bf16 a[28:31], a[216:219], v[156:159], a[28:31]
 s_waitcnt lgkmcnt(4)
 v_mul_f32 v112, v112, v214
 v_mul_f32 v113, v113, v214
 v_cvt_pk_bf16_f32 v133, v186, v187
 v_mul_f32 v114, v114, v214
 v_mfma_f32_16x16x32_bf16 a[28:31], a[220:223], v[164:167], a[28:31]
 v_mul_f32 v115, v115, v214
 v_mul_f32 v116, v116, v214
 v_exp_f32 v189, v13
 v_mul_f32 v117, v117, v214
 v_mfma_f32_16x16x32_bf16 a[36:39], a[224:227], v[156:159], a[36:39]
 v_mul_f32 v118, v118, v214
 v_mul_f32 v119, v119, v214
 v_cvt_pk_bf16_f32 v96, v112, v113
 v_mfma_f32_16x16x32_bf16 a[36:39], a[228:231], v[164:167], a[36:39]
 v_cvt_pk_bf16_f32 v97, v114, v115
 v_cvt_pk_bf16_f32 v98, v116, v117
 v_cvt_pk_bf16_f32 v99, v118, v119
 v_mfma_f32_16x16x32_bf16 a[44:47], a[232:235], v[156:159], a[44:47]
 buffer_store_dwordx4 v[96:99], v251, s[52:55], s76 offen offset:0 sc1
 v_exp_f32 v190, v14
 v_accvgpr_read_b32 v112, a16
 v_mfma_f32_16x16x32_bf16 a[44:47], a[236:239], v[164:167], a[44:47]
 s_waitcnt lgkmcnt(0)
 v_accvgpr_read_b32 v113, a17
 v_accvgpr_read_b32 v114, a18
 v_accvgpr_read_b32 v115, a19
 v_mfma_f32_16x16x32_bf16 a[52:55], a[240:243], v[156:159], a[52:55]
 v_accvgpr_read_b32 v116, a24
 v_accvgpr_read_b32 v117, a25
 v_cvt_pk_bf16_f32 v134, v188, v189
 v_accvgpr_read_b32 v118, a26
 v_accvgpr_read_b32 v119, a27
 v_mfma_f32_16x16x32_bf16 a[52:55], a[244:247], v[164:167], a[52:55]
 v_mul_f32 v112, v112, v214
 v_mul_f32 v113, v113, v214
 v_exp_f32 v191, v15
 v_mul_f32 v114, v114, v214
 v_mfma_f32_16x16x32_bf16 a[60:63], a[248:251], v[156:159], a[60:63]
 v_mul_f32 v115, v115, v214
 v_mul_f32 v116, v116, v214
 v_mul_f32 v117, v117, v214
 v_mfma_f32_16x16x32_bf16 a[60:63], a[252:255], v[164:167], a[60:63]
 v_mul_f32 v118, v118, v214
 v_mul_f32 v119, v119, v214
 v_cvt_pk_bf16_f32 v100, v112, v113
 v_mfma_f32_16x16x32_bf16 a[68:71], a[192:195], v[140:143], a[68:71]
 v_exp_f32 v184, v0
 v_cvt_pk_bf16_f32 v101, v114, v115
 v_cvt_pk_bf16_f32 v102, v116, v117
 v_cvt_pk_bf16_f32 v103, v118, v119
 v_mfma_f32_16x16x32_bf16 a[68:71], a[196:199], v[148:151], a[68:71]
 buffer_store_dwordx4 v[100:103], v251, s[52:55], s76 offen offset:1024 sc1
 v_xor_b32 v217, 0x10000, v217
 v_cvt_pk_bf16_f32 v135, v190, v191
 v_accvgpr_read_b32 v112, a32
 v_mfma_f32_16x16x32_bf16 a[64:67], a[196:199], v[144:147], a[64:67]
 s_waitcnt vmcnt(14)
 v_accvgpr_read_b32 v113, a33
 v_accvgpr_read_b32 v114, a34
 v_accvgpr_read_b32 v115, a35
 v_mfma_f32_16x16x32_bf16 a[64:67], a[192:195], v[136:139], a[64:67]
 s_barrier
 v_accvgpr_read_b32 v116, a40
 v_accvgpr_read_b32 v117, a41
 v_exp_f32 v185, v1
 v_accvgpr_read_b32 v118, a42
 v_mfma_f32_16x16x32_bf16 a[76:79], a[200:203], v[140:143], a[76:79]
 s_add_u32 m0, s67, 0
 v_accvgpr_read_b32 v119, a43
 v_mul_f32 v112, v112, v214
 v_mul_f32 v113, v113, v214
 v_mfma_f32_16x16x32_bf16 v[196:199], v[208:211], v[132:135], 0
 v_mul_f32 v114, v114, v214
 v_mul_f32 v115, v115, v214
 v_mfma_f32_16x16x32_bf16 a[76:79], a[204:207], v[148:151], a[76:79]
 ds_read_b128 a[192:195], v217 offset:16384
 v_mul_f32 v116, v116, v214
 v_exp_f32 v186, v2
 v_mfma_f32_16x16x32_bf16 a[72:75], a[204:207], v[144:147], a[72:75]
 ds_read_b128 a[196:199], v217 offset:17408
 v_mul_f32 v117, v117, v214
 v_mul_f32 v118, v118, v214
 v_mul_f32 v119, v119, v214
 v_cvt_pk_bf16_f32 v96, v112, v113
 v_mfma_f32_16x16x32_bf16 a[72:75], a[200:203], v[136:139], a[72:75]
 buffer_load_dwordx4 v218, s[56:59], s66 offen offset:0 sc1 lds
 v_cvt_pk_bf16_f32 v97, v114, v115
 v_cvt_pk_bf16_f32 v98, v116, v117
 v_cvt_pk_bf16_f32 v99, v118, v119
 v_mfma_f32_16x16x32_bf16 a[84:87], a[208:211], v[140:143], a[84:87]
 buffer_store_dwordx4 v[96:99], v251, s[52:55], s76 offen offset:2048 sc1
 v_cvt_pk_bf16_f32 v128, v184, v185
 v_accvgpr_read_b32 v112, a48
 v_mfma_f32_16x16x32_bf16 a[84:87], a[212:215], v[148:151], a[84:87]
 v_accvgpr_read_b32 v113, a49
 v_accvgpr_read_b32 v114, a50
 v_exp_f32 v187, v3
 v_accvgpr_read_b32 v115, a51
 v_mfma_f32_16x16x32_bf16 a[80:83], a[212:215], v[144:147], a[80:83]
 ds_read_b128 a[200:203], v217 offset:18432
 ds_read_b128 a[204:207], v217 offset:19456
 v_accvgpr_read_b32 v116, a56
 v_accvgpr_read_b32 v117, a57
 v_accvgpr_read_b32 v118, a58
 v_mfma_f32_16x16x32_bf16 a[80:83], a[208:211], v[136:139], a[80:83]
 v_accvgpr_read_b32 v119, a59
 v_mul_f32 v112, v112, v214
 v_mul_f32 v113, v113, v214
 v_exp_f32 v188, v4
 v_mfma_f32_16x16x32_bf16 a[92:95], a[216:219], v[140:143], a[92:95]
 buffer_load_dwordx4 v218, s[56:59], s66 offen offset:1024 sc1 lds
 v_mul_f32 v114, v114, v214
 v_mul_f32 v115, v115, v214
 v_mul_f32 v116, v116, v214
 v_mfma_f32_16x16x32_bf16 a[92:95], a[220:223], v[148:151], a[92:95]
 v_mul_f32 v117, v117, v214
 v_mul_f32 v118, v118, v214
 v_mul_f32 v119, v119, v214
 v_mfma_f32_16x16x32_bf16 a[88:91], a[220:223], v[144:147], a[88:91]
 ds_read_b128 a[208:211], v217 offset:20480
 ds_read_b128 a[212:215], v217 offset:21504
 v_cvt_pk_bf16_f32 v100, v112, v113
 v_cvt_pk_bf16_f32 v129, v186, v187
 v_cvt_pk_bf16_f32 v101, v114, v115
 v_cvt_pk_bf16_f32 v102, v116, v117
 v_mfma_f32_16x16x32_bf16 a[88:91], a[216:219], v[136:139], a[88:91]
 ds_read_b128 a[216:219], v217 offset:22528
 v_cvt_pk_bf16_f32 v103, v118, v119
 v_exp_f32 v189, v5
 v_mfma_f32_16x16x32_bf16 a[100:103], a[224:227], v[140:143], a[100:103]
 buffer_store_dwordx4 v[100:103], v251, s[52:55], s76 offen offset:3072 sc1
 v_rcp_f32 v215, v215
 v_accvgpr_read_b32 v112, a4
 v_accvgpr_read_b32 v113, a5
 v_mfma_f32_16x16x32_bf16 a[100:103], a[228:231], v[148:151], a[100:103]
 v_accvgpr_read_b32 v114, a6
 v_accvgpr_read_b32 v115, a7
 v_exp_f32 v190, v6
 v_accvgpr_read_b32 v116, a12
 v_mfma_f32_16x16x32_bf16 a[96:99], a[228:231], v[144:147], a[96:99]
 ds_read_b128 a[220:223], v217 offset:23552
 buffer_load_dwordx4 v218, s[56:59], s66 offen offset:2048 sc1 lds
 v_accvgpr_read_b32 v117, a13
 v_accvgpr_read_b32 v118, a14
 v_accvgpr_read_b32 v119, a15
 v_mfma_f32_16x16x32_bf16 a[96:99], a[224:227], v[136:139], a[96:99]
 v_mul_f32 v112, v112, v215
 v_mul_f32 v113, v113, v215
 v_mul_f32 v114, v114, v215
 v_mfma_f32_16x16x32_bf16 a[108:111], a[232:235], v[140:143], a[108:111]
 v_cvt_pk_bf16_f32 v130, v188, v189
 v_mul_f32 v115, v115, v215
 v_mul_f32 v116, v116, v215
 v_mul_f32 v117, v117, v215
 v_mfma_f32_16x16x32_bf16 a[108:111], a[236:239], v[148:151], a[108:111]
 v_mul_f32 v118, v118, v215
 v_mul_f32 v119, v119, v215
 v_exp_f32 v191, v7
 v_cvt_pk_bf16_f32 v96, v112, v113
 v_mfma_f32_16x16x32_bf16 a[104:107], a[236:239], v[144:147], a[104:107]
 v_cvt_pk_bf16_f32 v97, v114, v115
 v_cvt_pk_bf16_f32 v98, v116, v117
 v_cvt_pk_bf16_f32 v99, v118, v119
 v_mfma_f32_16x16x32_bf16 a[104:107], a[232:235], v[136:139], a[104:107]
 buffer_store_dwordx4 v[96:99], v251, s[52:55], s77 offen offset:0 sc1
 v_exp_f32 v184, v24
 v_accvgpr_read_b32 v112, a20
 v_mfma_f32_16x16x32_bf16 a[116:119], a[240:243], v[140:143], a[116:119]
 buffer_load_dwordx4 v218, s[56:59], s66 offen offset:3072 sc1 lds
 v_accvgpr_read_b32 v113, a21
 v_accvgpr_read_b32 v114, a22
 v_accvgpr_read_b32 v115, a23
 v_mfma_f32_16x16x32_bf16 a[116:119], a[244:247], v[148:151], a[116:119]
 s_add_u32 m0, s67, 4096
 v_accvgpr_read_b32 v116, a28
 v_accvgpr_read_b32 v117, a29
 v_accvgpr_read_b32 v118, a30
 v_accvgpr_read_b32 v119, a31
 v_mfma_f32_16x16x32_bf16 a[112:115], a[244:247], v[144:147], a[112:115]
 v_cvt_pk_bf16_f32 v131, v190, v191
 v_mul_f32 v112, v112, v215
 v_mul_f32 v113, v113, v215
 v_mul_f32 v114, v114, v215
 v_mfma_f32_16x16x32_bf16 a[112:115], a[240:243], v[136:139], a[112:115]
 v_exp_f32 v185, v25
 v_mul_f32 v115, v115, v215
 v_mul_f32 v116, v116, v215
 v_mul_f32 v117, v117, v215
 v_mfma_f32_16x16x32_bf16 a[124:127], a[248:251], v[140:143], a[124:127]
 v_mul_f32 v118, v118, v215
 v_mul_f32 v119, v119, v215
 v_cvt_pk_bf16_f32 v100, v112, v113
 v_mfma_f32_16x16x32_bf16 v[192:195], v[208:211], v[128:131], 0
 v_cvt_pk_bf16_f32 v101, v114, v115
 v_cvt_pk_bf16_f32 v102, v116, v117
 v_mfma_f32_16x16x32_bf16 a[124:127], a[252:255], v[148:151], a[124:127]
 v_exp_f32 v186, v26
 v_cvt_pk_bf16_f32 v103, v118, v119
 v_mfma_f32_16x16x32_bf16 a[120:123], a[252:255], v[144:147], a[120:123]
 buffer_load_dwordx4 v219, s[56:59], s66 offen offset:0 sc1 lds
 buffer_store_dwordx4 v[100:103], v251, s[52:55], s77 offen offset:1024 sc1
 v_accvgpr_read_b32 v112, a36
 v_mfma_f32_16x16x32_bf16 a[120:123], a[248:251], v[136:139], a[120:123]
 s_waitcnt lgkmcnt(4)
 v_accvgpr_read_b32 v113, a37
 v_accvgpr_read_b32 v114, a38
 v_accvgpr_read_b32 v115, a39
 v_mfma_f32_16x16x32_bf16 v[40:43], a[192:195], a[164:167], v[172:175]
 v_cvt_pk_bf16_f32 v148, v184, v185
 v_accvgpr_read_b32 v116, a44
 v_accvgpr_read_b32 v117, a45
 v_accvgpr_read_b32 v118, a46
 v_exp_f32 v187, v27
 v_mfma_f32_16x16x32_bf16 v[40:43], a[196:199], a[172:175], v[40:43]
 v_accvgpr_read_b32 v119, a47
 v_mul_f32 v112, v112, v215
 v_mul_f32 v113, v113, v215
 v_mfma_f32_16x16x32_bf16 v[40:43], a[200:203], a[180:183], v[40:43]
 v_mul_f32 v114, v114, v215
 v_mul_f32 v115, v115, v215
 v_exp_f32 v188, v28
 v_mul_f32 v116, v116, v215
 v_mfma_f32_16x16x32_bf16 v[40:43], a[204:207], a[188:191], v[40:43]
 ds_read_b128 a[224:227], v217 offset:24576
 buffer_load_dwordx4 v219, s[56:59], s66 offen offset:1024 sc1 lds
 v_mul_f32 v117, v117, v215
 v_mul_f32 v118, v118, v215
 v_mul_f32 v119, v119, v215
 v_cvt_pk_bf16_f32 v149, v186, v187
 v_cvt_pk_bf16_f32 v96, v112, v113
 v_mfma_f32_16x16x32_bf16 v[32:35], a[204:207], a[184:187], v[168:171]
 v_cvt_pk_bf16_f32 v97, v114, v115
 v_cvt_pk_bf16_f32 v98, v116, v117
 v_exp_f32 v189, v29
 v_cvt_pk_bf16_f32 v99, v118, v119
 v_mfma_f32_16x16x32_bf16 v[32:35], a[200:203], a[176:179], v[32:35]
 ds_read_b128 a[228:231], v217 offset:25600
 ds_read_b128 a[232:235], v217 offset:26624
 buffer_store_dwordx4 v[96:99], v251, s[52:55], s77 offen offset:2048 sc1
 v_accvgpr_read_b32 v112, a52
 v_mfma_f32_16x16x32_bf16 v[32:35], a[196:199], a[168:171], v[32:35]
 s_waitcnt lgkmcnt(3)
 v_exp_f32 v190, v30
 v_accvgpr_read_b32 v113, a53
 v_accvgpr_read_b32 v114, a54
 v_accvgpr_read_b32 v115, a55
 v_mfma_f32_16x16x32_bf16 v[32:35], a[192:195], a[160:163], v[32:35]
 ds_read_b128 a[236:239], v217 offset:27648
 v_accvgpr_read_b32 v116, a60
 v_accvgpr_read_b32 v117, a61
 v_cvt_pk_bf16_f32 v150, v188, v189
 v_accvgpr_read_b32 v118, a62
 v_mfma_f32_16x16x32_bf16 v[44:47], a[208:211], a[164:167], v[172:175]
 v_accvgpr_read_b32 v119, a63
 v_mul_f32 v112, v112, v215
 v_mul_f32 v113, v113, v215
 v_mul_f32 v114, v114, v215
 v_mul_f32 v115, v115, v215
 v_mul_f32 v116, v116, v215
 v_mul_f32 v117, v117, v215
 v_mul_f32 v118, v118, v215
 v_mul_f32 v119, v119, v215
 v_cvt_pk_bf16_f32 v100, v112, v113
 v_cvt_pk_bf16_f32 v101, v114, v115
 v_cvt_pk_bf16_f32 v102, v116, v117
 v_cvt_pk_bf16_f32 v103, v118, v119
 v_exp_f32 v191, v31
 v_mfma_f32_16x16x32_bf16 v[44:47], a[212:215], a[172:175], v[44:47]
 buffer_store_dwordx4 v[100:103], v251, s[52:55], s77 offen offset:3072 sc1
 buffer_load_dwordx4 v219, s[56:59], s66 offen offset:2048 sc1 lds
 v_exp_f32 v184, v16
 v_mfma_f32_16x16x32_bf16 v[44:47], a[216:219], a[180:183], v[44:47]
 ds_read_b128 a[240:243], v217 offset:28672
 v_cvt_pk_bf16_f32 v151, v190, v191
 v_mfma_f32_16x16x32_bf16 v[44:47], a[220:223], a[188:191], v[44:47]
 v_exp_f32 v185, v17
 v_mfma_f32_16x16x32_bf16 v[36:39], a[220:223], a[184:187], v[168:171]
 ds_read_b128 a[244:247], v217 offset:29696
 ds_read_b128 a[248:251], v217 offset:30720
 v_mfma_f32_16x16x32_bf16 v[196:199], v[208:211], v[148:151], v[196:199]
 v_exp_f32 v186, v18
 v_mfma_f32_16x16x32_bf16 v[36:39], a[216:219], a[176:179], v[36:39]
 ds_read_b128 a[252:255], v217 offset:31744
 v_cvt_pk_bf16_f32 v144, v184, v185
 v_mfma_f32_16x16x32_bf16 v[36:39], a[212:215], a[168:171], v[36:39]
 buffer_load_dwordx4 v219, s[56:59], s66 offen offset:3072 sc1 lds
 v_mfma_f32_16x16x32_bf16 v[36:39], a[208:211], a[160:163], v[36:39]
 s_waitcnt lgkmcnt(4)
 v_exp_f32 v187, v19
 v_mfma_f32_16x16x32_bf16 v[56:59], a[224:227], a[164:167], v[172:175]
 s_add_u32 s66, s66, 32768
 v_exp_f32 v188, v20
 v_mfma_f32_16x16x32_bf16 v[56:59], a[228:231], a[172:175], v[56:59]
 ds_read_b128 a[192:195], v217 offset:0
 v_cvt_pk_bf16_f32 v145, v186, v187
 v_mfma_f32_16x16x32_bf16 v[56:59], a[232:235], a[180:183], v[56:59]
 v_exp_f32 v189, v21
 v_mfma_f32_16x16x32_bf16 v[56:59], a[236:239], a[188:191], v[56:59]
 ds_read_b128 a[196:199], v217 offset:8192
 ds_read_b128 a[200:203], v217 offset:1024
 v_mfma_f32_16x16x32_bf16 v[48:51], a[236:239], a[184:187], v[168:171]
 v_exp_f32 v190, v22
 v_mfma_f32_16x16x32_bf16 v[48:51], a[232:235], a[176:179], v[48:51]
 ds_read_b128 a[204:207], v217 offset:9216
 v_cvt_pk_bf16_f32 v146, v188, v189
 v_mfma_f32_16x16x32_bf16 v[48:51], a[228:231], a[168:171], v[48:51]
 s_waitcnt lgkmcnt(4)
 v_exp_f32 v191, v23
 v_mfma_f32_16x16x32_bf16 v[48:51], a[224:227], a[160:163], v[48:51]
 v_exp_f32 v184, v40
 v_mfma_f32_16x16x32_bf16 v[60:63], a[240:243], a[164:167], v[172:175]
 ds_read_b128 a[208:211], v217 offset:2048
 v_cvt_pk_bf16_f32 v147, v190, v191
 v_mfma_f32_16x16x32_bf16 v[60:63], a[244:247], a[172:175], v[60:63]
 v_exp_f32 v185, v41
 v_mfma_f32_16x16x32_bf16 v[60:63], a[248:251], a[180:183], v[60:63]
 ds_read_b128 a[212:215], v217 offset:10240
 ds_read_b128 a[216:219], v217 offset:3072
 v_mfma_f32_16x16x32_bf16 v[192:195], v[208:211], v[144:147], v[192:195]
 v_exp_f32 v186, v42
 v_mfma_f32_16x16x32_bf16 v[60:63], a[252:255], a[188:191], v[60:63]
 v_exp_f32 v187, v43
 v_mfma_f32_16x16x32_bf16 v[52:55], a[252:255], a[184:187], v[168:171]
 v_mfma_f32_16x16x32_bf16 v[52:55], a[248:251], a[176:179], v[52:55]
 s_waitcnt lgkmcnt(3)
 s_nop 1
 v_max_f32 v250, v196, v192
 v_cmp_lt_f32 vcc, s75, v250
 v_mfma_f32_16x16x32_bf16 v[52:55], a[244:247], a[168:171], v[52:55]
 ds_read_b128 a[220:223], v217 offset:11264
 v_mfma_f32_16x16x32_bf16 v[52:55], a[240:243], a[160:163], v[52:55]
 s_cbranch_vccnz Lrare32
Lback33:
 v_add_f32 v213, v213, v196
 v_add_f32 v212, v212, v192
 s_cmp_ge_u32 s70, 184
 s_cbranch_scc1 Lna34
 s_cmp_ge_u32 s70, 128
 s_cselect_b32 s76, 71318400, s43
 s_cmp_lg_u32 s60, 0
 s_cbranch_scc1 Lna36
 v_mov_b32 v250, 1
 v_mov_b32 v249, 0
 s_mov_b64 exec, 1
 buffer_atomic_add v250, v249, s[52:55], s76 offen sc1
 s_mov_b64 exec, -1
Lna36:
Lna34:
 s_lshl_b32 s74, s62, 1
 s_sub_u32 s74, 11, s74
 v_mfma_f32_16x16x32_bf16 a[68:71], a[192:195], v[132:135], a[68:71]
 ds_read_b128 a[224:227], v217 offset:4096
 v_cvt_pk_bf16_f32 v140, v184, v185
 v_mfma_f32_16x16x32_bf16 a[68:71], a[196:199], v[148:151], a[68:71]
 v_exp_f32 v188, v44
 v_mfma_f32_16x16x32_bf16 a[64:67], a[196:199], v[144:147], a[64:67]
 ds_read_b128 a[228:231], v217 offset:12288
 v_cvt_pk_bf16_f32 v141, v186, v187
 v_mfma_f32_16x16x32_bf16 a[64:67], a[192:195], v[128:131], a[64:67]
 v_exp_f32 v189, v45
 v_mfma_f32_16x16x32_bf16 a[76:79], a[200:203], v[132:135], a[76:79]
 ds_read_b128 a[232:235], v217 offset:5120
 ds_read_b128 a[236:239], v217 offset:13312
 v_mfma_f32_16x16x32_bf16 a[76:79], a[204:207], v[148:151], a[76:79]
 v_exp_f32 v190, v46
 v_mfma_f32_16x16x32_bf16 a[72:75], a[204:207], v[144:147], a[72:75]
 s_waitcnt lgkmcnt(4)
 ds_read_b128 a[240:243], v217 offset:6144
 v_cvt_pk_bf16_f32 v142, v188, v189
 v_mfma_f32_16x16x32_bf16 a[72:75], a[200:203], v[128:131], a[72:75]
 v_exp_f32 v191, v47
 v_mfma_f32_16x16x32_bf16 a[84:87], a[208:211], v[132:135], a[84:87]
 v_exp_f32 v184, v32
 v_mfma_f32_16x16x32_bf16 a[84:87], a[212:215], v[148:151], a[84:87]
 ds_read_b128 a[244:247], v217 offset:14336
 v_cvt_pk_bf16_f32 v143, v190, v191
 v_mfma_f32_16x16x32_bf16 a[80:83], a[212:215], v[144:147], a[80:83]
 v_exp_f32 v185, v33
 v_mfma_f32_16x16x32_bf16 a[80:83], a[208:211], v[128:131], a[80:83]
 ds_read_b128 a[248:251], v217 offset:7168
 ds_read_b128 a[252:255], v217 offset:15360
 v_mfma_f32_16x16x32_bf16 v[196:199], v[208:211], v[140:143], 0
 v_mfma_f32_16x16x32_bf16 a[92:95], a[216:219], v[132:135], a[92:95]
 v_exp_f32 v186, v34
 v_mfma_f32_16x16x32_bf16 a[92:95], a[220:223], v[148:151], a[92:95]
 v_cvt_pk_bf16_f32 v136, v184, v185
 v_mfma_f32_16x16x32_bf16 a[88:91], a[220:223], v[144:147], a[88:91]
 s_waitcnt lgkmcnt(4)
 v_exp_f32 v187, v35
 v_mfma_f32_16x16x32_bf16 a[88:91], a[216:219], v[128:131], a[88:91]
 s_waitcnt vmcnt(8)
 v_mfma_f32_16x16x32_bf16 a[100:103], a[224:227], v[132:135], a[100:103]
 s_barrier
 ds_read_b128 a[192:195], v217 offset:49152
 ds_read_b128 a[196:199], v217 offset:50176
 v_mfma_f32_16x16x32_bf16 a[100:103], a[228:231], v[148:151], a[100:103]
 s_add_u32 m0, s67, 32768
 v_exp_f32 v188, v36
 v_mfma_f32_16x16x32_bf16 a[96:99], a[228:231], v[144:147], a[96:99]
 buffer_load_dwordx4 v218, s[56:59], s66 offen offset:0 sc1 lds
 v_mfma_f32_16x16x32_bf16 a[96:99], a[224:227], v[128:131], a[96:99]
 ds_read_b128 a[0:3], v236 offset:0
 v_cvt_pk_bf16_f32 v137, v186, v187
 v_mfma_f32_16x16x32_bf16 a[108:111], a[232:235], v[132:135], a[108:111]
 v_exp_f32 v189, v37
 v_mfma_f32_16x16x32_bf16 a[108:111], a[236:239], v[148:151], a[108:111]
 v_exp_f32 v190, v38
 v_mfma_f32_16x16x32_bf16 a[104:107], a[236:239], v[144:147], a[104:107]
 s_waitcnt lgkmcnt(3)
 ds_read_b128 a[200:203], v217 offset:51200
 ds_read_b128 a[204:207], v217 offset:52224
 v_mfma_f32_16x16x32_bf16 a[104:107], a[232:235], v[128:131], a[104:107]
 ds_read_b128 a[4:7], v236 offset:2048
 v_cvt_pk_bf16_f32 v138, v188, v189
 v_mfma_f32_16x16x32_bf16 a[116:119], a[240:243], v[132:135], a[116:119]
 v_exp_f32 v191, v39
 v_mfma_f32_16x16x32_bf16 a[116:119], a[244:247], v[148:151], a[116:119]
 buffer_load_dwordx4 v218, s[56:59], s66 offen offset:1024 sc1 lds
 v_mfma_f32_16x16x32_bf16 a[112:115], a[244:247], v[144:147], a[112:115]
 v_exp_f32 v184, v56
 v_mfma_f32_16x16x32_bf16 a[112:115], a[240:243], v[128:131], a[112:115]
 ds_read_b128 a[208:211], v217 offset:53248
 ds_read_b128 a[8:11], v236 offset:4096
 v_mfma_f32_16x16x32_bf16 a[124:127], a[248:251], v[132:135], a[124:127]
 ds_read_b128 a[212:215], v217 offset:54272
 v_cvt_pk_bf16_f32 v139, v190, v191
 v_exp_f32 v185, v57
 v_mfma_f32_16x16x32_bf16 a[124:127], a[252:255], v[148:151], a[124:127]
 ds_read_b128 a[216:219], v217 offset:55296
 ds_read_b128 a[220:223], v217 offset:56320
 v_mfma_f32_16x16x32_bf16 v[192:195], v[208:211], v[136:139], 0
 v_exp_f32 v186, v58
 v_mfma_f32_16x16x32_bf16 a[120:123], a[252:255], v[144:147], a[120:123]
 buffer_load_dwordx4 v218, s[56:59], s66 offen offset:2048 sc1 lds
 v_mfma_f32_16x16x32_bf16 a[120:123], a[248:251], v[128:131], a[120:123]
 s_waitcnt lgkmcnt(6)
 ds_read_b128 a[12:15], v236 offset:6144
 v_cvt_pk_bf16_f32 v148, v184, v185
 v_mfma_f32_16x16x32_bf16 v[8:11], a[192:195], a[164:167], v[172:175]
 v_exp_f32 v187, v59
 v_mfma_f32_16x16x32_bf16 v[8:11], a[196:199], a[172:175], v[8:11]
 v_exp_f32 v188, v60
 v_mfma_f32_16x16x32_bf16 v[8:11], a[200:203], a[180:183], v[8:11]
 ds_read_b128 a[224:227], v217 offset:57344
 v_cvt_pk_bf16_f32 v149, v186, v187
 v_mfma_f32_16x16x32_bf16 v[8:11], a[204:207], a[188:191], v[8:11]
 buffer_load_dwordx4 v218, s[56:59], s66 offen offset:3072 sc1 lds
 v_mfma_f32_16x16x32_bf16 v[0:3], a[204:207], a[184:187], v[168:171]
 s_waitcnt lgkmcnt(1)
 buffer_store_dwordx4 a[0:3], v251, s[52:55], s29 offen offset:0 sc1
 v_exp_f32 v189, v61
 v_mfma_f32_16x16x32_bf16 v[0:3], a[200:203], a[176:179], v[0:3]
 s_add_u32 m0, s67, 36864
 ds_read_b128 a[228:231], v217 offset:58368
 ds_read_b128 a[232:235], v217 offset:59392
 v_mfma_f32_16x16x32_bf16 v[0:3], a[196:199], a[168:171], v[0:3]
 s_waitcnt lgkmcnt(4)
 v_exp_f32 v190, v62
 v_mfma_f32_16x16x32_bf16 v[0:3], a[192:195], a[160:163], v[0:3]
 ds_read_b128 a[236:239], v217 offset:60416
 v_cvt_pk_bf16_f32 v150, v188, v189
 v_mfma_f32_16x16x32_bf16 v[12:15], a[208:211], a[164:167], v[172:175]
 v_exp_f32 v191, v63
 v_mfma_f32_16x16x32_bf16 v[12:15], a[212:215], a[172:175], v[12:15]
 v_exp_f32 v184, v48
 v_mfma_f32_16x16x32_bf16 v[12:15], a[216:219], a[180:183], v[12:15]
 buffer_load_dwordx4 v219, s[56:59], s66 offen offset:0 sc1 lds
 buffer_store_dwordx4 a[4:7], v251, s[52:55], s29 offen offset:1024 sc1
 v_mfma_f32_16x16x32_bf16 v[12:15], a[220:223], a[188:191], v[12:15]
 ds_read_b128 a[240:243], v217 offset:61440
 v_cvt_pk_bf16_f32 v151, v190, v191
 v_mfma_f32_16x16x32_bf16 v[4:7], a[220:223], a[184:187], v[168:171]
 v_exp_f32 v185, v49
 v_mfma_f32_16x16x32_bf16 v[4:7], a[216:219], a[176:179], v[4:7]
 ds_read_b128 a[244:247], v217 offset:62464
 ds_read_b128 a[248:251], v217 offset:63488
 v_mfma_f32_16x16x32_bf16 v[196:199], v[208:211], v[148:151], v[196:199]
 v_exp_f32 v186, v50
 v_mfma_f32_16x16x32_bf16 v[4:7], a[212:215], a[168:171], v[4:7]
 s_waitcnt lgkmcnt(3)
 ds_read_b128 a[252:255], v217 offset:64512
 v_cvt_pk_bf16_f32 v144, v184, v185
 v_mfma_f32_16x16x32_bf16 v[4:7], a[208:211], a[160:163], v[4:7]
 buffer_load_dwordx4 v219, s[56:59], s66 offen offset:1024 sc1 lds
 v_mfma_f32_16x16x32_bf16 v[24:27], a[224:227], a[164:167], v[172:175]
 v_exp_f32 v187, v51
 v_mfma_f32_16x16x32_bf16 v[24:27], a[228:231], a[172:175], v[24:27]
 buffer_store_dwordx4 a[8:11], v251, s[52:55], s29 offen offset:2048 sc1
 v_exp_f32 v188, v52
 v_mfma_f32_16x16x32_bf16 v[24:27], a[232:235], a[180:183], v[24:27]
 ds_read_b128 a[192:195], v217 offset:32768
 v_cvt_pk_bf16_f32 v145, v186, v187
 v_mfma_f32_16x16x32_bf16 v[24:27], a[236:239], a[188:191], v[24:27]
 v_exp_f32 v189, v53
 v_mfma_f32_16x16x32_bf16 v[16:19], a[236:239], a[184:187], v[168:171]
 ds_read_b128 a[196:199], v217 offset:40960
 ds_read_b128 a[200:203], v217 offset:33792
 v_mfma_f32_16x16x32_bf16 v[16:19], a[232:235], a[176:179], v[16:19]
 buffer_load_dwordx4 v219, s[56:59], s66 offen offset:2048 sc1 lds
 v_exp_f32 v190, v54
 v_mfma_f32_16x16x32_bf16 v[16:19], a[228:231], a[168:171], v[16:19]
 s_waitcnt lgkmcnt(3)
 ds_read_b128 a[204:207], v217 offset:41984
 v_cvt_pk_bf16_f32 v146, v188, v189
 v_mfma_f32_16x16x32_bf16 v[16:19], a[224:227], a[160:163], v[16:19]
 v_exp_f32 v191, v55
 v_mfma_f32_16x16x32_bf16 v[28:31], a[240:243], a[164:167], v[172:175]
 buffer_store_dwordx4 a[12:15], v251, s[52:55], s29 offen offset:3072 sc1
 v_mfma_f32_16x16x32_bf16 v[28:31], a[244:247], a[172:175], v[28:31]
 v_exp_f32 v184, v8
 v_mfma_f32_16x16x32_bf16 v[28:31], a[248:251], a[180:183], v[28:31]
 buffer_load_dwordx4 v219, s[56:59], s66 offen offset:3072 sc1 lds
 v_cvt_pk_bf16_f32 v147, v190, v191
 v_exp_f32 v185, v9
 v_mfma_f32_16x16x32_bf16 v[28:31], a[252:255], a[188:191], v[28:31]
 s_add_u32 s66, s66, 32768
 ds_read_b128 a[208:211], v217 offset:34816
 ds_read_b128 a[212:215], v217 offset:43008
 v_mfma_f32_16x16x32_bf16 v[192:195], v[208:211], v[144:147], v[192:195]
 s_xor_b32 s67, s67, 0x10000
 v_exp_f32 v186, v10
 v_mfma_f32_16x16x32_bf16 v[20:23], a[252:255], a[184:187], v[168:171]
 v_exp_f32 v187, v11
 v_mfma_f32_16x16x32_bf16 v[20:23], a[248:251], a[176:179], v[20:23]
 s_waitcnt lgkmcnt(2)
 ds_read_b128 a[216:219], v217 offset:35840
 s_nop 0
 v_max_f32 v250, v196, v192
 v_mfma_f32_16x16x32_bf16 v[20:23], a[244:247], a[168:171], v[20:23]
 ds_read_b128 a[220:223], v217 offset:44032
 v_cmp_lt_f32 vcc, s75, v250
 v_mfma_f32_16x16x32_bf16 v[20:23], a[240:243], a[160:163], v[20:23]
 s_cbranch_vccnz Lrare37
Lback38:
 v_add_f32 v213, v213, v196
 v_add_f32 v212, v212, v192
 v_mfma_f32_16x16x32_bf16 a[68:71], a[192:195], v[140:143], a[68:71]
 ds_read_b128 a[224:227], v217 offset:36864
 v_cvt_pk_bf16_f32 v132, v184, v185
 v_mfma_f32_16x16x32_bf16 a[68:71], a[196:199], v[148:151], a[68:71]
 v_exp_f32 v188, v12
 v_mfma_f32_16x16x32_bf16 a[64:67], a[196:199], v[144:147], a[64:67]
 ds_read_b128 a[228:231], v217 offset:45056
 v_cvt_pk_bf16_f32 v133, v186, v187
 v_mfma_f32_16x16x32_bf16 a[64:67], a[192:195], v[136:139], a[64:67]
 v_exp_f32 v189, v13
 v_mfma_f32_16x16x32_bf16 a[76:79], a[200:203], v[140:143], a[76:79]
 ds_read_b128 a[232:235], v217 offset:37888
 ds_read_b128 a[236:239], v217 offset:46080
 v_mfma_f32_16x16x32_bf16 a[76:79], a[204:207], v[148:151], a[76:79]
 v_exp_f32 v190, v14
 v_mfma_f32_16x16x32_bf16 a[72:75], a[204:207], v[144:147], a[72:75]
 s_waitcnt lgkmcnt(4)
 ds_read_b128 a[240:243], v217 offset:38912
 v_cvt_pk_bf16_f32 v134, v188, v189
 v_mfma_f32_16x16x32_bf16 a[72:75], a[200:203], v[136:139], a[72:75]
 v_exp_f32 v191, v15
 v_mfma_f32_16x16x32_bf16 a[84:87], a[208:211], v[140:143], a[84:87]
 v_exp_f32 v184, v0
 v_mfma_f32_16x16x32_bf16 a[84:87], a[212:215], v[148:151], a[84:87]
 ds_read_b128 a[244:247], v217 offset:47104
 v_cvt_pk_bf16_f32 v135, v190, v191
 v_mfma_f32_16x16x32_bf16 a[80:83], a[212:215], v[144:147], a[80:83]
 v_exp_f32 v185, v1
 v_mfma_f32_16x16x32_bf16 a[80:83], a[208:211], v[136:139], a[80:83]
 ds_read_b128 a[248:251], v217 offset:39936
 ds_read_b128 a[252:255], v217 offset:48128
 v_mfma_f32_16x16x32_bf16 v[196:199], v[208:211], v[132:135], 0
 v_mfma_f32_16x16x32_bf16 a[92:95], a[216:219], v[140:143], a[92:95]
 v_exp_f32 v186, v2
 v_mfma_f32_16x16x32_bf16 a[92:95], a[220:223], v[148:151], a[92:95]
 v_cvt_pk_bf16_f32 v128, v184, v185
 v_xor_b32 v217, 0x10000, v217
 v_mfma_f32_16x16x32_bf16 a[88:91], a[220:223], v[144:147], a[88:91]
 s_waitcnt lgkmcnt(4)
 v_exp_f32 v187, v3
 v_mfma_f32_16x16x32_bf16 a[88:91], a[216:219], v[136:139], a[88:91]
 s_waitcnt vmcnt(12)
 v_mfma_f32_16x16x32_bf16 a[100:103], a[224:227], v[140:143], a[100:103]
 s_barrier
 ds_read_b128 a[192:195], v217 offset:16384
 ds_read_b128 a[196:199], v217 offset:17408
 v_mfma_f32_16x16x32_bf16 a[100:103], a[228:231], v[148:151], a[100:103]
 s_add_u32 m0, s67, 0
 v_exp_f32 v188, v4
 v_mfma_f32_16x16x32_bf16 a[96:99], a[228:231], v[144:147], a[96:99]
 buffer_load_dwordx4 v218, s[56:59], s66 offen offset:0 sc1 lds
 v_mfma_f32_16x16x32_bf16 a[96:99], a[224:227], v[136:139], a[96:99]
 ds_read_b128 a[16:19], v237 offset:0
 v_cvt_pk_bf16_f32 v129, v186, v187
 v_mfma_f32_16x16x32_bf16 a[108:111], a[232:235], v[140:143], a[108:111]
 v_exp_f32 v189, v5
 v_mfma_f32_16x16x32_bf16 a[108:111], a[236:239], v[148:151], a[108:111]
 v_exp_f32 v190, v6
 v_mfma_f32_16x16x32_bf16 a[104:107], a[236:239], v[144:147], a[104:107]
 s_waitcnt lgkmcnt(3)
 ds_read_b128 a[200:203], v217 offset:18432
 ds_read_b128 a[204:207], v217 offset:19456
 v_mfma_f32_16x16x32_bf16 a[104:107], a[232:235], v[136:139], a[104:107]
 ds_read_b128 a[20:23], v237 offset:2048
 v_cvt_pk_bf16_f32 v130, v188, v189
 v_mfma_f32_16x16x32_bf16 a[116:119], a[240:243], v[140:143], a[116:119]
 v_exp_f32 v191, v7
 v_mfma_f32_16x16x32_bf16 a[116:119], a[244:247], v[148:151], a[116:119]
 buffer_load_dwordx4 v218, s[56:59], s66 offen offset:1024 sc1 lds
 v_mfma_f32_16x16x32_bf16 a[112:115], a[244:247], v[144:147], a[112:115]
 v_exp_f32 v184, v24
 v_mfma_f32_16x16x32_bf16 a[112:115], a[240:243], v[136:139], a[112:115]
 ds_read_b128 a[208:211], v217 offset:20480
 ds_read_b128 a[24:27], v237 offset:4096
 v_mfma_f32_16x16x32_bf16 a[124:127], a[248:251], v[140:143], a[124:127]
 ds_read_b128 a[212:215], v217 offset:21504
 v_cvt_pk_bf16_f32 v131, v190, v191
 v_exp_f32 v185, v25
 v_mfma_f32_16x16x32_bf16 a[124:127], a[252:255], v[148:151], a[124:127]
 ds_read_b128 a[216:219], v217 offset:22528
 ds_read_b128 a[220:223], v217 offset:23552
 v_mfma_f32_16x16x32_bf16 v[192:195], v[208:211], v[128:131], 0
 v_exp_f32 v186, v26
 v_mfma_f32_16x16x32_bf16 a[120:123], a[252:255], v[144:147], a[120:123]
 buffer_load_dwordx4 v218, s[56:59], s66 offen offset:2048 sc1 lds
 v_mfma_f32_16x16x32_bf16 a[120:123], a[248:251], v[136:139], a[120:123]
 s_waitcnt lgkmcnt(6)
 ds_read_b128 a[28:31], v237 offset:6144
 v_cvt_pk_bf16_f32 v148, v184, v185
 v_mfma_f32_16x16x32_bf16 v[40:43], a[192:195], a[164:167], v[172:175]
 v_exp_f32 v187, v27
 v_mfma_f32_16x16x32_bf16 v[40:43], a[196:199], a[172:175], v[40:43]
 v_exp_f32 v188, v28
 v_mfma_f32_16x16x32_bf16 v[40:43], a[200:203], a[180:183], v[40:43]
 ds_read_b128 a[224:227], v217 offset:24576
 v_cvt_pk_bf16_f32 v149, v186, v187
 v_mfma_f32_16x16x32_bf16 v[40:43], a[204:207], a[188:191], v[40:43]
 buffer_load_dwordx4 v218, s[56:59], s66 offen offset:3072 sc1 lds
 v_mfma_f32_16x16x32_bf16 v[32:35], a[204:207], a[184:187], v[168:171]
 s_waitcnt lgkmcnt(1)
 buffer_store_dwordx4 a[16:19], v251, s[52:55], s40 offen offset:0 sc1
 v_exp_f32 v189, v29
 v_mfma_f32_16x16x32_bf16 v[32:35], a[200:203], a[176:179], v[32:35]
 s_add_u32 m0, s67, 4096
 ds_read_b128 a[228:231], v217 offset:25600
 ds_read_b128 a[232:235], v217 offset:26624
 v_mfma_f32_16x16x32_bf16 v[32:35], a[196:199], a[168:171], v[32:35]
 s_waitcnt lgkmcnt(4)
 v_exp_f32 v190, v30
 v_mfma_f32_16x16x32_bf16 v[32:35], a[192:195], a[160:163], v[32:35]
 ds_read_b128 a[236:239], v217 offset:27648
 v_cvt_pk_bf16_f32 v150, v188, v189
 v_mfma_f32_16x16x32_bf16 v[44:47], a[208:211], a[164:167], v[172:175]
 v_exp_f32 v191, v31
 v_mfma_f32_16x16x32_bf16 v[44:47], a[212:215], a[172:175], v[44:47]
 v_exp_f32 v184, v16
 v_mfma_f32_16x16x32_bf16 v[44:47], a[216:219], a[180:183], v[44:47]
 buffer_load_dwordx4 v219, s[56:59], s66 offen offset:0 sc1 lds
 buffer_store_dwordx4 a[20:23], v251, s[52:55], s40 offen offset:1024 sc1
 v_mfma_f32_16x16x32_bf16 v[44:47], a[220:223], a[188:191], v[44:47]
 ds_read_b128 a[240:243], v217 offset:28672
 v_cvt_pk_bf16_f32 v151, v190, v191
 v_mfma_f32_16x16x32_bf16 v[36:39], a[220:223], a[184:187], v[168:171]
 v_exp_f32 v185, v17
 v_mfma_f32_16x16x32_bf16 v[36:39], a[216:219], a[176:179], v[36:39]
 ds_read_b128 a[244:247], v217 offset:29696
 ds_read_b128 a[248:251], v217 offset:30720
 v_mfma_f32_16x16x32_bf16 v[196:199], v[208:211], v[148:151], v[196:199]
 v_exp_f32 v186, v18
 v_mfma_f32_16x16x32_bf16 v[36:39], a[212:215], a[168:171], v[36:39]
 s_waitcnt lgkmcnt(3)
 ds_read_b128 a[252:255], v217 offset:31744
 v_cvt_pk_bf16_f32 v144, v184, v185
 v_mfma_f32_16x16x32_bf16 v[36:39], a[208:211], a[160:163], v[36:39]
 buffer_load_dwordx4 v219, s[56:59], s66 offen offset:1024 sc1 lds
 v_mfma_f32_16x16x32_bf16 v[56:59], a[224:227], a[164:167], v[172:175]
 v_exp_f32 v187, v19
 v_mfma_f32_16x16x32_bf16 v[56:59], a[228:231], a[172:175], v[56:59]
 buffer_store_dwordx4 a[24:27], v251, s[52:55], s40 offen offset:2048 sc1
 v_exp_f32 v188, v20
 v_mfma_f32_16x16x32_bf16 v[56:59], a[232:235], a[180:183], v[56:59]
 ds_read_b128 a[192:195], v217 offset:0
 v_cvt_pk_bf16_f32 v145, v186, v187
 v_mfma_f32_16x16x32_bf16 v[56:59], a[236:239], a[188:191], v[56:59]
 v_exp_f32 v189, v21
 v_mfma_f32_16x16x32_bf16 v[48:51], a[236:239], a[184:187], v[168:171]
 ds_read_b128 a[196:199], v217 offset:8192
 ds_read_b128 a[200:203], v217 offset:1024
 v_mfma_f32_16x16x32_bf16 v[48:51], a[232:235], a[176:179], v[48:51]
 buffer_load_dwordx4 v219, s[56:59], s66 offen offset:2048 sc1 lds
 v_exp_f32 v190, v22
 v_mfma_f32_16x16x32_bf16 v[48:51], a[228:231], a[168:171], v[48:51]
 s_waitcnt lgkmcnt(3)
 ds_read_b128 a[204:207], v217 offset:9216
 v_cvt_pk_bf16_f32 v146, v188, v189
 v_mfma_f32_16x16x32_bf16 v[48:51], a[224:227], a[160:163], v[48:51]
 v_exp_f32 v191, v23
 v_mfma_f32_16x16x32_bf16 v[60:63], a[240:243], a[164:167], v[172:175]
 buffer_store_dwordx4 a[28:31], v251, s[52:55], s40 offen offset:3072 sc1
 v_mfma_f32_16x16x32_bf16 v[60:63], a[244:247], a[172:175], v[60:63]
 v_exp_f32 v184, v40
 v_mfma_f32_16x16x32_bf16 v[60:63], a[248:251], a[180:183], v[60:63]
 buffer_load_dwordx4 v219, s[56:59], s66 offen offset:3072 sc1 lds
 v_cvt_pk_bf16_f32 v147, v190, v191
 v_exp_f32 v185, v41
 v_mfma_f32_16x16x32_bf16 v[60:63], a[252:255], a[188:191], v[60:63]
 s_add_u32 s66, s66, 32768
 ds_read_b128 a[208:211], v217 offset:2048
 ds_read_b128 a[212:215], v217 offset:10240
 v_mfma_f32_16x16x32_bf16 v[192:195], v[208:211], v[144:147], v[192:195]
 v_exp_f32 v186, v42
 v_mfma_f32_16x16x32_bf16 v[52:55], a[252:255], a[184:187], v[168:171]
 v_exp_f32 v187, v43
 v_mfma_f32_16x16x32_bf16 v[52:55], a[248:251], a[176:179], v[52:55]
 s_waitcnt lgkmcnt(2)
 ds_read_b128 a[216:219], v217 offset:3072
 s_nop 1
 v_max_f32 v250, v196, v192
 v_mfma_f32_16x16x32_bf16 v[52:55], a[244:247], a[168:171], v[52:55]
 ds_read_b128 a[220:223], v217 offset:11264
 v_cmp_lt_f32 vcc, s75, v250
 v_mfma_f32_16x16x32_bf16 v[52:55], a[240:243], a[160:163], v[52:55]
 s_cbranch_vccnz Lrare39
Lback40:
 v_add_f32 v213, v213, v196
 v_add_f32 v212, v212, v192
 s_cmp_eq_u32 s62, 6
 s_cbranch_scc1 Lj641
.p2align 3
Lp215:
 v_mfma_f32_16x16x32_bf16 a[68:71], a[192:195], v[132:135], a[68:71]
 ds_read_b128 a[224:227], v217 offset:4096
 v_cvt_pk_bf16_f32 v140, v184, v185
 v_mfma_f32_16x16x32_bf16 a[68:71], a[196:199], v[148:151], a[68:71]
 v_exp_f32 v188, v44
 v_mfma_f32_16x16x32_bf16 a[64:67], a[196:199], v[144:147], a[64:67]
 ds_read_b128 a[228:231], v217 offset:12288
 v_cvt_pk_bf16_f32 v141, v186, v187
 v_mfma_f32_16x16x32_bf16 a[64:67], a[192:195], v[128:131], a[64:67]
 v_exp_f32 v189, v45
 v_mfma_f32_16x16x32_bf16 a[76:79], a[200:203], v[132:135], a[76:79]
 ds_read_b128 a[232:235], v217 offset:5120
 ds_read_b128 a[236:239], v217 offset:13312
 v_mfma_f32_16x16x32_bf16 a[76:79], a[204:207], v[148:151], a[76:79]
 v_exp_f32 v190, v46
 v_mfma_f32_16x16x32_bf16 a[72:75], a[204:207], v[144:147], a[72:75]
 s_waitcnt lgkmcnt(4)
 ds_read_b128 a[240:243], v217 offset:6144
 v_cvt_pk_bf16_f32 v142, v188, v189
 v_mfma_f32_16x16x32_bf16 a[72:75], a[200:203], v[128:131], a[72:75]
 v_exp_f32 v191, v47
 v_mfma_f32_16x16x32_bf16 a[84:87], a[208:211], v[132:135], a[84:87]
 v_exp_f32 v184, v32
 v_mfma_f32_16x16x32_bf16 a[84:87], a[212:215], v[148:151], a[84:87]
 ds_read_b128 a[244:247], v217 offset:14336
 v_cvt_pk_bf16_f32 v143, v190, v191
 v_mfma_f32_16x16x32_bf16 a[80:83], a[212:215], v[144:147], a[80:83]
 v_exp_f32 v185, v33
 v_mfma_f32_16x16x32_bf16 a[80:83], a[208:211], v[128:131], a[80:83]
 ds_read_b128 a[248:251], v217 offset:7168
 ds_read_b128 a[252:255], v217 offset:15360
 v_mfma_f32_16x16x32_bf16 v[196:199], v[208:211], v[140:143], 0
 v_mfma_f32_16x16x32_bf16 a[92:95], a[216:219], v[132:135], a[92:95]
 v_exp_f32 v186, v34
 v_mfma_f32_16x16x32_bf16 a[92:95], a[220:223], v[148:151], a[92:95]
 v_cvt_pk_bf16_f32 v136, v184, v185
 v_mfma_f32_16x16x32_bf16 a[88:91], a[220:223], v[144:147], a[88:91]
 s_waitcnt lgkmcnt(4)
 v_exp_f32 v187, v35
 v_mfma_f32_16x16x32_bf16 a[88:91], a[216:219], v[128:131], a[88:91]
 s_waitcnt vmcnt(8)
 v_mfma_f32_16x16x32_bf16 a[100:103], a[224:227], v[132:135], a[100:103]
 s_barrier
 ds_read_b128 a[192:195], v217 offset:49152
 ds_read_b128 a[196:199], v217 offset:50176
 v_mfma_f32_16x16x32_bf16 a[100:103], a[228:231], v[148:151], a[100:103]
 s_add_u32 m0, s67, 32768
 v_exp_f32 v188, v36
 v_mfma_f32_16x16x32_bf16 a[96:99], a[228:231], v[144:147], a[96:99]
 buffer_load_dwordx4 v218, s[56:59], s66 offen offset:0 sc1 lds
 v_mfma_f32_16x16x32_bf16 a[96:99], a[224:227], v[128:131], a[96:99]
 ds_read_b128 a[200:203], v217 offset:51200
 v_cvt_pk_bf16_f32 v137, v186, v187
 v_mfma_f32_16x16x32_bf16 a[108:111], a[232:235], v[132:135], a[108:111]
 v_exp_f32 v189, v37
 v_mfma_f32_16x16x32_bf16 a[108:111], a[236:239], v[148:151], a[108:111]
 v_exp_f32 v190, v38
 v_mfma_f32_16x16x32_bf16 a[104:107], a[236:239], v[144:147], a[104:107]
 s_waitcnt lgkmcnt(3)
 ds_read_b128 a[204:207], v217 offset:52224
 v_cvt_pk_bf16_f32 v138, v188, v189
 v_mfma_f32_16x16x32_bf16 a[104:107], a[232:235], v[128:131], a[104:107]
 v_exp_f32 v191, v39
 v_mfma_f32_16x16x32_bf16 a[116:119], a[240:243], v[132:135], a[116:119]
 buffer_load_dwordx4 v218, s[56:59], s66 offen offset:1024 sc1 lds
 v_mfma_f32_16x16x32_bf16 a[116:119], a[244:247], v[148:151], a[116:119]
 v_exp_f32 v184, v56
 v_mfma_f32_16x16x32_bf16 a[112:115], a[244:247], v[144:147], a[112:115]
 ds_read_b128 a[208:211], v217 offset:53248
 v_cvt_pk_bf16_f32 v139, v190, v191
 v_mfma_f32_16x16x32_bf16 a[112:115], a[240:243], v[128:131], a[112:115]
 v_exp_f32 v185, v57
 v_mfma_f32_16x16x32_bf16 a[124:127], a[248:251], v[132:135], a[124:127]
 ds_read_b128 a[212:215], v217 offset:54272
 ds_read_b128 a[216:219], v217 offset:55296
 v_mfma_f32_16x16x32_bf16 v[192:195], v[208:211], v[136:139], 0
 v_exp_f32 v186, v58
 v_mfma_f32_16x16x32_bf16 a[124:127], a[252:255], v[148:151], a[124:127]
 ds_read_b128 a[220:223], v217 offset:56320
 v_cvt_pk_bf16_f32 v148, v184, v185
 v_mfma_f32_16x16x32_bf16 a[120:123], a[252:255], v[144:147], a[120:123]
 buffer_load_dwordx4 v218, s[56:59], s66 offen offset:2048 sc1 lds
 v_mfma_f32_16x16x32_bf16 a[120:123], a[248:251], v[128:131], a[120:123]
 s_waitcnt lgkmcnt(4)
 v_exp_f32 v187, v59
 v_mfma_f32_16x16x32_bf16 v[8:11], a[192:195], a[164:167], v[172:175]
 v_exp_f32 v188, v60
 v_mfma_f32_16x16x32_bf16 v[8:11], a[196:199], a[172:175], v[8:11]
 ds_read_b128 a[224:227], v217 offset:57344
 v_cvt_pk_bf16_f32 v149, v186, v187
 v_mfma_f32_16x16x32_bf16 v[8:11], a[200:203], a[180:183], v[8:11]
 buffer_load_dwordx4 v218, s[56:59], s66 offen offset:3072 sc1 lds
 v_mfma_f32_16x16x32_bf16 v[8:11], a[204:207], a[188:191], v[8:11]
 v_exp_f32 v189, v61
 v_mfma_f32_16x16x32_bf16 v[0:3], a[204:207], a[184:187], v[168:171]
 ds_read_b128 a[228:231], v217 offset:58368
 ds_read_b128 a[232:235], v217 offset:59392
 v_mfma_f32_16x16x32_bf16 v[0:3], a[200:203], a[176:179], v[0:3]
 s_add_u32 m0, s67, 36864
 v_exp_f32 v190, v62
 v_mfma_f32_16x16x32_bf16 v[0:3], a[196:199], a[168:171], v[0:3]
 s_waitcnt lgkmcnt(3)
 ds_read_b128 a[236:239], v217 offset:60416
 v_cvt_pk_bf16_f32 v150, v188, v189
 v_mfma_f32_16x16x32_bf16 v[0:3], a[192:195], a[160:163], v[0:3]
 v_exp_f32 v191, v63
 v_mfma_f32_16x16x32_bf16 v[12:15], a[208:211], a[164:167], v[172:175]
 v_exp_f32 v184, v48
 v_mfma_f32_16x16x32_bf16 v[12:15], a[212:215], a[172:175], v[12:15]
 buffer_load_dwordx4 v219, s[56:59], s66 offen offset:0 sc1 lds
 v_mfma_f32_16x16x32_bf16 v[12:15], a[216:219], a[180:183], v[12:15]
 ds_read_b128 a[240:243], v217 offset:61440
 v_cvt_pk_bf16_f32 v151, v190, v191
 v_mfma_f32_16x16x32_bf16 v[12:15], a[220:223], a[188:191], v[12:15]
 v_exp_f32 v185, v49
 v_mfma_f32_16x16x32_bf16 v[4:7], a[220:223], a[184:187], v[168:171]
 ds_read_b128 a[244:247], v217 offset:62464
 ds_read_b128 a[248:251], v217 offset:63488
 v_mfma_f32_16x16x32_bf16 v[196:199], v[208:211], v[148:151], v[196:199]
 v_exp_f32 v186, v50
 v_mfma_f32_16x16x32_bf16 v[4:7], a[216:219], a[176:179], v[4:7]
 ds_read_b128 a[252:255], v217 offset:64512
 v_cvt_pk_bf16_f32 v144, v184, v185
 v_mfma_f32_16x16x32_bf16 v[4:7], a[212:215], a[168:171], v[4:7]
 buffer_load_dwordx4 v219, s[56:59], s66 offen offset:1024 sc1 lds
 v_mfma_f32_16x16x32_bf16 v[4:7], a[208:211], a[160:163], v[4:7]
 s_waitcnt lgkmcnt(4)
 v_exp_f32 v187, v51
 v_mfma_f32_16x16x32_bf16 v[24:27], a[224:227], a[164:167], v[172:175]
 v_exp_f32 v188, v52
 v_mfma_f32_16x16x32_bf16 v[24:27], a[228:231], a[172:175], v[24:27]
 ds_read_b128 a[192:195], v217 offset:32768
 v_cvt_pk_bf16_f32 v145, v186, v187
 v_mfma_f32_16x16x32_bf16 v[24:27], a[232:235], a[180:183], v[24:27]
 v_exp_f32 v189, v53
 v_mfma_f32_16x16x32_bf16 v[24:27], a[236:239], a[188:191], v[24:27]
 ds_read_b128 a[196:199], v217 offset:40960
 ds_read_b128 a[200:203], v217 offset:33792
 v_mfma_f32_16x16x32_bf16 v[16:19], a[236:239], a[184:187], v[168:171]
 buffer_load_dwordx4 v219, s[56:59], s66 offen offset:2048 sc1 lds
 v_mfma_f32_16x16x32_bf16 v[16:19], a[232:235], a[176:179], v[16:19]
 v_exp_f32 v190, v54
 v_mfma_f32_16x16x32_bf16 v[16:19], a[228:231], a[168:171], v[16:19]
 s_waitcnt lgkmcnt(3)
 ds_read_b128 a[204:207], v217 offset:41984
 v_cvt_pk_bf16_f32 v146, v188, v189
 v_mfma_f32_16x16x32_bf16 v[16:19], a[224:227], a[160:163], v[16:19]
 v_exp_f32 v191, v55
 v_mfma_f32_16x16x32_bf16 v[28:31], a[240:243], a[164:167], v[172:175]
 v_exp_f32 v184, v8
 v_mfma_f32_16x16x32_bf16 v[28:31], a[244:247], a[172:175], v[28:31]
 buffer_load_dwordx4 v219, s[56:59], s66 offen offset:3072 sc1 lds
 v_mfma_f32_16x16x32_bf16 v[28:31], a[248:251], a[180:183], v[28:31]
 v_cvt_pk_bf16_f32 v147, v190, v191
 v_exp_f32 v185, v9
 v_mfma_f32_16x16x32_bf16 v[28:31], a[252:255], a[188:191], v[28:31]
 s_add_u32 s66, s66, 32768
 ds_read_b128 a[208:211], v217 offset:34816
 ds_read_b128 a[212:215], v217 offset:43008
 v_mfma_f32_16x16x32_bf16 v[192:195], v[208:211], v[144:147], v[192:195]
 s_xor_b32 s67, s67, 0x10000
 v_exp_f32 v186, v10
 v_mfma_f32_16x16x32_bf16 v[20:23], a[252:255], a[184:187], v[168:171]
 v_exp_f32 v187, v11
 v_mfma_f32_16x16x32_bf16 v[20:23], a[248:251], a[176:179], v[20:23]
 s_waitcnt lgkmcnt(2)
 ds_read_b128 a[216:219], v217 offset:35840
 s_nop 0
 v_max_f32 v250, v196, v192
 v_mfma_f32_16x16x32_bf16 v[20:23], a[244:247], a[168:171], v[20:23]
 ds_read_b128 a[220:223], v217 offset:44032
 v_cmp_lt_f32 vcc, s75, v250
 v_mfma_f32_16x16x32_bf16 v[20:23], a[240:243], a[160:163], v[20:23]
 s_cbranch_vccnz Lrare42
Lback43:
 v_add_f32 v213, v213, v196
 v_add_f32 v212, v212, v192
 v_mfma_f32_16x16x32_bf16 a[68:71], a[192:195], v[140:143], a[68:71]
 ds_read_b128 a[224:227], v217 offset:36864
 v_cvt_pk_bf16_f32 v132, v184, v185
 v_mfma_f32_16x16x32_bf16 a[68:71], a[196:199], v[148:151], a[68:71]
 s_sub_u32 s74, s74, 1
 v_exp_f32 v188, v12
 v_mfma_f32_16x16x32_bf16 a[64:67], a[196:199], v[144:147], a[64:67]
 ds_read_b128 a[228:231], v217 offset:45056
 v_cvt_pk_bf16_f32 v133, v186, v187
 v_mfma_f32_16x16x32_bf16 a[64:67], a[192:195], v[136:139], a[64:67]
 v_exp_f32 v189, v13
 v_mfma_f32_16x16x32_bf16 a[76:79], a[200:203], v[140:143], a[76:79]
 ds_read_b128 a[232:235], v217 offset:37888
 ds_read_b128 a[236:239], v217 offset:46080
 v_mfma_f32_16x16x32_bf16 a[76:79], a[204:207], v[148:151], a[76:79]
 v_exp_f32 v190, v14
 v_mfma_f32_16x16x32_bf16 a[72:75], a[204:207], v[144:147], a[72:75]
 s_waitcnt lgkmcnt(4)
 ds_read_b128 a[240:243], v217 offset:38912
 v_cvt_pk_bf16_f32 v134, v188, v189
 v_mfma_f32_16x16x32_bf16 a[72:75], a[200:203], v[136:139], a[72:75]
 v_exp_f32 v191, v15
 v_mfma_f32_16x16x32_bf16 a[84:87], a[208:211], v[140:143], a[84:87]
 v_exp_f32 v184, v0
 v_mfma_f32_16x16x32_bf16 a[84:87], a[212:215], v[148:151], a[84:87]
 ds_read_b128 a[244:247], v217 offset:47104
 v_cvt_pk_bf16_f32 v135, v190, v191
 v_mfma_f32_16x16x32_bf16 a[80:83], a[212:215], v[144:147], a[80:83]
 v_exp_f32 v185, v1
 v_mfma_f32_16x16x32_bf16 a[80:83], a[208:211], v[136:139], a[80:83]
 ds_read_b128 a[248:251], v217 offset:39936
 ds_read_b128 a[252:255], v217 offset:48128
 v_mfma_f32_16x16x32_bf16 v[196:199], v[208:211], v[132:135], 0
 v_mfma_f32_16x16x32_bf16 a[92:95], a[216:219], v[140:143], a[92:95]
 v_exp_f32 v186, v2
 v_mfma_f32_16x16x32_bf16 a[92:95], a[220:223], v[148:151], a[92:95]
 v_cvt_pk_bf16_f32 v128, v184, v185
 v_xor_b32 v217, 0x10000, v217
 v_mfma_f32_16x16x32_bf16 a[88:91], a[220:223], v[144:147], a[88:91]
 s_waitcnt lgkmcnt(4)
 v_exp_f32 v187, v3
 v_mfma_f32_16x16x32_bf16 a[88:91], a[216:219], v[136:139], a[88:91]
 s_waitcnt vmcnt(8)
 v_mfma_f32_16x16x32_bf16 a[100:103], a[224:227], v[140:143], a[100:103]
 s_barrier
 ds_read_b128 a[192:195], v217 offset:16384
 ds_read_b128 a[196:199], v217 offset:17408
 v_mfma_f32_16x16x32_bf16 a[100:103], a[228:231], v[148:151], a[100:103]
 s_add_u32 m0, s67, 0
 v_exp_f32 v188, v4
 v_mfma_f32_16x16x32_bf16 a[96:99], a[228:231], v[144:147], a[96:99]
 buffer_load_dwordx4 v218, s[56:59], s66 offen offset:0 sc1 lds
 v_mfma_f32_16x16x32_bf16 a[96:99], a[224:227], v[136:139], a[96:99]
 ds_read_b128 a[200:203], v217 offset:18432
 v_cvt_pk_bf16_f32 v129, v186, v187
 v_mfma_f32_16x16x32_bf16 a[108:111], a[232:235], v[140:143], a[108:111]
 v_exp_f32 v189, v5
 v_mfma_f32_16x16x32_bf16 a[108:111], a[236:239], v[148:151], a[108:111]
 v_exp_f32 v190, v6
 v_mfma_f32_16x16x32_bf16 a[104:107], a[236:239], v[144:147], a[104:107]
 s_waitcnt lgkmcnt(3)
 ds_read_b128 a[204:207], v217 offset:19456
 v_cvt_pk_bf16_f32 v130, v188, v189
 v_mfma_f32_16x16x32_bf16 a[104:107], a[232:235], v[136:139], a[104:107]
 v_exp_f32 v191, v7
 v_mfma_f32_16x16x32_bf16 a[116:119], a[240:243], v[140:143], a[116:119]
 buffer_load_dwordx4 v218, s[56:59], s66 offen offset:1024 sc1 lds
 v_mfma_f32_16x16x32_bf16 a[116:119], a[244:247], v[148:151], a[116:119]
 v_exp_f32 v184, v24
 v_mfma_f32_16x16x32_bf16 a[112:115], a[244:247], v[144:147], a[112:115]
 ds_read_b128 a[208:211], v217 offset:20480
 v_cvt_pk_bf16_f32 v131, v190, v191
 v_mfma_f32_16x16x32_bf16 a[112:115], a[240:243], v[136:139], a[112:115]
 v_exp_f32 v185, v25
 v_mfma_f32_16x16x32_bf16 a[124:127], a[248:251], v[140:143], a[124:127]
 ds_read_b128 a[212:215], v217 offset:21504
 ds_read_b128 a[216:219], v217 offset:22528
 v_mfma_f32_16x16x32_bf16 v[192:195], v[208:211], v[128:131], 0
 v_exp_f32 v186, v26
 v_mfma_f32_16x16x32_bf16 a[124:127], a[252:255], v[148:151], a[124:127]
 ds_read_b128 a[220:223], v217 offset:23552
 v_cvt_pk_bf16_f32 v148, v184, v185
 v_mfma_f32_16x16x32_bf16 a[120:123], a[252:255], v[144:147], a[120:123]
 buffer_load_dwordx4 v218, s[56:59], s66 offen offset:2048 sc1 lds
 v_mfma_f32_16x16x32_bf16 a[120:123], a[248:251], v[136:139], a[120:123]
 s_waitcnt lgkmcnt(4)
 v_exp_f32 v187, v27
 v_mfma_f32_16x16x32_bf16 v[40:43], a[192:195], a[164:167], v[172:175]
 v_exp_f32 v188, v28
 v_mfma_f32_16x16x32_bf16 v[40:43], a[196:199], a[172:175], v[40:43]
 ds_read_b128 a[224:227], v217 offset:24576
 v_cvt_pk_bf16_f32 v149, v186, v187
 v_mfma_f32_16x16x32_bf16 v[40:43], a[200:203], a[180:183], v[40:43]
 buffer_load_dwordx4 v218, s[56:59], s66 offen offset:3072 sc1 lds
 v_mfma_f32_16x16x32_bf16 v[40:43], a[204:207], a[188:191], v[40:43]
 v_exp_f32 v189, v29
 v_mfma_f32_16x16x32_bf16 v[32:35], a[204:207], a[184:187], v[168:171]
 ds_read_b128 a[228:231], v217 offset:25600
 ds_read_b128 a[232:235], v217 offset:26624
 v_mfma_f32_16x16x32_bf16 v[32:35], a[200:203], a[176:179], v[32:35]
 s_add_u32 m0, s67, 4096
 v_exp_f32 v190, v30
 v_mfma_f32_16x16x32_bf16 v[32:35], a[196:199], a[168:171], v[32:35]
 s_waitcnt lgkmcnt(3)
 ds_read_b128 a[236:239], v217 offset:27648
 v_cvt_pk_bf16_f32 v150, v188, v189
 v_mfma_f32_16x16x32_bf16 v[32:35], a[192:195], a[160:163], v[32:35]
 v_exp_f32 v191, v31
 v_mfma_f32_16x16x32_bf16 v[44:47], a[208:211], a[164:167], v[172:175]
 v_exp_f32 v184, v16
 v_mfma_f32_16x16x32_bf16 v[44:47], a[212:215], a[172:175], v[44:47]
 buffer_load_dwordx4 v219, s[56:59], s66 offen offset:0 sc1 lds
 v_mfma_f32_16x16x32_bf16 v[44:47], a[216:219], a[180:183], v[44:47]
 ds_read_b128 a[240:243], v217 offset:28672
 v_cvt_pk_bf16_f32 v151, v190, v191
 v_mfma_f32_16x16x32_bf16 v[44:47], a[220:223], a[188:191], v[44:47]
 v_exp_f32 v185, v17
 v_mfma_f32_16x16x32_bf16 v[36:39], a[220:223], a[184:187], v[168:171]
 ds_read_b128 a[244:247], v217 offset:29696
 ds_read_b128 a[248:251], v217 offset:30720
 v_mfma_f32_16x16x32_bf16 v[196:199], v[208:211], v[148:151], v[196:199]
 v_exp_f32 v186, v18
 v_mfma_f32_16x16x32_bf16 v[36:39], a[216:219], a[176:179], v[36:39]
 ds_read_b128 a[252:255], v217 offset:31744
 v_cvt_pk_bf16_f32 v144, v184, v185
 v_mfma_f32_16x16x32_bf16 v[36:39], a[212:215], a[168:171], v[36:39]
 buffer_load_dwordx4 v219, s[56:59], s66 offen offset:1024 sc1 lds
 v_mfma_f32_16x16x32_bf16 v[36:39], a[208:211], a[160:163], v[36:39]
 s_waitcnt lgkmcnt(4)
 v_exp_f32 v187, v19
 v_mfma_f32_16x16x32_bf16 v[56:59], a[224:227], a[164:167], v[172:175]
 v_exp_f32 v188, v20
 v_mfma_f32_16x16x32_bf16 v[56:59], a[228:231], a[172:175], v[56:59]
 ds_read_b128 a[192:195], v217 offset:0
 v_cvt_pk_bf16_f32 v145, v186, v187
 v_mfma_f32_16x16x32_bf16 v[56:59], a[232:235], a[180:183], v[56:59]
 v_exp_f32 v189, v21
 v_mfma_f32_16x16x32_bf16 v[56:59], a[236:239], a[188:191], v[56:59]
 ds_read_b128 a[196:199], v217 offset:8192
 ds_read_b128 a[200:203], v217 offset:1024
 v_mfma_f32_16x16x32_bf16 v[48:51], a[236:239], a[184:187], v[168:171]
 buffer_load_dwordx4 v219, s[56:59], s66 offen offset:2048 sc1 lds
 v_mfma_f32_16x16x32_bf16 v[48:51], a[232:235], a[176:179], v[48:51]
 v_exp_f32 v190, v22
 v_mfma_f32_16x16x32_bf16 v[48:51], a[228:231], a[168:171], v[48:51]
 s_waitcnt lgkmcnt(3)
 ds_read_b128 a[204:207], v217 offset:9216
 v_cvt_pk_bf16_f32 v146, v188, v189
 v_mfma_f32_16x16x32_bf16 v[48:51], a[224:227], a[160:163], v[48:51]
 v_exp_f32 v191, v23
 v_mfma_f32_16x16x32_bf16 v[60:63], a[240:243], a[164:167], v[172:175]
 v_exp_f32 v184, v40
 v_mfma_f32_16x16x32_bf16 v[60:63], a[244:247], a[172:175], v[60:63]
 buffer_load_dwordx4 v219, s[56:59], s66 offen offset:3072 sc1 lds
 v_mfma_f32_16x16x32_bf16 v[60:63], a[248:251], a[180:183], v[60:63]
 v_cvt_pk_bf16_f32 v147, v190, v191
 v_exp_f32 v185, v41
 v_mfma_f32_16x16x32_bf16 v[60:63], a[252:255], a[188:191], v[60:63]
 s_add_u32 s66, s66, 32768
 ds_read_b128 a[208:211], v217 offset:2048
 ds_read_b128 a[212:215], v217 offset:10240
 v_mfma_f32_16x16x32_bf16 v[192:195], v[208:211], v[144:147], v[192:195]
 v_exp_f32 v186, v42
 v_mfma_f32_16x16x32_bf16 v[52:55], a[252:255], a[184:187], v[168:171]
 v_exp_f32 v187, v43
 v_mfma_f32_16x16x32_bf16 v[52:55], a[248:251], a[176:179], v[52:55]
 s_cmp_lg_u32 s74, 0
 ds_read_b128 a[216:219], v217 offset:3072
 s_nop 1
 v_max_f32 v250, v196, v192
 v_mfma_f32_16x16x32_bf16 v[52:55], a[244:247], a[168:171], v[52:55]
 s_waitcnt lgkmcnt(3)
 ds_read_b128 a[220:223], v217 offset:11264
 v_cmp_lt_f32 vcc, s75, v250
 v_mfma_f32_16x16x32_bf16 v[52:55], a[240:243], a[160:163], v[52:55]
 s_cbranch_vccnz Lrare44
Lback45:
 v_add_f32 v213, v213, v196
 v_add_f32 v212, v212, v192
 s_cbranch_scc1 Lp215
 v_mfma_f32_16x16x32_bf16 a[68:71], a[192:195], v[132:135], a[68:71]
 ds_read_b128 a[224:227], v217 offset:4096
 v_cvt_pk_bf16_f32 v140, v184, v185
 v_mfma_f32_16x16x32_bf16 a[68:71], a[196:199], v[148:151], a[68:71]
 v_exp_f32 v188, v44
 v_mfma_f32_16x16x32_bf16 a[64:67], a[196:199], v[144:147], a[64:67]
 buffer_load_dword v239, v238, s[52:55], s43 offen sc1
 v_mfma_f32_16x16x32_bf16 a[64:67], a[192:195], v[128:131], a[64:67]
 ds_read_b128 a[228:231], v217 offset:12288
 v_cvt_pk_bf16_f32 v141, v186, v187
 v_mfma_f32_16x16x32_bf16 a[76:79], a[200:203], v[132:135], a[76:79]
 v_exp_f32 v189, v45
 v_mfma_f32_16x16x32_bf16 a[76:79], a[204:207], v[148:151], a[76:79]
 ds_read_b128 a[232:235], v217 offset:5120
 ds_read_b128 a[236:239], v217 offset:13312
 v_mfma_f32_16x16x32_bf16 a[72:75], a[204:207], v[144:147], a[72:75]
 s_waitcnt lgkmcnt(4)
 v_exp_f32 v190, v46
 v_mfma_f32_16x16x32_bf16 a[72:75], a[200:203], v[128:131], a[72:75]
 ds_read_b128 a[240:243], v217 offset:6144
 v_cvt_pk_bf16_f32 v142, v188, v189
 v_mfma_f32_16x16x32_bf16 a[84:87], a[208:211], v[132:135], a[84:87]
 v_exp_f32 v191, v47
 v_mfma_f32_16x16x32_bf16 a[84:87], a[212:215], v[148:151], a[84:87]
 v_exp_f32 v184, v32
 v_mfma_f32_16x16x32_bf16 a[80:83], a[212:215], v[144:147], a[80:83]
 ds_read_b128 a[244:247], v217 offset:14336
 v_cvt_pk_bf16_f32 v143, v190, v191
 v_mfma_f32_16x16x32_bf16 a[80:83], a[208:211], v[128:131], a[80:83]
 v_exp_f32 v185, v33
 v_mfma_f32_16x16x32_bf16 a[92:95], a[216:219], v[132:135], a[92:95]
 ds_read_b128 a[248:251], v217 offset:7168
 ds_read_b128 a[252:255], v217 offset:15360
 v_mfma_f32_16x16x32_bf16 v[196:199], v[208:211], v[140:143], 0
 v_exp_f32 v186, v34
 v_mfma_f32_16x16x32_bf16 a[92:95], a[220:223], v[148:151], a[92:95]
 v_cvt_pk_bf16_f32 v136, v184, v185
 v_mfma_f32_16x16x32_bf16 a[88:91], a[220:223], v[144:147], a[88:91]
 s_waitcnt lgkmcnt(4)
 v_exp_f32 v187, v35
 v_mfma_f32_16x16x32_bf16 a[88:91], a[216:219], v[128:131], a[88:91]
 s_waitcnt vmcnt(9)
 v_mfma_f32_16x16x32_bf16 a[100:103], a[224:227], v[132:135], a[100:103]
 s_barrier
 ds_read_b128 a[192:195], v217 offset:49152
 ds_read_b128 a[196:199], v217 offset:50176
 v_mfma_f32_16x16x32_bf16 a[100:103], a[228:231], v[148:151], a[100:103]
 s_add_u32 m0, s67, 32768
 v_exp_f32 v188, v36
 v_mfma_f32_16x16x32_bf16 a[96:99], a[228:231], v[144:147], a[96:99]
 buffer_load_dwordx4 v218, s[56:59], s66 offen offset:0 sc1 lds
 v_mfma_f32_16x16x32_bf16 a[96:99], a[224:227], v[128:131], a[96:99]
 s_waitcnt vmcnt(1)
 v_cvt_pk_bf16_f32 v137, v186, v187
 v_cmp_gt_u32 vcc, 128, v239
 v_mfma_f32_16x16x32_bf16 a[108:111], a[232:235], v[132:135], a[108:111]
 v_exp_f32 v189, v37
 v_mfma_f32_16x16x32_bf16 a[108:111], a[236:239], v[148:151], a[108:111]
 s_cbranch_vccnz Lrps46
Lrpb47:
 v_exp_f32 v190, v38
 v_mfma_f32_16x16x32_bf16 a[104:107], a[236:239], v[144:147], a[104:107]
 s_waitcnt lgkmcnt(2)
 ds_read_b128 a[200:203], v217 offset:51200
 ds_read_b128 a[204:207], v217 offset:52224
 v_mfma_f32_16x16x32_bf16 a[104:107], a[232:235], v[128:131], a[104:107]
 ds_read_b128 a[208:211], v217 offset:53248
 v_cvt_pk_bf16_f32 v138, v188, v189
 v_mfma_f32_16x16x32_bf16 a[116:119], a[240:243], v[132:135], a[116:119]
 buffer_load_dwordx4 a[128:131], v251, s[52:55], s71 offen offset:0 sc1
 v_mfma_f32_16x16x32_bf16 a[116:119], a[244:247], v[148:151], a[116:119]
 buffer_load_dwordx4 v218, s[56:59], s66 offen offset:1024 sc1 lds
 v_exp_f32 v191, v39
 v_mfma_f32_16x16x32_bf16 a[112:115], a[244:247], v[144:147], a[112:115]
 v_exp_f32 v184, v56
 v_mfma_f32_16x16x32_bf16 a[112:115], a[240:243], v[128:131], a[112:115]
 ds_read_b128 a[212:215], v217 offset:54272
 v_cvt_pk_bf16_f32 v139, v190, v191
 v_mfma_f32_16x16x32_bf16 a[124:127], a[248:251], v[132:135], a[124:127]
 v_exp_f32 v185, v57
 v_mfma_f32_16x16x32_bf16 a[124:127], a[252:255], v[148:151], a[124:127]
 buffer_load_dwordx4 a[132:135], v251, s[52:55], s71 offen offset:1024 sc1
 v_mfma_f32_16x16x32_bf16 v[192:195], v[208:211], v[136:139], 0
 v_exp_f32 v186, v58
 v_mfma_f32_16x16x32_bf16 a[120:123], a[252:255], v[144:147], a[120:123]
 s_waitcnt lgkmcnt(2)
 ds_read_b128 a[216:219], v217 offset:55296
 ds_read_b128 a[220:223], v217 offset:56320
 v_mfma_f32_16x16x32_bf16 a[120:123], a[248:251], v[128:131], a[120:123]
 buffer_load_dwordx4 v218, s[56:59], s66 offen offset:2048 sc1 lds
 v_mfma_f32_16x16x32_bf16 v[8:11], a[192:195], a[164:167], v[172:175]
 ds_read_b128 a[224:227], v217 offset:57344
 v_cvt_pk_bf16_f32 v148, v184, v185
 v_exp_f32 v187, v59
 v_mfma_f32_16x16x32_bf16 v[8:11], a[196:199], a[172:175], v[8:11]
 v_exp_f32 v188, v60
 v_mfma_f32_16x16x32_bf16 v[8:11], a[200:203], a[180:183], v[8:11]
 buffer_load_dwordx4 a[136:139], v251, s[52:55], s71 offen offset:2048 sc1
 v_mfma_f32_16x16x32_bf16 v[8:11], a[204:207], a[188:191], v[8:11]
 ds_read_b128 a[228:231], v217 offset:58368
 v_cvt_pk_bf16_f32 v149, v186, v187
 v_mfma_f32_16x16x32_bf16 v[0:3], a[204:207], a[184:187], v[168:171]
 buffer_load_dwordx4 v218, s[56:59], s66 offen offset:3072 sc1 lds
 v_exp_f32 v189, v61
 v_mfma_f32_16x16x32_bf16 v[0:3], a[200:203], a[176:179], v[0:3]
 s_add_u32 m0, s67, 36864
 v_exp_f32 v190, v62
 v_mfma_f32_16x16x32_bf16 v[0:3], a[196:199], a[168:171], v[0:3]
 s_waitcnt lgkmcnt(2)
 ds_read_b128 a[232:235], v217 offset:59392
 ds_read_b128 a[236:239], v217 offset:60416
 v_mfma_f32_16x16x32_bf16 v[0:3], a[192:195], a[160:163], v[0:3]
 ds_read_b128 a[240:243], v217 offset:61440
 v_cvt_pk_bf16_f32 v150, v188, v189
 v_mfma_f32_16x16x32_bf16 v[12:15], a[208:211], a[164:167], v[172:175]
 buffer_load_dwordx4 a[140:143], v251, s[52:55], s71 offen offset:3072 sc1
 v_exp_f32 v191, v63
 v_mfma_f32_16x16x32_bf16 v[12:15], a[212:215], a[172:175], v[12:15]
 s_add_u32 s71, s71, 4096
 v_exp_f32 v184, v48
 v_mfma_f32_16x16x32_bf16 v[12:15], a[216:219], a[180:183], v[12:15]
 buffer_load_dwordx4 v219, s[56:59], s66 offen offset:0 sc1 lds
 v_mfma_f32_16x16x32_bf16 v[12:15], a[220:223], a[188:191], v[12:15]
 ds_read_b128 a[244:247], v217 offset:62464
 v_cvt_pk_bf16_f32 v151, v190, v191
 v_mfma_f32_16x16x32_bf16 v[4:7], a[220:223], a[184:187], v[168:171]
 v_exp_f32 v185, v49
 v_mfma_f32_16x16x32_bf16 v[4:7], a[216:219], a[176:179], v[4:7]
 buffer_load_dwordx4 a[144:147], v251, s[52:55], s71 offen offset:0 sc1
 v_mfma_f32_16x16x32_bf16 v[196:199], v[208:211], v[148:151], v[196:199]
 v_exp_f32 v186, v50
 v_mfma_f32_16x16x32_bf16 v[4:7], a[212:215], a[168:171], v[4:7]
 s_waitcnt lgkmcnt(2)
 ds_read_b128 a[248:251], v217 offset:63488
 ds_read_b128 a[252:255], v217 offset:64512
 v_mfma_f32_16x16x32_bf16 v[4:7], a[208:211], a[160:163], v[4:7]
 ds_read_b128 a[192:195], v217 offset:32768
 buffer_load_dwordx4 v219, s[56:59], s66 offen offset:1024 sc1 lds
 v_cvt_pk_bf16_f32 v144, v184, v185
 v_mfma_f32_16x16x32_bf16 v[24:27], a[224:227], a[164:167], v[172:175]
 v_exp_f32 v187, v51
 v_mfma_f32_16x16x32_bf16 v[24:27], a[228:231], a[172:175], v[24:27]
 v_exp_f32 v188, v52
 v_mfma_f32_16x16x32_bf16 v[24:27], a[232:235], a[180:183], v[24:27]
 buffer_load_dwordx4 a[148:151], v251, s[52:55], s71 offen offset:1024 sc1
 v_mfma_f32_16x16x32_bf16 v[24:27], a[236:239], a[188:191], v[24:27]
 ds_read_b128 a[196:199], v217 offset:40960
 v_cvt_pk_bf16_f32 v145, v186, v187
 v_exp_f32 v189, v53
 v_mfma_f32_16x16x32_bf16 v[16:19], a[236:239], a[184:187], v[168:171]
 buffer_load_dwordx4 v219, s[56:59], s66 offen offset:2048 sc1 lds
 v_mfma_f32_16x16x32_bf16 v[16:19], a[232:235], a[176:179], v[16:19]
 v_exp_f32 v190, v54
 v_mfma_f32_16x16x32_bf16 v[16:19], a[228:231], a[168:171], v[16:19]
 s_waitcnt lgkmcnt(2)
 ds_read_b128 a[200:203], v217 offset:33792
 v_cvt_pk_bf16_f32 v146, v188, v189
 v_mfma_f32_16x16x32_bf16 v[16:19], a[224:227], a[160:163], v[16:19]
 buffer_load_dwordx4 a[152:155], v251, s[52:55], s71 offen offset:2048 sc1
 v_exp_f32 v191, v55
 v_mfma_f32_16x16x32_bf16 v[28:31], a[240:243], a[164:167], v[172:175]
 ds_read_b128 a[204:207], v217 offset:41984
 ds_read_b128 a[208:211], v217 offset:34816
 v_mfma_f32_16x16x32_bf16 v[28:31], a[244:247], a[172:175], v[28:31]
 v_exp_f32 v184, v8
 v_mfma_f32_16x16x32_bf16 v[28:31], a[248:251], a[180:183], v[28:31]
 buffer_load_dwordx4 v219, s[56:59], s66 offen offset:3072 sc1 lds
 v_cvt_pk_bf16_f32 v147, v190, v191
 v_exp_f32 v185, v9
 v_mfma_f32_16x16x32_bf16 v[28:31], a[252:255], a[188:191], v[28:31]
 buffer_load_dwordx4 a[156:159], v251, s[52:55], s71 offen offset:3072 sc1
 v_mfma_f32_16x16x32_bf16 v[192:195], v[208:211], v[144:147], v[192:195]
 s_add_u32 s66, s66, 32768
 v_exp_f32 v186, v10
 v_mfma_f32_16x16x32_bf16 v[20:23], a[252:255], a[184:187], v[168:171]
 s_xor_b32 s67, s67, 0x10000
 v_exp_f32 v187, v11
 v_mfma_f32_16x16x32_bf16 v[20:23], a[248:251], a[176:179], v[20:23]
 s_add_u32 s71, s71, 4096
 ds_read_b128 a[212:215], v217 offset:43008
 ds_read_b128 a[216:219], v217 offset:35840
 v_mfma_f32_16x16x32_bf16 v[20:23], a[244:247], a[168:171], v[20:23]
 s_waitcnt lgkmcnt(3)
 ds_read_b128 a[220:223], v217 offset:44032
 v_max_f32 v250, v196, v192
 v_cmp_lt_f32 vcc, s75, v250
 v_mfma_f32_16x16x32_bf16 v[20:23], a[240:243], a[160:163], v[20:23]
 s_cbranch_vccnz Lrare48
Lback49:
 v_add_f32 v213, v213, v196
 v_add_f32 v212, v212, v192
 v_mfma_f32_16x16x32_bf16 a[68:71], a[192:195], v[140:143], a[68:71]
 ds_read_b128 a[224:227], v217 offset:36864
 v_cvt_pk_bf16_f32 v132, v184, v185
 v_mfma_f32_16x16x32_bf16 a[68:71], a[196:199], v[148:151], a[68:71]
 buffer_load_dwordx4 v[64:67], v251, s[52:55], s71 offen offset:0 sc1
 v_mfma_f32_16x16x32_bf16 a[64:67], a[196:199], v[144:147], a[64:67]
 v_exp_f32 v188, v12
 v_mfma_f32_16x16x32_bf16 a[64:67], a[192:195], v[136:139], a[64:67]
 ds_read_b128 a[228:231], v217 offset:45056
 v_cvt_pk_bf16_f32 v133, v186, v187
 v_mfma_f32_16x16x32_bf16 a[76:79], a[200:203], v[140:143], a[76:79]
 v_exp_f32 v189, v13
 v_mfma_f32_16x16x32_bf16 a[76:79], a[204:207], v[148:151], a[76:79]
 ds_read_b128 a[232:235], v217 offset:37888
 ds_read_b128 a[236:239], v217 offset:46080
 v_mfma_f32_16x16x32_bf16 a[72:75], a[204:207], v[144:147], a[72:75]
 s_waitcnt lgkmcnt(4)
 v_exp_f32 v190, v14
 v_mfma_f32_16x16x32_bf16 a[72:75], a[200:203], v[136:139], a[72:75]
 ds_read_b128 a[240:243], v217 offset:38912
 v_cvt_pk_bf16_f32 v134, v188, v189
 v_mfma_f32_16x16x32_bf16 a[84:87], a[208:211], v[140:143], a[84:87]
 v_exp_f32 v191, v15
 v_mfma_f32_16x16x32_bf16 a[84:87], a[212:215], v[148:151], a[84:87]
 buffer_load_dwordx4 v[68:71], v251, s[52:55], s71 offen offset:1024 sc1
 v_mfma_f32_16x16x32_bf16 a[80:83], a[212:215], v[144:147], a[80:83]
 v_exp_f32 v184, v0
 v_mfma_f32_16x16x32_bf16 a[80:83], a[208:211], v[136:139], a[80:83]
 ds_read_b128 a[244:247], v217 offset:47104
 v_cvt_pk_bf16_f32 v135, v190, v191
 v_mfma_f32_16x16x32_bf16 a[92:95], a[216:219], v[140:143], a[92:95]
 v_exp_f32 v185, v1
 v_mfma_f32_16x16x32_bf16 a[92:95], a[220:223], v[148:151], a[92:95]
 ds_read_b128 a[248:251], v217 offset:39936
 ds_read_b128 a[252:255], v217 offset:48128
 v_mfma_f32_16x16x32_bf16 v[196:199], v[208:211], v[132:135], 0
 v_exp_f32 v186, v2
 v_mfma_f32_16x16x32_bf16 a[88:91], a[220:223], v[144:147], a[88:91]
 s_waitcnt lgkmcnt(4)
 v_xor_b32 v217, 0x10000, v217
 v_cvt_pk_bf16_f32 v128, v184, v185
 v_mfma_f32_16x16x32_bf16 a[88:91], a[216:219], v[136:139], a[88:91]
 s_waitcnt vmcnt(18)
 v_exp_f32 v187, v3
 v_mfma_f32_16x16x32_bf16 a[100:103], a[224:227], v[140:143], a[100:103]
 s_barrier
 ds_read_b128 a[192:195], v217 offset:16384
 ds_read_b128 a[196:199], v217 offset:17408
 v_mfma_f32_16x16x32_bf16 a[100:103], a[228:231], v[148:151], a[100:103]
 buffer_load_dwordx4 v[72:75], v251, s[52:55], s71 offen offset:2048 sc1
 v_mfma_f32_16x16x32_bf16 a[96:99], a[228:231], v[144:147], a[96:99]
 s_add_u32 m0, s67, 0
 v_exp_f32 v188, v4
 v_mfma_f32_16x16x32_bf16 a[96:99], a[224:227], v[136:139], a[96:99]
 buffer_load_dwordx4 v218, s[56:59], s66 offen offset:0 sc1 lds
 v_mfma_f32_16x16x32_bf16 a[108:111], a[232:235], v[140:143], a[108:111]
 ds_read_b128 a[200:203], v217 offset:18432
 v_cvt_pk_bf16_f32 v129, v186, v187
 v_mfma_f32_16x16x32_bf16 a[108:111], a[236:239], v[148:151], a[108:111]
 v_exp_f32 v189, v5
 v_mfma_f32_16x16x32_bf16 a[104:107], a[236:239], v[144:147], a[104:107]
 s_waitcnt lgkmcnt(3)
 v_exp_f32 v190, v6
 v_mfma_f32_16x16x32_bf16 a[104:107], a[232:235], v[136:139], a[104:107]
 ds_read_b128 a[204:207], v217 offset:19456
 v_cvt_pk_bf16_f32 v130, v188, v189
 v_mfma_f32_16x16x32_bf16 a[116:119], a[240:243], v[140:143], a[116:119]
 v_exp_f32 v191, v7
 v_mfma_f32_16x16x32_bf16 a[116:119], a[244:247], v[148:151], a[116:119]
 buffer_load_dwordx4 v218, s[56:59], s66 offen offset:1024 sc1 lds
 v_mfma_f32_16x16x32_bf16 a[112:115], a[244:247], v[144:147], a[112:115]
 buffer_load_dwordx4 v[76:79], v251, s[52:55], s71 offen offset:3072 sc1
 v_exp_f32 v184, v24
 v_mfma_f32_16x16x32_bf16 a[112:115], a[240:243], v[136:139], a[112:115]
 ds_read_b128 a[208:211], v217 offset:20480
 v_cvt_pk_bf16_f32 v131, v190, v191
 v_mfma_f32_16x16x32_bf16 a[124:127], a[248:251], v[140:143], a[124:127]
 v_exp_f32 v185, v25
 v_mfma_f32_16x16x32_bf16 a[124:127], a[252:255], v[148:151], a[124:127]
 s_add_u32 s71, s71, 4096
 ds_read_b128 a[212:215], v217 offset:21504
 ds_read_b128 a[216:219], v217 offset:22528
 v_mfma_f32_16x16x32_bf16 v[192:195], v[208:211], v[128:131], 0
 v_exp_f32 v186, v26
 v_mfma_f32_16x16x32_bf16 a[120:123], a[252:255], v[144:147], a[120:123]
 s_waitcnt lgkmcnt(3)
 ds_read_b128 a[220:223], v217 offset:23552
 v_cvt_pk_bf16_f32 v148, v184, v185
 v_mfma_f32_16x16x32_bf16 a[120:123], a[248:251], v[136:139], a[120:123]
 buffer_load_dwordx4 v218, s[56:59], s66 offen offset:2048 sc1 lds
 v_mfma_f32_16x16x32_bf16 v[40:43], a[192:195], a[164:167], v[172:175]
 v_exp_f32 v187, v27
 v_mfma_f32_16x16x32_bf16 v[40:43], a[196:199], a[172:175], v[40:43]
 buffer_load_dwordx4 v[80:83], v251, s[52:55], s71 offen offset:0 sc1
 v_mfma_f32_16x16x32_bf16 v[40:43], a[200:203], a[180:183], v[40:43]
 v_exp_f32 v188, v28
 v_mfma_f32_16x16x32_bf16 v[40:43], a[204:207], a[188:191], v[40:43]
 ds_read_b128 a[224:227], v217 offset:24576
 v_cvt_pk_bf16_f32 v149, v186, v187
 v_mfma_f32_16x16x32_bf16 v[32:35], a[204:207], a[184:187], v[168:171]
 buffer_load_dwordx4 v218, s[56:59], s66 offen offset:3072 sc1 lds
 v_exp_f32 v189, v29
 v_mfma_f32_16x16x32_bf16 v[32:35], a[200:203], a[176:179], v[32:35]
 s_add_u32 m0, s67, 4096
 ds_read_b128 a[228:231], v217 offset:25600
 ds_read_b128 a[232:235], v217 offset:26624
 v_mfma_f32_16x16x32_bf16 v[32:35], a[196:199], a[168:171], v[32:35]
 s_waitcnt lgkmcnt(3)
 v_exp_f32 v190, v30
 v_mfma_f32_16x16x32_bf16 v[32:35], a[192:195], a[160:163], v[32:35]
 ds_read_b128 a[236:239], v217 offset:27648
 v_cvt_pk_bf16_f32 v150, v188, v189
 v_mfma_f32_16x16x32_bf16 v[44:47], a[208:211], a[164:167], v[172:175]
 v_exp_f32 v191, v31
 v_mfma_f32_16x16x32_bf16 v[44:47], a[212:215], a[172:175], v[44:47]
 buffer_load_dwordx4 v[84:87], v251, s[52:55], s71 offen offset:1024 sc1
 v_exp_f32 v184, v16
 v_mfma_f32_16x16x32_bf16 v[44:47], a[216:219], a[180:183], v[44:47]
 buffer_load_dwordx4 v219, s[56:59], s66 offen offset:0 sc1 lds
 v_mfma_f32_16x16x32_bf16 v[44:47], a[220:223], a[188:191], v[44:47]
 ds_read_b128 a[240:243], v217 offset:28672
 v_cvt_pk_bf16_f32 v151, v190, v191
 v_mfma_f32_16x16x32_bf16 v[36:39], a[220:223], a[184:187], v[168:171]
 v_exp_f32 v185, v17
 v_mfma_f32_16x16x32_bf16 v[36:39], a[216:219], a[176:179], v[36:39]
 ds_read_b128 a[244:247], v217 offset:29696
 ds_read_b128 a[248:251], v217 offset:30720
 v_mfma_f32_16x16x32_bf16 v[196:199], v[208:211], v[148:151], v[196:199]
 v_exp_f32 v186, v18
 v_mfma_f32_16x16x32_bf16 v[36:39], a[212:215], a[168:171], v[36:39]
 s_waitcnt lgkmcnt(3)
 ds_read_b128 a[252:255], v217 offset:31744
 v_cvt_pk_bf16_f32 v144, v184, v185
 v_mfma_f32_16x16x32_bf16 v[36:39], a[208:211], a[160:163], v[36:39]
 buffer_load_dwordx4 v219, s[56:59], s66 offen offset:1024 sc1 lds
 v_mfma_f32_16x16x32_bf16 v[56:59], a[224:227], a[164:167], v[172:175]
 v_exp_f32 v187, v19
 v_mfma_f32_16x16x32_bf16 v[56:59], a[228:231], a[172:175], v[56:59]
 buffer_load_dwordx4 v[88:91], v251, s[52:55], s71 offen offset:2048 sc1
 v_exp_f32 v188, v20
 v_mfma_f32_16x16x32_bf16 v[56:59], a[232:235], a[180:183], v[56:59]
 ds_read_b128 a[192:195], v217 offset:0
 v_cvt_pk_bf16_f32 v145, v186, v187
 v_mfma_f32_16x16x32_bf16 v[56:59], a[236:239], a[188:191], v[56:59]
 v_exp_f32 v189, v21
 v_mfma_f32_16x16x32_bf16 v[48:51], a[236:239], a[184:187], v[168:171]
 ds_read_b128 a[196:199], v217 offset:8192
 ds_read_b128 a[200:203], v217 offset:1024
 v_mfma_f32_16x16x32_bf16 v[48:51], a[232:235], a[176:179], v[48:51]
 buffer_load_dwordx4 v219, s[56:59], s66 offen offset:2048 sc1 lds
 v_exp_f32 v190, v22
 v_mfma_f32_16x16x32_bf16 v[48:51], a[228:231], a[168:171], v[48:51]
 s_waitcnt lgkmcnt(3)
 ds_read_b128 a[204:207], v217 offset:9216
 v_cvt_pk_bf16_f32 v146, v188, v189
 v_mfma_f32_16x16x32_bf16 v[48:51], a[224:227], a[160:163], v[48:51]
 v_exp_f32 v191, v23
 v_mfma_f32_16x16x32_bf16 v[60:63], a[240:243], a[164:167], v[172:175]
 v_exp_f32 v184, v40
 v_mfma_f32_16x16x32_bf16 v[60:63], a[244:247], a[172:175], v[60:63]
 buffer_load_dwordx4 v[92:95], v251, s[52:55], s71 offen offset:3072 sc1
 v_mfma_f32_16x16x32_bf16 v[60:63], a[248:251], a[180:183], v[60:63]
 buffer_load_dwordx4 v219, s[56:59], s66 offen offset:3072 sc1 lds
 v_cvt_pk_bf16_f32 v147, v190, v191
 v_exp_f32 v185, v41
 v_mfma_f32_16x16x32_bf16 v[60:63], a[252:255], a[188:191], v[60:63]
 s_add_u32 s66, s66, 32768
 ds_read_b128 a[208:211], v217 offset:2048
 ds_read_b128 a[212:215], v217 offset:10240
 v_mfma_f32_16x16x32_bf16 v[192:195], v[208:211], v[144:147], v[192:195]
 v_exp_f32 v186, v42
 v_mfma_f32_16x16x32_bf16 v[52:55], a[252:255], a[184:187], v[168:171]
 s_add_u32 s71, s71, 4096
 v_exp_f32 v187, v43
 v_mfma_f32_16x16x32_bf16 v[52:55], a[248:251], a[176:179], v[52:55]
 s_waitcnt lgkmcnt(2)
 ds_read_b128 a[216:219], v217 offset:3072
 s_nop 0
 v_max_f32 v250, v196, v192
 v_mfma_f32_16x16x32_bf16 v[52:55], a[244:247], a[168:171], v[52:55]
 ds_read_b128 a[220:223], v217 offset:11264
 v_cmp_lt_f32 vcc, s75, v250
 v_mfma_f32_16x16x32_bf16 v[52:55], a[240:243], a[160:163], v[52:55]
 s_cbranch_vccnz Lrare50
Lback51:
 v_add_f32 v213, v213, v196
 v_add_f32 v212, v212, v192
Lm235:
 v_mfma_f32_16x16x32_bf16 a[68:71], a[192:195], v[132:135], a[68:71]
 ds_read_b128 a[224:227], v217 offset:4096
 v_cndmask_b32 v0, v220, v168, s[8:9]
 v_mfma_f32_16x16x32_bf16 a[68:71], a[196:199], v[148:151], a[68:71]
 buffer_load_dwordx4 v[96:99], v251, s[52:55], s71 offen offset:0 sc1
 v_mfma_f32_16x16x32_bf16 a[64:67], a[196:199], v[144:147], a[64:67]
 ds_read_b128 a[228:231], v217 offset:12288
 v_cvt_pk_bf16_f32 v140, v184, v185
 v_mfma_f32_16x16x32_bf16 a[64:67], a[192:195], v[128:131], a[64:67]
 v_exp_f32 v188, v44
 v_mfma_f32_16x16x32_bf16 a[76:79], a[200:203], v[132:135], a[76:79]
 v_cvt_pk_bf16_f32 v141, v186, v187
 v_cndmask_b32 v1, v220, v168, s[10:11]
 v_mfma_f32_16x16x32_bf16 a[76:79], a[204:207], v[148:151], a[76:79]
 v_exp_f32 v189, v45
 v_mfma_f32_16x16x32_bf16 a[72:75], a[204:207], v[144:147], a[72:75]
 s_waitcnt lgkmcnt(2)
 ds_read_b128 a[232:235], v217 offset:5120
 ds_read_b128 a[236:239], v217 offset:13312
 v_mfma_f32_16x16x32_bf16 a[72:75], a[200:203], v[128:131], a[72:75]
 v_exp_f32 v190, v46
 v_mfma_f32_16x16x32_bf16 a[84:87], a[208:211], v[132:135], a[84:87]
 v_cvt_pk_bf16_f32 v142, v188, v189
 v_cndmask_b32 v2, v220, v168, s[12:13]
 v_mfma_f32_16x16x32_bf16 a[84:87], a[212:215], v[148:151], a[84:87]
 v_exp_f32 v191, v47
 v_mfma_f32_16x16x32_bf16 a[80:83], a[212:215], v[144:147], a[80:83]
 buffer_load_dwordx4 v[100:103], v251, s[52:55], s71 offen offset:1024 sc1
 v_mfma_f32_16x16x32_bf16 a[80:83], a[208:211], v[128:131], a[80:83]
 ds_read_b128 a[240:243], v217 offset:6144
 ds_read_b128 a[244:247], v217 offset:14336
 v_exp_f32 v184, v32
 v_mfma_f32_16x16x32_bf16 a[92:95], a[216:219], v[132:135], a[92:95]
 v_cvt_pk_bf16_f32 v143, v190, v191
 v_cndmask_b32 v3, v220, v168, s[14:15]
 v_mfma_f32_16x16x32_bf16 a[92:95], a[220:223], v[148:151], a[92:95]
 v_exp_f32 v185, v33
 v_mfma_f32_16x16x32_bf16 a[88:91], a[220:223], v[144:147], a[88:91]
 s_waitcnt lgkmcnt(2)
 ds_read_b128 a[248:251], v217 offset:7168
 ds_read_b128 a[252:255], v217 offset:15360
 v_mfma_f32_16x16x32_bf16 v[196:199], v[208:211], v[140:143], 0
 v_exp_f32 v186, v34
 v_mfma_f32_16x16x32_bf16 a[88:91], a[216:219], v[128:131], a[88:91]
 s_waitcnt vmcnt(10)
 v_cvt_pk_bf16_f32 v136, v184, v185
 v_cndmask_b32 v4, v220, v168, s[16:17]
 v_mfma_f32_16x16x32_bf16 a[100:103], a[224:227], v[132:135], a[100:103]
 s_barrier
 v_exp_f32 v187, v35
 v_mfma_f32_16x16x32_bf16 a[100:103], a[228:231], v[148:151], a[100:103]
 buffer_load_dwordx4 v[104:107], v251, s[52:55], s71 offen offset:2048 sc1
 v_mfma_f32_16x16x32_bf16 a[96:99], a[228:231], v[144:147], a[96:99]
 s_add_u32 m0, s67, 32768
 ds_read_b128 a[192:195], v217 offset:49152
 ds_read_b128 a[196:199], v217 offset:50176
 v_mfma_f32_16x16x32_bf16 a[96:99], a[224:227], v[128:131], a[96:99]
 v_exp_f32 v188, v36
 v_mfma_f32_16x16x32_bf16 a[108:111], a[232:235], v[132:135], a[108:111]
 buffer_load_dwordx4 v218, s[56:59], s66 offen offset:0 sc1 lds
 v_cvt_pk_bf16_f32 v137, v186, v187
 v_mfma_f32_16x16x32_bf16 a[108:111], a[236:239], v[148:151], a[108:111]
 ds_read_b128 a[200:203], v217 offset:51200
 v_cndmask_b32 v5, v220, v168, s[18:19]
 v_exp_f32 v189, v37
 v_mfma_f32_16x16x32_bf16 a[104:107], a[236:239], v[144:147], a[104:107]
 s_waitcnt lgkmcnt(3)
 v_exp_f32 v190, v38
 v_mfma_f32_16x16x32_bf16 a[104:107], a[232:235], v[128:131], a[104:107]
 ds_read_b128 a[204:207], v217 offset:52224
 v_cvt_pk_bf16_f32 v138, v188, v189
 v_mfma_f32_16x16x32_bf16 a[116:119], a[240:243], v[132:135], a[116:119]
 ds_read_b128 a[208:211], v217 offset:53248
 v_cndmask_b32 v6, v220, v168, s[20:21]
 v_mfma_f32_16x16x32_bf16 a[116:119], a[244:247], v[148:151], a[116:119]
 buffer_load_dwordx4 v218, s[56:59], s66 offen offset:1024 sc1 lds
 v_exp_f32 v191, v39
 v_mfma_f32_16x16x32_bf16 a[112:115], a[244:247], v[144:147], a[112:115]
 buffer_load_dwordx4 v[108:111], v251, s[52:55], s71 offen offset:3072 sc1
 v_exp_f32 v184, v56
 v_mfma_f32_16x16x32_bf16 a[112:115], a[240:243], v[128:131], a[112:115]
 v_cvt_pk_bf16_f32 v139, v190, v191
 v_cndmask_b32 v7, v220, v168, s[22:23]
 v_mfma_f32_16x16x32_bf16 a[124:127], a[248:251], v[132:135], a[124:127]
 v_exp_f32 v185, v57
 v_mfma_f32_16x16x32_bf16 a[124:127], a[252:255], v[148:151], a[124:127]
 s_add_u32 s71, s71, 4096
 ds_read_b128 a[212:215], v217 offset:54272
 ds_read_b128 a[216:219], v217 offset:55296
 v_mfma_f32_16x16x32_bf16 v[192:195], v[208:211], v[136:139], 0
 v_exp_f32 v186, v58
 v_mfma_f32_16x16x32_bf16 a[120:123], a[252:255], v[144:147], a[120:123]
 s_waitcnt lgkmcnt(3)
 ds_read_b128 a[220:223], v217 offset:56320
 v_cndmask_b32 v16, v220, v168, s[48:49]
 v_mfma_f32_16x16x32_bf16 a[120:123], a[248:251], v[128:131], a[120:123]
 buffer_load_dwordx4 v218, s[56:59], s66 offen offset:2048 sc1 lds
 v_mfma_f32_16x16x32_bf16 v[8:11], a[192:195], a[164:167], v[172:175]
 ds_read_b128 a[224:227], v217 offset:57344
 v_cvt_pk_bf16_f32 v148, v184, v185
 v_exp_f32 v187, v59
 v_mfma_f32_16x16x32_bf16 v[8:11], a[196:199], a[172:175], v[8:11]
 buffer_load_dwordx4 a[32:35], v251, s[52:55], s71 offen offset:0 sc1
 v_mfma_f32_16x16x32_bf16 v[8:11], a[200:203], a[180:183], v[8:11]
 v_exp_f32 v188, v60
 v_mfma_f32_16x16x32_bf16 v[8:11], a[204:207], a[188:191], v[8:11]
 v_cndmask_b32 v17, v220, v168, s[50:51]
 v_cvt_pk_bf16_f32 v149, v186, v187
 v_mfma_f32_16x16x32_bf16 v[0:3], a[204:207], a[184:187], v[0:3]
 buffer_load_dwordx4 v218, s[56:59], s66 offen offset:3072 sc1 lds
 v_exp_f32 v189, v61
 v_mfma_f32_16x16x32_bf16 v[0:3], a[200:203], a[176:179], v[0:3]
 s_add_u32 m0, s67, 36864
 ds_read_b128 a[228:231], v217 offset:58368
 ds_read_b128 a[232:235], v217 offset:59392
 v_mfma_f32_16x16x32_bf16 v[0:3], a[196:199], a[168:171], v[0:3]
 s_waitcnt lgkmcnt(3)
 v_exp_f32 v190, v62
 v_mfma_f32_16x16x32_bf16 v[0:3], a[192:195], a[160:163], v[0:3]
 ds_read_b128 a[236:239], v217 offset:60416
 v_cndmask_b32 v18, v220, v168, s[82:83]
 v_cvt_pk_bf16_f32 v150, v188, v189
 v_mfma_f32_16x16x32_bf16 v[12:15], a[208:211], a[164:167], v[172:175]
 v_exp_f32 v191, v63
 v_mfma_f32_16x16x32_bf16 v[12:15], a[212:215], a[172:175], v[12:15]
 buffer_load_dwordx4 a[36:39], v251, s[52:55], s71 offen offset:1024 sc1
 v_exp_f32 v184, v48
 v_mfma_f32_16x16x32_bf16 v[12:15], a[216:219], a[180:183], v[12:15]
 buffer_load_dwordx4 v219, s[56:59], s66 offen offset:0 sc1 lds
 v_cndmask_b32 v19, v220, v168, s[84:85]
 v_mfma_f32_16x16x32_bf16 v[12:15], a[220:223], a[188:191], v[12:15]
 ds_read_b128 a[240:243], v217 offset:61440
 v_cvt_pk_bf16_f32 v151, v190, v191
 v_mfma_f32_16x16x32_bf16 v[4:7], a[220:223], a[184:187], v[4:7]
 v_exp_f32 v185, v49
 v_mfma_f32_16x16x32_bf16 v[4:7], a[216:219], a[176:179], v[4:7]
 ds_read_b128 a[244:247], v217 offset:62464
 v_cndmask_b32 v20, v220, v168, s[86:87]
 v_mfma_f32_16x16x32_bf16 v[196:199], v[208:211], v[148:151], v[196:199]
 v_exp_f32 v186, v50
 v_mfma_f32_16x16x32_bf16 v[4:7], a[212:215], a[168:171], v[4:7]
 s_waitcnt lgkmcnt(2)
 ds_read_b128 a[248:251], v217 offset:63488
 ds_read_b128 a[252:255], v217 offset:64512
 v_mfma_f32_16x16x32_bf16 v[4:7], a[208:211], a[160:163], v[4:7]
 buffer_load_dwordx4 v219, s[56:59], s66 offen offset:1024 sc1 lds
 v_cvt_pk_bf16_f32 v144, v184, v185
 v_cndmask_b32 v21, v220, v168, s[88:89]
 v_mfma_f32_16x16x32_bf16 v[24:27], a[224:227], a[164:167], v[172:175]
 v_exp_f32 v187, v51
 v_mfma_f32_16x16x32_bf16 v[24:27], a[228:231], a[172:175], v[24:27]
 buffer_load_dwordx4 a[40:43], v251, s[52:55], s71 offen offset:2048 sc1
 v_exp_f32 v188, v52
 v_mfma_f32_16x16x32_bf16 v[24:27], a[232:235], a[180:183], v[24:27]
 ds_read_b128 a[192:195], v217 offset:32768
 v_cvt_pk_bf16_f32 v145, v186, v187
 v_mfma_f32_16x16x32_bf16 v[24:27], a[236:239], a[188:191], v[24:27]
 v_exp_f32 v189, v53
 v_mfma_f32_16x16x32_bf16 v[16:19], a[236:239], a[184:187], v[16:19]
 ds_read_b128 a[196:199], v217 offset:33792
 v_cndmask_b32 v22, v220, v168, s[90:91]
 v_mfma_f32_16x16x32_bf16 v[16:19], a[232:235], a[176:179], v[16:19]
 buffer_load_dwordx4 v219, s[56:59], s66 offen offset:2048 sc1 lds
 v_exp_f32 v190, v54
 v_mfma_f32_16x16x32_bf16 v[16:19], a[228:231], a[168:171], v[16:19]
 s_waitcnt lgkmcnt(2)
 ds_read_b128 a[200:203], v217 offset:34816
 v_cvt_pk_bf16_f32 v146, v188, v189
 v_mfma_f32_16x16x32_bf16 v[16:19], a[224:227], a[160:163], v[16:19]
 v_exp_f32 v191, v55
 v_mfma_f32_16x16x32_bf16 v[28:31], a[240:243], a[164:167], v[172:175]
 ds_read_b128 a[204:207], v217 offset:35840
 v_cndmask_b32 v23, v220, v168, s[92:93]
 v_mfma_f32_16x16x32_bf16 v[28:31], a[244:247], a[172:175], v[28:31]
 buffer_load_dwordx4 a[44:47], v251, s[52:55], s71 offen offset:3072 sc1
 v_exp_f32 v184, v8
 v_mfma_f32_16x16x32_bf16 v[28:31], a[248:251], a[180:183], v[28:31]
 buffer_load_dwordx4 v219, s[56:59], s66 offen offset:3072 sc1 lds
 v_cvt_pk_bf16_f32 v147, v190, v191
 v_exp_f32 v185, v9
 v_mfma_f32_16x16x32_bf16 v[28:31], a[252:255], a[188:191], v[28:31]
 s_add_u32 s66, s66, 32768
 ds_read_b128 a[208:211], v217 offset:36864
 ds_read_b128 a[212:215], v217 offset:37888
 v_mfma_f32_16x16x32_bf16 v[192:195], v[208:211], v[144:147], v[192:195]
 s_xor_b32 s67, s67, 0x10000
 v_exp_f32 v186, v10
 v_mfma_f32_16x16x32_bf16 v[20:23], a[252:255], a[184:187], v[20:23]
 s_add_u32 s71, s71, 4096
 v_exp_f32 v187, v11
 v_mfma_f32_16x16x32_bf16 v[20:23], a[248:251], a[176:179], v[20:23]
 s_waitcnt lgkmcnt(2)
 ds_read_b128 a[216:219], v217 offset:38912
 v_max_f32 v250, v196, v192
 v_mfma_f32_16x16x32_bf16 v[20:23], a[244:247], a[168:171], v[20:23]
 ds_read_b128 a[220:223], v217 offset:39936
 v_cmp_lt_f32 vcc, s75, v250
 v_mfma_f32_16x16x32_bf16 v[20:23], a[240:243], a[160:163], v[20:23]
 s_cbranch_vccnz Lrare52
Lback53:
 v_add_f32 v213, v213, v196
 v_add_f32 v212, v212, v192
 v_mfma_f32_16x16x32_bf16 a[68:71], a[192:195], v[140:143], a[68:71]
 ds_read_b128 a[224:227], v217 offset:40960
 v_cndmask_b32 v40, v220, v172, s[8:9]
 v_mfma_f32_16x16x32_bf16 a[64:67], a[192:195], v[136:139], a[64:67]
 buffer_load_dwordx4 a[48:51], v251, s[52:55], s71 offen offset:0 sc1
 v_mfma_f32_16x16x32_bf16 a[76:79], a[196:199], v[140:143], a[76:79]
 ds_read_b128 a[228:231], v217 offset:41984
 v_cvt_pk_bf16_f32 v132, v184, v185
 v_mfma_f32_16x16x32_bf16 a[72:75], a[196:199], v[136:139], a[72:75]
 v_exp_f32 v188, v12
 v_mfma_f32_16x16x32_bf16 a[84:87], a[200:203], v[140:143], a[84:87]
 v_cvt_pk_bf16_f32 v133, v186, v187
 v_cndmask_b32 v41, v220, v172, s[10:11]
 v_mfma_f32_16x16x32_bf16 a[80:83], a[200:203], v[136:139], a[80:83]
 v_exp_f32 v189, v13
 v_mfma_f32_16x16x32_bf16 a[92:95], a[204:207], v[140:143], a[92:95]
 s_waitcnt lgkmcnt(2)
 ds_read_b128 a[232:235], v217 offset:43008
 ds_read_b128 a[236:239], v217 offset:44032
 v_mfma_f32_16x16x32_bf16 a[88:91], a[204:207], v[136:139], a[88:91]
 v_exp_f32 v190, v14
 v_mfma_f32_16x16x32_bf16 a[100:103], a[208:211], v[140:143], a[100:103]
 buffer_load_dwordx4 a[52:55], v251, s[52:55], s71 offen offset:1024 sc1
 v_cndmask_b32 v42, v220, v172, s[12:13]
 v_cvt_pk_bf16_f32 v134, v188, v189
 v_mfma_f32_16x16x32_bf16 a[96:99], a[208:211], v[136:139], a[96:99]
 v_exp_f32 v191, v15
 v_mfma_f32_16x16x32_bf16 a[108:111], a[212:215], v[140:143], a[108:111]
 ds_read_b128 a[240:243], v217 offset:45056
 v_cndmask_b32 v43, v220, v172, s[14:15]
 v_mfma_f32_16x16x32_bf16 a[104:107], a[212:215], v[136:139], a[104:107]
 v_exp_f32 v184, v0
 v_mfma_f32_16x16x32_bf16 a[116:119], a[216:219], v[140:143], a[116:119]
 ds_read_b128 a[244:247], v217 offset:46080
 v_cvt_pk_bf16_f32 v135, v190, v191
 v_mfma_f32_16x16x32_bf16 a[112:115], a[216:219], v[136:139], a[112:115]
 ds_read_b128 a[248:251], v217 offset:47104
 v_cndmask_b32 v44, v220, v172, s[16:17]
 v_mfma_f32_16x16x32_bf16 a[124:127], a[220:223], v[140:143], a[124:127]
 ds_read_b128 a[252:255], v217 offset:48128
 buffer_load_dwordx4 a[56:59], v251, s[52:55], s71 offen offset:2048 sc1
 v_xor_b32 v217, 0x10000, v217
 v_exp_f32 v185, v1
 v_mfma_f32_16x16x32_bf16 a[120:123], a[220:223], v[136:139], a[120:123]
 s_waitcnt vmcnt(19)
 s_waitcnt lgkmcnt(4)
 v_cndmask_b32 v45, v220, v172, s[18:19]
 v_mfma_f32_16x16x32_bf16 v[196:199], v[208:211], v[132:135], 0
 v_exp_f32 v186, v2
 v_mfma_f32_16x16x32_bf16 a[68:71], a[224:227], v[148:151], a[68:71]
 s_barrier
 v_cvt_pk_bf16_f32 v128, v184, v185
 v_cndmask_b32 v46, v220, v172, s[20:21]
 v_mfma_f32_16x16x32_bf16 a[64:67], a[224:227], v[144:147], a[64:67]
 v_exp_f32 v187, v3
 v_mfma_f32_16x16x32_bf16 a[76:79], a[228:231], v[148:151], a[76:79]
 ds_read_b128 a[192:195], v217 offset:16384
 ds_read_b128 a[196:199], v217 offset:17408
 v_mfma_f32_16x16x32_bf16 a[72:75], a[228:231], v[144:147], a[72:75]
 v_exp_f32 v188, v4
 v_mfma_f32_16x16x32_bf16 a[84:87], a[232:235], v[148:151], a[84:87]
 buffer_load_dwordx4 a[60:63], v251, s[52:55], s71 offen offset:3072 sc1
 v_mfma_f32_16x16x32_bf16 a[80:83], a[232:235], v[144:147], a[80:83]
 s_add_u32 s71, s71, 4096
 v_cvt_pk_bf16_f32 v129, v186, v187
 v_cndmask_b32 v47, v220, v172, s[22:23]
 v_exp_f32 v189, v5
 v_mfma_f32_16x16x32_bf16 a[92:95], a[236:239], v[148:151], a[92:95]
 s_waitcnt lgkmcnt(2)
 ds_read_b128 a[200:203], v217 offset:18432
 ds_read_b128 a[204:207], v217 offset:19456
 v_mfma_f32_16x16x32_bf16 a[88:91], a[236:239], v[144:147], a[88:91]
 v_exp_f32 v190, v6
 v_mfma_f32_16x16x32_bf16 a[100:103], a[240:243], v[148:151], a[100:103]
 v_cndmask_b32 v56, v220, v172, s[48:49]
 v_cvt_pk_bf16_f32 v130, v188, v189
 v_mfma_f32_16x16x32_bf16 a[96:99], a[240:243], v[144:147], a[96:99]
 v_exp_f32 v191, v7
 v_mfma_f32_16x16x32_bf16 a[108:111], a[244:247], v[148:151], a[108:111]
 buffer_load_dwordx4 v[152:155], v251, s[52:55], s71 offen offset:0 sc1
 v_cndmask_b32 v57, v220, v172, s[50:51]
 v_mfma_f32_16x16x32_bf16 a[104:107], a[244:247], v[144:147], a[104:107]
 ds_read_b128 a[208:211], v217 offset:20480
 ds_read_b128 a[212:215], v217 offset:21504
 ds_read_b128 a[216:219], v217 offset:22528
 ds_read_b128 a[220:223], v217 offset:23552
 v_exp_f32 v184, v24
 v_mfma_f32_16x16x32_bf16 a[116:119], a[248:251], v[148:151], a[116:119]
 v_cvt_pk_bf16_f32 v131, v190, v191
 v_cndmask_b32 v58, v220, v172, s[82:83]
 v_mfma_f32_16x16x32_bf16 a[112:115], a[248:251], v[144:147], a[112:115]
 v_exp_f32 v185, v25
 v_mfma_f32_16x16x32_bf16 a[124:127], a[252:255], v[148:151], a[124:127]
 s_waitcnt lgkmcnt(4)
 ds_read_b128 a[224:227], v217 offset:24576
 ds_read_b128 a[228:231], v217 offset:25600
 v_mfma_f32_16x16x32_bf16 v[192:195], v[208:211], v[128:131], 0
 ds_read_b128 a[232:235], v217 offset:26624
 ds_read_b128 a[236:239], v217 offset:27648
 v_mfma_f32_16x16x32_bf16 a[120:123], a[252:255], v[144:147], a[120:123]
 buffer_load_dwordx4 v[156:159], v251, s[52:55], s71 offen offset:1024 sc1
 v_exp_f32 v186, v26
 v_cndmask_b32 v59, v220, v172, s[84:85]
 v_mfma_f32_16x16x32_bf16 v[40:43], a[192:195], a[164:167], v[40:43]
 v_cvt_pk_bf16_f32 v148, v184, v185
 v_cndmask_b32 v60, v220, v172, s[86:87]
 v_mfma_f32_16x16x32_bf16 v[40:43], a[196:199], a[172:175], v[40:43]
 v_exp_f32 v187, v27
 v_mfma_f32_16x16x32_bf16 v[40:43], a[200:203], a[180:183], v[40:43]
 s_waitcnt lgkmcnt(4)
 v_exp_f32 v188, v28
 v_cvt_pk_bf16_f32 v149, v186, v187
 v_mfma_f32_16x16x32_bf16 v[40:43], a[204:207], a[188:191], v[40:43]
 ds_read_b128 a[240:243], v217 offset:28672
 ds_read_b128 a[244:247], v217 offset:29696
 ds_read_b128 a[248:251], v217 offset:30720
 ds_read_b128 a[252:255], v217 offset:31744
 v_exp_f32 v189, v29
 v_exp_f32 v190, v30
 v_mfma_f32_16x16x32_bf16 v[44:47], a[208:211], a[164:167], v[44:47]
 v_cvt_pk_bf16_f32 v150, v188, v189
 v_cndmask_b32 v61, v220, v172, s[88:89]
 v_exp_f32 v191, v31
 v_mfma_f32_16x16x32_bf16 v[44:47], a[212:215], a[172:175], v[44:47]
 buffer_load_dwordx4 v[160:163], v251, s[52:55], s71 offen offset:2048 sc1
 v_exp_f32 v184, v16
 v_mfma_f32_16x16x32_bf16 v[44:47], a[216:219], a[180:183], v[44:47]
 s_waitcnt lgkmcnt(4)
 v_cvt_pk_bf16_f32 v151, v190, v191
 v_cndmask_b32 v62, v220, v172, s[90:91]
 v_exp_f32 v185, v17
 v_mfma_f32_16x16x32_bf16 v[44:47], a[220:223], a[188:191], v[44:47]
 ds_read_b128 a[192:195], v217 offset:0
 v_cndmask_b32 v63, v220, v172, s[92:93]
 v_mfma_f32_16x16x32_bf16 v[196:199], v[208:211], v[148:151], v[196:199]
 v_exp_f32 v186, v18
 v_mfma_f32_16x16x32_bf16 v[56:59], a[224:227], a[164:167], v[56:59]
 ds_read_b128 a[196:199], v217 offset:8192
 v_cvt_pk_bf16_f32 v144, v184, v185
 v_exp_f32 v187, v19
 v_mfma_f32_16x16x32_bf16 v[56:59], a[228:231], a[172:175], v[56:59]
 v_exp_f32 v188, v20
 v_cvt_pk_bf16_f32 v145, v186, v187
 v_mfma_f32_16x16x32_bf16 v[56:59], a[232:235], a[180:183], v[56:59]
 s_waitcnt lgkmcnt(2)
 ds_read_b128 a[200:203], v217 offset:1024
 v_exp_f32 v189, v21
 v_exp_f32 v190, v22
 v_cvt_pk_bf16_f32 v146, v188, v189
 v_exp_f32 v191, v23
 v_exp_f32 v184, v40
 v_cvt_pk_bf16_f32 v147, v190, v191
 v_exp_f32 v185, v41
 v_mfma_f32_16x16x32_bf16 v[56:59], a[236:239], a[188:191], v[56:59]
 ds_read_b128 a[204:207], v217 offset:9216
 ds_read_b128 a[208:211], v217 offset:2048
 buffer_load_dwordx4 v[164:167], v251, s[52:55], s71 offen offset:3072 sc1
 v_mfma_f32_16x16x32_bf16 v[192:195], v[208:211], v[144:147], v[192:195]
 v_exp_f32 v186, v42
 v_mfma_f32_16x16x32_bf16 v[60:63], a[240:243], a[164:167], v[60:63]
 s_add_u32 s71, s71, 4096
 v_exp_f32 v187, v43
 v_mfma_f32_16x16x32_bf16 v[60:63], a[244:247], a[172:175], v[60:63]
 s_waitcnt lgkmcnt(1)
 ds_read_b128 a[212:215], v217 offset:10240
 s_nop 0
 v_max_f32 v250, v196, v192
 v_mfma_f32_16x16x32_bf16 v[60:63], a[248:251], a[180:183], v[60:63]
 ds_read_b128 a[216:219], v217 offset:3072
 v_cmp_lt_f32 vcc, s75, v250
 v_mfma_f32_16x16x32_bf16 v[60:63], a[252:255], a[188:191], v[60:63]
 s_cbranch_vccnz Lrare54
Lback55:
 ds_read_b128 a[220:223], v217 offset:11264
 v_add_f32 v213, v213, v196
 v_add_f32 v212, v212, v192
LdrB12:
 v_mfma_f32_16x16x32_bf16 a[64:67], a[192:195], v[128:131], a[64:67]
 ds_read_b128 a[224:227], v217 offset:4096
 ds_read_b128 a[228:231], v217 offset:12288
 v_mfma_f32_16x16x32_bf16 a[64:67], a[196:199], v[144:147], a[64:67]
 ds_read_b128 a[232:235], v217 offset:5120
 ds_read_b128 a[236:239], v217 offset:13312
 v_mfma_f32_16x16x32_bf16 a[72:75], a[200:203], v[128:131], a[72:75]
 s_waitcnt lgkmcnt(4)
 ds_read_b128 a[240:243], v217 offset:6144
 ds_read_b128 a[244:247], v217 offset:14336
 v_mfma_f32_16x16x32_bf16 a[72:75], a[204:207], v[144:147], a[72:75]
 ds_read_b128 a[248:251], v217 offset:7168
 ds_read_b128 a[252:255], v217 offset:15360
 v_rcp_f32 v212, v212
 v_cvt_pk_bf16_f32 v140, v184, v185
 v_mfma_f32_16x16x32_bf16 a[80:83], a[208:211], v[128:131], a[80:83]
 s_lshl_b32 s76, s65, 17
 s_lshl_b32 s77, s61, 12
 s_add_u32 s76, s76, s77
 s_add_u32 s76, s76, 37748736
 s_add_u32 s77, s76, 524288
 v_exp_f32 v188, v44
 v_mfma_f32_16x16x32_bf16 a[80:83], a[212:215], v[144:147], a[80:83]
 v_cvt_pk_bf16_f32 v141, v186, v187
 v_mfma_f32_16x16x32_bf16 a[88:91], a[216:219], v[128:131], a[88:91]
 s_waitcnt lgkmcnt(4)
 v_exp_f32 v189, v45
 v_mfma_f32_16x16x32_bf16 a[88:91], a[220:223], v[144:147], a[88:91]
 v_accvgpr_read_b32 v16, a64
 v_accvgpr_read_b32 v17, a65
 v_accvgpr_read_b32 v18, a66
 v_accvgpr_read_b32 v19, a67
 v_accvgpr_read_b32 v20, a72
 v_accvgpr_read_b32 v21, a73
 v_mfma_f32_16x16x32_bf16 a[96:99], a[224:227], v[128:131], a[96:99]
 v_accvgpr_read_b32 v22, a74
 v_accvgpr_read_b32 v23, a75
 v_mfma_f32_16x16x32_bf16 a[96:99], a[228:231], v[144:147], a[96:99]
 v_mul_f32 v16, v16, v212
 v_mul_f32 v17, v17, v212
 v_mfma_f32_16x16x32_bf16 a[104:107], a[232:235], v[128:131], a[104:107]
 s_waitcnt lgkmcnt(0)
 v_exp_f32 v190, v46
 v_mfma_f32_16x16x32_bf16 a[104:107], a[236:239], v[144:147], a[104:107]
 v_mul_f32 v18, v18, v212
 v_mul_f32 v19, v19, v212
 v_mfma_f32_16x16x32_bf16 a[112:115], a[240:243], v[128:131], a[112:115]
 v_mul_f32 v20, v20, v212
 v_cvt_pk_bf16_f32 v142, v188, v189
 v_mfma_f32_16x16x32_bf16 a[112:115], a[244:247], v[144:147], a[112:115]
 v_mul_f32 v21, v21, v212
 v_mul_f32 v22, v22, v212
 v_mfma_f32_16x16x32_bf16 a[120:123], a[248:251], v[128:131], a[120:123]
 v_exp_f32 v191, v47
 v_mul_f32 v23, v23, v212
 v_mfma_f32_16x16x32_bf16 a[120:123], a[252:255], v[144:147], a[120:123]
 v_cvt_pk_bf16_f32 v0, v16, v17
 v_cvt_pk_bf16_f32 v1, v18, v19
 v_mfma_f32_16x16x32_bf16 a[68:71], a[196:199], v[148:151], a[68:71]
 v_cvt_pk_bf16_f32 v2, v20, v21
 v_cvt_pk_bf16_f32 v3, v22, v23
 v_mfma_f32_16x16x32_bf16 a[76:79], a[204:207], v[148:151], a[76:79]
 v_exp_f32 v184, v56
 v_mfma_f32_16x16x32_bf16 a[84:87], a[212:215], v[148:151], a[84:87]
 buffer_store_dwordx4 v[0:3], v251, s[52:55], s76 offen offset:0 sc1
 v_mfma_f32_16x16x32_bf16 a[92:95], a[220:223], v[148:151], a[92:95]
 v_cvt_pk_bf16_f32 v143, v190, v191
 v_accvgpr_read_b32 v16, a80
 v_mfma_f32_16x16x32_bf16 a[100:103], a[228:231], v[148:151], a[100:103]
 v_accvgpr_read_b32 v17, a81
 v_accvgpr_read_b32 v18, a82
 v_exp_f32 v185, v57
 v_mfma_f32_16x16x32_bf16 a[108:111], a[236:239], v[148:151], a[108:111]
 v_accvgpr_read_b32 v19, a83
 v_accvgpr_read_b32 v20, a88
 v_mfma_f32_16x16x32_bf16 v[196:199], v[208:211], v[140:143], 0
 v_accvgpr_read_b32 v21, a89
 v_accvgpr_read_b32 v22, a90
 v_mfma_f32_16x16x32_bf16 a[116:119], a[244:247], v[148:151], a[116:119]
 v_exp_f32 v186, v58
 v_mfma_f32_16x16x32_bf16 a[124:127], a[252:255], v[148:151], a[124:127]
 s_waitcnt vmcnt(9)
 v_accvgpr_read_b32 v23, a91
 v_mul_f32 v16, v16, v212
 v_mfma_f32_16x16x32_bf16 a[68:71], a[192:195], v[132:135], a[68:71]
 s_barrier
 v_mul_f32 v17, v17, v212
 v_cvt_pk_bf16_f32 v148, v184, v185
 v_mfma_f32_16x16x32_bf16 a[76:79], a[200:203], v[132:135], a[76:79]
 ds_read_b128 a[192:195], v217 offset:32768
 ds_read_b128 a[196:199], v217 offset:40960
 ds_read_b128 a[200:203], v217 offset:33792
 ds_read_b128 a[204:207], v217 offset:41984
 v_mfma_f32_16x16x32_bf16 a[84:87], a[208:211], v[132:135], a[84:87]
 v_exp_f32 v187, v59
 v_mul_f32 v18, v18, v212
 v_mfma_f32_16x16x32_bf16 a[92:95], a[216:219], v[132:135], a[92:95]
 v_mul_f32 v19, v19, v212
 v_mul_f32 v20, v20, v212
 v_exp_f32 v188, v60
 v_mfma_f32_16x16x32_bf16 a[100:103], a[224:227], v[132:135], a[100:103]
 ds_read_b128 a[208:211], v217 offset:34816
 v_mul_f32 v21, v21, v212
 v_mfma_f32_16x16x32_bf16 a[108:111], a[232:235], v[132:135], a[108:111]
 s_waitcnt lgkmcnt(1)
 ds_read_b128 a[212:215], v217 offset:43008
 v_cvt_pk_bf16_f32 v149, v186, v187
 v_mul_f32 v22, v22, v212
 v_exp_f32 v189, v61
 v_mfma_f32_16x16x32_bf16 a[116:119], a[240:243], v[132:135], a[116:119]
 ds_read_b128 a[216:219], v217 offset:35840
 ds_read_b128 a[220:223], v217 offset:44032
 v_mul_f32 v23, v23, v212
 v_cvt_pk_bf16_f32 v4, v16, v17
 v_cvt_pk_bf16_f32 v5, v18, v19
 v_cvt_pk_bf16_f32 v6, v20, v21
 v_cvt_pk_bf16_f32 v7, v22, v23
 v_exp_f32 v190, v62
 v_cvt_pk_bf16_f32 v150, v188, v189
 v_exp_f32 v191, v63
 s_nop 0
 v_cvt_pk_bf16_f32 v151, v190, v191
 v_mfma_f32_16x16x32_bf16 a[124:127], a[248:251], v[132:135], a[124:127]
 buffer_store_dwordx4 v[4:7], v251, s[52:55], s76 offen offset:1024 sc1
 v_mfma_f32_16x16x32_bf16 v[196:199], v[208:211], v[148:151], v[196:199]
 s_nop 7
 v_cmp_lt_f32 vcc, s75, v196
 s_cbranch_vccnz Lrare56
Lback57:
 v_add_f32 v213, v213, v196
 v_mfma_f32_16x16x32_bf16 a[68:71], a[192:195], v[140:143], a[68:71]
 ds_read_b128 a[224:227], v217 offset:36864
 ds_read_b128 a[228:231], v217 offset:45056
 v_mfma_f32_16x16x32_bf16 a[68:71], a[196:199], v[148:151], a[68:71]
 ds_read_b128 a[232:235], v217 offset:37888
 ds_read_b128 a[236:239], v217 offset:46080
 v_mfma_f32_16x16x32_bf16 a[76:79], a[200:203], v[140:143], a[76:79]
 s_waitcnt lgkmcnt(4)
 ds_read_b128 a[240:243], v217 offset:38912
 ds_read_b128 a[244:247], v217 offset:47104
 v_mfma_f32_16x16x32_bf16 a[76:79], a[204:207], v[148:151], a[76:79]
 ds_read_b128 a[248:251], v217 offset:39936
 ds_read_b128 a[252:255], v217 offset:48128
 v_accvgpr_read_b32 v16, a96
 v_accvgpr_read_b32 v17, a97
 v_mfma_f32_16x16x32_bf16 a[84:87], a[208:211], v[140:143], a[84:87]
 v_accvgpr_read_b32 v18, a98
 v_accvgpr_read_b32 v19, a99
 v_mfma_f32_16x16x32_bf16 a[84:87], a[212:215], v[148:151], a[84:87]
 v_accvgpr_read_b32 v20, a104
 v_accvgpr_read_b32 v21, a105
 v_mfma_f32_16x16x32_bf16 a[92:95], a[216:219], v[140:143], a[92:95]
 s_waitcnt lgkmcnt(4)
 v_accvgpr_read_b32 v22, a106
 v_accvgpr_read_b32 v23, a107
 v_mfma_f32_16x16x32_bf16 a[92:95], a[220:223], v[148:151], a[92:95]
 v_mul_f32 v16, v16, v212
 v_mul_f32 v17, v17, v212
 v_mfma_f32_16x16x32_bf16 a[100:103], a[224:227], v[140:143], a[100:103]
 v_mul_f32 v18, v18, v212
 v_mul_f32 v19, v19, v212
 v_mfma_f32_16x16x32_bf16 a[100:103], a[228:231], v[148:151], a[100:103]
 v_mul_f32 v20, v20, v212
 v_mul_f32 v21, v21, v212
 v_mfma_f32_16x16x32_bf16 a[108:111], a[232:235], v[140:143], a[108:111]
 s_waitcnt lgkmcnt(0)
 v_mul_f32 v22, v22, v212
 v_mul_f32 v23, v23, v212
 v_mfma_f32_16x16x32_bf16 a[108:111], a[236:239], v[148:151], a[108:111]
 v_cvt_pk_bf16_f32 v0, v16, v17
 v_cvt_pk_bf16_f32 v1, v18, v19
 v_mfma_f32_16x16x32_bf16 a[116:119], a[240:243], v[140:143], a[116:119]
 v_mfma_f32_16x16x32_bf16 a[116:119], a[244:247], v[148:151], a[116:119]
 v_cvt_pk_bf16_f32 v2, v20, v21
 v_cvt_pk_bf16_f32 v3, v22, v23
 v_mfma_f32_16x16x32_bf16 a[124:127], a[248:251], v[140:143], a[124:127]
 buffer_store_dwordx4 v[0:3], v251, s[52:55], s76 offen offset:2048 sc1
 v_mfma_f32_16x16x32_bf16 a[124:127], a[252:255], v[148:151], a[124:127]
 v_accvgpr_read_b32 v16, a112
 v_accvgpr_read_b32 v17, a113
 v_accvgpr_read_b32 v18, a114
 v_accvgpr_read_b32 v19, a115
 v_accvgpr_read_b32 v20, a120
 v_accvgpr_read_b32 v21, a121
 v_accvgpr_read_b32 v22, a122
 v_accvgpr_read_b32 v23, a123
 v_pk_mul_f32 v[16:17], v[16:17], v[212:213] op_sel:[0,0] op_sel_hi:[1,0]
 v_pk_mul_f32 v[18:19], v[18:19], v[212:213] op_sel:[0,0] op_sel_hi:[1,0]
 v_pk_mul_f32 v[20:21], v[20:21], v[212:213] op_sel:[0,0] op_sel_hi:[1,0]
 v_pk_mul_f32 v[22:23], v[22:23], v[212:213] op_sel:[0,0] op_sel_hi:[1,0]
 v_cvt_pk_bf16_f32 v4, v16, v17
 v_cvt_pk_bf16_f32 v5, v18, v19
 v_cvt_pk_bf16_f32 v6, v20, v21
 v_cvt_pk_bf16_f32 v7, v22, v23
 buffer_store_dwordx4 v[4:7], v251, s[52:55], s76 offen offset:3072 sc1
 v_rcp_f32 v213, v213
 v_accvgpr_read_b32 v16, a68
 v_accvgpr_read_b32 v17, a69
 v_accvgpr_read_b32 v18, a70
 v_accvgpr_read_b32 v19, a71
 v_accvgpr_read_b32 v20, a76
 v_accvgpr_read_b32 v21, a77
 v_accvgpr_read_b32 v22, a78
 v_accvgpr_read_b32 v23, a79
 v_pk_mul_f32 v[16:17], v[16:17], v[212:213] op_sel:[0,1] op_sel_hi:[1,1]
 v_pk_mul_f32 v[18:19], v[18:19], v[212:213] op_sel:[0,1] op_sel_hi:[1,1]
 v_pk_mul_f32 v[20:21], v[20:21], v[212:213] op_sel:[0,1] op_sel_hi:[1,1]
 v_pk_mul_f32 v[22:23], v[22:23], v[212:213] op_sel:[0,1] op_sel_hi:[1,1]
 v_cvt_pk_bf16_f32 v0, v16, v17
 v_cvt_pk_bf16_f32 v1, v18, v19
 v_cvt_pk_bf16_f32 v2, v20, v21
 v_cvt_pk_bf16_f32 v3, v22, v23
 buffer_store_dwordx4 v[0:3], v251, s[52:55], s77 offen offset:0 sc1
 v_accvgpr_read_b32 v16, a84
 v_accvgpr_read_b32 v17, a85
 v_accvgpr_read_b32 v18, a86
 v_accvgpr_read_b32 v19, a87
 v_accvgpr_read_b32 v20, a92
 v_accvgpr_read_b32 v21, a93
 v_accvgpr_read_b32 v22, a94
 v_accvgpr_read_b32 v23, a95
 v_pk_mul_f32 v[16:17], v[16:17], v[212:213] op_sel:[0,1] op_sel_hi:[1,1]
 v_pk_mul_f32 v[18:19], v[18:19], v[212:213] op_sel:[0,1] op_sel_hi:[1,1]
 v_pk_mul_f32 v[20:21], v[20:21], v[212:213] op_sel:[0,1] op_sel_hi:[1,1]
 v_pk_mul_f32 v[22:23], v[22:23], v[212:213] op_sel:[0,1] op_sel_hi:[1,1]
 v_cvt_pk_bf16_f32 v4, v16, v17
 v_cvt_pk_bf16_f32 v5, v18, v19
 v_cvt_pk_bf16_f32 v6, v20, v21
 v_cvt_pk_bf16_f32 v7, v22, v23
 buffer_store_dwordx4 v[4:7], v251, s[52:55], s77 offen offset:1024 sc1
 v_accvgpr_read_b32 v16, a100
 v_accvgpr_read_b32 v17, a101
 v_accvgpr_read_b32 v18, a102
 v_accvgpr_read_b32 v19, a103
 v_accvgpr_read_b32 v20, a108
 v_accvgpr_read_b32 v21, a109
 v_accvgpr_read_b32 v22, a110
 v_accvgpr_read_b32 v23, a111
 v_pk_mul_f32 v[16:17], v[16:17], v[212:213] op_sel:[0,1] op_sel_hi:[1,1]
 v_pk_mul_f32 v[18:19], v[18:19], v[212:213] op_sel:[0,1] op_sel_hi:[1,1]
 v_pk_mul_f32 v[20:21], v[20:21], v[212:213] op_sel:[0,1] op_sel_hi:[1,1]
 v_pk_mul_f32 v[22:23], v[22:23], v[212:213] op_sel:[0,1] op_sel_hi:[1,1]
 v_cvt_pk_bf16_f32 v0, v16, v17
 v_cvt_pk_bf16_f32 v1, v18, v19
 v_cvt_pk_bf16_f32 v2, v20, v21
 v_cvt_pk_bf16_f32 v3, v22, v23
 buffer_store_dwordx4 v[0:3], v251, s[52:55], s77 offen offset:2048 sc1
 v_accvgpr_read_b32 v16, a116
 v_accvgpr_read_b32 v17, a117
 v_accvgpr_read_b32 v18, a118
 v_accvgpr_read_b32 v19, a119
 v_accvgpr_read_b32 v20, a124
 v_accvgpr_read_b32 v21, a125
 v_accvgpr_read_b32 v22, a126
 v_accvgpr_read_b32 v23, a127
 v_pk_mul_f32 v[16:17], v[16:17], v[212:213] op_sel:[0,1] op_sel_hi:[1,1]
 v_pk_mul_f32 v[18:19], v[18:19], v[212:213] op_sel:[0,1] op_sel_hi:[1,1]
 v_pk_mul_f32 v[20:21], v[20:21], v[212:213] op_sel:[0,1] op_sel_hi:[1,1]
 v_pk_mul_f32 v[22:23], v[22:23], v[212:213] op_sel:[0,1] op_sel_hi:[1,1]
 v_cvt_pk_bf16_f32 v4, v16, v17
 v_cvt_pk_bf16_f32 v5, v18, v19
 v_cvt_pk_bf16_f32 v6, v20, v21
 v_cvt_pk_bf16_f32 v7, v22, v23
 buffer_store_dwordx4 v[4:7], v251, s[52:55], s77 offen offset:3072 sc1
 s_lshl_b32 s77, s62, 7
 s_add_u32 s77, s77, 71307264
 s_and_b32 s78, s2, 7
 s_lshl_b32 s78, s78, 2
 s_bfe_u32 s79, s2, 0x20003
 s_add_u32 s74, s78, s79
 s_lshr_b32 s75, s2, 5
 s_lshl_b32 s76, s60, 15
 v_and_b32 v250, 7, v253
 v_lshlrev_b32 v239, 7, v250
 v_add_u32 v250, 0, v252
 v_and_b32 v250, 3, v250
 v_lshl_add_u32 v172, v250, 17, v251
 v_add_u32 v250, 1, v252
 v_and_b32 v250, 3, v250
 v_lshl_add_u32 v173, v250, 17, v251
 v_add_u32 v250, 2, v252
 v_and_b32 v250, 3, v250
 v_lshl_add_u32 v174, v250, 17, v251
 v_add_u32 v250, 3, v252
 v_and_b32 v250, 3, v250
 v_lshl_add_u32 v175, v250, 17, v251
 s_xor_b32 s88, s74, 1
 s_lshl_b32 s88, s88, 19
 s_lshl_b32 s78, s60, 14
 s_add_u32 s88, s88, s78
 s_and_b32 s78, s74, 1
 s_lshl_b32 s78, s78, 16
 s_add_u32 s88, s88, s78
 s_add_u32 s88, s88, 37748736
 v_bfe_u32 v248, v253, 2, 2
 v_lshlrev_b32 v248, 3, v248
 v_and_b32 v250, 3, v253
 v_add_u32 v248, v248, v250
 v_and_b32 v250, 1, v252
 v_lshl_add_u32 v248, v250, 2, v248
 v_lshrrev_b32 v250, 1, v252
 v_lshl_add_u32 v248, v250, 5, v248
 v_lshrrev_b32 v249, 4, v253
 v_lshlrev_b32 v249, 3, v249
 v_lshl_add_u32 v237, v248, 10, v249
 v_lshl_add_u32 v176, v252, 14, v251
Ltail:
 s_waitcnt vmcnt(0)
 s_barrier
 s_cmp_lg_u32 s60, 0
 s_cbranch_scc1 Lna58
 v_mov_b32 v250, 1
 v_mov_b32 v249, 0
 s_mov_b64 exec, 1
 buffer_atomic_add v250, v249, s[52:55], s77 offen sc1
 s_mov_b64 exec, -1
Lna58:
 buffer_load_dwordx4 v[112:115], v251, s[52:55], s71 offen offset:0 sc1
 buffer_load_dwordx4 v[116:119], v251, s[52:55], s71 offen offset:1024 sc1
 buffer_load_dwordx4 v[120:123], v251, s[52:55], s71 offen offset:2048 sc1
 buffer_load_dwordx4 v[124:127], v251, s[52:55], s71 offen offset:3072 sc1
 s_add_u32 s71, s71, 4096
 buffer_load_dwordx4 a[0:3], v251, s[52:55], s71 offen offset:0 sc1
 buffer_load_dwordx4 a[4:7], v251, s[52:55], s71 offen offset:1024 sc1
 buffer_load_dwordx4 a[8:11], v251, s[52:55], s71 offen offset:2048 sc1
 buffer_load_dwordx4 a[12:15], v251, s[52:55], s71 offen offset:3072 sc1
 s_add_u32 s71, s71, 4096
 buffer_load_dwordx4 a[16:19], v251, s[52:55], s71 offen offset:0 sc1
 buffer_load_dwordx4 a[20:23], v251, s[52:55], s71 offen offset:1024 sc1
 buffer_load_dwordx4 a[24:27], v251, s[52:55], s71 offen offset:2048 sc1
 buffer_load_dwordx4 a[28:31], v251, s[52:55], s71 offen offset:3072 sc1
 s_add_u32 s71, s71, 4096
 buffer_load_dwordx4 a[160:163], v251, s[52:55], s71 offen offset:0 sc1
 buffer_load_dwordx4 a[164:167], v251, s[52:55], s71 offen offset:1024 sc1
 buffer_load_dwordx4 a[168:171], v251, s[52:55], s71 offen offset:2048 sc1
 buffer_load_dwordx4 a[172:175], v251, s[52:55], s71 offen offset:3072 sc1
 s_add_u32 s71, s71, 4096
 s_lshl_b32 s78, s74, 16
 s_lshl_b32 s79, s75, 7
 s_add_u32 s89, s78, s79
 s_lshr_b32 s78, s74, 1
 s_sub_u32 s79, 15, s78
 s_min_u32 s78, s78, s79
 v_mov_b32 v186, 0
 s_lshl_b32 s77, s78, 7
 s_add_u32 s77, s77, 71307264
 s_cmp_lg_u32 s60, 0
 s_cbranch_scc1 Lpi59
 buffer_load_dword v238, v186, s[52:55], s77 offen sc1
Lpi59:
 s_and_b32 s78, s2, 7
 s_lshl_b32 s78, s78, 1
 s_bfe_u32 s79, s2, 0x10003
 s_add_u32 s80, s78, s79
 s_lshr_b32 s81, s2, 4
 s_lshl_b32 s82, s81, 16
 s_lshl_b32 s78, s60, 12
 s_add_u32 s82, s82, s78
 s_add_u32 s82, s82, 88080384
 s_cmp_ge_u32 s2, 224
 s_cselect_b32 s82, 0x10000000, s82
 s_bfe_u32 s78, s2, 0x20001
 s_lshl_b32 s78, s78, 3
 s_bfe_u32 s79, s2, 0x30003
 s_add_u32 s83, s78, s79
 s_and_b32 s78, s2, 1
 s_lshl_b32 s78, s78, 2
 s_lshr_b32 s79, s2, 6
 s_add_u32 s84, s78, s79
 s_lshl_b32 s86, s83, 18
 s_lshl_b32 s78, s60, 16
 s_add_u32 s86, s86, s78
 s_add_u32 s86, s86, 92274688
 s_mul_i32 s85, s84, 458752
 s_lshl_b32 s78, s60, 14
 s_add_u32 s85, s85, s78
 s_add_u32 s85, s85, 62914560
 s_mul_i32 s87, s75, 114688
 s_mul_i32 s78, s60, 28672
 s_add_u32 s87, s87, s78
 s_add_u32 s87, s87, 90177536
 v_add_u32 v250, 1, v252
 v_and_b32 v250, 3, v250
 v_lshl_add_u32 v187, v250, 13, v251
 v_add_u32 v187, 131072, v187
 v_add_u32 v250, 2, v252
 v_and_b32 v250, 3, v250
 v_lshl_add_u32 v188, v250, 13, v251
 v_add_u32 v188, 131072, v188
 v_add_u32 v250, 3, v252
 v_and_b32 v250, 3, v250
 v_lshl_add_u32 v189, v250, 15, v251
 v_lshl_add_u32 v190, v252, 13, v251
 v_add_u32 v190, 131072, v190
 v_lshl_add_u32 v191, v252, 15, v251
 buffer_load_dwordx4 a[176:179], v251, s[52:55], s71 offen offset:0 sc1
 buffer_load_dwordx4 a[180:183], v251, s[52:55], s71 offen offset:1024 sc1
 buffer_load_dwordx4 a[184:187], v251, s[52:55], s71 offen offset:2048 sc1
 buffer_load_dwordx4 a[188:191], v251, s[52:55], s71 offen offset:3072 sc1
 s_add_u32 s71, s71, 4096
 buffer_load_dwordx4 a[192:195], v251, s[52:55], s71 offen offset:0 sc1
 buffer_load_dwordx4 a[196:199], v251, s[52:55], s71 offen offset:1024 sc1
 buffer_load_dwordx4 a[200:203], v251, s[52:55], s71 offen offset:2048 sc1
 buffer_load_dwordx4 a[204:207], v251, s[52:55], s71 offen offset:3072 sc1
 s_add_u32 s71, s71, 4096
 buffer_load_dwordx4 a[208:211], v251, s[52:55], s71 offen offset:0 sc1
 buffer_load_dwordx4 a[212:215], v251, s[52:55], s71 offen offset:1024 sc1
 buffer_load_dwordx4 a[216:219], v251, s[52:55], s71 offen offset:2048 sc1
 buffer_load_dwordx4 a[220:223], v251, s[52:55], s71 offen offset:3072 sc1
 s_add_u32 s71, s71, 4096
 buffer_load_dwordx4 a[224:227], v251, s[52:55], s71 offen offset:0 sc1
 buffer_load_dwordx4 a[228:231], v251, s[52:55], s71 offen offset:1024 sc1
 buffer_load_dwordx4 a[232:235], v251, s[52:55], s71 offen offset:2048 sc1
 buffer_load_dwordx4 a[236:239], v251, s[52:55], s71 offen offset:3072 sc1
 s_add_u32 s71, s71, 4096
 s_cmp_lg_u32 s60, 0
 s_cbranch_scc1 Lpw60
 s_waitcnt vmcnt(16)
 s_mov_b32 s63, 131072
Lsp61:
 v_cmp_gt_u32 vcc, 32, v238
 s_cbranch_vccz Lgo62
 s_sub_u32 s63, s63, 1
 s_cbranch_scc1 Lgo62
 s_sleep 1
 buffer_load_dword v238, v186, s[52:55], s77 offen sc1
 s_waitcnt vmcnt(0)
 s_branch Lsp61
Lgo62:
Lpw60:
 s_barrier
 s_mov_b32 s77, 71307264
 buffer_load_dwordx4 a[64:67], v173, s[52:55], s88 offen offset:0 sc1
 buffer_load_dwordx4 a[68:71], v173, s[52:55], s88 offen offset:1024 sc1
 buffer_load_dwordx4 a[72:75], v173, s[52:55], s88 offen offset:2048 sc1
 buffer_load_dwordx4 a[76:79], v173, s[52:55], s88 offen offset:3072 sc1
 s_add_u32 s88, s88, 4096
 buffer_load_dwordx4 a[80:83], v173, s[52:55], s88 offen offset:0 sc1
 buffer_load_dwordx4 a[84:87], v173, s[52:55], s88 offen offset:1024 sc1
 buffer_load_dwordx4 a[88:91], v173, s[52:55], s88 offen offset:2048 sc1
 buffer_load_dwordx4 a[92:95], v173, s[52:55], s88 offen offset:3072 sc1
 s_add_u32 s88, s88, 4096
 buffer_load_dwordx4 a[96:99], v173, s[52:55], s88 offen offset:0 sc1
 buffer_load_dwordx4 a[100:103], v173, s[52:55], s88 offen offset:1024 sc1
 buffer_load_dwordx4 a[104:107], v173, s[52:55], s88 offen offset:2048 sc1
 buffer_load_dwordx4 a[108:111], v173, s[52:55], s88 offen offset:3072 sc1
 s_add_u32 s88, s88, 4096
 s_lshl_b32 s90, s2, 14
 s_lshl_b32 s78, s60, 12
 s_add_u32 s90, s90, s78
 s_add_u32 s90, s90, 100663296
 s_lshl_b32 s91, s2, 7
 s_add_u32 s91, s91, 71335936
 v_lshl_add_u32 v248, v252, 6, v253
 v_min_u32 v248, 1, v248
 v_lshlrev_b32 v248, 30, v248
 v_mov_b32 v249, 1
 s_waitcnt vmcnt(8)
 v_mfma_f32_16x16x32_bf16 v[16:19], a[128:131], a[64:67], 0
 buffer_load_dwordx4 a[112:115], v173, s[52:55], s88 offen offset:0 sc1
 v_mfma_f32_16x16x32_bf16 v[16:19], a[144:147], a[68:71], v[16:19]
 v_mfma_f32_16x16x32_bf16 v[16:19], v[64:67], a[72:75], v[16:19]
 v_mfma_f32_16x16x32_bf16 v[16:19], v[80:83], a[76:79], v[16:19]
 buffer_load_dwordx4 a[116:119], v173, s[52:55], s88 offen offset:1024 sc1
 v_mfma_f32_16x16x32_bf16 v[20:23], v[84:87], a[76:79], 0
 v_mfma_f32_16x16x32_bf16 v[20:23], v[68:71], a[72:75], v[20:23]
 v_mfma_f32_16x16x32_bf16 v[20:23], a[148:151], a[68:71], v[20:23]
 v_mfma_f32_16x16x32_bf16 v[20:23], a[132:135], a[64:67], v[20:23]
 buffer_load_dwordx4 a[120:123], v173, s[52:55], s88 offen offset:2048 sc1
 v_mfma_f32_16x16x32_bf16 v[24:27], a[136:139], a[64:67], 0
 v_mfma_f32_16x16x32_bf16 v[24:27], a[152:155], a[68:71], v[24:27]
 v_mfma_f32_16x16x32_bf16 v[24:27], v[72:75], a[72:75], v[24:27]
 v_mfma_f32_16x16x32_bf16 v[24:27], v[88:91], a[76:79], v[24:27]
 buffer_load_dwordx4 a[124:127], v173, s[52:55], s88 offen offset:3072 sc1
 v_mfma_f32_16x16x32_bf16 v[28:31], v[92:95], a[76:79], 0
 s_sub_u32 s88, s88, 12288
 v_mfma_f32_16x16x32_bf16 v[28:31], v[76:79], a[72:75], v[28:31]
 v_mfma_f32_16x16x32_bf16 v[28:31], a[156:159], a[68:71], v[28:31]
 v_mfma_f32_16x16x32_bf16 v[28:31], a[140:143], a[64:67], v[28:31]
 s_waitcnt vmcnt(8)
 v_mfma_f32_16x16x32_bf16 v[16:19], v[96:99], a[80:83], v[16:19]
 buffer_load_dwordx4 a[64:67], v174, s[52:55], s88 offen offset:0 sc1
 v_mfma_f32_16x16x32_bf16 v[16:19], a[32:35], a[84:87], v[16:19]
 v_mfma_f32_16x16x32_bf16 v[16:19], a[48:51], a[88:91], v[16:19]
 v_mfma_f32_16x16x32_bf16 v[16:19], v[152:155], a[92:95], v[16:19]
 buffer_load_dwordx4 a[68:71], v174, s[52:55], s88 offen offset:1024 sc1
 v_mfma_f32_16x16x32_bf16 v[20:23], v[156:159], a[92:95], v[20:23]
 v_mfma_f32_16x16x32_bf16 v[20:23], a[52:55], a[88:91], v[20:23]
 v_mfma_f32_16x16x32_bf16 v[20:23], a[36:39], a[84:87], v[20:23]
 v_mfma_f32_16x16x32_bf16 v[20:23], v[100:103], a[80:83], v[20:23]
 buffer_load_dwordx4 a[72:75], v174, s[52:55], s88 offen offset:2048 sc1
 v_mfma_f32_16x16x32_bf16 v[24:27], v[104:107], a[80:83], v[24:27]
 v_mfma_f32_16x16x32_bf16 v[24:27], a[40:43], a[84:87], v[24:27]
 v_mfma_f32_16x16x32_bf16 v[24:27], a[56:59], a[88:91], v[24:27]
 v_mfma_f32_16x16x32_bf16 v[24:27], v[160:163], a[92:95], v[24:27]
 buffer_load_dwordx4 a[76:79], v174, s[52:55], s88 offen offset:3072 sc1
 v_mfma_f32_16x16x32_bf16 v[28:31], v[164:167], a[92:95], v[28:31]
 s_add_u32 s88, s88, 4096
 v_mfma_f32_16x16x32_bf16 v[28:31], a[60:63], a[88:91], v[28:31]
 v_mfma_f32_16x16x32_bf16 v[28:31], a[44:47], a[84:87], v[28:31]
 v_mfma_f32_16x16x32_bf16 v[28:31], v[108:111], a[80:83], v[28:31]
 s_waitcnt vmcnt(8)
 v_mfma_f32_16x16x32_bf16 v[16:19], v[112:115], a[96:99], v[16:19]
 buffer_load_dwordx4 a[80:83], v174, s[52:55], s88 offen offset:0 sc1
 v_mfma_f32_16x16x32_bf16 v[16:19], a[0:3], a[100:103], v[16:19]
 v_mfma_f32_16x16x32_bf16 v[16:19], a[16:19], a[104:107], v[16:19]
 v_mfma_f32_16x16x32_bf16 v[16:19], a[160:163], a[108:111], v[16:19]
 buffer_load_dwordx4 a[84:87], v174, s[52:55], s88 offen offset:1024 sc1
 v_mfma_f32_16x16x32_bf16 v[20:23], a[164:167], a[108:111], v[20:23]
 v_mfma_f32_16x16x32_bf16 v[20:23], a[20:23], a[104:107], v[20:23]
 v_mfma_f32_16x16x32_bf16 v[20:23], a[4:7], a[100:103], v[20:23]
 v_mfma_f32_16x16x32_bf16 v[20:23], v[116:119], a[96:99], v[20:23]
 buffer_load_dwordx4 a[88:91], v174, s[52:55], s88 offen offset:2048 sc1
 v_mfma_f32_16x16x32_bf16 v[24:27], v[120:123], a[96:99], v[24:27]
 v_mfma_f32_16x16x32_bf16 v[24:27], a[8:11], a[100:103], v[24:27]
 v_mfma_f32_16x16x32_bf16 v[24:27], a[24:27], a[104:107], v[24:27]
 v_mfma_f32_16x16x32_bf16 v[24:27], a[168:171], a[108:111], v[24:27]
 buffer_load_dwordx4 a[92:95], v174, s[52:55], s88 offen offset:3072 sc1
 v_mfma_f32_16x16x32_bf16 v[28:31], a[172:175], a[108:111], v[28:31]
 s_add_u32 s88, s88, 4096
 v_mfma_f32_16x16x32_bf16 v[28:31], a[28:31], a[104:107], v[28:31]
 v_mfma_f32_16x16x32_bf16 v[28:31], a[12:15], a[100:103], v[28:31]
 v_mfma_f32_16x16x32_bf16 v[28:31], v[124:127], a[96:99], v[28:31]
 s_waitcnt vmcnt(8)
 v_mfma_f32_16x16x32_bf16 v[16:19], a[176:179], a[112:115], v[16:19]
 buffer_load_dwordx4 a[96:99], v174, s[52:55], s88 offen offset:0 sc1
 v_mfma_f32_16x16x32_bf16 v[16:19], a[192:195], a[116:119], v[16:19]
 v_mfma_f32_16x16x32_bf16 v[16:19], a[208:211], a[120:123], v[16:19]
 v_mfma_f32_16x16x32_bf16 v[16:19], a[224:227], a[124:127], v[16:19]
 buffer_load_dwordx4 a[100:103], v174, s[52:55], s88 offen offset:1024 sc1
 v_mfma_f32_16x16x32_bf16 v[20:23], a[228:231], a[124:127], v[20:23]
 v_mfma_f32_16x16x32_bf16 v[20:23], a[212:215], a[120:123], v[20:23]
 v_mfma_f32_16x16x32_bf16 v[20:23], a[196:199], a[116:119], v[20:23]
 v_mfma_f32_16x16x32_bf16 v[20:23], a[180:183], a[112:115], v[20:23]
 buffer_load_dwordx4 a[104:107], v174, s[52:55], s88 offen offset:2048 sc1
 v_mfma_f32_16x16x32_bf16 v[24:27], a[184:187], a[112:115], v[24:27]
 v_mfma_f32_16x16x32_bf16 v[24:27], a[200:203], a[116:119], v[24:27]
 v_mfma_f32_16x16x32_bf16 v[24:27], a[216:219], a[120:123], v[24:27]
 v_mfma_f32_16x16x32_bf16 v[24:27], a[232:235], a[124:127], v[24:27]
 buffer_load_dwordx4 a[108:111], v174, s[52:55], s88 offen offset:3072 sc1
 v_mfma_f32_16x16x32_bf16 v[28:31], a[236:239], a[124:127], v[28:31]
 s_add_u32 s88, s88, 4096
 v_mfma_f32_16x16x32_bf16 v[28:31], a[220:223], a[120:123], v[28:31]
 v_mfma_f32_16x16x32_bf16 v[28:31], a[204:207], a[116:119], v[28:31]
 v_mfma_f32_16x16x32_bf16 v[28:31], a[188:191], a[112:115], v[28:31]
 s_waitcnt vmcnt(8)
 v_mfma_f32_16x16x32_bf16 v[32:35], a[128:131], a[64:67], 0
 buffer_load_dwordx4 a[112:115], v174, s[52:55], s88 offen offset:0 sc1
 v_mfma_f32_16x16x32_bf16 v[32:35], a[144:147], a[68:71], v[32:35]
 v_mfma_f32_16x16x32_bf16 v[32:35], v[64:67], a[72:75], v[32:35]
 v_mfma_f32_16x16x32_bf16 v[32:35], v[80:83], a[76:79], v[32:35]
 buffer_load_dwordx4 a[116:119], v174, s[52:55], s88 offen offset:1024 sc1
 v_mfma_f32_16x16x32_bf16 v[36:39], v[84:87], a[76:79], 0
 v_mfma_f32_16x16x32_bf16 v[36:39], v[68:71], a[72:75], v[36:39]
 ds_write_b128 v187, v[16:19] offset:0
 ds_write_b128 v187, v[20:23] offset:1024
 v_mfma_f32_16x16x32_bf16 v[36:39], a[148:151], a[68:71], v[36:39]
 ds_write_b128 v187, v[24:27] offset:2048
 ds_write_b128 v187, v[28:31] offset:3072
 v_mfma_f32_16x16x32_bf16 v[36:39], a[132:135], a[64:67], v[36:39]
 buffer_load_dwordx4 a[120:123], v174, s[52:55], s88 offen offset:2048 sc1
 v_mfma_f32_16x16x32_bf16 v[40:43], a[136:139], a[64:67], 0
 v_mfma_f32_16x16x32_bf16 v[40:43], a[152:155], a[68:71], v[40:43]
 v_mfma_f32_16x16x32_bf16 v[40:43], v[72:75], a[72:75], v[40:43]
 v_mfma_f32_16x16x32_bf16 v[40:43], v[88:91], a[76:79], v[40:43]
 buffer_load_dwordx4 a[124:127], v174, s[52:55], s88 offen offset:3072 sc1
 v_mfma_f32_16x16x32_bf16 v[44:47], v[92:95], a[76:79], 0
 s_sub_u32 s88, s88, 12288
 v_mfma_f32_16x16x32_bf16 v[44:47], v[76:79], a[72:75], v[44:47]
 v_mfma_f32_16x16x32_bf16 v[44:47], a[156:159], a[68:71], v[44:47]
 v_mfma_f32_16x16x32_bf16 v[44:47], a[140:143], a[64:67], v[44:47]
 s_waitcnt vmcnt(8)
 v_mfma_f32_16x16x32_bf16 v[32:35], v[96:99], a[80:83], v[32:35]
 buffer_load_dwordx4 a[64:67], v175, s[52:55], s88 offen offset:0 sc1
 v_mfma_f32_16x16x32_bf16 v[32:35], a[32:35], a[84:87], v[32:35]
 v_mfma_f32_16x16x32_bf16 v[32:35], a[48:51], a[88:91], v[32:35]
 v_mfma_f32_16x16x32_bf16 v[32:35], v[152:155], a[92:95], v[32:35]
 buffer_load_dwordx4 a[68:71], v175, s[52:55], s88 offen offset:1024 sc1
 v_mfma_f32_16x16x32_bf16 v[36:39], v[156:159], a[92:95], v[36:39]
 v_mfma_f32_16x16x32_bf16 v[36:39], a[52:55], a[88:91], v[36:39]
 v_mfma_f32_16x16x32_bf16 v[36:39], a[36:39], a[84:87], v[36:39]
 v_mfma_f32_16x16x32_bf16 v[36:39], v[100:103], a[80:83], v[36:39]
 buffer_load_dwordx4 a[72:75], v175, s[52:55], s88 offen offset:2048 sc1
 v_mfma_f32_16x16x32_bf16 v[40:43], v[104:107], a[80:83], v[40:43]
 v_mfma_f32_16x16x32_bf16 v[40:43], a[40:43], a[84:87], v[40:43]
 v_mfma_f32_16x16x32_bf16 v[40:43], a[56:59], a[88:91], v[40:43]
 v_mfma_f32_16x16x32_bf16 v[40:43], v[160:163], a[92:95], v[40:43]
 buffer_load_dwordx4 a[76:79], v175, s[52:55], s88 offen offset:3072 sc1
 v_mfma_f32_16x16x32_bf16 v[44:47], v[164:167], a[92:95], v[44:47]
 s_add_u32 s88, s88, 4096
 v_mfma_f32_16x16x32_bf16 v[44:47], a[60:63], a[88:91], v[44:47]
 v_mfma_f32_16x16x32_bf16 v[44:47], a[44:47], a[84:87], v[44:47]
 v_mfma_f32_16x16x32_bf16 v[44:47], v[108:111], a[80:83], v[44:47]
 s_waitcnt vmcnt(8)
 v_mfma_f32_16x16x32_bf16 v[32:35], v[112:115], a[96:99], v[32:35]
 buffer_load_dwordx4 a[80:83], v175, s[52:55], s88 offen offset:0 sc1
 v_mfma_f32_16x16x32_bf16 v[32:35], a[0:3], a[100:103], v[32:35]
 v_mfma_f32_16x16x32_bf16 v[32:35], a[16:19], a[104:107], v[32:35]
 buffer_load_dwordx4 a[84:87], v175, s[52:55], s88 offen offset:1024 sc1
 v_mfma_f32_16x16x32_bf16 v[32:35], a[160:163], a[108:111], v[32:35]
 v_mfma_f32_16x16x32_bf16 v[36:39], a[164:167], a[108:111], v[36:39]
 v_mfma_f32_16x16x32_bf16 v[36:39], a[20:23], a[104:107], v[36:39]
 buffer_load_dwordx4 a[88:91], v175, s[52:55], s88 offen offset:2048 sc1
 v_mfma_f32_16x16x32_bf16 v[36:39], a[4:7], a[100:103], v[36:39]
 v_mfma_f32_16x16x32_bf16 v[36:39], v[116:119], a[96:99], v[36:39]
 v_mfma_f32_16x16x32_bf16 v[40:43], v[120:123], a[96:99], v[40:43]
 buffer_load_dwordx4 a[92:95], v175, s[52:55], s88 offen offset:3072 sc1
 v_mfma_f32_16x16x32_bf16 v[40:43], a[8:11], a[100:103], v[40:43]
 s_add_u32 s88, s88, 4096
 v_mfma_f32_16x16x32_bf16 v[40:43], a[24:27], a[104:107], v[40:43]
 v_mfma_f32_16x16x32_bf16 v[40:43], a[168:171], a[108:111], v[40:43]
 buffer_load_dword v238, v239, s[52:55], s77 offen sc1
 v_mfma_f32_16x16x32_bf16 v[44:47], a[172:175], a[108:111], v[44:47]
 v_mfma_f32_16x16x32_bf16 v[44:47], a[28:31], a[104:107], v[44:47]
 v_mfma_f32_16x16x32_bf16 v[44:47], a[12:15], a[100:103], v[44:47]
 v_mfma_f32_16x16x32_bf16 v[44:47], v[124:127], a[96:99], v[44:47]
 s_waitcnt vmcnt(9)
 v_mfma_f32_16x16x32_bf16 v[32:35], a[176:179], a[112:115], v[32:35]
 buffer_load_dwordx4 a[96:99], v175, s[52:55], s88 offen offset:0 sc1
 v_mfma_f32_16x16x32_bf16 v[32:35], a[192:195], a[116:119], v[32:35]
 v_mfma_f32_16x16x32_bf16 v[32:35], a[208:211], a[120:123], v[32:35]
 v_mfma_f32_16x16x32_bf16 v[32:35], a[224:227], a[124:127], v[32:35]
 buffer_load_dwordx4 a[100:103], v175, s[52:55], s88 offen offset:1024 sc1
 v_mfma_f32_16x16x32_bf16 v[36:39], a[228:231], a[124:127], v[36:39]
 v_mfma_f32_16x16x32_bf16 v[36:39], a[212:215], a[120:123], v[36:39]
 v_mfma_f32_16x16x32_bf16 v[36:39], a[196:199], a[116:119], v[36:39]
 v_mfma_f32_16x16x32_bf16 v[36:39], a[180:183], a[112:115], v[36:39]
 buffer_load_dwordx4 a[104:107], v175, s[52:55], s88 offen offset:2048 sc1
 v_mfma_f32_16x16x32_bf16 v[40:43], a[184:187], a[112:115], v[40:43]
 v_mfma_f32_16x16x32_bf16 v[40:43], a[200:203], a[116:119], v[40:43]
 v_mfma_f32_16x16x32_bf16 v[40:43], a[216:219], a[120:123], v[40:43]
 v_mfma_f32_16x16x32_bf16 v[40:43], a[232:235], a[124:127], v[40:43]
 buffer_load_dwordx4 a[108:111], v175, s[52:55], s88 offen offset:3072 sc1
 v_mfma_f32_16x16x32_bf16 v[44:47], a[236:239], a[124:127], v[44:47]
 s_add_u32 s88, s88, 4096
 v_mfma_f32_16x16x32_bf16 v[44:47], a[220:223], a[120:123], v[44:47]
 v_mfma_f32_16x16x32_bf16 v[44:47], a[204:207], a[116:119], v[44:47]
 v_mfma_f32_16x16x32_bf16 v[44:47], a[188:191], a[112:115], v[44:47]
 s_waitcnt vmcnt(9)
 v_mfma_f32_16x16x32_bf16 v[48:51], a[128:131], a[64:67], 0
 buffer_load_dwordx4 a[112:115], v175, s[52:55], s88 offen offset:0 sc1
 v_mfma_f32_16x16x32_bf16 v[48:51], a[144:147], a[68:71], v[48:51]
 v_mfma_f32_16x16x32_bf16 v[48:51], v[64:67], a[72:75], v[48:51]
 v_mfma_f32_16x16x32_bf16 v[48:51], v[80:83], a[76:79], v[48:51]
 buffer_load_dwordx4 a[116:119], v175, s[52:55], s88 offen offset:1024 sc1
 v_mfma_f32_16x16x32_bf16 v[52:55], v[84:87], a[76:79], 0
 v_mfma_f32_16x16x32_bf16 v[52:55], v[68:71], a[72:75], v[52:55]
 ds_write_b128 v188, v[32:35] offset:4096
 ds_write_b128 v188, v[36:39] offset:5120
 v_mfma_f32_16x16x32_bf16 v[52:55], a[148:151], a[68:71], v[52:55]
 ds_write_b128 v188, v[40:43] offset:6144
 ds_write_b128 v188, v[44:47] offset:7168
 v_mfma_f32_16x16x32_bf16 v[52:55], a[132:135], a[64:67], v[52:55]
 buffer_load_dwordx4 a[120:123], v175, s[52:55], s88 offen offset:2048 sc1
 v_mfma_f32_16x16x32_bf16 v[56:59], a[136:139], a[64:67], 0
 v_mfma_f32_16x16x32_bf16 v[56:59], a[152:155], a[68:71], v[56:59]
 v_mfma_f32_16x16x32_bf16 v[56:59], v[72:75], a[72:75], v[56:59]
 v_mfma_f32_16x16x32_bf16 v[56:59], v[88:91], a[76:79], v[56:59]
 buffer_load_dwordx4 a[124:127], v175, s[52:55], s88 offen offset:3072 sc1
 v_mfma_f32_16x16x32_bf16 v[60:63], v[92:95], a[76:79], 0
 s_sub_u32 s88, s88, 12288
 v_mfma_f32_16x16x32_bf16 v[60:63], v[76:79], a[72:75], v[60:63]
 v_mfma_f32_16x16x32_bf16 v[60:63], a[156:159], a[68:71], v[60:63]
 v_mfma_f32_16x16x32_bf16 v[60:63], a[140:143], a[64:67], v[60:63]
 s_waitcnt vmcnt(9)
 v_mfma_f32_16x16x32_bf16 v[48:51], v[96:99], a[80:83], v[48:51]
 buffer_load_dwordx4 a[64:67], v172, s[52:55], s88 offen offset:0 sc1
 v_mfma_f32_16x16x32_bf16 v[48:51], a[32:35], a[84:87], v[48:51]
 v_mfma_f32_16x16x32_bf16 v[48:51], a[48:51], a[88:91], v[48:51]
 v_mfma_f32_16x16x32_bf16 v[48:51], v[152:155], a[92:95], v[48:51]
 buffer_load_dwordx4 a[68:71], v172, s[52:55], s88 offen offset:1024 sc1
 v_mfma_f32_16x16x32_bf16 v[52:55], v[156:159], a[92:95], v[52:55]
 v_mfma_f32_16x16x32_bf16 v[52:55], a[52:55], a[88:91], v[52:55]
 v_mfma_f32_16x16x32_bf16 v[52:55], a[36:39], a[84:87], v[52:55]
 v_mfma_f32_16x16x32_bf16 v[52:55], v[100:103], a[80:83], v[52:55]
 buffer_load_dwordx4 a[72:75], v172, s[52:55], s88 offen offset:2048 sc1
 v_mfma_f32_16x16x32_bf16 v[56:59], v[104:107], a[80:83], v[56:59]
 v_mfma_f32_16x16x32_bf16 v[56:59], a[40:43], a[84:87], v[56:59]
 v_mfma_f32_16x16x32_bf16 v[56:59], a[56:59], a[88:91], v[56:59]
 v_mfma_f32_16x16x32_bf16 v[56:59], v[160:163], a[92:95], v[56:59]
 buffer_load_dwordx4 a[76:79], v172, s[52:55], s88 offen offset:3072 sc1
 v_mfma_f32_16x16x32_bf16 v[60:63], v[164:167], a[92:95], v[60:63]
 s_add_u32 s88, s88, 4096
 v_mfma_f32_16x16x32_bf16 v[60:63], a[60:63], a[88:91], v[60:63]
 v_mfma_f32_16x16x32_bf16 v[60:63], a[44:47], a[84:87], v[60:63]
 v_mfma_f32_16x16x32_bf16 v[60:63], v[108:111], a[80:83], v[60:63]
 s_waitcnt vmcnt(8)
 v_mfma_f32_16x16x32_bf16 v[48:51], v[112:115], a[96:99], v[48:51]
 buffer_load_dwordx4 a[80:83], v172, s[52:55], s88 offen offset:0 sc1
 v_mfma_f32_16x16x32_bf16 v[48:51], a[0:3], a[100:103], v[48:51]
 v_mfma_f32_16x16x32_bf16 v[48:51], a[16:19], a[104:107], v[48:51]
 v_mfma_f32_16x16x32_bf16 v[48:51], a[160:163], a[108:111], v[48:51]
 buffer_load_dwordx4 a[84:87], v172, s[52:55], s88 offen offset:1024 sc1
 v_mfma_f32_16x16x32_bf16 v[52:55], a[164:167], a[108:111], v[52:55]
 v_mfma_f32_16x16x32_bf16 v[52:55], a[20:23], a[104:107], v[52:55]
 v_mfma_f32_16x16x32_bf16 v[52:55], a[4:7], a[100:103], v[52:55]
 buffer_load_dwordx4 a[88:91], v172, s[52:55], s88 offen offset:2048 sc1
 v_mfma_f32_16x16x32_bf16 v[52:55], v[116:119], a[96:99], v[52:55]
 v_mfma_f32_16x16x32_bf16 v[56:59], v[120:123], a[96:99], v[56:59]
 v_mfma_f32_16x16x32_bf16 v[56:59], a[8:11], a[100:103], v[56:59]
 buffer_load_dwordx4 a[92:95], v172, s[52:55], s88 offen offset:3072 sc1
 v_mfma_f32_16x16x32_bf16 v[56:59], a[24:27], a[104:107], v[56:59]
 s_add_u32 s88, s88, 4096
 v_mfma_f32_16x16x32_bf16 v[56:59], a[168:171], a[108:111], v[56:59]
 s_waitcnt vmcnt(16)
 v_mfma_f32_16x16x32_bf16 v[60:63], a[172:175], a[108:111], v[60:63]
 v_mfma_f32_16x16x32_bf16 v[60:63], a[28:31], a[104:107], v[60:63]
 v_cmp_gt_u32 vcc, 32, v238
 v_mfma_f32_16x16x32_bf16 v[60:63], a[12:15], a[100:103], v[60:63]
 s_cbranch_vccnz Lts63
Ltb64:
 v_mfma_f32_16x16x32_bf16 v[60:63], v[124:127], a[96:99], v[60:63]
 s_waitcnt vmcnt(8)
 v_mfma_f32_16x16x32_bf16 v[48:51], a[176:179], a[112:115], v[48:51]
 buffer_load_dwordx4 a[96:99], v172, s[52:55], s88 offen offset:0 sc1
 v_mfma_f32_16x16x32_bf16 v[48:51], a[192:195], a[116:119], v[48:51]
 buffer_load_dwordx4 a[100:103], v172, s[52:55], s88 offen offset:1024 sc1
 v_mfma_f32_16x16x32_bf16 v[48:51], a[208:211], a[120:123], v[48:51]
 v_mfma_f32_16x16x32_bf16 v[48:51], a[224:227], a[124:127], v[48:51]
 buffer_load_dwordx4 a[104:107], v172, s[52:55], s88 offen offset:2048 sc1
 v_mfma_f32_16x16x32_bf16 v[52:55], a[228:231], a[124:127], v[52:55]
 v_mfma_f32_16x16x32_bf16 v[52:55], a[212:215], a[120:123], v[52:55]
 buffer_load_dwordx4 a[108:111], v172, s[52:55], s88 offen offset:3072 sc1
 v_mfma_f32_16x16x32_bf16 v[52:55], a[196:199], a[116:119], v[52:55]
 s_add_u32 s88, s88, 4096
 v_mfma_f32_16x16x32_bf16 v[52:55], a[180:183], a[112:115], v[52:55]
 buffer_load_dwordx2 v[178:179], v237, s[4:7], s89 offen offset:0
 v_mfma_f32_16x16x32_bf16 v[56:59], a[184:187], a[112:115], v[56:59]
 v_mfma_f32_16x16x32_bf16 v[56:59], a[200:203], a[116:119], v[56:59]
 buffer_load_dwordx2 v[180:181], v237, s[4:7], s89 offen offset:32
 v_mfma_f32_16x16x32_bf16 v[56:59], a[216:219], a[120:123], v[56:59]
 v_mfma_f32_16x16x32_bf16 v[56:59], a[232:235], a[124:127], v[56:59]
 buffer_load_dwordx2 v[182:183], v237, s[4:7], s89 offen offset:64
 v_mfma_f32_16x16x32_bf16 v[60:63], a[236:239], a[124:127], v[60:63]
 v_mfma_f32_16x16x32_bf16 v[60:63], a[220:223], a[120:123], v[60:63]
 buffer_load_dwordx2 v[184:185], v237, s[4:7], s89 offen offset:96
 v_mfma_f32_16x16x32_bf16 v[60:63], a[204:207], a[116:119], v[60:63]
 v_mfma_f32_16x16x32_bf16 v[60:63], a[188:191], a[112:115], v[60:63]
 s_waitcnt vmcnt(12)
 v_mfma_f32_16x16x32_bf16 v[0:3], a[128:131], a[64:67], 0
 buffer_load_dwordx4 a[112:115], v172, s[52:55], s88 offen offset:0 sc1
 v_mfma_f32_16x16x32_bf16 v[0:3], a[144:147], a[68:71], v[0:3]
 v_mfma_f32_16x16x32_bf16 v[0:3], v[64:67], a[72:75], v[0:3]
 v_mfma_f32_16x16x32_bf16 v[0:3], v[80:83], a[76:79], v[0:3]
 buffer_load_dwordx4 a[116:119], v172, s[52:55], s88 offen offset:1024 sc1
 v_mfma_f32_16x16x32_bf16 v[4:7], v[84:87], a[76:79], 0
 v_mfma_f32_16x16x32_bf16 v[4:7], v[68:71], a[72:75], v[4:7]
 ds_write_b128 v189, v[48:51] offset:28672
 ds_write_b128 v189, v[52:55] offset:29696
 v_mfma_f32_16x16x32_bf16 v[4:7], a[148:151], a[68:71], v[4:7]
 ds_write_b128 v189, v[56:59] offset:30720
 ds_write_b128 v189, v[60:63] offset:31744
 v_mfma_f32_16x16x32_bf16 v[4:7], a[132:135], a[64:67], v[4:7]
 buffer_load_dwordx4 a[120:123], v172, s[52:55], s88 offen offset:2048 sc1
 v_mfma_f32_16x16x32_bf16 v[8:11], a[136:139], a[64:67], 0
 v_mfma_f32_16x16x32_bf16 v[8:11], a[152:155], a[68:71], v[8:11]
 v_mfma_f32_16x16x32_bf16 v[8:11], v[72:75], a[72:75], v[8:11]
 v_mfma_f32_16x16x32_bf16 v[8:11], v[88:91], a[76:79], v[8:11]
 buffer_load_dwordx4 a[124:127], v172, s[52:55], s88 offen offset:3072 sc1
 v_mfma_f32_16x16x32_bf16 v[12:15], v[92:95], a[76:79], 0
 s_waitcnt lgkmcnt(0)
 v_mfma_f32_16x16x32_bf16 v[12:15], v[76:79], a[72:75], v[12:15]
 s_barrier
 ds_read_b128 v[128:131], v190 offset:0
 ds_read_b128 v[132:135], v190 offset:1024
 v_mfma_f32_16x16x32_bf16 v[12:15], a[156:159], a[68:71], v[12:15]
 s_sub_u32 s88, s88, 12288
 s_xor_b32 s88, s88, 0x80000
 ds_read_b128 v[136:139], v190 offset:2048
 v_mfma_f32_16x16x32_bf16 v[12:15], a[140:143], a[64:67], v[12:15]
 s_waitcnt vmcnt(12)
 ds_read_b128 v[140:143], v190 offset:3072
 ds_read_b128 v[204:207], v190 offset:4096
 v_mfma_f32_16x16x32_bf16 v[0:3], v[96:99], a[80:83], v[0:3]
 ds_read_b128 v[208:211], v190 offset:5120
 ds_read_b128 v[212:215], v190 offset:6144
 ds_read_b128 v[216:219], v190 offset:7168
 ds_read_b128 v[220:223], v191 offset:28672
 ds_read_b128 v[224:227], v191 offset:29696
 ds_read_b128 v[228:231], v191 offset:30720
 ds_read_b128 v[232:235], v191 offset:31744
 v_mfma_f32_16x16x32_bf16 v[0:3], a[32:35], a[84:87], v[0:3]
 buffer_load_dwordx4 a[64:67], v173, s[52:55], s88 offen offset:0 sc1
 v_mfma_f32_16x16x32_bf16 v[0:3], a[48:51], a[88:91], v[0:3]
 v_mfma_f32_16x16x32_bf16 v[0:3], v[152:155], a[92:95], v[0:3]
 buffer_load_dwordx4 a[68:71], v173, s[52:55], s88 offen offset:1024 sc1
 v_mfma_f32_16x16x32_bf16 v[4:7], v[156:159], a[92:95], v[4:7]
 v_mfma_f32_16x16x32_bf16 v[4:7], a[52:55], a[88:91], v[4:7]
 v_mfma_f32_16x16x32_bf16 v[4:7], a[36:39], a[84:87], v[4:7]
 v_mfma_f32_16x16x32_bf16 v[4:7], v[100:103], a[80:83], v[4:7]
 buffer_load_dwordx4 a[72:75], v173, s[52:55], s88 offen offset:2048 sc1
 v_mfma_f32_16x16x32_bf16 v[8:11], v[104:107], a[80:83], v[8:11]
 s_waitcnt lgkmcnt(0)
 v_add_f32 v128, v128, v204
 v_add_f32 v129, v129, v205
 v_mfma_f32_16x16x32_bf16 v[8:11], a[40:43], a[84:87], v[8:11]
 v_mfma_f32_16x16x32_bf16 v[8:11], a[56:59], a[88:91], v[8:11]
 v_add_f32 v130, v130, v206
 v_add_f32 v131, v131, v207
 v_mfma_f32_16x16x32_bf16 v[8:11], v[160:163], a[92:95], v[8:11]
 buffer_load_dwordx4 a[76:79], v173, s[52:55], s88 offen offset:3072 sc1
 v_mfma_f32_16x16x32_bf16 v[12:15], v[164:167], a[92:95], v[12:15]
 s_add_u32 s88, s88, 4096
 v_add_f32 v132, v132, v208
 v_add_f32 v133, v133, v209
 v_mfma_f32_16x16x32_bf16 v[12:15], a[60:63], a[88:91], v[12:15]
 v_mfma_f32_16x16x32_bf16 v[12:15], a[44:47], a[84:87], v[12:15]
 v_mfma_f32_16x16x32_bf16 v[12:15], v[108:111], a[80:83], v[12:15]
 s_waitcnt vmcnt(12)
 v_add_f32 v134, v134, v210
 v_add_f32 v135, v135, v211
 v_mfma_f32_16x16x32_bf16 v[0:3], v[112:115], a[96:99], v[0:3]
 buffer_load_dwordx4 a[80:83], v173, s[52:55], s88 offen offset:0 sc1
 v_mfma_f32_16x16x32_bf16 v[0:3], a[0:3], a[100:103], v[0:3]
 buffer_load_dwordx4 a[84:87], v173, s[52:55], s88 offen offset:1024 sc1
 v_mfma_f32_16x16x32_bf16 v[0:3], a[16:19], a[104:107], v[0:3]
 v_add_f32 v136, v136, v212
 v_add_f32 v137, v137, v213
 v_mfma_f32_16x16x32_bf16 v[0:3], a[160:163], a[108:111], v[0:3]
 buffer_load_dwordx4 a[88:91], v173, s[52:55], s88 offen offset:2048 sc1
 v_mfma_f32_16x16x32_bf16 v[4:7], a[164:167], a[108:111], v[4:7]
 v_add_f32 v138, v138, v214
 v_add_f32 v139, v139, v215
 v_mfma_f32_16x16x32_bf16 v[4:7], a[20:23], a[104:107], v[4:7]
 buffer_load_dwordx4 a[92:95], v173, s[52:55], s88 offen offset:3072 sc1
 v_mfma_f32_16x16x32_bf16 v[4:7], a[4:7], a[100:103], v[4:7]
 s_add_u32 s88, s88, 4096
 v_add_f32 v140, v140, v216
 v_add_f32 v141, v141, v217
 v_mfma_f32_16x16x32_bf16 v[4:7], v[116:119], a[96:99], v[4:7]
 s_add_u32 m0, s76, 0
 v_mfma_f32_16x16x32_bf16 v[8:11], v[120:123], a[96:99], v[8:11]
 s_add_u32 s79, s82, 917504
 v_mfma_f32_16x16x32_bf16 v[8:11], a[8:11], a[100:103], v[8:11]
 buffer_load_dwordx4 v251, s[52:55], s79 offen offset:0 sc1 lds
 v_mfma_f32_16x16x32_bf16 v[8:11], a[24:27], a[104:107], v[8:11]
 buffer_load_dwordx4 v251, s[52:55], s79 offen offset:1024 sc1 lds
 v_mfma_f32_16x16x32_bf16 v[8:11], a[168:171], a[108:111], v[8:11]
 v_add_f32 v142, v142, v218
 v_add_f32 v143, v143, v219
 v_mfma_f32_16x16x32_bf16 v[12:15], a[172:175], a[108:111], v[12:15]
 buffer_load_dwordx4 v251, s[52:55], s79 offen offset:2048 sc1 lds
 v_mfma_f32_16x16x32_bf16 v[12:15], a[28:31], a[104:107], v[12:15]
 v_add_f32 v128, v128, v220
 v_add_f32 v129, v129, v221
 v_mfma_f32_16x16x32_bf16 v[12:15], a[12:15], a[100:103], v[12:15]
 buffer_load_dwordx4 v251, s[52:55], s79 offen offset:3072 sc1 lds
 v_mfma_f32_16x16x32_bf16 v[12:15], v[124:127], a[96:99], v[12:15]
 s_waitcnt vmcnt(12)
 v_add_f32 v130, v130, v222
 v_add_f32 v131, v131, v223
 v_mfma_f32_16x16x32_bf16 v[0:3], a[176:179], a[112:115], v[0:3]
 buffer_load_dwordx4 a[96:99], v173, s[52:55], s88 offen offset:0 sc1
 v_mfma_f32_16x16x32_bf16 v[0:3], a[192:195], a[116:119], v[0:3]
 v_add_f32 v132, v132, v224
 v_add_f32 v133, v133, v225
 v_mfma_f32_16x16x32_bf16 v[0:3], a[208:211], a[120:123], v[0:3]
 v_mfma_f32_16x16x32_bf16 v[0:3], a[224:227], a[124:127], v[0:3]
 v_add_f32 v134, v134, v226
 v_add_f32 v135, v135, v227
 v_mfma_f32_16x16x32_bf16 v[4:7], a[228:231], a[124:127], v[4:7]
 buffer_load_dwordx4 a[100:103], v173, s[52:55], s88 offen offset:1024 sc1
 v_mfma_f32_16x16x32_bf16 v[4:7], a[212:215], a[120:123], v[4:7]
 v_add_f32 v136, v136, v228
 v_add_f32 v137, v137, v229
 v_mfma_f32_16x16x32_bf16 v[4:7], a[196:199], a[116:119], v[4:7]
 v_mfma_f32_16x16x32_bf16 v[4:7], a[180:183], a[112:115], v[4:7]
 buffer_load_dwordx4 a[104:107], v173, s[52:55], s88 offen offset:2048 sc1
 v_mfma_f32_16x16x32_bf16 v[8:11], a[184:187], a[112:115], v[8:11]
 v_add_f32 v138, v138, v230
 v_add_f32 v139, v139, v231
 v_mfma_f32_16x16x32_bf16 v[8:11], a[200:203], a[116:119], v[8:11]
 v_mfma_f32_16x16x32_bf16 v[8:11], a[216:219], a[120:123], v[8:11]
 v_add_f32 v140, v140, v232
 v_add_f32 v141, v141, v233
 v_mfma_f32_16x16x32_bf16 v[8:11], a[232:235], a[124:127], v[8:11]
 buffer_load_dwordx4 a[108:111], v173, s[52:55], s88 offen offset:3072 sc1
 v_mfma_f32_16x16x32_bf16 v[12:15], a[236:239], a[124:127], v[12:15]
 s_add_u32 s88, s88, 4096
 v_mfma_f32_16x16x32_bf16 v[12:15], a[220:223], a[120:123], v[12:15]
 v_add_f32 v142, v142, v234
 v_add_f32 v143, v143, v235
 v_mfma_f32_16x16x32_bf16 v[12:15], a[204:207], a[116:119], v[12:15]
 v_mfma_f32_16x16x32_bf16 v[12:15], a[188:191], a[112:115], v[12:15]
 s_waitcnt vmcnt(12)
 v_mfma_f32_16x16x32_bf16 v[16:19], a[128:131], a[64:67], 0
 buffer_load_dwordx4 a[112:115], v173, s[52:55], s88 offen offset:0 sc1
 v_mfma_f32_16x16x32_bf16 v[16:19], a[144:147], a[68:71], v[16:19]
 v_mfma_f32_16x16x32_bf16 v[16:19], v[64:67], a[72:75], v[16:19]
 v_mfma_f32_16x16x32_bf16 v[16:19], v[80:83], a[76:79], v[16:19]
 buffer_load_dwordx4 a[116:119], v173, s[52:55], s88 offen offset:1024 sc1
 v_mfma_f32_16x16x32_bf16 v[20:23], v[84:87], a[76:79], 0
 v_mfma_f32_16x16x32_bf16 v[20:23], v[68:71], a[72:75], v[20:23]
 v_add_f32 v128, v128, v0
 v_add_f32 v129, v129, v1
 v_mfma_f32_16x16x32_bf16 v[20:23], a[148:151], a[68:71], v[20:23]
 v_add_f32 v130, v130, v2
 v_add_f32 v131, v131, v3
 v_mfma_f32_16x16x32_bf16 v[20:23], a[132:135], a[64:67], v[20:23]
 buffer_load_dwordx4 a[120:123], v173, s[52:55], s88 offen offset:2048 sc1
 v_mfma_f32_16x16x32_bf16 v[24:27], a[136:139], a[64:67], 0
 v_add_f32 v132, v132, v4
 v_add_f32 v133, v133, v5
 v_mfma_f32_16x16x32_bf16 v[24:27], a[152:155], a[68:71], v[24:27]
 v_add_f32 v134, v134, v6
 v_add_f32 v135, v135, v7
 v_mfma_f32_16x16x32_bf16 v[24:27], v[72:75], a[72:75], v[24:27]
 v_add_f32 v136, v136, v8
 v_add_f32 v137, v137, v9
 v_mfma_f32_16x16x32_bf16 v[24:27], v[88:91], a[76:79], v[24:27]
 buffer_load_dwordx4 a[124:127], v173, s[52:55], s88 offen offset:3072 sc1
 v_mfma_f32_16x16x32_bf16 v[28:31], v[92:95], a[76:79], 0
 s_sub_u32 s88, s88, 12288
 v_add_f32 v138, v138, v10
 v_add_f32 v139, v139, v11
 v_mfma_f32_16x16x32_bf16 v[28:31], v[76:79], a[72:75], v[28:31]
 v_add_f32 v140, v140, v12
 v_add_f32 v141, v141, v13
 v_mfma_f32_16x16x32_bf16 v[28:31], a[156:159], a[68:71], v[28:31]
 v_add_f32 v142, v142, v14
 v_add_f32 v143, v143, v15
 v_mfma_f32_16x16x32_bf16 v[28:31], a[140:143], a[64:67], v[28:31]
 s_waitcnt vmcnt(12)
 v_mfma_f32_16x16x32_bf16 v[16:19], v[96:99], a[80:83], v[16:19]
 buffer_load_dwordx4 a[64:67], v174, s[52:55], s88 offen offset:0 sc1
 v_mfma_f32_16x16x32_bf16 v[16:19], a[32:35], a[84:87], v[16:19]
 buffer_load_dwordx4 a[68:71], v174, s[52:55], s88 offen offset:1024 sc1
 v_mfma_f32_16x16x32_bf16 v[16:19], a[48:51], a[88:91], v[16:19]
 v_mfma_f32_16x16x32_bf16 v[16:19], v[152:155], a[92:95], v[16:19]
 buffer_load_dwordx4 a[72:75], v174, s[52:55], s88 offen offset:2048 sc1
 v_mfma_f32_16x16x32_bf16 v[20:23], v[156:159], a[92:95], v[20:23]
 v_mfma_f32_16x16x32_bf16 v[20:23], a[52:55], a[88:91], v[20:23]
 buffer_load_dwordx4 a[76:79], v174, s[52:55], s88 offen offset:3072 sc1
 v_mfma_f32_16x16x32_bf16 v[20:23], a[36:39], a[84:87], v[20:23]
 s_add_u32 s88, s88, 4096
 v_mfma_f32_16x16x32_bf16 v[20:23], v[100:103], a[80:83], v[20:23]
 buffer_store_dwordx4 v[128:131], v251, s[52:55], s90 offen offset:0 sc1
 v_mfma_f32_16x16x32_bf16 v[24:27], v[104:107], a[80:83], v[24:27]
 v_mfma_f32_16x16x32_bf16 v[24:27], a[40:43], a[84:87], v[24:27]
 buffer_store_dwordx4 v[132:135], v251, s[52:55], s90 offen offset:1024 sc1
 v_mfma_f32_16x16x32_bf16 v[24:27], a[56:59], a[88:91], v[24:27]
 v_mfma_f32_16x16x32_bf16 v[24:27], v[160:163], a[92:95], v[24:27]
 buffer_store_dwordx4 v[136:139], v251, s[52:55], s90 offen offset:2048 sc1
 v_mfma_f32_16x16x32_bf16 v[28:31], v[164:167], a[92:95], v[28:31]
 v_mfma_f32_16x16x32_bf16 v[28:31], a[60:63], a[88:91], v[28:31]
 buffer_store_dwordx4 v[140:143], v251, s[52:55], s90 offen offset:3072 sc1
 v_mfma_f32_16x16x32_bf16 v[28:31], a[44:47], a[84:87], v[28:31]
 s_xor_b32 s90, s90, 131072
 v_mfma_f32_16x16x32_bf16 v[28:31], v[108:111], a[80:83], v[28:31]
 s_waitcnt vmcnt(12)
 v_mfma_f32_16x16x32_bf16 v[16:19], v[112:115], a[96:99], v[16:19]
 buffer_load_dwordx4 a[80:83], v174, s[52:55], s88 offen offset:0 sc1
 v_mfma_f32_16x16x32_bf16 v[16:19], a[0:3], a[100:103], v[16:19]
 v_mfma_f32_16x16x32_bf16 v[16:19], a[16:19], a[104:107], v[16:19]
 v_mfma_f32_16x16x32_bf16 v[16:19], a[160:163], a[108:111], v[16:19]
 buffer_load_dwordx4 a[84:87], v174, s[52:55], s88 offen offset:1024 sc1
 v_mfma_f32_16x16x32_bf16 v[20:23], a[164:167], a[108:111], v[20:23]
 v_mfma_f32_16x16x32_bf16 v[20:23], a[20:23], a[104:107], v[20:23]
 v_mfma_f32_16x16x32_bf16 v[20:23], a[4:7], a[100:103], v[20:23]
 v_mfma_f32_16x16x32_bf16 v[20:23], v[116:119], a[96:99], v[20:23]
 buffer_load_dwordx4 a[88:91], v174, s[52:55], s88 offen offset:2048 sc1
 v_mfma_f32_16x16x32_bf16 v[24:27], v[120:123], a[96:99], v[24:27]
 v_mfma_f32_16x16x32_bf16 v[24:27], a[8:11], a[100:103], v[24:27]
 v_mfma_f32_16x16x32_bf16 v[24:27], a[24:27], a[104:107], v[24:27]
 v_mfma_f32_16x16x32_bf16 v[24:27], a[168:171], a[108:111], v[24:27]
 buffer_load_dwordx4 a[92:95], v174, s[52:55], s88 offen offset:3072 sc1
 v_mfma_f32_16x16x32_bf16 v[28:31], a[172:175], a[108:111], v[28:31]
 s_add_u32 s88, s88, 4096
 v_mfma_f32_16x16x32_bf16 v[28:31], a[28:31], a[104:107], v[28:31]
 v_mfma_f32_16x16x32_bf16 v[28:31], a[12:15], a[100:103], v[28:31]
 v_mfma_f32_16x16x32_bf16 v[28:31], v[124:127], a[96:99], v[28:31]
 s_waitcnt vmcnt(12)
 v_mfma_f32_16x16x32_bf16 v[16:19], a[176:179], a[112:115], v[16:19]
 buffer_load_dwordx4 a[96:99], v174, s[52:55], s88 offen offset:0 sc1
 v_mfma_f32_16x16x32_bf16 v[16:19], a[192:195], a[116:119], v[16:19]
 buffer_load_dwordx4 a[100:103], v174, s[52:55], s88 offen offset:1024 sc1
 v_mfma_f32_16x16x32_bf16 v[16:19], a[208:211], a[120:123], v[16:19]
 v_mfma_f32_16x16x32_bf16 v[16:19], a[224:227], a[124:127], v[16:19]
 buffer_load_dwordx4 a[104:107], v174, s[52:55], s88 offen offset:2048 sc1
 v_mfma_f32_16x16x32_bf16 v[20:23], a[228:231], a[124:127], v[20:23]
 v_mfma_f32_16x16x32_bf16 v[20:23], a[212:215], a[120:123], v[20:23]
 buffer_load_dwordx4 a[108:111], v174, s[52:55], s88 offen offset:3072 sc1
 v_mfma_f32_16x16x32_bf16 v[20:23], a[196:199], a[116:119], v[20:23]
 s_add_u32 s88, s88, 4096
 v_mfma_f32_16x16x32_bf16 v[20:23], a[180:183], a[112:115], v[20:23]
 s_add_u32 m0, s76, 4096
 v_mfma_f32_16x16x32_bf16 v[24:27], a[184:187], a[112:115], v[24:27]
 s_add_u32 s79, s82, 933888
 v_mfma_f32_16x16x32_bf16 v[24:27], a[200:203], a[116:119], v[24:27]
 buffer_load_dwordx4 v251, s[52:55], s79 offen offset:0 sc1 lds
 v_mfma_f32_16x16x32_bf16 v[24:27], a[216:219], a[120:123], v[24:27]
 buffer_load_dwordx4 v251, s[52:55], s79 offen offset:1024 sc1 lds
 v_mfma_f32_16x16x32_bf16 v[24:27], a[232:235], a[124:127], v[24:27]
 buffer_load_dwordx4 v251, s[52:55], s79 offen offset:2048 sc1 lds
 v_mfma_f32_16x16x32_bf16 v[28:31], a[236:239], a[124:127], v[28:31]
 v_mfma_f32_16x16x32_bf16 v[28:31], a[220:223], a[120:123], v[28:31]
 buffer_load_dwordx4 v251, s[52:55], s79 offen offset:3072 sc1 lds
 v_mfma_f32_16x16x32_bf16 v[28:31], a[204:207], a[116:119], v[28:31]
 v_mfma_f32_16x16x32_bf16 v[28:31], a[188:191], a[112:115], v[28:31]
 s_waitcnt vmcnt(16)
 v_mfma_f32_16x16x32_bf16 v[32:35], a[128:131], a[64:67], 0
 s_waitcnt vmcnt(12)
 v_mfma_f32_16x16x32_bf16 v[32:35], a[144:147], a[68:71], v[32:35]
 s_barrier
 v_mfma_f32_16x16x32_bf16 v[32:35], v[64:67], a[72:75], v[32:35]
 buffer_atomic_add v249, v248, s[52:55], s91 offen sc1
 v_mfma_f32_16x16x32_bf16 v[32:35], v[80:83], a[76:79], v[32:35]
 s_xor_b32 s91, s91, 1024
 v_mfma_f32_16x16x32_bf16 v[36:39], v[84:87], a[76:79], 0
 buffer_load_dwordx4 a[112:115], v174, s[52:55], s88 offen offset:0 sc1
 v_mfma_f32_16x16x32_bf16 v[36:39], v[68:71], a[72:75], v[36:39]
 ds_write_b128 v187, v[16:19] offset:0
 ds_write_b128 v187, v[20:23] offset:1024
 v_mfma_f32_16x16x32_bf16 v[36:39], a[148:151], a[68:71], v[36:39]
 buffer_load_dwordx4 a[116:119], v174, s[52:55], s88 offen offset:1024 sc1
 v_mfma_f32_16x16x32_bf16 v[36:39], a[132:135], a[64:67], v[36:39]
 ds_write_b128 v187, v[24:27] offset:2048
 ds_write_b128 v187, v[28:31] offset:3072
 v_mfma_f32_16x16x32_bf16 v[40:43], a[136:139], a[64:67], 0
 v_mfma_f32_16x16x32_bf16 v[40:43], a[152:155], a[68:71], v[40:43]
 buffer_load_dwordx4 a[120:123], v174, s[52:55], s88 offen offset:2048 sc1
 v_mfma_f32_16x16x32_bf16 v[40:43], v[72:75], a[72:75], v[40:43]
 v_mfma_f32_16x16x32_bf16 v[40:43], v[88:91], a[76:79], v[40:43]
 v_mfma_f32_16x16x32_bf16 v[44:47], v[92:95], a[76:79], 0
 buffer_load_dwordx4 a[124:127], v174, s[52:55], s88 offen offset:3072 sc1
 v_mfma_f32_16x16x32_bf16 v[44:47], v[76:79], a[72:75], v[44:47]
 s_sub_u32 s88, s88, 12288
 v_mfma_f32_16x16x32_bf16 v[44:47], a[156:159], a[68:71], v[44:47]
 v_mfma_f32_16x16x32_bf16 v[44:47], a[140:143], a[64:67], v[44:47]
 s_waitcnt vmcnt(13)
 v_mfma_f32_16x16x32_bf16 v[32:35], v[96:99], a[80:83], v[32:35]
 buffer_load_dwordx4 a[64:67], v175, s[52:55], s88 offen offset:0 sc1
 v_mfma_f32_16x16x32_bf16 v[32:35], a[32:35], a[84:87], v[32:35]
 v_mfma_f32_16x16x32_bf16 v[32:35], a[48:51], a[88:91], v[32:35]
 v_mfma_f32_16x16x32_bf16 v[32:35], v[152:155], a[92:95], v[32:35]
 buffer_load_dwordx4 a[68:71], v175, s[52:55], s88 offen offset:1024 sc1
 v_mfma_f32_16x16x32_bf16 v[36:39], v[156:159], a[92:95], v[36:39]
 v_mfma_f32_16x16x32_bf16 v[36:39], a[52:55], a[88:91], v[36:39]
 v_mfma_f32_16x16x32_bf16 v[36:39], a[36:39], a[84:87], v[36:39]
 v_mfma_f32_16x16x32_bf16 v[36:39], v[100:103], a[80:83], v[36:39]
 buffer_load_dwordx4 a[72:75], v175, s[52:55], s88 offen offset:2048 sc1
 v_mfma_f32_16x16x32_bf16 v[40:43], v[104:107], a[80:83], v[40:43]
 v_mfma_f32_16x16x32_bf16 v[40:43], a[40:43], a[84:87], v[40:43]
 v_mfma_f32_16x16x32_bf16 v[40:43], a[56:59], a[88:91], v[40:43]
 v_mfma_f32_16x16x32_bf16 v[40:43], v[160:163], a[92:95], v[40:43]
 buffer_load_dwordx4 a[76:79], v175, s[52:55], s88 offen offset:3072 sc1
 v_mfma_f32_16x16x32_bf16 v[44:47], v[164:167], a[92:95], v[44:47]
 s_add_u32 s88, s88, 4096
 v_mfma_f32_16x16x32_bf16 v[44:47], a[60:63], a[88:91], v[44:47]
 v_mfma_f32_16x16x32_bf16 v[44:47], a[44:47], a[84:87], v[44:47]
 v_mfma_f32_16x16x32_bf16 v[44:47], v[108:111], a[80:83], v[44:47]
 s_waitcnt vmcnt(13)
 v_mfma_f32_16x16x32_bf16 v[32:35], v[112:115], a[96:99], v[32:35]
 buffer_load_dwordx4 a[80:83], v175, s[52:55], s88 offen offset:0 sc1
 v_mfma_f32_16x16x32_bf16 v[32:35], a[0:3], a[100:103], v[32:35]
 buffer_load_dwordx4 a[84:87], v175, s[52:55], s88 offen offset:1024 sc1
 v_mfma_f32_16x16x32_bf16 v[32:35], a[16:19], a[104:107], v[32:35]
 v_mfma_f32_16x16x32_bf16 v[32:35], a[160:163], a[108:111], v[32:35]
 buffer_load_dwordx4 a[88:91], v175, s[52:55], s88 offen offset:2048 sc1
 v_mfma_f32_16x16x32_bf16 v[36:39], a[164:167], a[108:111], v[36:39]
 v_mfma_f32_16x16x32_bf16 v[36:39], a[20:23], a[104:107], v[36:39]
 buffer_load_dwordx4 a[92:95], v175, s[52:55], s88 offen offset:3072 sc1
 v_mfma_f32_16x16x32_bf16 v[36:39], a[4:7], a[100:103], v[36:39]
 s_add_u32 s88, s88, 4096
 v_mfma_f32_16x16x32_bf16 v[36:39], v[116:119], a[96:99], v[36:39]
 s_add_u32 m0, s76, 8192
 v_mfma_f32_16x16x32_bf16 v[40:43], v[120:123], a[96:99], v[40:43]
 s_add_u32 s79, s82, 950272
 v_mfma_f32_16x16x32_bf16 v[40:43], a[8:11], a[100:103], v[40:43]
 buffer_load_dwordx4 v251, s[52:55], s79 offen offset:0 sc1 lds
 v_mfma_f32_16x16x32_bf16 v[40:43], a[24:27], a[104:107], v[40:43]
 buffer_load_dwordx4 v251, s[52:55], s79 offen offset:1024 sc1 lds
 v_mfma_f32_16x16x32_bf16 v[40:43], a[168:171], a[108:111], v[40:43]
 buffer_load_dwordx4 v251, s[52:55], s79 offen offset:2048 sc1 lds
 v_mfma_f32_16x16x32_bf16 v[44:47], a[172:175], a[108:111], v[44:47]
 v_mfma_f32_16x16x32_bf16 v[44:47], a[28:31], a[104:107], v[44:47]
 buffer_load_dwordx4 v251, s[52:55], s79 offen offset:3072 sc1 lds
 v_mfma_f32_16x16x32_bf16 v[44:47], a[12:15], a[100:103], v[44:47]
 v_mfma_f32_16x16x32_bf16 v[44:47], v[124:127], a[96:99], v[44:47]
 s_waitcnt vmcnt(12)
 v_mfma_f32_16x16x32_bf16 v[32:35], a[176:179], a[112:115], v[32:35]
 buffer_load_dwordx4 a[96:99], v175, s[52:55], s88 offen offset:0 sc1
 v_mfma_f32_16x16x32_bf16 v[32:35], a[192:195], a[116:119], v[32:35]
 v_mfma_f32_16x16x32_bf16 v[32:35], a[208:211], a[120:123], v[32:35]
 v_mfma_f32_16x16x32_bf16 v[32:35], a[224:227], a[124:127], v[32:35]
 buffer_load_dwordx4 a[100:103], v175, s[52:55], s88 offen offset:1024 sc1
 v_mfma_f32_16x16x32_bf16 v[36:39], a[228:231], a[124:127], v[36:39]
 v_mfma_f32_16x16x32_bf16 v[36:39], a[212:215], a[120:123], v[36:39]
 v_mfma_f32_16x16x32_bf16 v[36:39], a[196:199], a[116:119], v[36:39]
 v_mfma_f32_16x16x32_bf16 v[36:39], a[180:183], a[112:115], v[36:39]
 buffer_load_dwordx4 a[104:107], v175, s[52:55], s88 offen offset:2048 sc1
 v_mfma_f32_16x16x32_bf16 v[40:43], a[184:187], a[112:115], v[40:43]
 v_mfma_f32_16x16x32_bf16 v[40:43], a[200:203], a[116:119], v[40:43]
 v_mfma_f32_16x16x32_bf16 v[40:43], a[216:219], a[120:123], v[40:43]
 v_mfma_f32_16x16x32_bf16 v[40:43], a[232:235], a[124:127], v[40:43]
 buffer_load_dwordx4 a[108:111], v175, s[52:55], s88 offen offset:3072 sc1
 v_mfma_f32_16x16x32_bf16 v[44:47], a[236:239], a[124:127], v[44:47]
 s_add_u32 s88, s88, 4096
 v_mfma_f32_16x16x32_bf16 v[44:47], a[220:223], a[120:123], v[44:47]
 v_mfma_f32_16x16x32_bf16 v[44:47], a[204:207], a[116:119], v[44:47]
 v_mfma_f32_16x16x32_bf16 v[44:47], a[188:191], a[112:115], v[44:47]
 s_waitcnt vmcnt(12)
 v_mfma_f32_16x16x32_bf16 v[48:51], a[128:131], a[64:67], 0
 buffer_load_dword v238, v186, s[52:55], s91 offen sc1
 v_mfma_f32_16x16x32_bf16 v[48:51], a[144:147], a[68:71], v[48:51]
 v_mfma_f32_16x16x32_bf16 v[48:51], v[64:67], a[72:75], v[48:51]
 buffer_load_dwordx4 a[112:115], v175, s[52:55], s88 offen offset:0 sc1
 v_mfma_f32_16x16x32_bf16 v[48:51], v[80:83], a[76:79], v[48:51]
 v_mfma_f32_16x16x32_bf16 v[52:55], v[84:87], a[76:79], 0
 v_mfma_f32_16x16x32_bf16 v[52:55], v[68:71], a[72:75], v[52:55]
 ds_write_b128 v188, v[32:35] offset:4096
 ds_write_b128 v188, v[36:39] offset:5120
 v_mfma_f32_16x16x32_bf16 v[52:55], a[148:151], a[68:71], v[52:55]
 buffer_load_dwordx4 a[116:119], v175, s[52:55], s88 offen offset:1024 sc1
 v_mfma_f32_16x16x32_bf16 v[52:55], a[132:135], a[64:67], v[52:55]
 ds_write_b128 v188, v[40:43] offset:6144
 ds_write_b128 v188, v[44:47] offset:7168
 v_mfma_f32_16x16x32_bf16 v[56:59], a[136:139], a[64:67], 0
 buffer_load_dwordx4 a[120:123], v175, s[52:55], s88 offen offset:2048 sc1
 v_mfma_f32_16x16x32_bf16 v[56:59], a[152:155], a[68:71], v[56:59]
 v_mfma_f32_16x16x32_bf16 v[56:59], v[72:75], a[72:75], v[56:59]
 v_mfma_f32_16x16x32_bf16 v[56:59], v[88:91], a[76:79], v[56:59]
 buffer_load_dwordx4 a[124:127], v175, s[52:55], s88 offen offset:3072 sc1
 v_mfma_f32_16x16x32_bf16 v[60:63], v[92:95], a[76:79], 0
 s_sub_u32 s88, s88, 12288
 v_mfma_f32_16x16x32_bf16 v[60:63], v[76:79], a[72:75], v[60:63]
 v_mfma_f32_16x16x32_bf16 v[60:63], a[156:159], a[68:71], v[60:63]
 v_mfma_f32_16x16x32_bf16 v[60:63], a[140:143], a[64:67], v[60:63]
 s_waitcnt vmcnt(13)
 v_mfma_f32_16x16x32_bf16 v[48:51], v[96:99], a[80:83], v[48:51]
 buffer_load_dwordx4 a[64:67], v172, s[52:55], s88 offen offset:0 sc1
 v_mfma_f32_16x16x32_bf16 v[48:51], a[32:35], a[84:87], v[48:51]
 v_mfma_f32_16x16x32_bf16 v[48:51], a[48:51], a[88:91], v[48:51]
 v_mfma_f32_16x16x32_bf16 v[48:51], v[152:155], a[92:95], v[48:51]
 buffer_load_dwordx4 a[68:71], v172, s[52:55], s88 offen offset:1024 sc1
 v_mfma_f32_16x16x32_bf16 v[52:55], v[156:159], a[92:95], v[52:55]
 v_mfma_f32_16x16x32_bf16 v[52:55], a[52:55], a[88:91], v[52:55]
 v_mfma_f32_16x16x32_bf16 v[52:55], a[36:39], a[84:87], v[52:55]
 v_mfma_f32_16x16x32_bf16 v[52:55], v[100:103], a[80:83], v[52:55]
 buffer_load_dwordx4 a[72:75], v172, s[52:55], s88 offen offset:2048 sc1
 v_mfma_f32_16x16x32_bf16 v[56:59], v[104:107], a[80:83], v[56:59]
 v_mfma_f32_16x16x32_bf16 v[56:59], a[40:43], a[84:87], v[56:59]
 v_mfma_f32_16x16x32_bf16 v[56:59], a[56:59], a[88:91], v[56:59]
 v_mfma_f32_16x16x32_bf16 v[56:59], v[160:163], a[92:95], v[56:59]
 buffer_load_dwordx4 a[76:79], v172, s[52:55], s88 offen offset:3072 sc1
 v_mfma_f32_16x16x32_bf16 v[60:63], v[164:167], a[92:95], v[60:63]
 s_add_u32 s88, s88, 4096
 v_mfma_f32_16x16x32_bf16 v[60:63], a[60:63], a[88:91], v[60:63]
 v_mfma_f32_16x16x32_bf16 v[60:63], a[44:47], a[84:87], v[60:63]
 v_mfma_f32_16x16x32_bf16 v[60:63], v[108:111], a[80:83], v[60:63]
 s_waitcnt vmcnt(9)
 v_mfma_f32_16x16x32_bf16 v[48:51], v[112:115], a[96:99], v[48:51]
 buffer_load_dwordx4 a[80:83], v172, s[52:55], s88 offen offset:0 sc1
 v_mfma_f32_16x16x32_bf16 v[48:51], a[0:3], a[100:103], v[48:51]
 v_lshlrev_b32 v32, 16, v178
 v_and_b32 v33, 0xffff0000, v178
 v_mfma_f32_16x16x32_bf16 v[48:51], a[16:19], a[104:107], v[48:51]
 buffer_load_dwordx4 a[84:87], v172, s[52:55], s88 offen offset:1024 sc1
 v_mfma_f32_16x16x32_bf16 v[48:51], a[160:163], a[108:111], v[48:51]
 buffer_load_dwordx4 a[88:91], v172, s[52:55], s88 offen offset:2048 sc1
 v_mfma_f32_16x16x32_bf16 v[52:55], a[164:167], a[108:111], v[52:55]
 v_lshlrev_b32 v34, 16, v179
 v_and_b32 v35, 0xffff0000, v179
 v_mfma_f32_16x16x32_bf16 v[52:55], a[20:23], a[104:107], v[52:55]
 buffer_load_dwordx4 a[92:95], v172, s[52:55], s88 offen offset:3072 sc1
 v_mfma_f32_16x16x32_bf16 v[52:55], a[4:7], a[100:103], v[52:55]
 s_add_u32 s88, s88, 4096
 v_mfma_f32_16x16x32_bf16 v[52:55], v[116:119], a[96:99], v[52:55]
 s_waitcnt vmcnt(12)
 v_lshlrev_b32 v36, 16, v180
 v_and_b32 v37, 0xffff0000, v180
 v_mfma_f32_16x16x32_bf16 v[56:59], v[120:123], a[96:99], v[56:59]
 v_cmp_gt_u32 vcc, 1, v238
 v_mfma_f32_16x16x32_bf16 v[56:59], a[8:11], a[100:103], v[56:59]
 s_cbranch_vccnz Lts65
Ltb66:
 v_mfma_f32_16x16x32_bf16 v[56:59], a[24:27], a[104:107], v[56:59]
 buffer_load_dwordx4 v[16:19], v251, s[52:55], s90 offen offset:0 sc1
 v_mfma_f32_16x16x32_bf16 v[56:59], a[168:171], a[108:111], v[56:59]
 buffer_load_dwordx4 v[20:23], v251, s[52:55], s90 offen offset:1024 sc1
 v_mfma_f32_16x16x32_bf16 v[60:63], a[172:175], a[108:111], v[60:63]
 buffer_load_dwordx4 v[24:27], v251, s[52:55], s90 offen offset:2048 sc1
 v_mfma_f32_16x16x32_bf16 v[60:63], a[28:31], a[104:107], v[60:63]
 v_lshlrev_b32 v38, 16, v181
 v_and_b32 v39, 0xffff0000, v181
 v_mfma_f32_16x16x32_bf16 v[60:63], a[12:15], a[100:103], v[60:63]
 buffer_load_dwordx4 v[28:31], v251, s[52:55], s90 offen offset:3072 sc1
 v_mfma_f32_16x16x32_bf16 v[60:63], v[124:127], a[96:99], v[60:63]
 s_waitcnt vmcnt(12)
 v_lshlrev_b32 v40, 16, v182
 v_and_b32 v41, 0xffff0000, v182
 v_mfma_f32_16x16x32_bf16 v[48:51], a[176:179], a[112:115], v[48:51]
 buffer_load_dwordx4 a[96:99], v172, s[52:55], s88 offen offset:0 sc1
 v_mfma_f32_16x16x32_bf16 v[48:51], a[192:195], a[116:119], v[48:51]
 v_mfma_f32_16x16x32_bf16 v[48:51], a[208:211], a[120:123], v[48:51]
 v_mfma_f32_16x16x32_bf16 v[48:51], a[224:227], a[124:127], v[48:51]
 buffer_load_dwordx4 a[100:103], v172, s[52:55], s88 offen offset:1024 sc1
 v_mfma_f32_16x16x32_bf16 v[52:55], a[228:231], a[124:127], v[52:55]
 v_lshlrev_b32 v42, 16, v183
 v_and_b32 v43, 0xffff0000, v183
 v_mfma_f32_16x16x32_bf16 v[52:55], a[212:215], a[120:123], v[52:55]
 v_mfma_f32_16x16x32_bf16 v[52:55], a[196:199], a[116:119], v[52:55]
 v_mfma_f32_16x16x32_bf16 v[52:55], a[180:183], a[112:115], v[52:55]
 buffer_load_dwordx4 a[104:107], v172, s[52:55], s88 offen offset:2048 sc1
 v_mfma_f32_16x16x32_bf16 v[56:59], a[184:187], a[112:115], v[56:59]
 v_lshlrev_b32 v44, 16, v184
 v_and_b32 v45, 0xffff0000, v184
 v_mfma_f32_16x16x32_bf16 v[56:59], a[200:203], a[116:119], v[56:59]
 v_mfma_f32_16x16x32_bf16 v[56:59], a[216:219], a[120:123], v[56:59]
 v_mfma_f32_16x16x32_bf16 v[56:59], a[232:235], a[124:127], v[56:59]
 buffer_load_dwordx4 a[108:111], v172, s[52:55], s88 offen offset:3072 sc1
 v_mfma_f32_16x16x32_bf16 v[60:63], a[236:239], a[124:127], v[60:63]
 s_add_u32 s88, s88, 4096
 v_lshlrev_b32 v46, 16, v185
 v_and_b32 v47, 0xffff0000, v185
 v_mfma_f32_16x16x32_bf16 v[60:63], a[220:223], a[120:123], v[60:63]
 v_mfma_f32_16x16x32_bf16 v[60:63], a[204:207], a[116:119], v[60:63]
 v_mfma_f32_16x16x32_bf16 v[60:63], a[188:191], a[112:115], v[60:63]
 s_waitcnt vmcnt(12)
 v_mfma_f32_16x16x32_bf16 v[0:3], a[128:131], a[64:67], 0
 buffer_load_dwordx4 a[112:115], v172, s[52:55], s88 offen offset:0 sc1
 v_mfma_f32_16x16x32_bf16 v[0:3], a[144:147], a[68:71], v[0:3]
 v_mfma_f32_16x16x32_bf16 v[0:3], v[64:67], a[72:75], v[0:3]
 v_mfma_f32_16x16x32_bf16 v[0:3], v[80:83], a[76:79], v[0:3]
 buffer_load_dwordx4 a[116:119], v172, s[52:55], s88 offen offset:1024 sc1
 v_mfma_f32_16x16x32_bf16 v[4:7], v[84:87], a[76:79], 0
 v_mfma_f32_16x16x32_bf16 v[4:7], v[68:71], a[72:75], v[4:7]
 ds_write_b128 v189, v[48:51] offset:28672
 ds_write_b128 v189, v[52:55] offset:29696
 v_mfma_f32_16x16x32_bf16 v[4:7], a[148:151], a[68:71], v[4:7]
 ds_write_b128 v189, v[56:59] offset:30720
 ds_write_b128 v189, v[60:63] offset:31744
 v_mfma_f32_16x16x32_bf16 v[4:7], a[132:135], a[64:67], v[4:7]
 buffer_load_dwordx4 a[120:123], v172, s[52:55], s88 offen offset:2048 sc1
 v_mfma_f32_16x16x32_bf16 v[8:11], a[136:139], a[64:67], 0
 v_mfma_f32_16x16x32_bf16 v[8:11], a[152:155], a[68:71], v[8:11]
 v_mfma_f32_16x16x32_bf16 v[8:11], v[72:75], a[72:75], v[8:11]
 v_mfma_f32_16x16x32_bf16 v[8:11], v[88:91], a[76:79], v[8:11]
 buffer_load_dwordx4 a[124:127], v172, s[52:55], s88 offen offset:3072 sc1
 v_mfma_f32_16x16x32_bf16 v[12:15], v[92:95], a[76:79], 0
 s_waitcnt lgkmcnt(0)
 v_mfma_f32_16x16x32_bf16 v[12:15], v[76:79], a[72:75], v[12:15]
 s_barrier
 ds_read_b128 v[128:131], v190 offset:0
 ds_read_b128 v[132:135], v190 offset:1024
 v_mfma_f32_16x16x32_bf16 v[12:15], a[156:159], a[68:71], v[12:15]
 s_sub_u32 s88, s88, 12288
 ds_read_b128 v[136:139], v190 offset:2048
 ds_read_b128 v[140:143], v190 offset:3072
 v_mfma_f32_16x16x32_bf16 v[12:15], a[140:143], a[64:67], v[12:15]
 s_waitcnt vmcnt(12)
 ds_read_b128 v[204:207], v190 offset:4096
 ds_read_b128 v[208:211], v190 offset:5120
 v_mfma_f32_16x16x32_bf16 v[0:3], v[96:99], a[80:83], v[0:3]
 s_add_u32 m0, s76, 12288
 ds_read_b128 v[212:215], v190 offset:6144
 ds_read_b128 v[216:219], v190 offset:7168
 ds_read_b128 v[220:223], v191 offset:28672
 ds_read_b128 v[224:227], v191 offset:29696
 ds_read_b128 v[228:231], v191 offset:30720
 ds_read_b128 v[232:235], v191 offset:31744
 v_mfma_f32_16x16x32_bf16 v[0:3], a[32:35], a[84:87], v[0:3]
 s_add_u32 s79, s82, 966656
 v_mfma_f32_16x16x32_bf16 v[0:3], a[48:51], a[88:91], v[0:3]
 buffer_load_dwordx4 v251, s[52:55], s79 offen offset:0 sc1 lds
 v_mfma_f32_16x16x32_bf16 v[0:3], v[152:155], a[92:95], v[0:3]
 buffer_load_dwordx4 v251, s[52:55], s79 offen offset:1024 sc1 lds
 v_mfma_f32_16x16x32_bf16 v[4:7], v[156:159], a[92:95], v[4:7]
 v_mfma_f32_16x16x32_bf16 v[4:7], a[52:55], a[88:91], v[4:7]
 v_mfma_f32_16x16x32_bf16 v[4:7], a[36:39], a[84:87], v[4:7]
 v_mfma_f32_16x16x32_bf16 v[4:7], v[100:103], a[80:83], v[4:7]
 buffer_load_dwordx4 v251, s[52:55], s79 offen offset:2048 sc1 lds
 v_mfma_f32_16x16x32_bf16 v[8:11], v[104:107], a[80:83], v[8:11]
 s_waitcnt lgkmcnt(0)
 v_add_f32 v128, v128, v204
 v_add_f32 v129, v129, v205
 v_mfma_f32_16x16x32_bf16 v[8:11], a[40:43], a[84:87], v[8:11]
 v_add_f32 v130, v130, v206
 v_add_f32 v131, v131, v207
 v_mfma_f32_16x16x32_bf16 v[8:11], a[56:59], a[88:91], v[8:11]
 v_add_f32 v132, v132, v208
 v_add_f32 v133, v133, v209
 v_mfma_f32_16x16x32_bf16 v[8:11], v[160:163], a[92:95], v[8:11]
 buffer_load_dwordx4 v251, s[52:55], s79 offen offset:3072 sc1 lds
 v_mfma_f32_16x16x32_bf16 v[12:15], v[164:167], a[92:95], v[12:15]
 v_add_f32 v134, v134, v210
 v_add_f32 v135, v135, v211
 v_mfma_f32_16x16x32_bf16 v[12:15], a[60:63], a[88:91], v[12:15]
 v_add_f32 v136, v136, v212
 v_add_f32 v137, v137, v213
 v_mfma_f32_16x16x32_bf16 v[12:15], a[44:47], a[84:87], v[12:15]
 v_add_f32 v138, v138, v214
 v_add_f32 v139, v139, v215
 v_mfma_f32_16x16x32_bf16 v[12:15], v[108:111], a[80:83], v[12:15]
 s_waitcnt vmcnt(8)
 v_add_f32 v140, v140, v216
 v_add_f32 v141, v141, v217
 v_mfma_f32_16x16x32_bf16 v[0:3], v[112:115], a[96:99], v[0:3]
 s_add_u32 m0, s76, 16384
 v_add_f32 v142, v142, v218
 v_add_f32 v143, v143, v219
 v_mfma_f32_16x16x32_bf16 v[0:3], a[0:3], a[100:103], v[0:3]
 s_add_u32 s79, s82, 0
 v_add_f32 v128, v128, v220
 v_add_f32 v129, v129, v221
 v_mfma_f32_16x16x32_bf16 v[0:3], a[16:19], a[104:107], v[0:3]
 buffer_load_dwordx4 v251, s[52:55], s79 offen offset:0 sc1 lds
 v_mfma_f32_16x16x32_bf16 v[0:3], a[160:163], a[108:111], v[0:3]
 v_add_f32 v130, v130, v222
 v_add_f32 v131, v131, v223
 v_mfma_f32_16x16x32_bf16 v[4:7], a[164:167], a[108:111], v[4:7]
 buffer_load_dwordx4 v251, s[52:55], s79 offen offset:1024 sc1 lds
 v_mfma_f32_16x16x32_bf16 v[4:7], a[20:23], a[104:107], v[4:7]
 v_add_f32 v132, v132, v224
 v_add_f32 v133, v133, v225
 v_mfma_f32_16x16x32_bf16 v[4:7], a[4:7], a[100:103], v[4:7]
 v_add_f32 v134, v134, v226
 v_add_f32 v135, v135, v227
 v_mfma_f32_16x16x32_bf16 v[4:7], v[116:119], a[96:99], v[4:7]
 v_add_f32 v136, v136, v228
 v_add_f32 v137, v137, v229
 v_mfma_f32_16x16x32_bf16 v[8:11], v[120:123], a[96:99], v[8:11]
 buffer_load_dwordx4 v251, s[52:55], s79 offen offset:2048 sc1 lds
 v_mfma_f32_16x16x32_bf16 v[8:11], a[8:11], a[100:103], v[8:11]
 v_add_f32 v138, v138, v230
 v_add_f32 v139, v139, v231
 v_mfma_f32_16x16x32_bf16 v[8:11], a[24:27], a[104:107], v[8:11]
 v_add_f32 v140, v140, v232
 v_add_f32 v141, v141, v233
 v_mfma_f32_16x16x32_bf16 v[8:11], a[168:171], a[108:111], v[8:11]
 v_add_f32 v142, v142, v234
 v_add_f32 v143, v143, v235
 v_mfma_f32_16x16x32_bf16 v[12:15], a[172:175], a[108:111], v[12:15]
 buffer_load_dwordx4 v251, s[52:55], s79 offen offset:3072 sc1 lds
 v_mfma_f32_16x16x32_bf16 v[12:15], a[28:31], a[104:107], v[12:15]
 v_add_f32 v128, v128, v32
 v_add_f32 v129, v129, v33
 v_mfma_f32_16x16x32_bf16 v[12:15], a[12:15], a[100:103], v[12:15]
 v_add_f32 v130, v130, v34
 v_add_f32 v131, v131, v35
 v_mfma_f32_16x16x32_bf16 v[12:15], v[124:127], a[96:99], v[12:15]
 s_waitcnt vmcnt(8)
 v_add_f32 v132, v132, v36
 v_add_f32 v133, v133, v37
 v_mfma_f32_16x16x32_bf16 v[0:3], a[176:179], a[112:115], v[0:3]
 v_add_f32 v134, v134, v38
 v_add_f32 v135, v135, v39
 v_mfma_f32_16x16x32_bf16 v[0:3], a[192:195], a[116:119], v[0:3]
 v_add_f32 v136, v136, v40
 v_add_f32 v137, v137, v41
 v_mfma_f32_16x16x32_bf16 v[0:3], a[208:211], a[120:123], v[0:3]
 v_add_f32 v138, v138, v42
 v_add_f32 v139, v139, v43
 v_mfma_f32_16x16x32_bf16 v[0:3], a[224:227], a[124:127], v[0:3]
 v_add_f32 v140, v140, v44
 v_add_f32 v141, v141, v45
 v_mfma_f32_16x16x32_bf16 v[4:7], a[228:231], a[124:127], v[4:7]
 v_add_f32 v142, v142, v46
 v_add_f32 v143, v143, v47
 v_mfma_f32_16x16x32_bf16 v[4:7], a[212:215], a[120:123], v[4:7]
 s_waitcnt vmcnt(16)
 v_add_f32 v128, v128, v16
 v_add_f32 v129, v129, v17
 v_mfma_f32_16x16x32_bf16 v[4:7], a[196:199], a[116:119], v[4:7]
 v_mfma_f32_16x16x32_bf16 v[4:7], a[180:183], a[112:115], v[4:7]
 v_add_f32 v130, v130, v18
 v_add_f32 v131, v131, v19
 v_mfma_f32_16x16x32_bf16 v[8:11], a[184:187], a[112:115], v[8:11]
 v_add_f32 v132, v132, v20
 v_add_f32 v133, v133, v21
 v_mfma_f32_16x16x32_bf16 v[8:11], a[200:203], a[116:119], v[8:11]
 v_add_f32 v134, v134, v22
 v_add_f32 v135, v135, v23
 v_mfma_f32_16x16x32_bf16 v[8:11], a[216:219], a[120:123], v[8:11]
 v_add_f32 v136, v136, v24
 v_add_f32 v137, v137, v25
 v_mfma_f32_16x16x32_bf16 v[8:11], a[232:235], a[124:127], v[8:11]
 v_mfma_f32_16x16x32_bf16 v[12:15], a[236:239], a[124:127], v[12:15]
 v_add_f32 v138, v138, v26
 v_add_f32 v139, v139, v27
 v_mfma_f32_16x16x32_bf16 v[12:15], a[220:223], a[120:123], v[12:15]
 v_add_f32 v140, v140, v28
 v_add_f32 v141, v141, v29
 v_mfma_f32_16x16x32_bf16 v[12:15], a[204:207], a[116:119], v[12:15]
 v_add_f32 v142, v142, v30
 v_add_f32 v143, v143, v31
 v_mfma_f32_16x16x32_bf16 v[12:15], a[188:191], a[112:115], v[12:15]
 v_pk_add_f32 v[0:1], v[0:1], v[128:129]
 v_pk_add_f32 v[2:3], v[2:3], v[130:131]
 v_pk_add_f32 v[4:5], v[4:5], v[132:133]
 v_pk_add_f32 v[6:7], v[6:7], v[134:135]
 v_pk_add_f32 v[8:9], v[8:9], v[136:137]
 v_pk_add_f32 v[10:11], v[10:11], v[138:139]
 s_nop 1
 v_pk_add_f32 v[12:13], v[12:13], v[140:141]
 v_pk_add_f32 v[14:15], v[14:15], v[142:143]
 v_cvt_pk_bf16_f32 v240, v0, v1
 v_cvt_pk_bf16_f32 v241, v2, v3
 v_cvt_pk_bf16_f32 v242, v4, v5
 v_cvt_pk_bf16_f32 v243, v6, v7
 v_cvt_pk_bf16_f32 v244, v8, v9
 v_cvt_pk_bf16_f32 v245, v10, v11
 v_cvt_pk_bf16_f32 v246, v12, v13
 v_cvt_pk_bf16_f32 v247, v14, v15
 s_lshl_b32 s79, s75, 11
 s_lshl_b32 s78, s74, 16
 s_add_u32 s79, s79, s78
 s_add_u32 s79, s79, 54525952
 buffer_store_dwordx4 v[240:243], v176, s[52:55], s79 offen offset:0 sc1
 buffer_store_dwordx4 v[244:247], v176, s[52:55], s79 offen offset:1024 sc1
 v_lshlrev_b32 v112, 16, v240
 v_and_b32 v113, 0xffff0000, v240
 v_lshlrev_b32 v114, 16, v241
 v_and_b32 v115, 0xffff0000, v241
 v_lshlrev_b32 v116, 16, v242
 v_and_b32 v117, 0xffff0000, v242
 v_lshlrev_b32 v118, 16, v243
 v_and_b32 v119, 0xffff0000, v243
 v_lshlrev_b32 v120, 16, v244
 v_and_b32 v121, 0xffff0000, v244
 v_lshlrev_b32 v122, 16, v245
 v_and_b32 v123, 0xffff0000, v245
 v_lshlrev_b32 v124, 16, v246
 v_and_b32 v125, 0xffff0000, v246
 v_lshlrev_b32 v126, 16, v247
 v_and_b32 v127, 0xffff0000, v247
 v_add_f32 v192, v112, v113
 v_mul_f32 v193, v112, v112
 v_fmac_f32 v193, v113, v113
 v_add_f32 v192, v192, v114
 v_fmac_f32 v193, v114, v114
 v_add_f32 v192, v192, v115
 v_fmac_f32 v193, v115, v115
 v_add_f32 v192, v192, v116
 v_fmac_f32 v193, v116, v116
 v_add_f32 v192, v192, v117
 v_fmac_f32 v193, v117, v117
 v_add_f32 v192, v192, v118
 v_fmac_f32 v193, v118, v118
 v_add_f32 v192, v192, v119
 v_fmac_f32 v193, v119, v119
 v_add_f32 v192, v192, v120
 v_fmac_f32 v193, v120, v120
 v_add_f32 v192, v192, v121
 v_fmac_f32 v193, v121, v121
 v_add_f32 v192, v192, v122
 v_fmac_f32 v193, v122, v122
 v_add_f32 v192, v192, v123
 v_fmac_f32 v193, v123, v123
 v_add_f32 v192, v192, v124
 v_fmac_f32 v193, v124, v124
 v_add_f32 v192, v192, v125
 v_fmac_f32 v193, v125, v125
 v_add_f32 v192, v192, v126
 v_fmac_f32 v193, v126, v126
 v_add_f32 v192, v192, v127
 v_fmac_f32 v193, v127, v127
 v_mov_b32 v194, v192
 v_mov_b32 v195, v193
 s_nop 0
 v_permlane16_swap_b32 v194, v192
 v_permlane16_swap_b32 v195, v193
 v_add_f32 v192, v192, v194
 v_add_f32 v193, v193, v195
 v_mov_b32 v194, v192
 v_mov_b32 v195, v193
 s_nop 0
 v_permlane32_swap_b32 v194, v192
 v_permlane32_swap_b32 v195, v193
 v_add_f32 v192, v192, v194
 v_add_f32 v193, v193, v195
 v_lshlrev_b32 v250, 3, v253
 v_lshl_add_u32 v250, v252, 10, v250
 s_lshl_b32 s78, s74, 12
 s_lshl_b32 s79, s75, 7
 s_add_u32 s78, s78, s79
 s_add_u32 s78, s78, 71368704
 s_mov_b64 exec, 0xffff
 buffer_store_dwordx2 v[192:193], v250, s[52:55], s78 offen sc1
 s_mov_b64 exec, -1
 s_lshr_b32 s77, s74, 1
 s_lshl_b32 s77, s77, 7
 s_add_u32 s77, s77, 71308288
 v_mov_b32 v239, 0
 s_waitcnt vmcnt(0)
 s_barrier
 s_cmp_lg_u32 s60, 0
 s_cbranch_scc1 Lna67
 v_mov_b32 v250, 1
 v_mov_b32 v249, 0
 s_mov_b64 exec, 1
 buffer_atomic_add v250, v249, s[52:55], s77 offen sc1
 s_mov_b64 exec, -1
Lna67:
 s_cmp_ge_u32 s2, 224
 s_cbranch_scc1 Lidle468
 s_lshl_b32 s77, s80, 7
 s_add_u32 s77, s77, 71308288
 s_add_u32 m0, s76, 20480
 s_add_u32 s79, s82, 16384
 buffer_load_dwordx4 v251, s[52:55], s79 offen offset:0 sc1 lds
 buffer_load_dwordx4 v251, s[52:55], s79 offen offset:1024 sc1 lds
 buffer_load_dwordx4 v251, s[52:55], s79 offen offset:2048 sc1 lds
 buffer_load_dwordx4 v251, s[52:55], s79 offen offset:3072 sc1 lds
 s_add_u32 m0, s76, 24576
 s_add_u32 s79, s82, 32768
 buffer_load_dwordx4 v251, s[52:55], s79 offen offset:0 sc1 lds
 buffer_load_dwordx4 v251, s[52:55], s79 offen offset:1024 sc1 lds
 buffer_load_dwordx4 v251, s[52:55], s79 offen offset:2048 sc1 lds
 buffer_load_dwordx4 v251, s[52:55], s79 offen offset:3072 sc1 lds
 s_add_u32 m0, s76, 28672
 s_add_u32 s79, s82, 49152
 buffer_load_dwordx4 v251, s[52:55], s79 offen offset:0 sc1 lds
 buffer_load_dwordx4 v251, s[52:55], s79 offen offset:1024 sc1 lds
 buffer_load_dwordx4 v251, s[52:55], s79 offen offset:2048 sc1 lds
 buffer_load_dwordx4 v251, s[52:55], s79 offen offset:3072 sc1 lds
 v_lshl_add_u32 v6, v252, 15, v251
 ds_read_b128 v[12:15], v6 offset:0
 ds_read_b128 v[16:19], v6 offset:1024
 ds_read_b128 v[20:23], v6 offset:2048
 ds_read_b128 v[24:27], v6 offset:3072
 ds_read_b128 v[28:31], v6 offset:4096
 ds_read_b128 v[32:35], v6 offset:5120
 ds_read_b128 v[36:39], v6 offset:6144
 ds_read_b128 v[40:43], v6 offset:7168
 v_mov_b32 v2, 0x3f803f80
 v_mov_b32 v3, 0x3f803f80
 v_mov_b32 v4, 0x3f803f80
 v_mov_b32 v5, 0x3f803f80
 s_lshl_b32 s93, s80, 2
 s_add_u32 s93, s93, s60
 s_lshl_b32 s90, s93, 15
 s_add_u32 s90, s90, 54525952
 s_lshl_b32 s78, s93, 11
 s_add_u32 s78, s78, 71368704
 s_mul_i32 s92, s80, 14336
 s_add_u32 s92, s92, 71565312
 s_waitcnt lgkmcnt(4)
 v_mfma_f32_16x16x32_bf16 v[124:127], v[2:5], v[12:15], 0
 ds_read_b128 v[44:47], v6 offset:8192
 v_mfma_f32_16x16x32_bf16 v[128:131], v[2:5], v[16:19], 0
 ds_read_b128 v[48:51], v6 offset:9216
 v_mfma_f32_16x16x32_bf16 v[132:135], v[2:5], v[20:23], 0
 ds_read_b128 v[52:55], v6 offset:10240
 v_mfma_f32_16x16x32_bf16 v[136:139], v[2:5], v[24:27], 0
 ds_read_b128 v[56:59], v6 offset:11264
 s_waitcnt lgkmcnt(4)
 v_mfma_f32_16x16x32_bf16 v[124:127], v[2:5], v[28:31], v[124:127]
 ds_read_b128 v[12:15], v6 offset:12288
 v_mfma_f32_16x16x32_bf16 v[128:131], v[2:5], v[32:35], v[128:131]
 ds_read_b128 v[16:19], v6 offset:13312
 v_mfma_f32_16x16x32_bf16 v[132:135], v[2:5], v[36:39], v[132:135]
 ds_read_b128 v[20:23], v6 offset:14336
 v_mfma_f32_16x16x32_bf16 v[136:139], v[2:5], v[40:43], v[136:139]
 ds_read_b128 v[24:27], v6 offset:15360
 v_add_u32 v0, 0x10000, v251
 v_add_u32 v1, 16384, v251
 v_mov_b32 v8, 0xc0135761
 v_mov_b32 v9, 0xc0135761
 v_mov_b32 v10, 0xbdd2d3e8
 v_mov_b32 v11, 0xbdd2d3e8
 v_and_b32 v250, 15, v253
 v_lshlrev_b32 v250, 3, v250
 v_bfe_u32 v249, v253, 4, 1
 v_lshl_add_u32 v164, v249, 10, v250
 v_lshrrev_b32 v249, 5, v253
 v_lshl_add_u32 v164, v249, 9, v164
 v_lshlrev_b32 v248, 13, v252
 v_add_u32 v248, 131072, v248
 v_add_u32 v7, v248, v251
 v_and_b32 v250, 15, v253
 v_lshl_add_u32 v167, v250, 2, v248
 v_and_b32 v250, 31, v253
 v_lshl_add_u32 v165, v250, 2, v248
 v_lshrrev_b32 v250, 4, v253
 v_lshl_add_u32 v166, v250, 4, v248
 v_and_b32 v250, 31, v253
 v_lshlrev_b32 v250, 3, v250
 v_lshl_add_u32 v250, v252, 8, v250
 v_lshrrev_b32 v249, 5, v253
 v_mul_u32_u24 v249, 7168, v249
 v_add_u32 v168, v250, v249
 v_lshrrev_b32 v250, 4, v253
 v_lshlrev_b32 v250, 5, v250
 v_lshl_add_u32 v250, v252, 8, v250
 v_bfe_u32 v249, v253, 3, 1
 v_lshl_add_u32 v250, v249, 7, v250
 v_bfe_u32 v249, v253, 2, 1
 v_lshl_add_u32 v169, v249, 4, v250
 v_xor_b32 v170, 8192, v7
 v_xor_b32 v171, 16384, v7
 v_xor_b32 v172, 24576, v7
 s_cmp_lg_u32 s60, 0
 s_cbranch_scc1 Lpi70
 buffer_load_dword v238, v239, s[52:55], s77 offen sc1
Lpi70:
 s_waitcnt lgkmcnt(4)
 v_mfma_f32_16x16x32_bf16 v[124:127], v[2:5], v[44:47], v[124:127]
 ds_read_b128 v[28:31], v6 offset:16384
 v_mfma_f32_16x16x32_bf16 v[128:131], v[2:5], v[48:51], v[128:131]
 ds_read_b128 v[32:35], v6 offset:17408
 v_mfma_f32_16x16x32_bf16 v[132:135], v[2:5], v[52:55], v[132:135]
 ds_read_b128 v[36:39], v6 offset:18432
 v_mfma_f32_16x16x32_bf16 v[136:139], v[2:5], v[56:59], v[136:139]
 ds_read_b128 v[40:43], v6 offset:19456
 s_waitcnt vmcnt(8)
 s_waitcnt lgkmcnt(4)
 v_mfma_f32_16x16x32_bf16 v[124:127], v[2:5], v[12:15], v[124:127]
 ds_read_b128 v[44:47], v6 offset:20480
 v_mfma_f32_16x16x32_bf16 v[128:131], v[2:5], v[16:19], v[128:131]
 ds_read_b128 v[48:51], v6 offset:21504
 v_mfma_f32_16x16x32_bf16 v[132:135], v[2:5], v[20:23], v[132:135]
 ds_read_b128 v[52:55], v6 offset:22528
 v_mfma_f32_16x16x32_bf16 v[136:139], v[2:5], v[24:27], v[136:139]
 ds_read_b128 v[56:59], v6 offset:23552
 s_waitcnt vmcnt(4)
 s_waitcnt lgkmcnt(4)
 v_mfma_f32_16x16x32_bf16 v[140:143], v[28:31], v[2:5], 0
 ds_read_b128 v[12:15], v6 offset:24576
 v_mfma_f32_16x16x32_bf16 v[144:147], v[32:35], v[2:5], 0
 ds_read_b128 v[16:19], v6 offset:25600
 v_mfma_f32_16x16x32_bf16 v[148:151], v[36:39], v[2:5], 0
 ds_read_b128 v[20:23], v6 offset:26624
 v_mfma_f32_16x16x32_bf16 v[152:155], v[40:43], v[2:5], 0
 ds_read_b128 v[24:27], v6 offset:27648
 s_waitcnt vmcnt(0)
 s_waitcnt lgkmcnt(4)
 v_mfma_f32_16x16x32_bf16 v[140:143], v[44:47], v[2:5], v[140:143]
 ds_read_b128 v[28:31], v6 offset:28672
 v_mfma_f32_16x16x32_bf16 v[144:147], v[48:51], v[2:5], v[144:147]
 ds_read_b128 v[32:35], v6 offset:29696
 v_mfma_f32_16x16x32_bf16 v[148:151], v[52:55], v[2:5], v[148:151]
 ds_read_b128 v[36:39], v6 offset:30720
 v_mfma_f32_16x16x32_bf16 v[152:155], v[56:59], v[2:5], v[152:155]
 ds_read_b128 v[40:43], v6 offset:31744
 s_waitcnt lgkmcnt(4)
 v_mfma_f32_16x16x32_bf16 v[140:143], v[12:15], v[2:5], v[140:143]
 v_mfma_f32_16x16x32_bf16 v[144:147], v[16:19], v[2:5], v[144:147]
 v_mfma_f32_16x16x32_bf16 v[148:151], v[20:23], v[2:5], v[148:151]
 v_mfma_f32_16x16x32_bf16 v[152:155], v[24:27], v[2:5], v[152:155]
 s_waitcnt lgkmcnt(0)
 v_mfma_f32_16x16x32_bf16 v[140:143], v[28:31], v[2:5], v[140:143]
 v_mfma_f32_16x16x32_bf16 v[144:147], v[32:35], v[2:5], v[144:147]
 v_mfma_f32_16x16x32_bf16 v[148:151], v[36:39], v[2:5], v[148:151]
 v_mfma_f32_16x16x32_bf16 v[152:155], v[40:43], v[2:5], v[152:155]
 v_mov_b32 v125, v128
 v_mov_b32 v126, v132
 v_mov_b32 v127, v136
 s_nop 4
 ds_write_b128 v7, v[124:127] offset:1024
 ds_write_b128 v7, v[140:143] offset:2048
 ds_write_b128 v7, v[144:147] offset:3072
 ds_write_b128 v7, v[148:151] offset:4096
 ds_write_b128 v7, v[152:155] offset:5120
 s_waitcnt lgkmcnt(0)
 s_cmp_lg_u32 s60, 0
 s_cbranch_scc1 Lpw71
 s_waitcnt vmcnt(0)
 s_mov_b32 s63, 131072
Lsp72:
 v_cmp_gt_u32 vcc, 16, v238
 s_cbranch_vccz Lgo73
 s_sub_u32 s63, s63, 1
 s_cbranch_scc1 Lgo73
 s_sleep 1
 buffer_load_dword v238, v239, s[52:55], s77 offen sc1
 s_waitcnt vmcnt(0)
 s_branch Lsp72
Lgo73:
Lpw71:
 s_barrier
 buffer_load_dwordx4 a[0:3], v251, s[52:55], s90 offen offset:0 sc1
 buffer_load_dwordx4 a[4:7], v1, s[52:55], s90 offen offset:0 sc1
 buffer_load_dwordx4 a[8:11], v251, s[52:55], s90 offen offset:1024 sc1
 buffer_load_dwordx4 a[12:15], v1, s[52:55], s90 offen offset:1024 sc1
 buffer_load_dwordx4 a[16:19], v251, s[52:55], s90 offen offset:2048 sc1
 buffer_load_dwordx4 a[20:23], v1, s[52:55], s90 offen offset:2048 sc1
 buffer_load_dwordx4 a[24:27], v251, s[52:55], s90 offen offset:3072 sc1
 buffer_load_dwordx4 a[28:31], v1, s[52:55], s90 offen offset:3072 sc1
 s_add_u32 s90, s90, 4096
 buffer_load_dwordx2 v[156:157], v164, s[52:55], s78 offen offset:0 sc1
 buffer_load_dwordx2 v[158:159], v164, s[52:55], s78 offen offset:128 sc1
 buffer_load_dwordx2 v[160:161], v164, s[52:55], s78 offen offset:256 sc1
 buffer_load_dwordx2 v[162:163], v164, s[52:55], s78 offen offset:384 sc1
 ds_read_b128 v[60:63], v170 offset:1024
 ds_read_b128 v[64:67], v170 offset:2048
 ds_read_b128 v[68:71], v170 offset:3072
 ds_read_b128 v[72:75], v170 offset:4096
 ds_read_b128 v[76:79], v170 offset:5120
 ds_read_b128 v[80:83], v171 offset:1024
 ds_read_b128 v[84:87], v171 offset:2048
 ds_read_b128 v[88:91], v171 offset:3072
 ds_read_b128 v[92:95], v171 offset:4096
 ds_read_b128 v[96:99], v171 offset:5120
 ds_read_b128 v[100:103], v172 offset:1024
 ds_read_b128 v[104:107], v172 offset:2048
 ds_read_b128 v[108:111], v172 offset:3072
 ds_read_b128 v[112:115], v172 offset:4096
 ds_read_b128 v[116:119], v172 offset:5120
 s_waitcnt lgkmcnt(10)
 v_pk_add_f32 v[124:125], v[124:125], v[60:61]
 v_pk_add_f32 v[126:127], v[126:127], v[62:63]
 v_pk_add_f32 v[140:141], v[140:141], v[64:65]
 v_pk_add_f32 v[142:143], v[142:143], v[66:67]
 v_pk_add_f32 v[144:145], v[144:145], v[68:69]
 v_pk_add_f32 v[146:147], v[146:147], v[70:71]
 v_pk_add_f32 v[148:149], v[148:149], v[72:73]
 v_pk_add_f32 v[150:151], v[150:151], v[74:75]
 v_pk_add_f32 v[152:153], v[152:153], v[76:77]
 v_pk_add_f32 v[154:155], v[154:155], v[78:79]
 s_waitcnt lgkmcnt(5)
 v_pk_add_f32 v[124:125], v[124:125], v[80:81]
 v_pk_add_f32 v[126:127], v[126:127], v[82:83]
 v_pk_add_f32 v[140:141], v[140:141], v[84:85]
 v_pk_add_f32 v[142:143], v[142:143], v[86:87]
 v_pk_add_f32 v[144:145], v[144:145], v[88:89]
 v_pk_add_f32 v[146:147], v[146:147], v[90:91]
 v_pk_add_f32 v[148:149], v[148:149], v[92:93]
 v_pk_add_f32 v[150:151], v[150:151], v[94:95]
 v_pk_add_f32 v[152:153], v[152:153], v[96:97]
 v_pk_add_f32 v[154:155], v[154:155], v[98:99]
 s_waitcnt lgkmcnt(0)
 v_pk_add_f32 v[124:125], v[124:125], v[100:101]
 v_pk_add_f32 v[126:127], v[126:127], v[102:103]
 v_pk_add_f32 v[140:141], v[140:141], v[104:105]
 v_pk_add_f32 v[142:143], v[142:143], v[106:107]
 v_pk_add_f32 v[144:145], v[144:145], v[108:109]
 v_pk_add_f32 v[146:147], v[146:147], v[110:111]
 v_pk_add_f32 v[148:149], v[148:149], v[112:113]
 v_pk_add_f32 v[150:151], v[150:151], v[114:115]
 v_pk_add_f32 v[152:153], v[152:153], v[116:117]
 v_pk_add_f32 v[154:155], v[154:155], v[118:119]
 ds_read_b128 v[12:15], v251 offset:0
 ds_read_b128 v[16:19], v251 offset:1024
 ds_read_b128 v[20:23], v251 offset:2048
 ds_read_b128 v[24:27], v251 offset:3072
 ds_read_b128 v[28:31], v251 offset:32768
 ds_read_b128 v[32:35], v251 offset:33792
 ds_read_b128 v[36:39], v251 offset:34816
 ds_read_b128 v[40:43], v251 offset:35840
 buffer_load_dwordx4 a[32:35], v251, s[52:55], s90 offen offset:0 sc1
 buffer_load_dwordx4 a[36:39], v1, s[52:55], s90 offen offset:0 sc1
 buffer_load_dwordx4 a[40:43], v251, s[52:55], s90 offen offset:1024 sc1
 buffer_load_dwordx4 a[44:47], v1, s[52:55], s90 offen offset:1024 sc1
 s_waitcnt vmcnt(14) lgkmcnt(4)
 v_mfma_f32_16x16x32_bf16 v[60:63], a[0:3], v[12:15], 0
 ds_read_b128 v[44:47], v251 offset:16384
 v_mfma_f32_16x16x32_bf16 v[76:79], a[4:7], v[12:15], 0
 buffer_load_dwordx4 a[48:51], v251, s[52:55], s90 offen offset:2048 sc1
 v_mfma_f32_16x16x32_bf16 v[64:67], a[0:3], v[16:19], 0
 ds_read_b128 v[48:51], v251 offset:17408
 v_mfma_f32_16x16x32_bf16 v[80:83], a[4:7], v[16:19], 0
 buffer_load_dwordx4 a[52:55], v1, s[52:55], s90 offen offset:2048 sc1
 v_mfma_f32_16x16x32_bf16 v[68:71], a[0:3], v[20:23], 0
 ds_read_b128 v[52:55], v251 offset:18432
 v_mfma_f32_16x16x32_bf16 v[84:87], a[4:7], v[20:23], 0
 v_mfma_f32_16x16x32_bf16 v[72:75], a[0:3], v[24:27], 0
 ds_read_b128 v[56:59], v251 offset:19456
 v_mfma_f32_16x16x32_bf16 v[88:91], a[4:7], v[24:27], 0
 s_waitcnt vmcnt(14) lgkmcnt(4)
 v_mfma_f32_16x16x32_bf16 v[60:63], a[8:11], v[28:31], v[60:63]
 ds_read_b128 v[12:15], v0 offset:0
 v_mfma_f32_16x16x32_bf16 v[76:79], a[12:15], v[28:31], v[76:79]
 buffer_load_dwordx4 a[56:59], v251, s[52:55], s90 offen offset:3072 sc1
 v_mfma_f32_16x16x32_bf16 v[64:67], a[8:11], v[32:35], v[64:67]
 ds_read_b128 v[16:19], v0 offset:1024
 v_mfma_f32_16x16x32_bf16 v[80:83], a[12:15], v[32:35], v[80:83]
 buffer_load_dwordx4 a[60:63], v1, s[52:55], s90 offen offset:3072 sc1
 v_mfma_f32_16x16x32_bf16 v[68:71], a[8:11], v[36:39], v[68:71]
 ds_read_b128 v[20:23], v0 offset:2048
 v_mfma_f32_16x16x32_bf16 v[84:87], a[12:15], v[36:39], v[84:87]
 s_add_u32 s90, s90, 4096
 v_mfma_f32_16x16x32_bf16 v[72:75], a[8:11], v[40:43], v[72:75]
 ds_read_b128 v[24:27], v0 offset:3072
 v_mfma_f32_16x16x32_bf16 v[88:91], a[12:15], v[40:43], v[88:91]
 s_waitcnt lgkmcnt(4)
 v_mfma_f32_16x16x32_bf16 v[92:95], v[44:47], a[0:3], 0
 ds_read_b128 v[28:31], v0 offset:32768
 v_mfma_f32_16x16x32_bf16 v[108:111], v[44:47], a[4:7], 0
 v_mfma_f32_16x16x32_bf16 v[96:99], v[48:51], a[0:3], 0
 ds_read_b128 v[32:35], v0 offset:33792
 v_mfma_f32_16x16x32_bf16 v[112:115], v[48:51], a[4:7], 0
 v_mfma_f32_16x16x32_bf16 v[100:103], v[52:55], a[0:3], 0
 ds_read_b128 v[36:39], v0 offset:34816
 v_mfma_f32_16x16x32_bf16 v[116:119], v[52:55], a[4:7], 0
 v_mfma_f32_16x16x32_bf16 v[104:107], v[56:59], a[0:3], 0
 ds_read_b128 v[40:43], v0 offset:35840
 v_mfma_f32_16x16x32_bf16 v[120:123], v[56:59], a[4:7], 0
 s_waitcnt vmcnt(14) lgkmcnt(4)
 v_mfma_f32_16x16x32_bf16 v[60:63], a[16:19], v[12:15], v[60:63]
 ds_read_b128 v[44:47], v251 offset:4096
 v_mfma_f32_16x16x32_bf16 v[76:79], a[20:23], v[12:15], v[76:79]
 buffer_load_dwordx4 a[64:67], v251, s[52:55], s90 offen offset:0 sc1
 v_mfma_f32_16x16x32_bf16 v[64:67], a[16:19], v[16:19], v[64:67]
 ds_read_b128 v[48:51], v251 offset:5120
 v_mfma_f32_16x16x32_bf16 v[80:83], a[20:23], v[16:19], v[80:83]
 buffer_load_dwordx4 a[68:71], v1, s[52:55], s90 offen offset:0 sc1
 v_mfma_f32_16x16x32_bf16 v[68:71], a[16:19], v[20:23], v[68:71]
 ds_read_b128 v[52:55], v251 offset:6144
 v_mfma_f32_16x16x32_bf16 v[84:87], a[20:23], v[20:23], v[84:87]
 v_mfma_f32_16x16x32_bf16 v[72:75], a[16:19], v[24:27], v[72:75]
 ds_read_b128 v[56:59], v251 offset:7168
 v_mfma_f32_16x16x32_bf16 v[88:91], a[20:23], v[24:27], v[88:91]
 s_waitcnt vmcnt(14) lgkmcnt(4)
 v_mfma_f32_16x16x32_bf16 v[60:63], a[24:27], v[28:31], v[60:63]
 ds_read_b128 v[12:15], v251 offset:49152
 v_mfma_f32_16x16x32_bf16 v[76:79], a[28:31], v[28:31], v[76:79]
 buffer_load_dwordx4 a[72:75], v251, s[52:55], s90 offen offset:1024 sc1
 v_mfma_f32_16x16x32_bf16 v[64:67], a[24:27], v[32:35], v[64:67]
 ds_read_b128 v[16:19], v251 offset:50176
 v_mfma_f32_16x16x32_bf16 v[80:83], a[28:31], v[32:35], v[80:83]
 buffer_load_dwordx4 a[76:79], v1, s[52:55], s90 offen offset:1024 sc1
 v_mfma_f32_16x16x32_bf16 v[68:71], a[24:27], v[36:39], v[68:71]
 ds_read_b128 v[20:23], v251 offset:51200
 v_mfma_f32_16x16x32_bf16 v[84:87], a[28:31], v[36:39], v[84:87]
 v_mfma_f32_16x16x32_bf16 v[72:75], a[24:27], v[40:43], v[72:75]
 ds_read_b128 v[24:27], v251 offset:52224
 v_mfma_f32_16x16x32_bf16 v[88:91], a[28:31], v[40:43], v[88:91]
 s_waitcnt vmcnt(10) lgkmcnt(4)
 v_mfma_f32_16x16x32_bf16 v[60:63], a[32:35], v[44:47], v[60:63]
 ds_read_b128 v[28:31], v251 offset:36864
 v_mfma_f32_16x16x32_bf16 v[76:79], a[36:39], v[44:47], v[76:79]
 buffer_load_dwordx4 a[80:83], v251, s[52:55], s90 offen offset:2048 sc1
 v_mfma_f32_16x16x32_bf16 v[64:67], a[32:35], v[48:51], v[64:67]
 ds_read_b128 v[32:35], v251 offset:37888
 v_mfma_f32_16x16x32_bf16 v[80:83], a[36:39], v[48:51], v[80:83]
 buffer_load_dwordx4 a[84:87], v1, s[52:55], s90 offen offset:2048 sc1
 v_mfma_f32_16x16x32_bf16 v[68:71], a[32:35], v[52:55], v[68:71]
 ds_read_b128 v[36:39], v251 offset:38912
 v_mfma_f32_16x16x32_bf16 v[84:87], a[36:39], v[52:55], v[84:87]
 v_mfma_f32_16x16x32_bf16 v[72:75], a[32:35], v[56:59], v[72:75]
 ds_read_b128 v[40:43], v251 offset:39936
 v_mfma_f32_16x16x32_bf16 v[88:91], a[36:39], v[56:59], v[88:91]
 s_waitcnt lgkmcnt(4)
 v_mfma_f32_16x16x32_bf16 v[92:95], v[12:15], a[8:11], v[92:95]
 ds_read_b128 v[44:47], v0 offset:4096
 v_mfma_f32_16x16x32_bf16 v[108:111], v[12:15], a[12:15], v[108:111]
 v_mfma_f32_16x16x32_bf16 v[96:99], v[16:19], a[8:11], v[96:99]
 ds_read_b128 v[48:51], v0 offset:5120
 v_mfma_f32_16x16x32_bf16 v[112:115], v[16:19], a[12:15], v[112:115]
 v_mfma_f32_16x16x32_bf16 v[100:103], v[20:23], a[8:11], v[100:103]
 ds_read_b128 v[52:55], v0 offset:6144
 v_mfma_f32_16x16x32_bf16 v[116:119], v[20:23], a[12:15], v[116:119]
 v_mfma_f32_16x16x32_bf16 v[104:107], v[24:27], a[8:11], v[104:107]
 ds_read_b128 v[56:59], v0 offset:7168
 v_mfma_f32_16x16x32_bf16 v[120:123], v[24:27], a[12:15], v[120:123]
 s_waitcnt vmcnt(10) lgkmcnt(4)
 v_mfma_f32_16x16x32_bf16 v[60:63], a[40:43], v[28:31], v[60:63]
 ds_read_b128 v[12:15], v0 offset:36864
 v_mfma_f32_16x16x32_bf16 v[76:79], a[44:47], v[28:31], v[76:79]
 buffer_load_dwordx4 a[88:91], v251, s[52:55], s90 offen offset:3072 sc1
 v_mfma_f32_16x16x32_bf16 v[64:67], a[40:43], v[32:35], v[64:67]
 ds_read_b128 v[16:19], v0 offset:37888
 v_mfma_f32_16x16x32_bf16 v[80:83], a[44:47], v[32:35], v[80:83]
 buffer_load_dwordx4 a[92:95], v1, s[52:55], s90 offen offset:3072 sc1
 v_mfma_f32_16x16x32_bf16 v[68:71], a[40:43], v[36:39], v[68:71]
 ds_read_b128 v[20:23], v0 offset:38912
 v_mfma_f32_16x16x32_bf16 v[84:87], a[44:47], v[36:39], v[84:87]
 s_add_u32 s90, s90, 4096
 v_mfma_f32_16x16x32_bf16 v[72:75], a[40:43], v[40:43], v[72:75]
 ds_read_b128 v[24:27], v0 offset:39936
 v_mfma_f32_16x16x32_bf16 v[88:91], a[44:47], v[40:43], v[88:91]
 s_waitcnt vmcnt(10) lgkmcnt(4)
 v_mfma_f32_16x16x32_bf16 v[60:63], a[48:51], v[44:47], v[60:63]
 ds_read_b128 v[28:31], v0 offset:16384
 v_mfma_f32_16x16x32_bf16 v[76:79], a[52:55], v[44:47], v[76:79]
 buffer_load_dwordx4 a[96:99], v251, s[52:55], s90 offen offset:0 sc1
 v_mfma_f32_16x16x32_bf16 v[64:67], a[48:51], v[48:51], v[64:67]
 ds_read_b128 v[32:35], v0 offset:17408
 v_mfma_f32_16x16x32_bf16 v[80:83], a[52:55], v[48:51], v[80:83]
 buffer_load_dwordx4 a[100:103], v1, s[52:55], s90 offen offset:0 sc1
 v_mfma_f32_16x16x32_bf16 v[68:71], a[48:51], v[52:55], v[68:71]
 ds_read_b128 v[36:39], v0 offset:18432
 v_mfma_f32_16x16x32_bf16 v[84:87], a[52:55], v[52:55], v[84:87]
 v_mfma_f32_16x16x32_bf16 v[72:75], a[48:51], v[56:59], v[72:75]
 ds_read_b128 v[40:43], v0 offset:19456
 v_mfma_f32_16x16x32_bf16 v[88:91], a[52:55], v[56:59], v[88:91]
 s_waitcnt vmcnt(10) lgkmcnt(4)
 v_mfma_f32_16x16x32_bf16 v[60:63], a[56:59], v[12:15], v[60:63]
 ds_read_b128 v[44:47], v251 offset:8192
 v_mfma_f32_16x16x32_bf16 v[76:79], a[60:63], v[12:15], v[76:79]
 buffer_load_dwordx4 a[104:107], v251, s[52:55], s90 offen offset:1024 sc1
 v_mfma_f32_16x16x32_bf16 v[64:67], a[56:59], v[16:19], v[64:67]
 ds_read_b128 v[48:51], v251 offset:9216
 v_mfma_f32_16x16x32_bf16 v[80:83], a[60:63], v[16:19], v[80:83]
 buffer_load_dwordx4 a[108:111], v1, s[52:55], s90 offen offset:1024 sc1
 v_mfma_f32_16x16x32_bf16 v[68:71], a[56:59], v[20:23], v[68:71]
 ds_read_b128 v[52:55], v251 offset:10240
 v_mfma_f32_16x16x32_bf16 v[84:87], a[60:63], v[20:23], v[84:87]
 v_mfma_f32_16x16x32_bf16 v[72:75], a[56:59], v[24:27], v[72:75]
 ds_read_b128 v[56:59], v251 offset:11264
 v_mfma_f32_16x16x32_bf16 v[88:91], a[60:63], v[24:27], v[88:91]
 s_waitcnt lgkmcnt(4)
 v_mfma_f32_16x16x32_bf16 v[92:95], v[28:31], a[16:19], v[92:95]
 ds_read_b128 v[12:15], v251 offset:40960
 v_add_f32 v194, v156, v158
 v_mfma_f32_16x16x32_bf16 v[108:111], v[28:31], a[20:23], v[108:111]
 v_add_f32 v195, v157, v159
 v_mfma_f32_16x16x32_bf16 v[96:99], v[32:35], a[16:19], v[96:99]
 ds_read_b128 v[16:19], v251 offset:41984
 v_add_f32 v196, v160, v162
 v_mfma_f32_16x16x32_bf16 v[112:115], v[32:35], a[20:23], v[112:115]
 v_add_f32 v197, v161, v163
 v_mfma_f32_16x16x32_bf16 v[100:103], v[36:39], a[16:19], v[100:103]
 ds_read_b128 v[20:23], v251 offset:43008
 v_add_f32 v194, v194, v196
 v_mfma_f32_16x16x32_bf16 v[116:119], v[36:39], a[20:23], v[116:119]
 v_add_f32 v195, v195, v197
 v_mfma_f32_16x16x32_bf16 v[104:107], v[40:43], a[16:19], v[104:107]
 ds_read_b128 v[24:27], v251 offset:44032
 v_mov_b32 v196, v194
 v_mfma_f32_16x16x32_bf16 v[120:123], v[40:43], a[20:23], v[120:123]
 v_mov_b32 v197, v195
 s_waitcnt vmcnt(10) lgkmcnt(4)
 v_mfma_f32_16x16x32_bf16 v[60:63], a[64:67], v[44:47], v[60:63]
 ds_read_b128 v[28:31], v0 offset:8192
 s_nop 0
 v_mfma_f32_16x16x32_bf16 v[76:79], a[68:71], v[44:47], v[76:79]
 buffer_load_dwordx4 a[112:115], v251, s[52:55], s90 offen offset:2048 sc1
 v_permlane32_swap_b32 v196, v194
 v_mfma_f32_16x16x32_bf16 v[64:67], a[64:67], v[48:51], v[64:67]
 ds_read_b128 v[32:35], v0 offset:9216
 v_permlane32_swap_b32 v197, v195
 v_mfma_f32_16x16x32_bf16 v[80:83], a[68:71], v[48:51], v[80:83]
 buffer_load_dwordx4 a[116:119], v1, s[52:55], s90 offen offset:2048 sc1
 v_add_f32 v194, v194, v196
 v_mfma_f32_16x16x32_bf16 v[68:71], a[64:67], v[52:55], v[68:71]
 ds_read_b128 v[36:39], v0 offset:10240
 v_add_f32 v195, v195, v197
 v_mfma_f32_16x16x32_bf16 v[84:87], a[68:71], v[52:55], v[84:87]
 v_mul_f32 v194, 0x3b000000, v194
 v_mfma_f32_16x16x32_bf16 v[72:75], a[64:67], v[56:59], v[72:75]
 ds_read_b128 v[40:43], v0 offset:11264
 v_mul_f32 v195, 0x3b000000, v195
 v_mfma_f32_16x16x32_bf16 v[88:91], a[68:71], v[56:59], v[88:91]
 v_fma_f32 v195, -v194, v194, v195
 s_waitcnt vmcnt(10) lgkmcnt(4)
 v_mfma_f32_16x16x32_bf16 v[60:63], a[72:75], v[12:15], v[60:63]
 ds_read_b128 v[44:47], v0 offset:49152
 v_max_f32 v195, 0, v195
 v_mfma_f32_16x16x32_bf16 v[76:79], a[76:79], v[12:15], v[76:79]
 buffer_load_dwordx4 a[120:123], v251, s[52:55], s90 offen offset:3072 sc1
 v_add_f32 v195, 0x3727c5ac, v195
 v_mfma_f32_16x16x32_bf16 v[64:67], a[72:75], v[16:19], v[64:67]
 ds_read_b128 v[48:51], v0 offset:50176
 v_rsq_f32 v195, v195
 v_mfma_f32_16x16x32_bf16 v[80:83], a[76:79], v[16:19], v[80:83]
 buffer_load_dwordx4 a[124:127], v1, s[52:55], s90 offen offset:3072 sc1
 s_nop 0
 v_mfma_f32_16x16x32_bf16 v[68:71], a[72:75], v[20:23], v[68:71]
 ds_read_b128 v[52:55], v0 offset:51200
 v_mul_f32 v194, v194, v195
 v_mfma_f32_16x16x32_bf16 v[84:87], a[76:79], v[20:23], v[84:87]
 s_add_u32 s90, s90, 4096
 v_swap_b32 v194, v195
 v_mfma_f32_16x16x32_bf16 v[72:75], a[72:75], v[24:27], v[72:75]
 ds_read_b128 v[56:59], v0 offset:52224
 v_sub_f32 v195, 0, v195
 v_mfma_f32_16x16x32_bf16 v[88:91], a[76:79], v[24:27], v[88:91]
 s_waitcnt vmcnt(10) lgkmcnt(4)
 ds_write2_b32 v165, v194, v195 offset0:0 offset1:32
 ds_read_b128 v[174:177], v166 offset:0
 ds_read_b128 v[178:181], v166 offset:64
 ds_read_b128 v[182:185], v166 offset:128
 ds_read_b128 v[186:189], v166 offset:192
 ds_read2_b32 v[190:191], v167 offset0:0 offset1:32
 ds_read2_b32 v[192:193], v167 offset0:16 offset1:48
 v_mfma_f32_16x16x32_bf16 v[60:63], a[80:83], v[28:31], v[60:63]
 ds_read_b128 v[12:15], v0 offset:40960
 v_mfma_f32_16x16x32_bf16 v[76:79], a[84:87], v[28:31], v[76:79]
 v_mfma_f32_16x16x32_bf16 v[64:67], a[80:83], v[32:35], v[64:67]
 ds_read_b128 v[16:19], v0 offset:41984
 v_mfma_f32_16x16x32_bf16 v[80:83], a[84:87], v[32:35], v[80:83]
 v_mfma_f32_16x16x32_bf16 v[68:71], a[80:83], v[36:39], v[68:71]
 ds_read_b128 v[20:23], v0 offset:43008
 v_mfma_f32_16x16x32_bf16 v[84:87], a[84:87], v[36:39], v[84:87]
 v_mfma_f32_16x16x32_bf16 v[72:75], a[80:83], v[40:43], v[72:75]
 ds_read_b128 v[24:27], v0 offset:44032
 v_mfma_f32_16x16x32_bf16 v[88:91], a[84:87], v[40:43], v[88:91]
 s_waitcnt lgkmcnt(4)
 v_mfma_f32_16x16x32_bf16 v[92:95], v[44:47], a[24:27], v[92:95]
 ds_read_b128 v[28:31], v251 offset:12288
 v_mfma_f32_16x16x32_bf16 v[108:111], v[44:47], a[28:31], v[108:111]
 v_mfma_f32_16x16x32_bf16 v[96:99], v[48:51], a[24:27], v[96:99]
 ds_read_b128 v[32:35], v251 offset:13312
 v_mfma_f32_16x16x32_bf16 v[112:115], v[48:51], a[28:31], v[112:115]
 v_mfma_f32_16x16x32_bf16 v[100:103], v[52:55], a[24:27], v[100:103]
 ds_read_b128 v[36:39], v251 offset:14336
 v_mfma_f32_16x16x32_bf16 v[116:119], v[52:55], a[28:31], v[116:119]
 v_mfma_f32_16x16x32_bf16 v[104:107], v[56:59], a[24:27], v[104:107]
 ds_read_b128 v[40:43], v251 offset:15360
 v_mfma_f32_16x16x32_bf16 v[120:123], v[56:59], a[28:31], v[120:123]
 s_waitcnt vmcnt(8) lgkmcnt(4)
 v_mfma_f32_16x16x32_bf16 v[60:63], a[88:91], v[12:15], v[60:63]
 ds_read_b128 v[44:47], v251 offset:45056
 v_mfma_f32_16x16x32_bf16 v[76:79], a[92:95], v[12:15], v[76:79]
 v_mfma_f32_16x16x32_bf16 v[64:67], a[88:91], v[16:19], v[64:67]
 ds_read_b128 v[48:51], v251 offset:46080
 v_mfma_f32_16x16x32_bf16 v[80:83], a[92:95], v[16:19], v[80:83]
 v_mfma_f32_16x16x32_bf16 v[68:71], a[88:91], v[20:23], v[68:71]
 ds_read_b128 v[52:55], v251 offset:47104
 v_mfma_f32_16x16x32_bf16 v[84:87], a[92:95], v[20:23], v[84:87]
 v_mfma_f32_16x16x32_bf16 v[72:75], a[88:91], v[24:27], v[72:75]
 ds_read_b128 v[56:59], v251 offset:48128
 v_mfma_f32_16x16x32_bf16 v[88:91], a[92:95], v[24:27], v[88:91]
 s_waitcnt vmcnt(6) lgkmcnt(4)
 v_mfma_f32_16x16x32_bf16 v[60:63], a[96:99], v[28:31], v[60:63]
 ds_read_b128 v[12:15], v0 offset:12288
 v_mfma_f32_16x16x32_bf16 v[76:79], a[100:103], v[28:31], v[76:79]
 buffer_load_dwordx4 a[128:131], v251, s[52:55], s86 offen offset:0 sc1
 v_mfma_f32_16x16x32_bf16 v[64:67], a[96:99], v[32:35], v[64:67]
 ds_read_b128 v[16:19], v0 offset:13312
 v_mfma_f32_16x16x32_bf16 v[80:83], a[100:103], v[32:35], v[80:83]
 buffer_load_dwordx4 a[132:135], v251, s[52:55], s86 offen offset:1024 sc1
 v_mfma_f32_16x16x32_bf16 v[68:71], a[96:99], v[36:39], v[68:71]
 ds_read_b128 v[20:23], v0 offset:14336
 v_mfma_f32_16x16x32_bf16 v[84:87], a[100:103], v[36:39], v[84:87]
 buffer_load_dwordx4 a[136:139], v251, s[52:55], s86 offen offset:2048 sc1
 v_mfma_f32_16x16x32_bf16 v[72:75], a[96:99], v[40:43], v[72:75]
 ds_read_b128 v[24:27], v0 offset:15360
 v_mfma_f32_16x16x32_bf16 v[88:91], a[100:103], v[40:43], v[88:91]
 buffer_load_dwordx4 a[140:143], v251, s[52:55], s86 offen offset:3072 sc1
 s_add_u32 s86, s86, 4096
 s_waitcnt vmcnt(8) lgkmcnt(4)
 v_mfma_f32_16x16x32_bf16 v[60:63], a[104:107], v[44:47], v[60:63]
 ds_read_b128 v[28:31], v0 offset:45056
 v_mfma_f32_16x16x32_bf16 v[76:79], a[108:111], v[44:47], v[76:79]
 v_mfma_f32_16x16x32_bf16 v[64:67], a[104:107], v[48:51], v[64:67]
 ds_read_b128 v[32:35], v0 offset:46080
 v_mfma_f32_16x16x32_bf16 v[80:83], a[108:111], v[48:51], v[80:83]
 v_mfma_f32_16x16x32_bf16 v[68:71], a[104:107], v[52:55], v[68:71]
 ds_read_b128 v[36:39], v0 offset:47104
 v_mfma_f32_16x16x32_bf16 v[84:87], a[108:111], v[52:55], v[84:87]
 v_mfma_f32_16x16x32_bf16 v[72:75], a[104:107], v[56:59], v[72:75]
 ds_read_b128 v[40:43], v0 offset:48128
 v_mfma_f32_16x16x32_bf16 v[88:91], a[108:111], v[56:59], v[88:91]
 s_waitcnt vmcnt(6) lgkmcnt(4)
 v_mfma_f32_16x16x32_bf16 v[60:63], a[112:115], v[12:15], v[60:63]
 ds_read_b128 v[44:47], v251 offset:20480
 v_mfma_f32_16x16x32_bf16 v[76:79], a[116:119], v[12:15], v[76:79]
 v_mfma_f32_16x16x32_bf16 v[64:67], a[112:115], v[16:19], v[64:67]
 ds_read_b128 v[48:51], v251 offset:21504
 v_mfma_f32_16x16x32_bf16 v[80:83], a[116:119], v[16:19], v[80:83]
 v_mfma_f32_16x16x32_bf16 v[68:71], a[112:115], v[20:23], v[68:71]
 ds_read_b128 v[52:55], v251 offset:22528
 v_mfma_f32_16x16x32_bf16 v[84:87], a[116:119], v[20:23], v[84:87]
 v_mfma_f32_16x16x32_bf16 v[72:75], a[112:115], v[24:27], v[72:75]
 ds_read_b128 v[56:59], v251 offset:23552
 v_mfma_f32_16x16x32_bf16 v[88:91], a[116:119], v[24:27], v[88:91]
 s_waitcnt vmcnt(4) lgkmcnt(4)
 v_mfma_f32_16x16x32_bf16 v[60:63], a[120:123], v[28:31], v[60:63]
 ds_read_b128 v[12:15], v251 offset:53248
 v_mfma_f32_16x16x32_bf16 v[76:79], a[124:127], v[28:31], v[76:79]
 buffer_load_dwordx4 a[144:147], v251, s[52:55], s86 offen offset:0 sc1
 v_mfma_f32_16x16x32_bf16 v[64:67], a[120:123], v[32:35], v[64:67]
 ds_read_b128 v[16:19], v251 offset:54272
 v_mfma_f32_16x16x32_bf16 v[80:83], a[124:127], v[32:35], v[80:83]
 buffer_load_dwordx4 a[148:151], v251, s[52:55], s86 offen offset:1024 sc1
 v_mfma_f32_16x16x32_bf16 v[68:71], a[120:123], v[36:39], v[68:71]
 ds_read_b128 v[20:23], v251 offset:55296
 v_mfma_f32_16x16x32_bf16 v[84:87], a[124:127], v[36:39], v[84:87]
 buffer_load_dwordx4 a[152:155], v251, s[52:55], s86 offen offset:2048 sc1
 v_mfma_f32_16x16x32_bf16 v[72:75], a[120:123], v[40:43], v[72:75]
 ds_read_b128 v[24:27], v251 offset:56320
 v_mfma_f32_16x16x32_bf16 v[88:91], a[124:127], v[40:43], v[88:91]
 buffer_load_dwordx4 a[156:159], v251, s[52:55], s86 offen offset:3072 sc1
 s_add_u32 s86, s86, 4096
 s_nop 3
 buffer_load_dwordx4 a[160:163], v251, s[52:55], s86 offen offset:0 sc1
 v_pk_mul_f32 v[60:61], v[60:61], v[174:175]
 v_pk_fma_f32 v[60:61], v[182:183], v[124:125], v[60:61] op_sel:[0,0,0] op_sel_hi:[1,0,1]
 v_pk_mul_f32 v[62:63], v[62:63], v[176:177]
 v_pk_fma_f32 v[62:63], v[184:185], v[124:125], v[62:63] op_sel:[0,0,0] op_sel_hi:[1,0,1]
 v_pk_mul_f32 v[64:65], v[64:65], v[174:175]
 v_pk_fma_f32 v[64:65], v[182:183], v[124:125], v[64:65] op_sel:[0,1,0] op_sel_hi:[1,1,1]
 v_pk_mul_f32 v[66:67], v[66:67], v[176:177]
 v_pk_fma_f32 v[66:67], v[184:185], v[124:125], v[66:67] op_sel:[0,1,0] op_sel_hi:[1,1,1]
 v_pk_mul_f32 v[198:199], v[60:61], v[60:61]
 buffer_load_dwordx4 a[164:167], v251, s[52:55], s86 offen offset:1024 sc1
 v_pk_mul_f32 v[200:201], v[62:63], v[62:63]
 v_pk_mul_f32 v[202:203], v[64:65], v[64:65]
 v_pk_mul_f32 v[204:205], v[66:67], v[66:67]
 v_pk_fma_f32 v[198:199], v[198:199], v[10:11], v[8:9]
 v_pk_fma_f32 v[200:201], v[200:201], v[10:11], v[8:9]
 v_pk_fma_f32 v[202:203], v[202:203], v[10:11], v[8:9]
 v_pk_fma_f32 v[204:205], v[204:205], v[10:11], v[8:9]
 v_pk_mul_f32 v[198:199], v[198:199], v[60:61]
 v_pk_mul_f32 v[200:201], v[200:201], v[62:63]
 buffer_load_dwordx4 a[168:171], v251, s[52:55], s86 offen offset:2048 sc1
 v_pk_mul_f32 v[202:203], v[202:203], v[64:65]
 v_pk_mul_f32 v[204:205], v[204:205], v[66:67]
 v_exp_f32 v198, v198
 v_exp_f32 v199, v199
 v_exp_f32 v200, v200
 v_exp_f32 v201, v201
 v_exp_f32 v202, v202
 v_exp_f32 v203, v203
 v_exp_f32 v204, v204
 buffer_load_dwordx4 a[172:175], v251, s[52:55], s86 offen offset:3072 sc1
 v_exp_f32 v205, v205
 v_pk_add_f32 v[198:199], v[198:199], 1.0 op_sel_hi:[1,0]
 v_pk_add_f32 v[200:201], v[200:201], 1.0 op_sel_hi:[1,0]
 v_pk_add_f32 v[202:203], v[202:203], 1.0 op_sel_hi:[1,0]
 v_pk_add_f32 v[204:205], v[204:205], 1.0 op_sel_hi:[1,0]
 v_rcp_f32 v198, v198
 v_rcp_f32 v199, v199
 v_rcp_f32 v200, v200
 v_rcp_f32 v201, v201
 s_add_u32 s86, s86, 4096
 v_rcp_f32 v202, v202
 v_rcp_f32 v203, v203
 v_rcp_f32 v204, v204
 v_rcp_f32 v205, v205
 v_pk_mul_f32 v[60:61], v[60:61], v[198:199]
 v_pk_mul_f32 v[62:63], v[62:63], v[200:201]
 v_pk_mul_f32 v[64:65], v[64:65], v[202:203]
 v_pk_mul_f32 v[66:67], v[66:67], v[204:205]
 buffer_load_dwordx4 a[176:179], v251, s[52:55], s86 offen offset:0 sc1
 v_pk_mul_f32 v[68:69], v[68:69], v[174:175]
 v_pk_fma_f32 v[68:69], v[182:183], v[126:127], v[68:69] op_sel:[0,0,0] op_sel_hi:[1,0,1]
 v_pk_mul_f32 v[70:71], v[70:71], v[176:177]
 v_pk_fma_f32 v[70:71], v[184:185], v[126:127], v[70:71] op_sel:[0,0,0] op_sel_hi:[1,0,1]
 v_pk_mul_f32 v[72:73], v[72:73], v[174:175]
 v_pk_fma_f32 v[72:73], v[182:183], v[126:127], v[72:73] op_sel:[0,1,0] op_sel_hi:[1,1,1]
 v_pk_mul_f32 v[74:75], v[74:75], v[176:177]
 v_pk_fma_f32 v[74:75], v[184:185], v[126:127], v[74:75] op_sel:[0,1,0] op_sel_hi:[1,1,1]
 v_pk_mul_f32 v[198:199], v[68:69], v[68:69]
 buffer_load_dwordx4 a[180:183], v251, s[52:55], s86 offen offset:1024 sc1
 v_pk_mul_f32 v[200:201], v[70:71], v[70:71]
 v_pk_mul_f32 v[202:203], v[72:73], v[72:73]
 v_pk_mul_f32 v[204:205], v[74:75], v[74:75]
 v_pk_fma_f32 v[198:199], v[198:199], v[10:11], v[8:9]
 v_pk_fma_f32 v[200:201], v[200:201], v[10:11], v[8:9]
 v_pk_fma_f32 v[202:203], v[202:203], v[10:11], v[8:9]
 v_pk_fma_f32 v[204:205], v[204:205], v[10:11], v[8:9]
 v_pk_mul_f32 v[198:199], v[198:199], v[68:69]
 v_pk_mul_f32 v[200:201], v[200:201], v[70:71]
 buffer_load_dwordx4 a[184:187], v251, s[52:55], s86 offen offset:2048 sc1
 v_pk_mul_f32 v[202:203], v[202:203], v[72:73]
 v_pk_mul_f32 v[204:205], v[204:205], v[74:75]
 v_exp_f32 v198, v198
 v_exp_f32 v199, v199
 v_exp_f32 v200, v200
 v_exp_f32 v201, v201
 v_exp_f32 v202, v202
 v_exp_f32 v203, v203
 v_exp_f32 v204, v204
 buffer_load_dwordx4 a[188:191], v251, s[52:55], s86 offen offset:3072 sc1
 v_exp_f32 v205, v205
 v_pk_add_f32 v[198:199], v[198:199], 1.0 op_sel_hi:[1,0]
 v_pk_add_f32 v[200:201], v[200:201], 1.0 op_sel_hi:[1,0]
 v_pk_add_f32 v[202:203], v[202:203], 1.0 op_sel_hi:[1,0]
 v_pk_add_f32 v[204:205], v[204:205], 1.0 op_sel_hi:[1,0]
 v_rcp_f32 v198, v198
 v_rcp_f32 v199, v199
 v_rcp_f32 v200, v200
 v_rcp_f32 v201, v201
 s_add_u32 s86, s86, 4096
 v_rcp_f32 v202, v202
 v_rcp_f32 v203, v203
 v_rcp_f32 v204, v204
 v_rcp_f32 v205, v205
 v_pk_mul_f32 v[68:69], v[68:69], v[198:199]
 v_pk_mul_f32 v[70:71], v[70:71], v[200:201]
 v_pk_mul_f32 v[72:73], v[72:73], v[202:203]
 v_pk_mul_f32 v[74:75], v[74:75], v[204:205]
 buffer_load_dwordx4 a[192:195], v251, s[52:55], s86 offen offset:0 sc1
 v_pk_mul_f32 v[76:77], v[76:77], v[178:179]
 v_pk_fma_f32 v[76:77], v[186:187], v[124:125], v[76:77] op_sel:[0,0,0] op_sel_hi:[1,0,1]
 v_pk_mul_f32 v[78:79], v[78:79], v[180:181]
 v_pk_fma_f32 v[78:79], v[188:189], v[124:125], v[78:79] op_sel:[0,0,0] op_sel_hi:[1,0,1]
 v_pk_mul_f32 v[80:81], v[80:81], v[178:179]
 v_pk_fma_f32 v[80:81], v[186:187], v[124:125], v[80:81] op_sel:[0,1,0] op_sel_hi:[1,1,1]
 v_pk_mul_f32 v[82:83], v[82:83], v[180:181]
 v_pk_fma_f32 v[82:83], v[188:189], v[124:125], v[82:83] op_sel:[0,1,0] op_sel_hi:[1,1,1]
 v_pk_mul_f32 v[198:199], v[76:77], v[76:77]
 buffer_load_dwordx4 a[196:199], v251, s[52:55], s86 offen offset:1024 sc1
 v_pk_mul_f32 v[200:201], v[78:79], v[78:79]
 v_pk_mul_f32 v[202:203], v[80:81], v[80:81]
 v_pk_mul_f32 v[204:205], v[82:83], v[82:83]
 v_pk_fma_f32 v[198:199], v[198:199], v[10:11], v[8:9]
 v_pk_fma_f32 v[200:201], v[200:201], v[10:11], v[8:9]
 v_pk_fma_f32 v[202:203], v[202:203], v[10:11], v[8:9]
 v_pk_fma_f32 v[204:205], v[204:205], v[10:11], v[8:9]
 v_pk_mul_f32 v[198:199], v[198:199], v[76:77]
 v_pk_mul_f32 v[200:201], v[200:201], v[78:79]
 buffer_load_dwordx4 a[200:203], v251, s[52:55], s86 offen offset:2048 sc1
 v_pk_mul_f32 v[202:203], v[202:203], v[80:81]
 v_pk_mul_f32 v[204:205], v[204:205], v[82:83]
 v_exp_f32 v198, v198
 v_exp_f32 v199, v199
 v_exp_f32 v200, v200
 v_exp_f32 v201, v201
 v_exp_f32 v202, v202
 v_exp_f32 v203, v203
 v_exp_f32 v204, v204
 buffer_load_dwordx4 a[204:207], v251, s[52:55], s86 offen offset:3072 sc1
 v_exp_f32 v205, v205
 v_pk_add_f32 v[198:199], v[198:199], 1.0 op_sel_hi:[1,0]
 v_pk_add_f32 v[200:201], v[200:201], 1.0 op_sel_hi:[1,0]
 v_pk_add_f32 v[202:203], v[202:203], 1.0 op_sel_hi:[1,0]
 v_pk_add_f32 v[204:205], v[204:205], 1.0 op_sel_hi:[1,0]
 v_rcp_f32 v198, v198
 v_rcp_f32 v199, v199
 v_rcp_f32 v200, v200
 v_rcp_f32 v201, v201
 s_add_u32 s86, s86, 4096
 v_rcp_f32 v202, v202
 v_rcp_f32 v203, v203
 v_rcp_f32 v204, v204
 v_rcp_f32 v205, v205
 v_pk_mul_f32 v[76:77], v[76:77], v[198:199]
 v_pk_mul_f32 v[78:79], v[78:79], v[200:201]
 v_pk_mul_f32 v[80:81], v[80:81], v[202:203]
 v_pk_mul_f32 v[82:83], v[82:83], v[204:205]
 buffer_load_dwordx4 a[208:211], v251, s[52:55], s86 offen offset:0 sc1
 v_pk_mul_f32 v[84:85], v[84:85], v[178:179]
 v_pk_fma_f32 v[84:85], v[186:187], v[126:127], v[84:85] op_sel:[0,0,0] op_sel_hi:[1,0,1]
 v_pk_mul_f32 v[86:87], v[86:87], v[180:181]
 v_pk_fma_f32 v[86:87], v[188:189], v[126:127], v[86:87] op_sel:[0,0,0] op_sel_hi:[1,0,1]
 v_pk_mul_f32 v[88:89], v[88:89], v[178:179]
 v_pk_fma_f32 v[88:89], v[186:187], v[126:127], v[88:89] op_sel:[0,1,0] op_sel_hi:[1,1,1]
 v_pk_mul_f32 v[90:91], v[90:91], v[180:181]
 v_pk_fma_f32 v[90:91], v[188:189], v[126:127], v[90:91] op_sel:[0,1,0] op_sel_hi:[1,1,1]
 v_pk_mul_f32 v[198:199], v[84:85], v[84:85]
 buffer_load_dwordx4 a[212:215], v251, s[52:55], s86 offen offset:1024 sc1
 v_pk_mul_f32 v[200:201], v[86:87], v[86:87]
 v_pk_mul_f32 v[202:203], v[88:89], v[88:89]
 v_pk_mul_f32 v[204:205], v[90:91], v[90:91]
 v_pk_fma_f32 v[198:199], v[198:199], v[10:11], v[8:9]
 v_pk_fma_f32 v[200:201], v[200:201], v[10:11], v[8:9]
 v_pk_fma_f32 v[202:203], v[202:203], v[10:11], v[8:9]
 v_pk_fma_f32 v[204:205], v[204:205], v[10:11], v[8:9]
 v_pk_mul_f32 v[198:199], v[198:199], v[84:85]
 v_pk_mul_f32 v[200:201], v[200:201], v[86:87]
 buffer_load_dwordx4 a[216:219], v251, s[52:55], s86 offen offset:2048 sc1
 v_pk_mul_f32 v[202:203], v[202:203], v[88:89]
 v_pk_mul_f32 v[204:205], v[204:205], v[90:91]
 v_exp_f32 v198, v198
 v_exp_f32 v199, v199
 v_exp_f32 v200, v200
 v_exp_f32 v201, v201
 v_exp_f32 v202, v202
 v_exp_f32 v203, v203
 v_exp_f32 v204, v204
 buffer_load_dwordx4 a[220:223], v251, s[52:55], s86 offen offset:3072 sc1
 v_exp_f32 v205, v205
 v_pk_add_f32 v[198:199], v[198:199], 1.0 op_sel_hi:[1,0]
 v_pk_add_f32 v[200:201], v[200:201], 1.0 op_sel_hi:[1,0]
 v_pk_add_f32 v[202:203], v[202:203], 1.0 op_sel_hi:[1,0]
 v_pk_add_f32 v[204:205], v[204:205], 1.0 op_sel_hi:[1,0]
 v_rcp_f32 v198, v198
 v_rcp_f32 v199, v199
 v_rcp_f32 v200, v200
 v_rcp_f32 v201, v201
 s_add_u32 s86, s86, 4096
 v_rcp_f32 v202, v202
 v_rcp_f32 v203, v203
 v_rcp_f32 v204, v204
 v_rcp_f32 v205, v205
 v_pk_mul_f32 v[84:85], v[84:85], v[198:199]
 v_pk_mul_f32 v[86:87], v[86:87], v[200:201]
 v_pk_mul_f32 v[88:89], v[88:89], v[202:203]
 v_pk_mul_f32 v[90:91], v[90:91], v[204:205]
 v_pk_add_f32 v[174:175], v[60:61], v[64:65]
 v_pk_mul_f32 v[176:177], v[60:61], v[60:61]
 v_pk_add_f32 v[198:199], v[68:69], v[72:73]
 v_pk_fma_f32 v[176:177], v[64:65], v[64:65], v[176:177]
 v_pk_add_f32 v[174:175], v[174:175], v[198:199]
 v_pk_fma_f32 v[176:177], v[68:69], v[68:69], v[176:177]
 v_pk_fma_f32 v[176:177], v[72:73], v[72:73], v[176:177]
 v_pk_add_f32 v[178:179], v[62:63], v[66:67]
 v_pk_mul_f32 v[180:181], v[62:63], v[62:63]
 v_pk_add_f32 v[198:199], v[70:71], v[74:75]
 v_pk_fma_f32 v[180:181], v[66:67], v[66:67], v[180:181]
 v_pk_add_f32 v[178:179], v[178:179], v[198:199]
 v_pk_fma_f32 v[180:181], v[70:71], v[70:71], v[180:181]
 v_pk_fma_f32 v[180:181], v[74:75], v[74:75], v[180:181]
 v_pk_add_f32 v[182:183], v[76:77], v[80:81]
 v_pk_mul_f32 v[184:185], v[76:77], v[76:77]
 v_pk_add_f32 v[198:199], v[84:85], v[88:89]
 v_pk_fma_f32 v[184:185], v[80:81], v[80:81], v[184:185]
 v_pk_add_f32 v[182:183], v[182:183], v[198:199]
 v_pk_fma_f32 v[184:185], v[84:85], v[84:85], v[184:185]
 v_pk_fma_f32 v[184:185], v[88:89], v[88:89], v[184:185]
 v_pk_add_f32 v[186:187], v[78:79], v[82:83]
 v_pk_mul_f32 v[188:189], v[78:79], v[78:79]
 v_pk_add_f32 v[198:199], v[86:87], v[90:91]
 v_pk_fma_f32 v[188:189], v[82:83], v[82:83], v[188:189]
 v_pk_add_f32 v[186:187], v[186:187], v[198:199]
 v_pk_fma_f32 v[188:189], v[86:87], v[86:87], v[188:189]
 v_pk_fma_f32 v[188:189], v[90:91], v[90:91], v[188:189]
 v_add_f32_dpp v174, v174, v174 row_ror:8 row_mask:0xf bank_mask:0x3
 v_add_f32_dpp v175, v175, v175 row_ror:8 row_mask:0xf bank_mask:0x3
 v_add_f32_dpp v176, v176, v176 row_ror:8 row_mask:0xf bank_mask:0x3
 v_add_f32_dpp v177, v177, v177 row_ror:8 row_mask:0xf bank_mask:0x3
 v_add_f32_dpp v178, v178, v178 row_ror:8 row_mask:0xf bank_mask:0x3
 v_add_f32_dpp v179, v179, v179 row_ror:8 row_mask:0xf bank_mask:0x3
 v_add_f32_dpp v180, v180, v180 row_ror:8 row_mask:0xf bank_mask:0x3
 v_add_f32_dpp v181, v181, v181 row_ror:8 row_mask:0xf bank_mask:0x3
 v_add_f32_dpp v174, v182, v182 row_ror:8 row_mask:0xf bank_mask:0xc
 v_add_f32_dpp v175, v183, v183 row_ror:8 row_mask:0xf bank_mask:0xc
 v_add_f32_dpp v176, v184, v184 row_ror:8 row_mask:0xf bank_mask:0xc
 v_add_f32_dpp v177, v185, v185 row_ror:8 row_mask:0xf bank_mask:0xc
 v_add_f32_dpp v178, v186, v186 row_ror:8 row_mask:0xf bank_mask:0xc
 v_add_f32_dpp v179, v187, v187 row_ror:8 row_mask:0xf bank_mask:0xc
 v_add_f32_dpp v180, v188, v188 row_ror:8 row_mask:0xf bank_mask:0xc
 v_add_f32_dpp v181, v189, v189 row_ror:8 row_mask:0xf bank_mask:0xc
 v_add_f32_dpp v174, v174, v174 row_half_mirror row_mask:0xf bank_mask:0x5
 v_add_f32_dpp v175, v175, v175 row_half_mirror row_mask:0xf bank_mask:0x5
 v_add_f32_dpp v176, v176, v176 row_half_mirror row_mask:0xf bank_mask:0x5
 v_add_f32_dpp v177, v177, v177 row_half_mirror row_mask:0xf bank_mask:0x5
 v_add_f32_dpp v174, v178, v178 row_half_mirror row_mask:0xf bank_mask:0xa
 v_add_f32_dpp v175, v179, v179 row_half_mirror row_mask:0xf bank_mask:0xa
 v_add_f32_dpp v176, v180, v180 row_half_mirror row_mask:0xf bank_mask:0xa
 v_add_f32_dpp v177, v181, v181 row_half_mirror row_mask:0xf bank_mask:0xa
 v_add_f32_dpp v174, v174, v174 quad_perm:[1,0,3,2] row_mask:0xf bank_mask:0xf
 v_add_f32_dpp v175, v175, v175 quad_perm:[1,0,3,2] row_mask:0xf bank_mask:0xf
 v_add_f32_dpp v176, v176, v176 quad_perm:[1,0,3,2] row_mask:0xf bank_mask:0xf
 v_add_f32_dpp v177, v177, v177 quad_perm:[1,0,3,2] row_mask:0xf bank_mask:0xf
 v_add_f32_dpp v178, v174, v174 quad_perm:[2,3,0,1] row_mask:0xf bank_mask:0xf
 v_add_f32_dpp v180, v175, v175 quad_perm:[2,3,0,1] row_mask:0xf bank_mask:0xf
 v_add_f32_dpp v179, v176, v176 quad_perm:[2,3,0,1] row_mask:0xf bank_mask:0xf
 v_add_f32_dpp v181, v177, v177 quad_perm:[2,3,0,1] row_mask:0xf bank_mask:0xf
 s_lshl_b32 s78, s81, 10
 s_add_u32 s78, s78, s92
 s_mov_b32 exec_lo, 0x11111111
 s_mov_b32 exec_hi, 0x11111111
 buffer_store_dwordx4 v[178:181], v169, s[52:55], s78 offen sc1
 s_mov_b64 exec, -1
 s_add_u32 s78, s92, 4096
 s_waitcnt lgkmcnt(4)
 v_mfma_f32_16x16x32_bf16 v[92:95], v[44:47], a[32:35], v[92:95]
 ds_read_b128 v[28:31], v0 offset:20480
 v_mfma_f32_16x16x32_bf16 v[108:111], v[44:47], a[36:39], v[108:111]
 buffer_load_dwordx4 a[224:227], v251, s[52:55], s86 offen offset:0 sc1
 v_mfma_f32_16x16x32_bf16 v[96:99], v[48:51], a[32:35], v[96:99]
 ds_read_b128 v[32:35], v0 offset:21504
 v_mfma_f32_16x16x32_bf16 v[112:115], v[48:51], a[36:39], v[112:115]
 buffer_load_dwordx4 a[228:231], v251, s[52:55], s86 offen offset:1024 sc1
 v_mfma_f32_16x16x32_bf16 v[100:103], v[52:55], a[32:35], v[100:103]
 ds_read_b128 v[36:39], v0 offset:22528
 v_mfma_f32_16x16x32_bf16 v[116:119], v[52:55], a[36:39], v[116:119]
 buffer_load_dwordx4 a[232:235], v251, s[52:55], s86 offen offset:2048 sc1
 v_mfma_f32_16x16x32_bf16 v[104:107], v[56:59], a[32:35], v[104:107]
 ds_read_b128 v[40:43], v0 offset:23552
 v_mfma_f32_16x16x32_bf16 v[120:123], v[56:59], a[36:39], v[120:123]
 buffer_load_dwordx4 a[236:239], v251, s[52:55], s86 offen offset:3072 sc1
 s_add_u32 s86, s86, 4096
 s_waitcnt lgkmcnt(4)
 v_mfma_f32_16x16x32_bf16 v[92:95], v[12:15], a[40:43], v[92:95]
 ds_read_b128 v[44:47], v0 offset:53248
 v_mfma_f32_16x16x32_bf16 v[108:111], v[12:15], a[44:47], v[108:111]
 v_mfma_f32_16x16x32_bf16 v[96:99], v[16:19], a[40:43], v[96:99]
 ds_read_b128 v[48:51], v0 offset:54272
 v_mfma_f32_16x16x32_bf16 v[112:115], v[16:19], a[44:47], v[112:115]
 v_mfma_f32_16x16x32_bf16 v[100:103], v[20:23], a[40:43], v[100:103]
 ds_read_b128 v[52:55], v0 offset:55296
 v_mfma_f32_16x16x32_bf16 v[116:119], v[20:23], a[44:47], v[116:119]
 v_mfma_f32_16x16x32_bf16 v[104:107], v[24:27], a[40:43], v[104:107]
 ds_read_b128 v[56:59], v0 offset:56320
 v_mfma_f32_16x16x32_bf16 v[120:123], v[24:27], a[44:47], v[120:123]
 s_waitcnt lgkmcnt(4)
 v_mfma_f32_16x16x32_bf16 v[92:95], v[28:31], a[48:51], v[92:95]
 ds_read_b128 v[12:15], v251 offset:24576
 v_mfma_f32_16x16x32_bf16 v[108:111], v[28:31], a[52:55], v[108:111]
 buffer_load_dwordx4 a[240:243], v251, s[52:55], s86 offen offset:0 sc1
 v_mfma_f32_16x16x32_bf16 v[96:99], v[32:35], a[48:51], v[96:99]
 ds_read_b128 v[16:19], v251 offset:25600
 v_mfma_f32_16x16x32_bf16 v[112:115], v[32:35], a[52:55], v[112:115]
 buffer_load_dwordx4 a[244:247], v251, s[52:55], s86 offen offset:1024 sc1
 v_mfma_f32_16x16x32_bf16 v[100:103], v[36:39], a[48:51], v[100:103]
 ds_read_b128 v[20:23], v251 offset:26624
 v_mfma_f32_16x16x32_bf16 v[116:119], v[36:39], a[52:55], v[116:119]
 buffer_load_dwordx4 a[248:251], v251, s[52:55], s86 offen offset:2048 sc1
 v_mfma_f32_16x16x32_bf16 v[104:107], v[40:43], a[48:51], v[104:107]
 ds_read_b128 v[24:27], v251 offset:27648
 v_mfma_f32_16x16x32_bf16 v[120:123], v[40:43], a[52:55], v[120:123]
 buffer_load_dwordx4 a[252:255], v251, s[52:55], s86 offen offset:3072 sc1
 s_add_u32 s86, s86, 4096
 s_waitcnt lgkmcnt(4)
 v_mfma_f32_16x16x32_bf16 v[92:95], v[44:47], a[56:59], v[92:95]
 ds_read_b128 v[28:31], v251 offset:57344
 v_mfma_f32_16x16x32_bf16 v[108:111], v[44:47], a[60:63], v[108:111]
 v_mfma_f32_16x16x32_bf16 v[96:99], v[48:51], a[56:59], v[96:99]
 ds_read_b128 v[32:35], v251 offset:58368
 v_mfma_f32_16x16x32_bf16 v[112:115], v[48:51], a[60:63], v[112:115]
 v_mfma_f32_16x16x32_bf16 v[100:103], v[52:55], a[56:59], v[100:103]
 ds_read_b128 v[36:39], v251 offset:59392
 v_mfma_f32_16x16x32_bf16 v[116:119], v[52:55], a[60:63], v[116:119]
 v_mfma_f32_16x16x32_bf16 v[104:107], v[56:59], a[56:59], v[104:107]
 ds_read_b128 v[40:43], v251 offset:60416
 v_mfma_f32_16x16x32_bf16 v[120:123], v[56:59], a[60:63], v[120:123]
 s_waitcnt lgkmcnt(4)
 v_mfma_f32_16x16x32_bf16 v[92:95], v[12:15], a[64:67], v[92:95]
 ds_read_b128 v[44:47], v0 offset:24576
 v_mfma_f32_16x16x32_bf16 v[108:111], v[12:15], a[68:71], v[108:111]
 buffer_load_dwordx4 a[0:3], v251, s[52:55], s86 offen offset:0 sc1
 v_mfma_f32_16x16x32_bf16 v[96:99], v[16:19], a[64:67], v[96:99]
 ds_read_b128 v[48:51], v0 offset:25600
 v_mfma_f32_16x16x32_bf16 v[112:115], v[16:19], a[68:71], v[112:115]
 buffer_load_dwordx4 a[4:7], v251, s[52:55], s86 offen offset:1024 sc1
 v_mfma_f32_16x16x32_bf16 v[100:103], v[20:23], a[64:67], v[100:103]
 ds_read_b128 v[52:55], v0 offset:26624
 v_mfma_f32_16x16x32_bf16 v[116:119], v[20:23], a[68:71], v[116:119]
 buffer_load_dwordx4 a[8:11], v251, s[52:55], s86 offen offset:2048 sc1
 v_mfma_f32_16x16x32_bf16 v[104:107], v[24:27], a[64:67], v[104:107]
 ds_read_b128 v[56:59], v0 offset:27648
 v_mfma_f32_16x16x32_bf16 v[120:123], v[24:27], a[68:71], v[120:123]
 buffer_load_dwordx4 a[12:15], v251, s[52:55], s86 offen offset:3072 sc1
 s_add_u32 s86, s86, 4096
 s_waitcnt lgkmcnt(4)
 v_mfma_f32_16x16x32_bf16 v[92:95], v[28:31], a[72:75], v[92:95]
 ds_read_b128 v[12:15], v0 offset:57344
 v_mfma_f32_16x16x32_bf16 v[108:111], v[28:31], a[76:79], v[108:111]
 v_mfma_f32_16x16x32_bf16 v[96:99], v[32:35], a[72:75], v[96:99]
 ds_read_b128 v[16:19], v0 offset:58368
 v_mfma_f32_16x16x32_bf16 v[112:115], v[32:35], a[76:79], v[112:115]
 v_mfma_f32_16x16x32_bf16 v[100:103], v[36:39], a[72:75], v[100:103]
 ds_read_b128 v[20:23], v0 offset:59392
 v_mfma_f32_16x16x32_bf16 v[116:119], v[36:39], a[76:79], v[116:119]
 v_mfma_f32_16x16x32_bf16 v[104:107], v[40:43], a[72:75], v[104:107]
 ds_read_b128 v[24:27], v0 offset:60416
 v_mfma_f32_16x16x32_bf16 v[120:123], v[40:43], a[76:79], v[120:123]
 s_waitcnt lgkmcnt(4)
 v_mfma_f32_16x16x32_bf16 v[92:95], v[44:47], a[80:83], v[92:95]
 ds_read_b128 v[28:31], v251 offset:28672
 v_mfma_f32_16x16x32_bf16 v[108:111], v[44:47], a[84:87], v[108:111]
 buffer_load_dwordx2 v[206:207], v168, s[52:55], s92 offen offset:0 sc1
 v_mfma_f32_16x16x32_bf16 v[96:99], v[48:51], a[80:83], v[96:99]
 ds_read_b128 v[32:35], v251 offset:29696
 v_mfma_f32_16x16x32_bf16 v[112:115], v[48:51], a[84:87], v[112:115]
 buffer_load_dwordx2 v[208:209], v168, s[52:55], s92 offen offset:1024 sc1
 v_mfma_f32_16x16x32_bf16 v[100:103], v[52:55], a[80:83], v[100:103]
 ds_read_b128 v[36:39], v251 offset:30720
 v_mfma_f32_16x16x32_bf16 v[116:119], v[52:55], a[84:87], v[116:119]
 buffer_load_dwordx2 v[210:211], v168, s[52:55], s92 offen offset:2048 sc1
 v_mfma_f32_16x16x32_bf16 v[104:107], v[56:59], a[80:83], v[104:107]
 ds_read_b128 v[40:43], v251 offset:31744
 v_mfma_f32_16x16x32_bf16 v[120:123], v[56:59], a[84:87], v[120:123]
 buffer_load_dwordx2 v[212:213], v168, s[52:55], s92 offen offset:3072 sc1
 s_waitcnt lgkmcnt(4)
 v_mfma_f32_16x16x32_bf16 v[92:95], v[12:15], a[88:91], v[92:95]
 ds_read_b128 v[44:47], v251 offset:61440
 v_mfma_f32_16x16x32_bf16 v[108:111], v[12:15], a[92:95], v[108:111]
 buffer_load_dwordx2 v[214:215], v168, s[52:55], s78 offen offset:0 sc1
 v_mfma_f32_16x16x32_bf16 v[96:99], v[16:19], a[88:91], v[96:99]
 ds_read_b128 v[48:51], v251 offset:62464
 v_mfma_f32_16x16x32_bf16 v[112:115], v[16:19], a[92:95], v[112:115]
 buffer_load_dwordx2 v[216:217], v168, s[52:55], s78 offen offset:1024 sc1
 v_mfma_f32_16x16x32_bf16 v[100:103], v[20:23], a[88:91], v[100:103]
 ds_read_b128 v[52:55], v251 offset:63488
 v_mfma_f32_16x16x32_bf16 v[116:119], v[20:23], a[92:95], v[116:119]
 buffer_load_dwordx2 v[218:219], v168, s[52:55], s78 offen offset:2048 sc1
 v_mfma_f32_16x16x32_bf16 v[104:107], v[24:27], a[88:91], v[104:107]
 ds_read_b128 v[56:59], v251 offset:64512
 v_mfma_f32_16x16x32_bf16 v[120:123], v[24:27], a[92:95], v[120:123]
 s_waitcnt lgkmcnt(4)
 v_mfma_f32_16x16x32_bf16 v[92:95], v[28:31], a[96:99], v[92:95]
 ds_read_b128 v[12:15], v0 offset:28672
 v_mfma_f32_16x16x32_bf16 v[108:111], v[28:31], a[100:103], v[108:111]
 buffer_load_dwordx4 a[16:19], v251, s[52:55], s86 offen offset:0 sc1
 v_mfma_f32_16x16x32_bf16 v[96:99], v[32:35], a[96:99], v[96:99]
 ds_read_b128 v[16:19], v0 offset:29696
 v_mfma_f32_16x16x32_bf16 v[112:115], v[32:35], a[100:103], v[112:115]
 buffer_load_dwordx4 a[20:23], v251, s[52:55], s86 offen offset:1024 sc1
 v_mfma_f32_16x16x32_bf16 v[100:103], v[36:39], a[96:99], v[100:103]
 ds_read_b128 v[20:23], v0 offset:30720
 v_mfma_f32_16x16x32_bf16 v[116:119], v[36:39], a[100:103], v[116:119]
 buffer_load_dwordx4 a[24:27], v251, s[52:55], s86 offen offset:2048 sc1
 v_mfma_f32_16x16x32_bf16 v[104:107], v[40:43], a[96:99], v[104:107]
 ds_read_b128 v[24:27], v0 offset:31744
 v_mfma_f32_16x16x32_bf16 v[120:123], v[40:43], a[100:103], v[120:123]
 buffer_load_dwordx4 a[28:31], v251, s[52:55], s86 offen offset:3072 sc1
 s_add_u32 s86, s86, 4096
 s_waitcnt lgkmcnt(4)
 v_mfma_f32_16x16x32_bf16 v[92:95], v[44:47], a[104:107], v[92:95]
 ds_read_b128 v[28:31], v0 offset:61440
 v_mfma_f32_16x16x32_bf16 v[108:111], v[44:47], a[108:111], v[108:111]
 v_mfma_f32_16x16x32_bf16 v[96:99], v[48:51], a[104:107], v[96:99]
 ds_read_b128 v[32:35], v0 offset:62464
 v_mfma_f32_16x16x32_bf16 v[112:115], v[48:51], a[108:111], v[112:115]
 v_mfma_f32_16x16x32_bf16 v[100:103], v[52:55], a[104:107], v[100:103]
 ds_read_b128 v[36:39], v0 offset:63488
 v_mfma_f32_16x16x32_bf16 v[116:119], v[52:55], a[108:111], v[116:119]
 v_mfma_f32_16x16x32_bf16 v[104:107], v[56:59], a[104:107], v[104:107]
 ds_read_b128 v[40:43], v0 offset:64512
 v_mfma_f32_16x16x32_bf16 v[120:123], v[56:59], a[108:111], v[120:123]
 s_mov_b32 s63, 131072
 s_waitcnt vmcnt(4)
Lpoll74:
 v_max_u32 v250, v206, v207
 v_max3_u32 v250, v250, v208, v209
 v_max3_u32 v250, v250, v210, v211
 v_max3_u32 v250, v250, v212, v213
 v_max3_u32 v250, v250, v214, v215
 v_max3_u32 v250, v250, v216, v217
 v_max3_u32 v250, v250, v218, v219
 v_cmp_eq_u32 vcc, -1, v250
 s_cbranch_vccz Lgot75
 s_sub_u32 s63, s63, 1
 s_cbranch_scc1 Lgot75
 s_sleep 2
 buffer_load_dwordx2 v[206:207], v168, s[52:55], s92 offen offset:0 sc1
 buffer_load_dwordx2 v[208:209], v168, s[52:55], s92 offen offset:1024 sc1
 buffer_load_dwordx2 v[210:211], v168, s[52:55], s92 offen offset:2048 sc1
 buffer_load_dwordx2 v[212:213], v168, s[52:55], s92 offen offset:3072 sc1
 buffer_load_dwordx2 v[214:215], v168, s[52:55], s78 offen offset:0 sc1
 buffer_load_dwordx2 v[216:217], v168, s[52:55], s78 offen offset:1024 sc1
 buffer_load_dwordx2 v[218:219], v168, s[52:55], s78 offen offset:2048 sc1
 s_waitcnt vmcnt(0)
 s_branch Lpoll74
Lgot75:
 v_pk_add_f32 v[194:195], v[206:207], v[208:209]
 v_pk_add_f32 v[194:195], v[194:195], v[210:211]
 v_pk_add_f32 v[194:195], v[194:195], v[212:213]
 v_pk_add_f32 v[194:195], v[194:195], v[214:215]
 v_pk_add_f32 v[194:195], v[194:195], v[216:217]
 v_pk_add_f32 v[194:195], v[194:195], v[218:219]
 v_mov_b32 v196, v194
 v_mov_b32 v197, v195
 s_nop 0
 v_permlane32_swap_b32 v196, v194
 v_permlane32_swap_b32 v197, v195
 v_add_f32 v194, v194, v196
 v_add_f32 v195, v195, v197
 v_mul_f32 v194, 0x3a924925, v194
 v_mul_f32 v195, 0x3a924925, v195
 v_fma_f32 v195, -v194, v194, v195
 v_max_f32 v195, 0, v195
 v_add_f32 v195, 0x3727c5ac, v195
 v_rsq_f32 v195, v195
 s_nop 0
 v_mul_f32 v194, v194, v195
 v_swap_b32 v194, v195
 v_sub_f32 v195, 0, v195
 ds_write2_b32 v165, v194, v195 offset0:0 offset1:32
 ds_read_b128 v[174:177], v166 offset:0
 ds_read_b128 v[178:181], v166 offset:64
 ds_read_b128 v[182:185], v166 offset:128
 ds_read_b128 v[186:189], v166 offset:192
 s_lshl_b32 s78, s81, 18
 s_lshl_b32 s79, s93, 10
 s_add_u32 s78, s78, s79
 s_add_u32 s78, s78, 62914560
 s_lshl_b32 s77, s81, 7
 s_add_u32 s77, s77, 71310336
 s_waitcnt lgkmcnt(0)
 v_pk_fma_f32 v[60:61], v[60:61], v[174:175], v[182:183]
 v_pk_fma_f32 v[62:63], v[62:63], v[176:177], v[184:185]
 v_pk_fma_f32 v[76:77], v[76:77], v[178:179], v[186:187]
 v_pk_fma_f32 v[78:79], v[78:79], v[180:181], v[188:189]
 v_cvt_pk_bf16_f32 v124, v60, v61
 v_cvt_pk_bf16_f32 v125, v62, v63
 v_cvt_pk_bf16_f32 v126, v76, v77
 v_cvt_pk_bf16_f32 v127, v78, v79
 buffer_store_dwordx4 v[124:127], v251, s[52:55], s78 offen sc1
 s_add_u32 s78, s78, 65536
 v_pk_fma_f32 v[64:65], v[64:65], v[174:175], v[182:183]
 v_pk_fma_f32 v[66:67], v[66:67], v[176:177], v[184:185]
 v_pk_fma_f32 v[80:81], v[80:81], v[178:179], v[186:187]
 v_pk_fma_f32 v[82:83], v[82:83], v[180:181], v[188:189]
 v_cvt_pk_bf16_f32 v128, v64, v65
 v_cvt_pk_bf16_f32 v129, v66, v67
 v_cvt_pk_bf16_f32 v130, v80, v81
 v_cvt_pk_bf16_f32 v131, v82, v83
 buffer_store_dwordx4 v[128:131], v251, s[52:55], s78 offen sc1
 s_add_u32 s78, s78, 65536
 v_pk_fma_f32 v[68:69], v[68:69], v[174:175], v[182:183]
 v_pk_fma_f32 v[70:71], v[70:71], v[176:177], v[184:185]
 v_pk_fma_f32 v[84:85], v[84:85], v[178:179], v[186:187]
 v_pk_fma_f32 v[86:87], v[86:87], v[180:181], v[188:189]
 v_cvt_pk_bf16_f32 v132, v68, v69
 v_cvt_pk_bf16_f32 v133, v70, v71
 v_cvt_pk_bf16_f32 v134, v84, v85
 v_cvt_pk_bf16_f32 v135, v86, v87
 buffer_store_dwordx4 v[132:135], v251, s[52:55], s78 offen sc1
 s_add_u32 s78, s78, 65536
 v_pk_fma_f32 v[72:73], v[72:73], v[174:175], v[182:183]
 v_pk_fma_f32 v[74:75], v[74:75], v[176:177], v[184:185]
 v_pk_fma_f32 v[88:89], v[88:89], v[178:179], v[186:187]
 v_pk_fma_f32 v[90:91], v[90:91], v[180:181], v[188:189]
 v_cvt_pk_bf16_f32 v136, v72, v73
 v_cvt_pk_bf16_f32 v137, v74, v75
 v_cvt_pk_bf16_f32 v138, v88, v89
 v_cvt_pk_bf16_f32 v139, v90, v91
 buffer_store_dwordx4 v[136:139], v251, s[52:55], s78 offen sc1
 s_mul_i32 s90, s93, 57344
 s_lshl_b32 s78, s81, 11
 s_add_u32 s90, s90, s78
 s_add_u32 s90, s90, 58720256
 s_add_u32 s79, s90, 28672
 v_lshlrev_b32 v164, 3, v253
 s_waitcnt lgkmcnt(4)
 v_mfma_f32_16x16x32_bf16 v[92:95], v[12:15], a[112:115], v[92:95]
 v_mfma_f32_16x16x32_bf16 v[108:111], v[12:15], a[116:119], v[108:111]
 v_mfma_f32_16x16x32_bf16 v[96:99], v[16:19], a[112:115], v[96:99]
 v_mfma_f32_16x16x32_bf16 v[112:115], v[16:19], a[116:119], v[112:115]
 v_mfma_f32_16x16x32_bf16 v[100:103], v[20:23], a[112:115], v[100:103]
 v_mfma_f32_16x16x32_bf16 v[116:119], v[20:23], a[116:119], v[116:119]
 v_mfma_f32_16x16x32_bf16 v[104:107], v[24:27], a[112:115], v[104:107]
 v_mfma_f32_16x16x32_bf16 v[120:123], v[24:27], a[116:119], v[120:123]
 s_waitcnt lgkmcnt(0)
 v_mfma_f32_16x16x32_bf16 v[92:95], v[28:31], a[120:123], v[92:95]
 v_mfma_f32_16x16x32_bf16 v[108:111], v[28:31], a[124:127], v[108:111]
 v_mfma_f32_16x16x32_bf16 v[96:99], v[32:35], a[120:123], v[96:99]
 v_mfma_f32_16x16x32_bf16 v[112:115], v[32:35], a[124:127], v[112:115]
 v_mfma_f32_16x16x32_bf16 v[100:103], v[36:39], a[120:123], v[100:103]
 v_mfma_f32_16x16x32_bf16 v[116:119], v[36:39], a[124:127], v[116:119]
 v_mfma_f32_16x16x32_bf16 v[104:107], v[40:43], a[120:123], v[104:107]
 v_mfma_f32_16x16x32_bf16 v[120:123], v[40:43], a[124:127], v[120:123]
 s_nop 3
 v_pk_mul_f32 v[92:93], v[92:93], v[190:191] op_sel_hi:[1,0]
 v_pk_fma_f32 v[92:93], v[190:191], v[140:141], v[92:93] op_sel:[1,0,0]
 v_pk_mul_f32 v[94:95], v[94:95], v[190:191] op_sel_hi:[1,0]
 v_pk_fma_f32 v[94:95], v[190:191], v[142:143], v[94:95] op_sel:[1,0,0]
 v_pk_mul_f32 v[96:97], v[96:97], v[190:191] op_sel_hi:[1,0]
 v_pk_fma_f32 v[96:97], v[190:191], v[144:145], v[96:97] op_sel:[1,0,0]
 v_pk_mul_f32 v[98:99], v[98:99], v[190:191] op_sel_hi:[1,0]
 v_pk_fma_f32 v[98:99], v[190:191], v[146:147], v[98:99] op_sel:[1,0,0]
 buffer_load_dwordx4 a[32:35], v251, s[52:55], s86 offen offset:0 sc1
 v_pk_mul_f32 v[198:199], v[92:93], v[92:93]
 v_pk_mul_f32 v[200:201], v[94:95], v[94:95]
 v_pk_mul_f32 v[202:203], v[96:97], v[96:97]
 v_pk_mul_f32 v[204:205], v[98:99], v[98:99]
 v_pk_fma_f32 v[198:199], v[198:199], v[10:11], v[8:9]
 v_pk_fma_f32 v[200:201], v[200:201], v[10:11], v[8:9]
 v_pk_fma_f32 v[202:203], v[202:203], v[10:11], v[8:9]
 v_pk_fma_f32 v[204:205], v[204:205], v[10:11], v[8:9]
 buffer_load_dwordx4 a[36:39], v251, s[52:55], s86 offen offset:1024 sc1
 v_pk_mul_f32 v[198:199], v[198:199], v[92:93]
 v_pk_mul_f32 v[200:201], v[200:201], v[94:95]
 v_pk_mul_f32 v[202:203], v[202:203], v[96:97]
 v_pk_mul_f32 v[204:205], v[204:205], v[98:99]
 v_exp_f32 v198, v198
 v_exp_f32 v199, v199
 v_exp_f32 v200, v200
 buffer_load_dwordx4 a[40:43], v251, s[52:55], s86 offen offset:2048 sc1
 v_exp_f32 v201, v201
 v_exp_f32 v202, v202
 v_exp_f32 v203, v203
 v_exp_f32 v204, v204
 v_exp_f32 v205, v205
 v_pk_add_f32 v[198:199], v[198:199], 1.0 op_sel_hi:[1,0]
 v_pk_add_f32 v[200:201], v[200:201], 1.0 op_sel_hi:[1,0]
 buffer_load_dwordx4 a[44:47], v251, s[52:55], s86 offen offset:3072 sc1
 v_pk_add_f32 v[202:203], v[202:203], 1.0 op_sel_hi:[1,0]
 v_pk_add_f32 v[204:205], v[204:205], 1.0 op_sel_hi:[1,0]
 v_rcp_f32 v198, v198
 v_rcp_f32 v199, v199
 v_rcp_f32 v200, v200
 v_rcp_f32 v201, v201
 v_rcp_f32 v202, v202
 s_add_u32 s86, s86, 4096
 v_rcp_f32 v203, v203
 v_rcp_f32 v204, v204
 v_rcp_f32 v205, v205
 v_pk_mul_f32 v[92:93], v[92:93], v[198:199]
 v_pk_mul_f32 v[94:95], v[94:95], v[200:201]
 v_pk_mul_f32 v[96:97], v[96:97], v[202:203]
 v_pk_mul_f32 v[98:99], v[98:99], v[204:205]
 v_cvt_pk_bf16_f32 v44, v92, v93
 v_cvt_pk_bf16_f32 v45, v94, v95
 v_cvt_pk_bf16_f32 v46, v96, v97
 v_cvt_pk_bf16_f32 v47, v98, v99
 s_mul_i32 s78, s81, 37452
 s_add_u32 s77, s78, 28089
 s_lshr_b32 s78, s78, 16
 s_lshr_b32 s77, s77, 16
 s_sub_u32 s77, s77, s78
 s_lshl_b32 s77, s77, 2
 s_add_u32 s77, s77, 4
 v_cmp_gt_u32 vcc, s77, v253
 v_lshlrev_b32 v249, 7, v253
 v_mov_b32 v248, 0x40000000
 v_cndmask_b32 v248, v248, v249, vcc
 s_lshl_b32 s77, s78, 9
 s_add_u32 s77, s77, 71322624
 s_waitcnt vmcnt(4)
 s_barrier
 s_cmp_lg_u32 s60, 0
 s_cbranch_scc1 Lnv76
 v_mov_b32 v250, 1
 buffer_atomic_add v250, v248, s[52:55], s77 offen sc1
Lnv76:
 buffer_store_dwordx2 v[44:45], v164, s[52:55], s90 offen offset:0 sc1
 buffer_store_dwordx2 v[46:47], v164, s[52:55], s90 offen offset:512 sc1
 v_pk_mul_f32 v[100:101], v[100:101], v[190:191] op_sel_hi:[1,0]
 v_pk_fma_f32 v[100:101], v[190:191], v[148:149], v[100:101] op_sel:[1,0,0]
 v_pk_mul_f32 v[102:103], v[102:103], v[190:191] op_sel_hi:[1,0]
 v_pk_fma_f32 v[102:103], v[190:191], v[150:151], v[102:103] op_sel:[1,0,0]
 v_pk_mul_f32 v[104:105], v[104:105], v[190:191] op_sel_hi:[1,0]
 v_pk_fma_f32 v[104:105], v[190:191], v[152:153], v[104:105] op_sel:[1,0,0]
 v_pk_mul_f32 v[106:107], v[106:107], v[190:191] op_sel_hi:[1,0]
 v_pk_fma_f32 v[106:107], v[190:191], v[154:155], v[106:107] op_sel:[1,0,0]
 buffer_load_dwordx4 a[48:51], v251, s[52:55], s86 offen offset:0 sc1
 v_pk_mul_f32 v[198:199], v[100:101], v[100:101]
 v_pk_mul_f32 v[200:201], v[102:103], v[102:103]
 v_pk_mul_f32 v[202:203], v[104:105], v[104:105]
 v_pk_mul_f32 v[204:205], v[106:107], v[106:107]
 v_pk_fma_f32 v[198:199], v[198:199], v[10:11], v[8:9]
 v_pk_fma_f32 v[200:201], v[200:201], v[10:11], v[8:9]
 v_pk_fma_f32 v[202:203], v[202:203], v[10:11], v[8:9]
 v_pk_fma_f32 v[204:205], v[204:205], v[10:11], v[8:9]
 buffer_load_dwordx4 a[52:55], v251, s[52:55], s86 offen offset:1024 sc1
 v_pk_mul_f32 v[198:199], v[198:199], v[100:101]
 v_pk_mul_f32 v[200:201], v[200:201], v[102:103]
 v_pk_mul_f32 v[202:203], v[202:203], v[104:105]
 v_pk_mul_f32 v[204:205], v[204:205], v[106:107]
 v_exp_f32 v198, v198
 v_exp_f32 v199, v199
 v_exp_f32 v200, v200
 buffer_load_dwordx4 a[56:59], v251, s[52:55], s86 offen offset:2048 sc1
 v_exp_f32 v201, v201
 v_exp_f32 v202, v202
 v_exp_f32 v203, v203
 v_exp_f32 v204, v204
 v_exp_f32 v205, v205
 v_pk_add_f32 v[198:199], v[198:199], 1.0 op_sel_hi:[1,0]
 v_pk_add_f32 v[200:201], v[200:201], 1.0 op_sel_hi:[1,0]
 buffer_load_dwordx4 a[60:63], v251, s[52:55], s86 offen offset:3072 sc1
 v_pk_add_f32 v[202:203], v[202:203], 1.0 op_sel_hi:[1,0]
 v_pk_add_f32 v[204:205], v[204:205], 1.0 op_sel_hi:[1,0]
 v_rcp_f32 v198, v198
 v_rcp_f32 v199, v199
 v_rcp_f32 v200, v200
 v_rcp_f32 v201, v201
 v_rcp_f32 v202, v202
 s_add_u32 s86, s86, 4096
 v_rcp_f32 v203, v203
 v_rcp_f32 v204, v204
 v_rcp_f32 v205, v205
 v_pk_mul_f32 v[100:101], v[100:101], v[198:199]
 v_pk_mul_f32 v[102:103], v[102:103], v[200:201]
 v_pk_mul_f32 v[104:105], v[104:105], v[202:203]
 v_pk_mul_f32 v[106:107], v[106:107], v[204:205]
 v_cvt_pk_bf16_f32 v48, v100, v101
 v_cvt_pk_bf16_f32 v49, v102, v103
 v_cvt_pk_bf16_f32 v50, v104, v105
 v_cvt_pk_bf16_f32 v51, v106, v107
 buffer_store_dwordx2 v[48:49], v164, s[52:55], s90 offen offset:1024 sc1
 buffer_store_dwordx2 v[50:51], v164, s[52:55], s90 offen offset:1536 sc1
 v_pk_mul_f32 v[108:109], v[108:109], v[192:193] op_sel_hi:[1,0]
 v_pk_fma_f32 v[108:109], v[192:193], v[140:141], v[108:109] op_sel:[1,0,0]
 v_pk_mul_f32 v[110:111], v[110:111], v[192:193] op_sel_hi:[1,0]
 v_pk_fma_f32 v[110:111], v[192:193], v[142:143], v[110:111] op_sel:[1,0,0]
 v_pk_mul_f32 v[112:113], v[112:113], v[192:193] op_sel_hi:[1,0]
 v_pk_fma_f32 v[112:113], v[192:193], v[144:145], v[112:113] op_sel:[1,0,0]
 v_pk_mul_f32 v[114:115], v[114:115], v[192:193] op_sel_hi:[1,0]
 v_pk_fma_f32 v[114:115], v[192:193], v[146:147], v[114:115] op_sel:[1,0,0]
 buffer_load_dwordx4 a[64:67], v251, s[52:55], s86 offen offset:0 sc1
 v_pk_mul_f32 v[198:199], v[108:109], v[108:109]
 v_pk_mul_f32 v[200:201], v[110:111], v[110:111]
 v_pk_mul_f32 v[202:203], v[112:113], v[112:113]
 v_pk_mul_f32 v[204:205], v[114:115], v[114:115]
 v_pk_fma_f32 v[198:199], v[198:199], v[10:11], v[8:9]
 v_pk_fma_f32 v[200:201], v[200:201], v[10:11], v[8:9]
 v_pk_fma_f32 v[202:203], v[202:203], v[10:11], v[8:9]
 v_pk_fma_f32 v[204:205], v[204:205], v[10:11], v[8:9]
 buffer_load_dwordx4 a[68:71], v251, s[52:55], s86 offen offset:1024 sc1
 v_pk_mul_f32 v[198:199], v[198:199], v[108:109]
 v_pk_mul_f32 v[200:201], v[200:201], v[110:111]
 v_pk_mul_f32 v[202:203], v[202:203], v[112:113]
 v_pk_mul_f32 v[204:205], v[204:205], v[114:115]
 v_exp_f32 v198, v198
 v_exp_f32 v199, v199
 v_exp_f32 v200, v200
 buffer_load_dwordx4 a[72:75], v251, s[52:55], s86 offen offset:2048 sc1
 v_exp_f32 v201, v201
 v_exp_f32 v202, v202
 v_exp_f32 v203, v203
 v_exp_f32 v204, v204
 v_exp_f32 v205, v205
 v_pk_add_f32 v[198:199], v[198:199], 1.0 op_sel_hi:[1,0]
 v_pk_add_f32 v[200:201], v[200:201], 1.0 op_sel_hi:[1,0]
 buffer_load_dwordx4 a[76:79], v251, s[52:55], s86 offen offset:3072 sc1
 v_pk_add_f32 v[202:203], v[202:203], 1.0 op_sel_hi:[1,0]
 v_pk_add_f32 v[204:205], v[204:205], 1.0 op_sel_hi:[1,0]
 v_rcp_f32 v198, v198
 v_rcp_f32 v199, v199
 v_rcp_f32 v200, v200
 v_rcp_f32 v201, v201
 v_rcp_f32 v202, v202
 s_add_u32 s86, s86, 4096
 v_rcp_f32 v203, v203
 v_rcp_f32 v204, v204
 v_rcp_f32 v205, v205
 v_pk_mul_f32 v[108:109], v[108:109], v[198:199]
 v_pk_mul_f32 v[110:111], v[110:111], v[200:201]
 v_pk_mul_f32 v[112:113], v[112:113], v[202:203]
 v_pk_mul_f32 v[114:115], v[114:115], v[204:205]
 v_cvt_pk_bf16_f32 v52, v108, v109
 v_cvt_pk_bf16_f32 v53, v110, v111
 v_cvt_pk_bf16_f32 v54, v112, v113
 v_cvt_pk_bf16_f32 v55, v114, v115
 buffer_store_dwordx2 v[52:53], v164, s[52:55], s79 offen offset:0 sc1
 buffer_store_dwordx2 v[54:55], v164, s[52:55], s79 offen offset:512 sc1
 v_pk_mul_f32 v[116:117], v[116:117], v[192:193] op_sel_hi:[1,0]
 v_pk_fma_f32 v[116:117], v[192:193], v[148:149], v[116:117] op_sel:[1,0,0]
 v_pk_mul_f32 v[118:119], v[118:119], v[192:193] op_sel_hi:[1,0]
 v_pk_fma_f32 v[118:119], v[192:193], v[150:151], v[118:119] op_sel:[1,0,0]
 v_pk_mul_f32 v[120:121], v[120:121], v[192:193] op_sel_hi:[1,0]
 v_pk_fma_f32 v[120:121], v[192:193], v[152:153], v[120:121] op_sel:[1,0,0]
 v_pk_mul_f32 v[122:123], v[122:123], v[192:193] op_sel_hi:[1,0]
 v_pk_fma_f32 v[122:123], v[192:193], v[154:155], v[122:123] op_sel:[1,0,0]
 buffer_load_dwordx4 a[80:83], v251, s[52:55], s86 offen offset:0 sc1
 v_pk_mul_f32 v[198:199], v[116:117], v[116:117]
 v_pk_mul_f32 v[200:201], v[118:119], v[118:119]
 v_pk_mul_f32 v[202:203], v[120:121], v[120:121]
 v_pk_mul_f32 v[204:205], v[122:123], v[122:123]
 v_pk_fma_f32 v[198:199], v[198:199], v[10:11], v[8:9]
 v_pk_fma_f32 v[200:201], v[200:201], v[10:11], v[8:9]
 v_pk_fma_f32 v[202:203], v[202:203], v[10:11], v[8:9]
 v_pk_fma_f32 v[204:205], v[204:205], v[10:11], v[8:9]
 buffer_load_dwordx4 a[84:87], v251, s[52:55], s86 offen offset:1024 sc1
 v_pk_mul_f32 v[198:199], v[198:199], v[116:117]
 v_pk_mul_f32 v[200:201], v[200:201], v[118:119]
 v_pk_mul_f32 v[202:203], v[202:203], v[120:121]
 v_pk_mul_f32 v[204:205], v[204:205], v[122:123]
 v_exp_f32 v198, v198
 v_exp_f32 v199, v199
 v_exp_f32 v200, v200
 buffer_load_dwordx4 a[88:91], v251, s[52:55], s86 offen offset:2048 sc1
 v_exp_f32 v201, v201
 v_exp_f32 v202, v202
 v_exp_f32 v203, v203
 v_exp_f32 v204, v204
 v_exp_f32 v205, v205
 v_pk_add_f32 v[198:199], v[198:199], 1.0 op_sel_hi:[1,0]
 v_pk_add_f32 v[200:201], v[200:201], 1.0 op_sel_hi:[1,0]
 buffer_load_dwordx4 a[92:95], v251, s[52:55], s86 offen offset:3072 sc1
 v_pk_add_f32 v[202:203], v[202:203], 1.0 op_sel_hi:[1,0]
 v_pk_add_f32 v[204:205], v[204:205], 1.0 op_sel_hi:[1,0]
 v_rcp_f32 v198, v198
 v_rcp_f32 v199, v199
 v_rcp_f32 v200, v200
 v_rcp_f32 v201, v201
 v_rcp_f32 v202, v202
 s_add_u32 s86, s86, 4096
 v_rcp_f32 v203, v203
 v_rcp_f32 v204, v204
 v_rcp_f32 v205, v205
 v_pk_mul_f32 v[116:117], v[116:117], v[198:199]
 v_pk_mul_f32 v[118:119], v[118:119], v[200:201]
 v_pk_mul_f32 v[120:121], v[120:121], v[202:203]
 v_pk_mul_f32 v[122:123], v[122:123], v[204:205]
 v_cvt_pk_bf16_f32 v56, v116, v117
 v_cvt_pk_bf16_f32 v57, v118, v119
 v_cvt_pk_bf16_f32 v58, v120, v121
 v_cvt_pk_bf16_f32 v59, v122, v123
 buffer_store_dwordx2 v[56:57], v164, s[52:55], s79 offen offset:1024 sc1
 buffer_store_dwordx2 v[58:59], v164, s[52:55], s79 offen offset:1536 sc1
 s_branch Lp569
Lidle468:
 s_lshl_b32 s77, s80, 7
 s_add_u32 s77, s77, 71308288
 s_cmp_lg_u32 s60, 0
 s_cbranch_scc1 Lpi77
 buffer_load_dword v238, v239, s[52:55], s77 offen sc1
Lpi77:
 s_cmp_lg_u32 s60, 0
 s_cbranch_scc1 Lpw78
 s_waitcnt vmcnt(0)
 s_mov_b32 s63, 131072
Lsp79:
 v_cmp_gt_u32 vcc, 16, v238
 s_cbranch_vccz Lgo80
 s_sub_u32 s63, s63, 1
 s_cbranch_scc1 Lgo80
 s_sleep 1
 buffer_load_dword v238, v239, s[52:55], s77 offen sc1
 s_waitcnt vmcnt(0)
 s_branch Lsp79
Lgo80:
Lpw78:
 s_barrier
 buffer_load_dwordx4 a[128:131], v251, s[52:55], s86 offen offset:0 sc1
 buffer_load_dwordx4 a[132:135], v251, s[52:55], s86 offen offset:1024 sc1
 buffer_load_dwordx4 a[136:139], v251, s[52:55], s86 offen offset:2048 sc1
 buffer_load_dwordx4 a[140:143], v251, s[52:55], s86 offen offset:3072 sc1
 s_add_u32 s86, s86, 4096
 s_waitcnt vmcnt(0)
 buffer_load_dwordx4 a[144:147], v251, s[52:55], s86 offen offset:0 sc1
 buffer_load_dwordx4 a[148:151], v251, s[52:55], s86 offen offset:1024 sc1
 buffer_load_dwordx4 a[152:155], v251, s[52:55], s86 offen offset:2048 sc1
 buffer_load_dwordx4 a[156:159], v251, s[52:55], s86 offen offset:3072 sc1
 s_add_u32 s86, s86, 4096
 s_waitcnt vmcnt(0)
 buffer_load_dwordx4 a[160:163], v251, s[52:55], s86 offen offset:0 sc1
 buffer_load_dwordx4 a[164:167], v251, s[52:55], s86 offen offset:1024 sc1
 buffer_load_dwordx4 a[168:171], v251, s[52:55], s86 offen offset:2048 sc1
 buffer_load_dwordx4 a[172:175], v251, s[52:55], s86 offen offset:3072 sc1
 s_add_u32 s86, s86, 4096
 s_waitcnt vmcnt(0)
 buffer_load_dwordx4 a[176:179], v251, s[52:55], s86 offen offset:0 sc1
 buffer_load_dwordx4 a[180:183], v251, s[52:55], s86 offen offset:1024 sc1
 buffer_load_dwordx4 a[184:187], v251, s[52:55], s86 offen offset:2048 sc1
 buffer_load_dwordx4 a[188:191], v251, s[52:55], s86 offen offset:3072 sc1
 s_add_u32 s86, s86, 4096
 s_waitcnt vmcnt(0)
 buffer_load_dwordx4 a[192:195], v251, s[52:55], s86 offen offset:0 sc1
 buffer_load_dwordx4 a[196:199], v251, s[52:55], s86 offen offset:1024 sc1
 buffer_load_dwordx4 a[200:203], v251, s[52:55], s86 offen offset:2048 sc1
 buffer_load_dwordx4 a[204:207], v251, s[52:55], s86 offen offset:3072 sc1
 s_add_u32 s86, s86, 4096
 s_waitcnt vmcnt(0)
 buffer_load_dwordx4 a[208:211], v251, s[52:55], s86 offen offset:0 sc1
 buffer_load_dwordx4 a[212:215], v251, s[52:55], s86 offen offset:1024 sc1
 buffer_load_dwordx4 a[216:219], v251, s[52:55], s86 offen offset:2048 sc1
 buffer_load_dwordx4 a[220:223], v251, s[52:55], s86 offen offset:3072 sc1
 s_add_u32 s86, s86, 4096
 s_waitcnt vmcnt(0)
 buffer_load_dwordx4 a[224:227], v251, s[52:55], s86 offen offset:0 sc1
 buffer_load_dwordx4 a[228:231], v251, s[52:55], s86 offen offset:1024 sc1
 buffer_load_dwordx4 a[232:235], v251, s[52:55], s86 offen offset:2048 sc1
 buffer_load_dwordx4 a[236:239], v251, s[52:55], s86 offen offset:3072 sc1
 s_add_u32 s86, s86, 4096
 s_waitcnt vmcnt(0)
 buffer_load_dwordx4 a[240:243], v251, s[52:55], s86 offen offset:0 sc1
 buffer_load_dwordx4 a[244:247], v251, s[52:55], s86 offen offset:1024 sc1
 buffer_load_dwordx4 a[248:251], v251, s[52:55], s86 offen offset:2048 sc1
 buffer_load_dwordx4 a[252:255], v251, s[52:55], s86 offen offset:3072 sc1
 s_add_u32 s86, s86, 4096
 s_waitcnt vmcnt(0)
 buffer_load_dwordx4 a[0:3], v251, s[52:55], s86 offen offset:0 sc1
 buffer_load_dwordx4 a[4:7], v251, s[52:55], s86 offen offset:1024 sc1
 buffer_load_dwordx4 a[8:11], v251, s[52:55], s86 offen offset:2048 sc1
 buffer_load_dwordx4 a[12:15], v251, s[52:55], s86 offen offset:3072 sc1
 s_add_u32 s86, s86, 4096
 s_waitcnt vmcnt(0)
 buffer_load_dwordx4 a[16:19], v251, s[52:55], s86 offen offset:0 sc1
 buffer_load_dwordx4 a[20:23], v251, s[52:55], s86 offen offset:1024 sc1
 buffer_load_dwordx4 a[24:27], v251, s[52:55], s86 offen offset:2048 sc1
 buffer_load_dwordx4 a[28:31], v251, s[52:55], s86 offen offset:3072 sc1
 s_add_u32 s86, s86, 4096
 s_waitcnt vmcnt(0)
 buffer_load_dwordx4 a[32:35], v251, s[52:55], s86 offen offset:0 sc1
 buffer_load_dwordx4 a[36:39], v251, s[52:55], s86 offen offset:1024 sc1
 buffer_load_dwordx4 a[40:43], v251, s[52:55], s86 offen offset:2048 sc1
 buffer_load_dwordx4 a[44:47], v251, s[52:55], s86 offen offset:3072 sc1
 s_add_u32 s86, s86, 4096
 s_waitcnt vmcnt(0)
 buffer_load_dwordx4 a[48:51], v251, s[52:55], s86 offen offset:0 sc1
 buffer_load_dwordx4 a[52:55], v251, s[52:55], s86 offen offset:1024 sc1
 buffer_load_dwordx4 a[56:59], v251, s[52:55], s86 offen offset:2048 sc1
 buffer_load_dwordx4 a[60:63], v251, s[52:55], s86 offen offset:3072 sc1
 s_add_u32 s86, s86, 4096
 s_waitcnt vmcnt(0)
 buffer_load_dwordx4 a[64:67], v251, s[52:55], s86 offen offset:0 sc1
 buffer_load_dwordx4 a[68:71], v251, s[52:55], s86 offen offset:1024 sc1
 buffer_load_dwordx4 a[72:75], v251, s[52:55], s86 offen offset:2048 sc1
 buffer_load_dwordx4 a[76:79], v251, s[52:55], s86 offen offset:3072 sc1
 s_add_u32 s86, s86, 4096
 s_waitcnt vmcnt(0)
 buffer_load_dwordx4 a[80:83], v251, s[52:55], s86 offen offset:0 sc1
 buffer_load_dwordx4 a[84:87], v251, s[52:55], s86 offen offset:1024 sc1
 buffer_load_dwordx4 a[88:91], v251, s[52:55], s86 offen offset:2048 sc1
 buffer_load_dwordx4 a[92:95], v251, s[52:55], s86 offen offset:3072 sc1
 s_add_u32 s86, s86, 4096
 s_waitcnt vmcnt(0)
Lp569:
 v_bfe_u32 v248, v253, 2, 2
 v_lshlrev_b32 v248, 3, v248
 v_and_b32 v250, 3, v253
 v_add_u32 v248, v248, v250
 v_and_b32 v250, 1, v252
 v_lshl_add_u32 v248, v250, 2, v248
 v_lshrrev_b32 v250, 1, v252
 v_lshl_add_u32 v248, v250, 5, v248
 v_lshlrev_b32 v218, 1, v248
 s_lshl_b32 s91, s83, 7
 buffer_load_ushort v200, v218, s[36:39], s91 offen
 s_mul_i32 s78, s84, 7
 s_add_u32 s79, s78, 6
 s_lshr_b32 s78, s78, 2
 s_lshr_b32 s79, s79, 2
 v_and_b32 v250, 3, v253
 v_add_u32 v250, s78, v250
 v_min_u32 v250, s79, v250
 v_lshlrev_b32 v239, 7, v250
 s_mov_b32 s77, 71310336
 s_sub_u32 s88, s79, s78
 s_add_u32 s88, s88, 1
 s_lshl_b32 s88, s88, 4
 v_mov_b32 v239, 0
 s_lshl_b32 s77, s84, 2
 s_bfe_u32 s78, s2, 0x20001
 s_add_u32 s77, s77, s78
 s_lshl_b32 s77, s77, 7
 s_add_u32 s77, s77, 71322624
 s_cmp_lg_u32 s60, 0
 s_cbranch_scc1 Lpi81
 buffer_load_dword v238, v239, s[52:55], s77 offen sc1
Lpi81:
 v_add_u32 v250, 1, v252
 v_and_b32 v250, 3, v250
 v_lshl_add_u32 v226, v250, 15, v251
 v_add_u32 v250, 2, v252
 v_and_b32 v250, 3, v250
 v_lshl_add_u32 v227, v250, 15, v251
 v_add_u32 v250, 3, v252
 v_and_b32 v250, 3, v250
 v_lshl_add_u32 v228, v250, 15, v251
 v_lshl_add_u32 v229, v252, 13, v251
 v_add_u32 v229, 131072, v229
 v_lshl_add_u32 v230, v252, 15, v251
 v_lshlrev_b32 v218, 3, v253
 s_lshl_b32 s78, s83, 2
 s_add_u32 s78, s78, s60
 s_mul_i32 s78, s78, 28672
 s_mul_i32 s79, s84, 3584
 s_add_u32 s78, s78, s79
 s_add_u32 s90, s78, 67108864
 s_add_u32 s78, s78, 58720256
 buffer_load_dwordx4 a[96:99], v251, s[52:55], s86 offen offset:0 sc1
 buffer_load_dwordx4 a[100:103], v251, s[52:55], s86 offen offset:1024 sc1
 buffer_load_dwordx4 a[104:107], v251, s[52:55], s86 offen offset:2048 sc1
 buffer_load_dwordx4 a[108:111], v251, s[52:55], s86 offen offset:3072 sc1
 s_add_u32 s86, s86, 4096
 buffer_load_dwordx4 a[112:115], v251, s[52:55], s86 offen offset:0 sc1
 buffer_load_dwordx4 a[116:119], v251, s[52:55], s86 offen offset:1024 sc1
 buffer_load_dwordx4 a[120:123], v251, s[52:55], s86 offen offset:2048 sc1
 buffer_load_dwordx4 a[124:127], v251, s[52:55], s86 offen offset:3072 sc1
 s_add_u32 s86, s86, 4096
 s_waitcnt vmcnt(8)
 v_lshlrev_b32 v200, 16, v200
 v_mov_b32 v201, v200
 v_mov_b32 v202, v200
 v_mov_b32 v203, v200
 s_cmp_lg_u32 s60, 0
 s_cbranch_scc1 Lpw82
 s_waitcnt vmcnt(8)
 s_mov_b32 s63, 131072
Lsp83:
 v_cmp_gt_u32 vcc, s88, v238
 s_cbranch_vccz Lgo84
 s_sub_u32 s63, s63, 1
 s_cbranch_scc1 Lgo84
 s_sleep 1
 buffer_load_dword v238, v239, s[52:55], s77 offen sc1
 s_waitcnt vmcnt(0)
 s_branch Lsp83
Lgo84:
Lpw82:
 s_barrier
 buffer_load_dwordx4 v[112:115], v251, s[52:55], s85 offen offset:0 sc1
 buffer_load_dwordx4 v[116:119], v251, s[52:55], s85 offen offset:1024 sc1
 buffer_load_dwordx4 v[120:123], v251, s[52:55], s85 offen offset:2048 sc1
 buffer_load_dwordx4 v[124:127], v251, s[52:55], s85 offen offset:3072 sc1
 s_add_u32 s85, s85, 4096
 buffer_load_dwordx4 v[128:131], v251, s[52:55], s85 offen offset:0 sc1
 buffer_load_dwordx4 v[132:135], v251, s[52:55], s85 offen offset:1024 sc1
 buffer_load_dwordx4 v[136:139], v251, s[52:55], s85 offen offset:2048 sc1
 buffer_load_dwordx4 v[140:143], v251, s[52:55], s85 offen offset:3072 sc1
 s_add_u32 s85, s85, 4096
 buffer_load_dwordx4 v[144:147], v251, s[52:55], s85 offen offset:0 sc1
 buffer_load_dwordx4 v[148:151], v251, s[52:55], s85 offen offset:1024 sc1
 buffer_load_dwordx4 v[152:155], v251, s[52:55], s85 offen offset:2048 sc1
 buffer_load_dwordx4 v[156:159], v251, s[52:55], s85 offen offset:3072 sc1
 s_add_u32 s85, s85, 4096
 s_lshl_b32 s77, s80, 7
 s_add_u32 s77, s77, 71316352
 s_cmp_ge_u32 s2, 224
 s_cselect_b32 s77, 0x10000000, s77
 v_lshl_add_u32 v248, v252, 6, v253
 v_min_u32 v248, 1, v248
 v_lshlrev_b32 v248, 30, v248
 v_mov_b32 v249, 1
 buffer_atomic_add v249, v248, s[52:55], s77 offen sc1
 s_lshr_b32 s77, s83, 1
 s_lshl_b32 s77, s77, 7
 s_add_u32 s77, s77, 71316352
 v_mov_b32 v239, 0
 s_waitcnt vmcnt(9)
 v_mfma_f32_16x16x32_bf16 v[4:7], v[112:115], a[132:135], 0
 buffer_load_dwordx4 v[160:163], v251, s[52:55], s85 offen offset:0 sc1
 v_mfma_f32_16x16x32_bf16 v[4:7], v[116:119], a[148:151], v[4:7]
 v_mfma_f32_16x16x32_bf16 v[4:7], v[120:123], a[164:167], v[4:7]
 v_mfma_f32_16x16x32_bf16 v[4:7], v[124:127], a[180:183], v[4:7]
 buffer_load_dwordx4 v[164:167], v251, s[52:55], s85 offen offset:1024 sc1
 v_mfma_f32_16x16x32_bf16 v[8:11], v[124:127], a[184:187], 0
 v_mfma_f32_16x16x32_bf16 v[8:11], v[120:123], a[168:171], v[8:11]
 v_mfma_f32_16x16x32_bf16 v[8:11], v[116:119], a[152:155], v[8:11]
 v_mfma_f32_16x16x32_bf16 v[8:11], v[112:115], a[136:139], v[8:11]
 buffer_load_dwordx4 v[168:171], v251, s[52:55], s85 offen offset:2048 sc1
 v_mfma_f32_16x16x32_bf16 v[12:15], v[112:115], a[140:143], 0
 v_mfma_f32_16x16x32_bf16 v[12:15], v[116:119], a[156:159], v[12:15]
 v_mfma_f32_16x16x32_bf16 v[12:15], v[120:123], a[172:175], v[12:15]
 v_mfma_f32_16x16x32_bf16 v[12:15], v[124:127], a[188:191], v[12:15]
 buffer_load_dwordx4 v[172:175], v251, s[52:55], s85 offen offset:3072 sc1
 v_mfma_f32_16x16x32_bf16 v[0:3], v[124:127], a[176:179], v[200:203]
 s_add_u32 s85, s85, 53248
 v_mfma_f32_16x16x32_bf16 v[0:3], v[120:123], a[160:163], v[0:3]
 v_mfma_f32_16x16x32_bf16 v[0:3], v[116:119], a[144:147], v[0:3]
 v_mfma_f32_16x16x32_bf16 v[0:3], v[112:115], a[128:131], v[0:3]
 s_waitcnt vmcnt(9)
 v_mfma_f32_16x16x32_bf16 v[4:7], v[128:131], a[196:199], v[4:7]
 buffer_load_dwordx4 v[112:115], v251, s[52:55], s85 offen offset:0 sc1
 v_mfma_f32_16x16x32_bf16 v[4:7], v[132:135], a[212:215], v[4:7]
 v_mfma_f32_16x16x32_bf16 v[4:7], v[136:139], a[228:231], v[4:7]
 v_mfma_f32_16x16x32_bf16 v[4:7], v[140:143], a[244:247], v[4:7]
 buffer_load_dwordx4 v[116:119], v251, s[52:55], s85 offen offset:1024 sc1
 v_mfma_f32_16x16x32_bf16 v[8:11], v[140:143], a[248:251], v[8:11]
 v_mfma_f32_16x16x32_bf16 v[8:11], v[136:139], a[232:235], v[8:11]
 v_mfma_f32_16x16x32_bf16 v[8:11], v[132:135], a[216:219], v[8:11]
 v_mfma_f32_16x16x32_bf16 v[8:11], v[128:131], a[200:203], v[8:11]
 buffer_load_dwordx4 v[120:123], v251, s[52:55], s85 offen offset:2048 sc1
 v_mfma_f32_16x16x32_bf16 v[12:15], v[128:131], a[204:207], v[12:15]
 v_mfma_f32_16x16x32_bf16 v[12:15], v[132:135], a[220:223], v[12:15]
 v_mfma_f32_16x16x32_bf16 v[12:15], v[136:139], a[236:239], v[12:15]
 v_mfma_f32_16x16x32_bf16 v[12:15], v[140:143], a[252:255], v[12:15]
 buffer_load_dwordx4 v[124:127], v251, s[52:55], s85 offen offset:3072 sc1
 v_mfma_f32_16x16x32_bf16 v[0:3], v[140:143], a[240:243], v[0:3]
 s_add_u32 s85, s85, 4096
 v_mfma_f32_16x16x32_bf16 v[0:3], v[136:139], a[224:227], v[0:3]
 v_mfma_f32_16x16x32_bf16 v[0:3], v[132:135], a[208:211], v[0:3]
 v_mfma_f32_16x16x32_bf16 v[0:3], v[128:131], a[192:195], v[0:3]
 s_waitcnt vmcnt(9)
 v_mfma_f32_16x16x32_bf16 v[4:7], v[144:147], a[4:7], v[4:7]
 buffer_load_dwordx4 v[128:131], v251, s[52:55], s85 offen offset:0 sc1
 v_mfma_f32_16x16x32_bf16 v[4:7], v[148:151], a[20:23], v[4:7]
 v_mfma_f32_16x16x32_bf16 v[4:7], v[152:155], a[36:39], v[4:7]
 v_mfma_f32_16x16x32_bf16 v[4:7], v[156:159], a[52:55], v[4:7]
 buffer_load_dwordx4 v[132:135], v251, s[52:55], s85 offen offset:1024 sc1
 v_mfma_f32_16x16x32_bf16 v[8:11], v[156:159], a[56:59], v[8:11]
 v_mfma_f32_16x16x32_bf16 v[8:11], v[152:155], a[40:43], v[8:11]
 v_mfma_f32_16x16x32_bf16 v[8:11], v[148:151], a[24:27], v[8:11]
 v_mfma_f32_16x16x32_bf16 v[8:11], v[144:147], a[8:11], v[8:11]
 buffer_load_dwordx4 v[136:139], v251, s[52:55], s85 offen offset:2048 sc1
 v_mfma_f32_16x16x32_bf16 v[12:15], v[144:147], a[12:15], v[12:15]
 v_mfma_f32_16x16x32_bf16 v[12:15], v[148:151], a[28:31], v[12:15]
 v_mfma_f32_16x16x32_bf16 v[12:15], v[152:155], a[44:47], v[12:15]
 v_mfma_f32_16x16x32_bf16 v[12:15], v[156:159], a[60:63], v[12:15]
 buffer_load_dwordx4 v[140:143], v251, s[52:55], s85 offen offset:3072 sc1
 v_mfma_f32_16x16x32_bf16 v[0:3], v[156:159], a[48:51], v[0:3]
 s_add_u32 s85, s85, 4096
 v_mfma_f32_16x16x32_bf16 v[0:3], v[152:155], a[32:35], v[0:3]
 v_mfma_f32_16x16x32_bf16 v[0:3], v[148:151], a[16:19], v[0:3]
 v_mfma_f32_16x16x32_bf16 v[0:3], v[144:147], a[0:3], v[0:3]
 s_waitcnt vmcnt(8)
 v_mfma_f32_16x16x32_bf16 v[4:7], v[160:163], a[68:71], v[4:7]
 buffer_load_dwordx4 v[144:147], v251, s[52:55], s85 offen offset:0 sc1
 v_mfma_f32_16x16x32_bf16 v[4:7], v[164:167], a[84:87], v[4:7]
 v_mfma_f32_16x16x32_bf16 v[4:7], v[168:171], a[100:103], v[4:7]
 v_mfma_f32_16x16x32_bf16 v[4:7], v[172:175], a[116:119], v[4:7]
 buffer_load_dwordx4 v[148:151], v251, s[52:55], s85 offen offset:1024 sc1
 v_mfma_f32_16x16x32_bf16 v[8:11], v[172:175], a[120:123], v[8:11]
 v_mfma_f32_16x16x32_bf16 v[8:11], v[168:171], a[104:107], v[8:11]
 v_mfma_f32_16x16x32_bf16 v[8:11], v[164:167], a[88:91], v[8:11]
 v_mfma_f32_16x16x32_bf16 v[8:11], v[160:163], a[72:75], v[8:11]
 buffer_load_dwordx4 v[152:155], v251, s[52:55], s85 offen offset:2048 sc1
 v_mfma_f32_16x16x32_bf16 v[12:15], v[160:163], a[76:79], v[12:15]
 v_mfma_f32_16x16x32_bf16 v[12:15], v[164:167], a[92:95], v[12:15]
 ds_write_b128 v226, v[4:7] offset:0
 v_mfma_f32_16x16x32_bf16 v[12:15], v[168:171], a[108:111], v[12:15]
 v_mfma_f32_16x16x32_bf16 v[12:15], v[172:175], a[124:127], v[12:15]
 buffer_load_dwordx4 v[156:159], v251, s[52:55], s85 offen offset:3072 sc1
 v_mfma_f32_16x16x32_bf16 v[0:3], v[172:175], a[112:115], v[0:3]
 s_add_u32 s85, s85, 4096
 v_mfma_f32_16x16x32_bf16 v[0:3], v[168:171], a[96:99], v[0:3]
 ds_write_b128 v227, v[8:11] offset:7168
 v_mfma_f32_16x16x32_bf16 v[0:3], v[164:167], a[80:83], v[0:3]
 v_mfma_f32_16x16x32_bf16 v[0:3], v[160:163], a[64:67], v[0:3]
 s_waitcnt vmcnt(8)
 v_mfma_f32_16x16x32_bf16 v[20:23], v[112:115], a[132:135], 0
 buffer_load_dwordx4 v[160:163], v251, s[52:55], s85 offen offset:0 sc1
 v_mfma_f32_16x16x32_bf16 v[20:23], v[116:119], a[148:151], v[20:23]
 ds_write_b128 v228, v[12:15] offset:14336
 v_mfma_f32_16x16x32_bf16 v[20:23], v[120:123], a[164:167], v[20:23]
 v_mfma_f32_16x16x32_bf16 v[20:23], v[124:127], a[180:183], v[20:23]
 buffer_load_dwordx4 v[164:167], v251, s[52:55], s85 offen offset:1024 sc1
 v_mfma_f32_16x16x32_bf16 v[24:27], v[124:127], a[184:187], 0
 v_mfma_f32_16x16x32_bf16 v[24:27], v[120:123], a[168:171], v[24:27]
 v_mfma_f32_16x16x32_bf16 v[24:27], v[116:119], a[152:155], v[24:27]
 v_mfma_f32_16x16x32_bf16 v[24:27], v[112:115], a[136:139], v[24:27]
 buffer_load_dwordx4 v[168:171], v251, s[52:55], s85 offen offset:2048 sc1
 v_mfma_f32_16x16x32_bf16 v[28:31], v[112:115], a[140:143], 0
 v_mfma_f32_16x16x32_bf16 v[28:31], v[116:119], a[156:159], v[28:31]
 v_mfma_f32_16x16x32_bf16 v[28:31], v[120:123], a[172:175], v[28:31]
 v_mfma_f32_16x16x32_bf16 v[28:31], v[124:127], a[188:191], v[28:31]
 buffer_load_dwordx4 v[172:175], v251, s[52:55], s85 offen offset:3072 sc1
 v_mfma_f32_16x16x32_bf16 v[16:19], v[124:127], a[176:179], v[200:203]
 s_add_u32 s85, s85, 53248
 v_mfma_f32_16x16x32_bf16 v[16:19], v[120:123], a[160:163], v[16:19]
 v_mfma_f32_16x16x32_bf16 v[16:19], v[116:119], a[144:147], v[16:19]
 v_mfma_f32_16x16x32_bf16 v[16:19], v[112:115], a[128:131], v[16:19]
 s_waitcnt vmcnt(8)
 v_mfma_f32_16x16x32_bf16 v[20:23], v[128:131], a[196:199], v[20:23]
 buffer_load_dwordx4 v[112:115], v251, s[52:55], s85 offen offset:0 sc1
 v_mfma_f32_16x16x32_bf16 v[20:23], v[132:135], a[212:215], v[20:23]
 v_mfma_f32_16x16x32_bf16 v[20:23], v[136:139], a[228:231], v[20:23]
 v_mfma_f32_16x16x32_bf16 v[20:23], v[140:143], a[244:247], v[20:23]
 buffer_load_dwordx4 v[116:119], v251, s[52:55], s85 offen offset:1024 sc1
 v_mfma_f32_16x16x32_bf16 v[24:27], v[140:143], a[248:251], v[24:27]
 v_mfma_f32_16x16x32_bf16 v[24:27], v[136:139], a[232:235], v[24:27]
 v_mfma_f32_16x16x32_bf16 v[24:27], v[132:135], a[216:219], v[24:27]
 v_mfma_f32_16x16x32_bf16 v[24:27], v[128:131], a[200:203], v[24:27]
 buffer_load_dwordx4 v[120:123], v251, s[52:55], s85 offen offset:2048 sc1
 v_mfma_f32_16x16x32_bf16 v[28:31], v[128:131], a[204:207], v[28:31]
 v_mfma_f32_16x16x32_bf16 v[28:31], v[132:135], a[220:223], v[28:31]
 v_mfma_f32_16x16x32_bf16 v[28:31], v[136:139], a[236:239], v[28:31]
 v_mfma_f32_16x16x32_bf16 v[28:31], v[140:143], a[252:255], v[28:31]
 buffer_load_dwordx4 v[124:127], v251, s[52:55], s85 offen offset:3072 sc1
 v_mfma_f32_16x16x32_bf16 v[16:19], v[140:143], a[240:243], v[16:19]
 s_add_u32 s85, s85, 4096
 v_mfma_f32_16x16x32_bf16 v[16:19], v[136:139], a[224:227], v[16:19]
 v_mfma_f32_16x16x32_bf16 v[16:19], v[132:135], a[208:211], v[16:19]
 v_mfma_f32_16x16x32_bf16 v[16:19], v[128:131], a[192:195], v[16:19]
 s_waitcnt vmcnt(8)
 v_mfma_f32_16x16x32_bf16 v[20:23], v[144:147], a[4:7], v[20:23]
 buffer_load_dwordx4 v[128:131], v251, s[52:55], s85 offen offset:0 sc1
 v_mfma_f32_16x16x32_bf16 v[20:23], v[148:151], a[20:23], v[20:23]
 v_mfma_f32_16x16x32_bf16 v[20:23], v[152:155], a[36:39], v[20:23]
 v_mfma_f32_16x16x32_bf16 v[20:23], v[156:159], a[52:55], v[20:23]
 buffer_load_dwordx4 v[132:135], v251, s[52:55], s85 offen offset:1024 sc1
 v_mfma_f32_16x16x32_bf16 v[24:27], v[156:159], a[56:59], v[24:27]
 v_mfma_f32_16x16x32_bf16 v[24:27], v[152:155], a[40:43], v[24:27]
 v_mfma_f32_16x16x32_bf16 v[24:27], v[148:151], a[24:27], v[24:27]
 v_mfma_f32_16x16x32_bf16 v[24:27], v[144:147], a[8:11], v[24:27]
 buffer_load_dwordx4 v[136:139], v251, s[52:55], s85 offen offset:2048 sc1
 v_mfma_f32_16x16x32_bf16 v[28:31], v[144:147], a[12:15], v[28:31]
 v_mfma_f32_16x16x32_bf16 v[28:31], v[148:151], a[28:31], v[28:31]
 v_mfma_f32_16x16x32_bf16 v[28:31], v[152:155], a[44:47], v[28:31]
 v_mfma_f32_16x16x32_bf16 v[28:31], v[156:159], a[60:63], v[28:31]
 buffer_load_dwordx4 v[140:143], v251, s[52:55], s85 offen offset:3072 sc1
 v_mfma_f32_16x16x32_bf16 v[16:19], v[156:159], a[48:51], v[16:19]
 s_add_u32 s85, s85, 4096
 v_mfma_f32_16x16x32_bf16 v[16:19], v[152:155], a[32:35], v[16:19]
 v_mfma_f32_16x16x32_bf16 v[16:19], v[148:151], a[16:19], v[16:19]
 v_mfma_f32_16x16x32_bf16 v[16:19], v[144:147], a[0:3], v[16:19]
 s_waitcnt vmcnt(8)
 v_mfma_f32_16x16x32_bf16 v[20:23], v[160:163], a[68:71], v[20:23]
 buffer_load_dword v238, v239, s[52:55], s77 offen sc1
 v_mfma_f32_16x16x32_bf16 v[20:23], v[164:167], a[84:87], v[20:23]
 v_mfma_f32_16x16x32_bf16 v[20:23], v[168:171], a[100:103], v[20:23]
 buffer_load_dwordx4 v[144:147], v251, s[52:55], s85 offen offset:0 sc1
 v_mfma_f32_16x16x32_bf16 v[20:23], v[172:175], a[116:119], v[20:23]
 v_mfma_f32_16x16x32_bf16 v[24:27], v[172:175], a[120:123], v[24:27]
 v_mfma_f32_16x16x32_bf16 v[24:27], v[168:171], a[104:107], v[24:27]
 buffer_load_dwordx4 v[148:151], v251, s[52:55], s85 offen offset:1024 sc1
 v_mfma_f32_16x16x32_bf16 v[24:27], v[164:167], a[88:91], v[24:27]
 v_mfma_f32_16x16x32_bf16 v[24:27], v[160:163], a[72:75], v[24:27]
 v_mfma_f32_16x16x32_bf16 v[28:31], v[160:163], a[76:79], v[28:31]
 buffer_load_dwordx4 v[152:155], v251, s[52:55], s85 offen offset:2048 sc1
 v_mfma_f32_16x16x32_bf16 v[28:31], v[164:167], a[92:95], v[28:31]
 ds_write_b128 v226, v[20:23] offset:1024
 v_mfma_f32_16x16x32_bf16 v[28:31], v[168:171], a[108:111], v[28:31]
 v_mfma_f32_16x16x32_bf16 v[28:31], v[172:175], a[124:127], v[28:31]
 buffer_load_dwordx4 v[156:159], v251, s[52:55], s85 offen offset:3072 sc1
 v_mfma_f32_16x16x32_bf16 v[16:19], v[172:175], a[112:115], v[16:19]
 s_add_u32 s85, s85, 4096
 v_mfma_f32_16x16x32_bf16 v[16:19], v[168:171], a[96:99], v[16:19]
 ds_write_b128 v227, v[24:27] offset:8192
 v_mfma_f32_16x16x32_bf16 v[16:19], v[164:167], a[80:83], v[16:19]
 v_mfma_f32_16x16x32_bf16 v[16:19], v[160:163], a[64:67], v[16:19]
 s_waitcnt vmcnt(9)
 v_mfma_f32_16x16x32_bf16 v[36:39], v[112:115], a[132:135], 0
 buffer_load_dwordx4 v[160:163], v251, s[52:55], s85 offen offset:0 sc1
 v_mfma_f32_16x16x32_bf16 v[36:39], v[116:119], a[148:151], v[36:39]
 ds_write_b128 v228, v[28:31] offset:15360
 v_mfma_f32_16x16x32_bf16 v[36:39], v[120:123], a[164:167], v[36:39]
 v_mfma_f32_16x16x32_bf16 v[36:39], v[124:127], a[180:183], v[36:39]
 buffer_load_dwordx4 v[164:167], v251, s[52:55], s85 offen offset:1024 sc1
 v_mfma_f32_16x16x32_bf16 v[40:43], v[124:127], a[184:187], 0
 v_mfma_f32_16x16x32_bf16 v[40:43], v[120:123], a[168:171], v[40:43]
 v_mfma_f32_16x16x32_bf16 v[40:43], v[116:119], a[152:155], v[40:43]
 s_waitcnt lgkmcnt(0)
 v_mfma_f32_16x16x32_bf16 v[40:43], v[112:115], a[136:139], v[40:43]
 s_barrier
 ds_read_b128 v[176:179], v230 offset:0
 ds_read_b128 v[180:183], v230 offset:7168
 v_mfma_f32_16x16x32_bf16 v[44:47], v[112:115], a[140:143], 0
 ds_read_b128 v[184:187], v230 offset:14336
 ds_read_b128 v[188:191], v230 offset:1024
 v_mfma_f32_16x16x32_bf16 v[44:47], v[116:119], a[156:159], v[44:47]
 ds_read_b128 v[192:195], v230 offset:8192
 ds_read_b128 v[196:199], v230 offset:15360
 v_mfma_f32_16x16x32_bf16 v[44:47], v[120:123], a[172:175], v[44:47]
 buffer_load_dwordx4 v[168:171], v251, s[52:55], s85 offen offset:2048 sc1
 v_mfma_f32_16x16x32_bf16 v[44:47], v[124:127], a[188:191], v[44:47]
 buffer_load_dwordx4 v[172:175], v251, s[52:55], s85 offen offset:3072 sc1
 v_mfma_f32_16x16x32_bf16 v[32:35], v[124:127], a[176:179], v[200:203]
 s_add_u32 s85, s85, 53248
 v_mfma_f32_16x16x32_bf16 v[32:35], v[120:123], a[160:163], v[32:35]
 v_mfma_f32_16x16x32_bf16 v[32:35], v[116:119], a[144:147], v[32:35]
 v_mfma_f32_16x16x32_bf16 v[32:35], v[112:115], a[128:131], v[32:35]
 s_waitcnt vmcnt(9)
 v_mfma_f32_16x16x32_bf16 v[36:39], v[128:131], a[196:199], v[36:39]
 buffer_load_dwordx4 v[112:115], v251, s[52:55], s85 offen offset:0 sc1
 v_mfma_f32_16x16x32_bf16 v[36:39], v[132:135], a[212:215], v[36:39]
 v_mfma_f32_16x16x32_bf16 v[36:39], v[136:139], a[228:231], v[36:39]
 v_mfma_f32_16x16x32_bf16 v[36:39], v[140:143], a[244:247], v[36:39]
 buffer_load_dwordx4 v[116:119], v251, s[52:55], s85 offen offset:1024 sc1
 v_mfma_f32_16x16x32_bf16 v[40:43], v[140:143], a[248:251], v[40:43]
 v_mfma_f32_16x16x32_bf16 v[40:43], v[136:139], a[232:235], v[40:43]
 v_mfma_f32_16x16x32_bf16 v[40:43], v[132:135], a[216:219], v[40:43]
 v_mfma_f32_16x16x32_bf16 v[40:43], v[128:131], a[200:203], v[40:43]
 buffer_load_dwordx4 v[120:123], v251, s[52:55], s85 offen offset:2048 sc1
 v_mfma_f32_16x16x32_bf16 v[44:47], v[128:131], a[204:207], v[44:47]
 v_mfma_f32_16x16x32_bf16 v[44:47], v[132:135], a[220:223], v[44:47]
 v_mfma_f32_16x16x32_bf16 v[44:47], v[136:139], a[236:239], v[44:47]
 v_mfma_f32_16x16x32_bf16 v[44:47], v[140:143], a[252:255], v[44:47]
 buffer_load_dwordx4 v[124:127], v251, s[52:55], s85 offen offset:3072 sc1
 v_mfma_f32_16x16x32_bf16 v[32:35], v[140:143], a[240:243], v[32:35]
 s_add_u32 s85, s85, 4096
 v_mfma_f32_16x16x32_bf16 v[32:35], v[136:139], a[224:227], v[32:35]
 v_mfma_f32_16x16x32_bf16 v[32:35], v[132:135], a[208:211], v[32:35]
 v_mfma_f32_16x16x32_bf16 v[32:35], v[128:131], a[192:195], v[32:35]
 s_waitcnt vmcnt(8)
 v_mfma_f32_16x16x32_bf16 v[36:39], v[144:147], a[4:7], v[36:39]
 buffer_load_dwordx4 v[128:131], v251, s[52:55], s85 offen offset:0 sc1
 v_mfma_f32_16x16x32_bf16 v[36:39], v[148:151], a[20:23], v[36:39]
 v_mfma_f32_16x16x32_bf16 v[36:39], v[152:155], a[36:39], v[36:39]
 v_mfma_f32_16x16x32_bf16 v[36:39], v[156:159], a[52:55], v[36:39]
 buffer_load_dwordx4 v[132:135], v251, s[52:55], s85 offen offset:1024 sc1
 v_mfma_f32_16x16x32_bf16 v[40:43], v[156:159], a[56:59], v[40:43]
 v_mfma_f32_16x16x32_bf16 v[40:43], v[152:155], a[40:43], v[40:43]
 v_mfma_f32_16x16x32_bf16 v[40:43], v[148:151], a[24:27], v[40:43]
 buffer_load_dwordx4 v[136:139], v251, s[52:55], s85 offen offset:2048 sc1
 v_mfma_f32_16x16x32_bf16 v[40:43], v[144:147], a[8:11], v[40:43]
 v_mfma_f32_16x16x32_bf16 v[44:47], v[144:147], a[12:15], v[44:47]
 v_mfma_f32_16x16x32_bf16 v[44:47], v[148:151], a[28:31], v[44:47]
 buffer_load_dwordx4 v[140:143], v251, s[52:55], s85 offen offset:3072 sc1
 v_mfma_f32_16x16x32_bf16 v[44:47], v[152:155], a[44:47], v[44:47]
 s_add_u32 s85, s85, 4096
 v_mfma_f32_16x16x32_bf16 v[44:47], v[156:159], a[60:63], v[44:47]
 s_waitcnt vmcnt(16)
 v_mfma_f32_16x16x32_bf16 v[32:35], v[156:159], a[48:51], v[32:35]
 v_mfma_f32_16x16x32_bf16 v[32:35], v[152:155], a[32:35], v[32:35]
 v_cmp_gt_u32 vcc, 14, v238
 v_mfma_f32_16x16x32_bf16 v[32:35], v[148:151], a[16:19], v[32:35]
 s_cbranch_vccnz Lts85
Ltb86:
 v_mfma_f32_16x16x32_bf16 v[32:35], v[144:147], a[0:3], v[32:35]
 s_waitcnt vmcnt(8)
 v_mfma_f32_16x16x32_bf16 v[36:39], v[160:163], a[68:71], v[36:39]
 buffer_load_dwordx4 v[144:147], v251, s[52:55], s85 offen offset:0 sc1
 v_mfma_f32_16x16x32_bf16 v[36:39], v[164:167], a[84:87], v[36:39]
 buffer_load_dwordx4 v[148:151], v251, s[52:55], s85 offen offset:1024 sc1
 v_mfma_f32_16x16x32_bf16 v[36:39], v[168:171], a[100:103], v[36:39]
 buffer_load_dwordx4 v[152:155], v251, s[52:55], s85 offen offset:2048 sc1
 v_mfma_f32_16x16x32_bf16 v[36:39], v[172:175], a[116:119], v[36:39]
 v_mfma_f32_16x16x32_bf16 v[40:43], v[172:175], a[120:123], v[40:43]
 buffer_load_dwordx4 v[156:159], v251, s[52:55], s85 offen offset:3072 sc1
 v_mfma_f32_16x16x32_bf16 v[40:43], v[168:171], a[104:107], v[40:43]
 s_add_u32 s85, s85, 4096
 v_mfma_f32_16x16x32_bf16 v[40:43], v[164:167], a[88:91], v[40:43]
 buffer_load_dwordx2 v[204:205], v218, s[52:55], s78 offen offset:0 sc1
 v_mfma_f32_16x16x32_bf16 v[40:43], v[160:163], a[72:75], v[40:43]
 buffer_load_dwordx2 v[206:207], v218, s[52:55], s78 offen offset:512 sc1
 v_mfma_f32_16x16x32_bf16 v[44:47], v[160:163], a[76:79], v[44:47]
 buffer_load_dwordx2 v[208:209], v218, s[52:55], s78 offen offset:1024 sc1
 v_mfma_f32_16x16x32_bf16 v[44:47], v[164:167], a[92:95], v[44:47]
 ds_write_b128 v226, v[36:39] offset:2048
 v_mfma_f32_16x16x32_bf16 v[44:47], v[168:171], a[108:111], v[44:47]
 buffer_load_dwordx2 v[210:211], v218, s[52:55], s78 offen offset:1536 sc1
 v_mfma_f32_16x16x32_bf16 v[44:47], v[172:175], a[124:127], v[44:47]
 buffer_load_dwordx2 v[212:213], v218, s[52:55], s78 offen offset:2048 sc1
 v_mfma_f32_16x16x32_bf16 v[32:35], v[172:175], a[112:115], v[32:35]
 buffer_load_dwordx2 v[214:215], v218, s[52:55], s78 offen offset:2560 sc1
 v_mfma_f32_16x16x32_bf16 v[32:35], v[168:171], a[96:99], v[32:35]
 ds_write_b128 v227, v[40:43] offset:9216
 v_mfma_f32_16x16x32_bf16 v[32:35], v[164:167], a[80:83], v[32:35]
 buffer_load_dwordx2 v[216:217], v218, s[52:55], s78 offen offset:3072 sc1
 v_mfma_f32_16x16x32_bf16 v[32:35], v[160:163], a[64:67], v[32:35]
 s_waitcnt vmcnt(15)
 v_mfma_f32_16x16x32_bf16 v[52:55], v[112:115], a[132:135], 0
 buffer_load_dwordx4 v[160:163], v251, s[52:55], s85 offen offset:0 sc1
 v_mfma_f32_16x16x32_bf16 v[52:55], v[116:119], a[148:151], v[52:55]
 ds_write_b128 v228, v[44:47] offset:16384
 v_mfma_f32_16x16x32_bf16 v[52:55], v[120:123], a[164:167], v[52:55]
 v_mfma_f32_16x16x32_bf16 v[52:55], v[124:127], a[180:183], v[52:55]
 buffer_load_dwordx4 v[164:167], v251, s[52:55], s85 offen offset:1024 sc1
 v_mfma_f32_16x16x32_bf16 v[56:59], v[124:127], a[184:187], 0
 v_mfma_f32_16x16x32_bf16 v[56:59], v[120:123], a[168:171], v[56:59]
 v_mfma_f32_16x16x32_bf16 v[56:59], v[116:119], a[152:155], v[56:59]
 v_mfma_f32_16x16x32_bf16 v[56:59], v[112:115], a[136:139], v[56:59]
 buffer_load_dwordx4 v[168:171], v251, s[52:55], s85 offen offset:2048 sc1
 v_mfma_f32_16x16x32_bf16 v[60:63], v[112:115], a[140:143], 0
 v_mfma_f32_16x16x32_bf16 v[60:63], v[116:119], a[156:159], v[60:63]
 v_mfma_f32_16x16x32_bf16 v[60:63], v[120:123], a[172:175], v[60:63]
 v_mfma_f32_16x16x32_bf16 v[60:63], v[124:127], a[188:191], v[60:63]
 buffer_load_dwordx4 v[172:175], v251, s[52:55], s85 offen offset:3072 sc1
 v_mfma_f32_16x16x32_bf16 v[48:51], v[124:127], a[176:179], v[200:203]
 s_add_u32 s85, s85, 53248
 v_mfma_f32_16x16x32_bf16 v[48:51], v[120:123], a[160:163], v[48:51]
 v_mfma_f32_16x16x32_bf16 v[48:51], v[116:119], a[144:147], v[48:51]
 v_mfma_f32_16x16x32_bf16 v[48:51], v[112:115], a[128:131], v[48:51]
 s_waitcnt vmcnt(15)
 v_mfma_f32_16x16x32_bf16 v[52:55], v[128:131], a[196:199], v[52:55]
 buffer_load_dwordx4 v[112:115], v251, s[52:55], s85 offen offset:0 sc1
 v_mfma_f32_16x16x32_bf16 v[52:55], v[132:135], a[212:215], v[52:55]
 v_mfma_f32_16x16x32_bf16 v[52:55], v[136:139], a[228:231], v[52:55]
 v_mfma_f32_16x16x32_bf16 v[52:55], v[140:143], a[244:247], v[52:55]
 buffer_load_dwordx4 v[116:119], v251, s[52:55], s85 offen offset:1024 sc1
 v_mfma_f32_16x16x32_bf16 v[56:59], v[140:143], a[248:251], v[56:59]
 v_mfma_f32_16x16x32_bf16 v[56:59], v[136:139], a[232:235], v[56:59]
 v_mfma_f32_16x16x32_bf16 v[56:59], v[132:135], a[216:219], v[56:59]
 v_mfma_f32_16x16x32_bf16 v[56:59], v[128:131], a[200:203], v[56:59]
 buffer_load_dwordx4 v[120:123], v251, s[52:55], s85 offen offset:2048 sc1
 v_mfma_f32_16x16x32_bf16 v[60:63], v[128:131], a[204:207], v[60:63]
 s_waitcnt lgkmcnt(3) vmcnt(7)
 v_add_f32 v0, v0, v176
 v_add_f32 v1, v1, v177
 v_mfma_f32_16x16x32_bf16 v[60:63], v[132:135], a[220:223], v[60:63]
 v_add_f32 v2, v2, v178
 v_add_f32 v3, v3, v179
 v_mfma_f32_16x16x32_bf16 v[60:63], v[136:139], a[236:239], v[60:63]
 v_mfma_f32_16x16x32_bf16 v[60:63], v[140:143], a[252:255], v[60:63]
 v_add_f32 v0, v0, v180
 v_add_f32 v1, v1, v181
 v_mfma_f32_16x16x32_bf16 v[48:51], v[140:143], a[240:243], v[48:51]
 buffer_load_dwordx4 v[124:127], v251, s[52:55], s85 offen offset:3072 sc1
 v_mfma_f32_16x16x32_bf16 v[48:51], v[136:139], a[224:227], v[48:51]
 s_add_u32 s85, s85, 4096
 v_add_f32 v2, v2, v182
 v_add_f32 v3, v3, v183
 v_mfma_f32_16x16x32_bf16 v[48:51], v[132:135], a[208:211], v[48:51]
 v_add_f32 v0, v0, v184
 v_add_f32 v1, v1, v185
 v_mfma_f32_16x16x32_bf16 v[48:51], v[128:131], a[192:195], v[48:51]
 s_waitcnt vmcnt(15)
 v_add_f32 v2, v2, v186
 v_add_f32 v3, v3, v187
 v_mfma_f32_16x16x32_bf16 v[52:55], v[144:147], a[4:7], v[52:55]
 buffer_load_dwordx4 v[128:131], v251, s[52:55], s85 offen offset:0 sc1
 v_mfma_f32_16x16x32_bf16 v[52:55], v[148:151], a[20:23], v[52:55]
 v_lshlrev_b32 v222, 16, v204
 v_and_b32 v223, 0xffff0000, v204
 v_mfma_f32_16x16x32_bf16 v[52:55], v[152:155], a[36:39], v[52:55]
 v_lshlrev_b32 v224, 16, v205
 v_and_b32 v225, 0xffff0000, v205
 v_mfma_f32_16x16x32_bf16 v[52:55], v[156:159], a[52:55], v[52:55]
 buffer_load_dwordx4 v[132:135], v251, s[52:55], s85 offen offset:1024 sc1
 v_mfma_f32_16x16x32_bf16 v[56:59], v[156:159], a[56:59], v[56:59]
 v_mul_f32 v222, v222, v0
 v_mul_f32 v223, v223, v1
 v_mfma_f32_16x16x32_bf16 v[56:59], v[152:155], a[40:43], v[56:59]
 v_mfma_f32_16x16x32_bf16 v[56:59], v[148:151], a[24:27], v[56:59]
 v_mul_f32 v224, v224, v2
 v_mul_f32 v225, v225, v3
 v_mfma_f32_16x16x32_bf16 v[56:59], v[144:147], a[8:11], v[56:59]
 buffer_load_dwordx4 v[136:139], v251, s[52:55], s85 offen offset:2048 sc1
 v_mfma_f32_16x16x32_bf16 v[60:63], v[144:147], a[12:15], v[60:63]
 v_cvt_pk_bf16_f32 v204, v222, v223
 v_cvt_pk_bf16_f32 v205, v224, v225
 v_mfma_f32_16x16x32_bf16 v[60:63], v[148:151], a[28:31], v[60:63]
 v_add_f32 v16, v16, v188
 v_add_f32 v17, v17, v189
 v_mfma_f32_16x16x32_bf16 v[60:63], v[152:155], a[44:47], v[60:63]
 v_add_f32 v18, v18, v190
 v_add_f32 v19, v19, v191
 v_mfma_f32_16x16x32_bf16 v[60:63], v[156:159], a[60:63], v[60:63]
 buffer_load_dwordx4 v[140:143], v251, s[52:55], s85 offen offset:3072 sc1
 v_mfma_f32_16x16x32_bf16 v[48:51], v[156:159], a[48:51], v[48:51]
 s_add_u32 s85, s85, 4096
 v_add_f32 v16, v16, v192
 v_add_f32 v17, v17, v193
 v_mfma_f32_16x16x32_bf16 v[48:51], v[152:155], a[32:35], v[48:51]
 v_add_f32 v18, v18, v194
 v_add_f32 v19, v19, v195
 v_mfma_f32_16x16x32_bf16 v[48:51], v[148:151], a[16:19], v[48:51]
 v_mfma_f32_16x16x32_bf16 v[48:51], v[144:147], a[0:3], v[48:51]
 s_waitcnt vmcnt(8)
 v_add_f32 v16, v16, v196
 v_add_f32 v17, v17, v197
 v_mfma_f32_16x16x32_bf16 v[52:55], v[160:163], a[68:71], v[52:55]
 buffer_load_dwordx4 v[144:147], v251, s[52:55], s85 offen offset:0 sc1
 v_mfma_f32_16x16x32_bf16 v[52:55], v[164:167], a[84:87], v[52:55]
 v_add_f32 v18, v18, v198
 v_add_f32 v19, v19, v199
 v_mfma_f32_16x16x32_bf16 v[52:55], v[168:171], a[100:103], v[52:55]
 v_lshlrev_b32 v222, 16, v206
 v_and_b32 v223, 0xffff0000, v206
 v_mfma_f32_16x16x32_bf16 v[52:55], v[172:175], a[116:119], v[52:55]
 buffer_load_dwordx4 v[148:151], v251, s[52:55], s85 offen offset:1024 sc1
 v_mfma_f32_16x16x32_bf16 v[56:59], v[172:175], a[120:123], v[56:59]
 v_lshlrev_b32 v224, 16, v207
 v_and_b32 v225, 0xffff0000, v207
 v_mfma_f32_16x16x32_bf16 v[56:59], v[168:171], a[104:107], v[56:59]
 v_mul_f32 v222, v222, v16
 v_mul_f32 v223, v223, v17
 v_mfma_f32_16x16x32_bf16 v[56:59], v[164:167], a[88:91], v[56:59]
 v_mfma_f32_16x16x32_bf16 v[56:59], v[160:163], a[72:75], v[56:59]
 v_mul_f32 v224, v224, v18
 v_mul_f32 v225, v225, v19
 v_mfma_f32_16x16x32_bf16 v[60:63], v[160:163], a[76:79], v[60:63]
 buffer_load_dwordx4 v[152:155], v251, s[52:55], s85 offen offset:2048 sc1
 v_mfma_f32_16x16x32_bf16 v[60:63], v[164:167], a[92:95], v[60:63]
 ds_write_b128 v226, v[52:55] offset:3072
 v_cvt_pk_bf16_f32 v206, v222, v223
 v_mfma_f32_16x16x32_bf16 v[60:63], v[168:171], a[108:111], v[60:63]
 v_cvt_pk_bf16_f32 v207, v224, v225
 v_mfma_f32_16x16x32_bf16 v[60:63], v[172:175], a[124:127], v[60:63]
 buffer_store_dwordx4 v[204:207], v251, s[52:55], s90 offen offset:0 sc1
 v_mfma_f32_16x16x32_bf16 v[48:51], v[172:175], a[112:115], v[48:51]
 buffer_load_dwordx4 v[156:159], v251, s[52:55], s85 offen offset:3072 sc1
 v_mfma_f32_16x16x32_bf16 v[48:51], v[168:171], a[96:99], v[48:51]
 s_add_u32 s85, s85, 4096
 ds_write_b128 v227, v[56:59] offset:10240
 v_mfma_f32_16x16x32_bf16 v[48:51], v[164:167], a[80:83], v[48:51]
 v_mfma_f32_16x16x32_bf16 v[48:51], v[160:163], a[64:67], v[48:51]
 s_waitcnt vmcnt(9)
 v_mfma_f32_16x16x32_bf16 v[4:7], v[112:115], a[132:135], 0
 buffer_load_dwordx4 v[160:163], v251, s[52:55], s85 offen offset:0 sc1
 v_mfma_f32_16x16x32_bf16 v[4:7], v[116:119], a[148:151], v[4:7]
 ds_write_b128 v228, v[60:63] offset:17408
 v_mfma_f32_16x16x32_bf16 v[4:7], v[120:123], a[164:167], v[4:7]
 v_mfma_f32_16x16x32_bf16 v[4:7], v[124:127], a[180:183], v[4:7]
 buffer_load_dwordx4 v[164:167], v251, s[52:55], s85 offen offset:1024 sc1
 v_mfma_f32_16x16x32_bf16 v[8:11], v[124:127], a[184:187], 0
 v_mfma_f32_16x16x32_bf16 v[8:11], v[120:123], a[168:171], v[8:11]
 v_mfma_f32_16x16x32_bf16 v[8:11], v[116:119], a[152:155], v[8:11]
 s_waitcnt lgkmcnt(0)
 v_mfma_f32_16x16x32_bf16 v[8:11], v[112:115], a[136:139], v[8:11]
 s_barrier
 ds_read_b128 v[176:179], v230 offset:2048
 ds_read_b128 v[180:183], v230 offset:9216
 v_mfma_f32_16x16x32_bf16 v[12:15], v[112:115], a[140:143], 0
 ds_read_b128 v[184:187], v230 offset:16384
 ds_read_b128 v[188:191], v230 offset:3072
 v_mfma_f32_16x16x32_bf16 v[12:15], v[116:119], a[156:159], v[12:15]
 ds_read_b128 v[192:195], v230 offset:10240
 ds_read_b128 v[196:199], v230 offset:17408
 v_mfma_f32_16x16x32_bf16 v[12:15], v[120:123], a[172:175], v[12:15]
 buffer_load_dwordx4 v[168:171], v251, s[52:55], s85 offen offset:2048 sc1
 v_mfma_f32_16x16x32_bf16 v[12:15], v[124:127], a[188:191], v[12:15]
 buffer_load_dwordx4 v[172:175], v251, s[52:55], s85 offen offset:3072 sc1
 v_mfma_f32_16x16x32_bf16 v[0:3], v[124:127], a[176:179], v[200:203]
 s_add_u32 s85, s85, 53248
 v_mfma_f32_16x16x32_bf16 v[0:3], v[120:123], a[160:163], v[0:3]
 v_mfma_f32_16x16x32_bf16 v[0:3], v[116:119], a[144:147], v[0:3]
 v_mfma_f32_16x16x32_bf16 v[0:3], v[112:115], a[128:131], v[0:3]
 s_waitcnt vmcnt(9)
 v_mfma_f32_16x16x32_bf16 v[4:7], v[128:131], a[196:199], v[4:7]
 buffer_load_dwordx4 v[112:115], v251, s[52:55], s85 offen offset:0 sc1
 v_mfma_f32_16x16x32_bf16 v[4:7], v[132:135], a[212:215], v[4:7]
 s_waitcnt lgkmcnt(0) vmcnt(22)
 v_add_f32 v32, v32, v176
 v_add_f32 v33, v33, v177
 v_mfma_f32_16x16x32_bf16 v[4:7], v[136:139], a[228:231], v[4:7]
 v_add_f32 v34, v34, v178
 v_add_f32 v35, v35, v179
 v_mfma_f32_16x16x32_bf16 v[4:7], v[140:143], a[244:247], v[4:7]
 buffer_load_dwordx4 v[116:119], v251, s[52:55], s85 offen offset:1024 sc1
 v_mfma_f32_16x16x32_bf16 v[8:11], v[140:143], a[248:251], v[8:11]
 v_add_f32 v32, v32, v180
 v_add_f32 v33, v33, v181
 v_mfma_f32_16x16x32_bf16 v[8:11], v[136:139], a[232:235], v[8:11]
 v_add_f32 v34, v34, v182
 v_add_f32 v35, v35, v183
 v_mfma_f32_16x16x32_bf16 v[8:11], v[132:135], a[216:219], v[8:11]
 v_mfma_f32_16x16x32_bf16 v[8:11], v[128:131], a[200:203], v[8:11]
 v_add_f32 v32, v32, v184
 v_add_f32 v33, v33, v185
 v_mfma_f32_16x16x32_bf16 v[12:15], v[128:131], a[204:207], v[12:15]
 buffer_load_dwordx4 v[120:123], v251, s[52:55], s85 offen offset:2048 sc1
 v_mfma_f32_16x16x32_bf16 v[12:15], v[132:135], a[220:223], v[12:15]
 v_add_f32 v34, v34, v186
 v_add_f32 v35, v35, v187
 v_mfma_f32_16x16x32_bf16 v[12:15], v[136:139], a[236:239], v[12:15]
 v_lshlrev_b32 v222, 16, v208
 v_and_b32 v223, 0xffff0000, v208
 v_mfma_f32_16x16x32_bf16 v[12:15], v[140:143], a[252:255], v[12:15]
 buffer_load_dwordx4 v[124:127], v251, s[52:55], s85 offen offset:3072 sc1
 v_mfma_f32_16x16x32_bf16 v[0:3], v[140:143], a[240:243], v[0:3]
 s_add_u32 s85, s85, 4096
 v_lshlrev_b32 v224, 16, v209
 v_and_b32 v225, 0xffff0000, v209
 v_mfma_f32_16x16x32_bf16 v[0:3], v[136:139], a[224:227], v[0:3]
 v_mul_f32 v222, v222, v32
 v_mul_f32 v223, v223, v33
 v_mfma_f32_16x16x32_bf16 v[0:3], v[132:135], a[208:211], v[0:3]
 v_mfma_f32_16x16x32_bf16 v[0:3], v[128:131], a[192:195], v[0:3]
 s_waitcnt vmcnt(8)
 v_mul_f32 v224, v224, v34
 v_mul_f32 v225, v225, v35
 v_mfma_f32_16x16x32_bf16 v[4:7], v[144:147], a[4:7], v[4:7]
 buffer_load_dwordx4 v[128:131], v251, s[52:55], s85 offen offset:0 sc1
 v_mfma_f32_16x16x32_bf16 v[4:7], v[148:151], a[20:23], v[4:7]
 v_cvt_pk_bf16_f32 v208, v222, v223
 v_cvt_pk_bf16_f32 v209, v224, v225
 v_mfma_f32_16x16x32_bf16 v[4:7], v[152:155], a[36:39], v[4:7]
 v_add_f32 v48, v48, v188
 v_add_f32 v49, v49, v189
 v_mfma_f32_16x16x32_bf16 v[4:7], v[156:159], a[52:55], v[4:7]
 buffer_load_dwordx4 v[132:135], v251, s[52:55], s85 offen offset:1024 sc1
 v_mfma_f32_16x16x32_bf16 v[8:11], v[156:159], a[56:59], v[8:11]
 v_add_f32 v50, v50, v190
 v_add_f32 v51, v51, v191
 v_mfma_f32_16x16x32_bf16 v[8:11], v[152:155], a[40:43], v[8:11]
 v_add_f32 v48, v48, v192
 v_add_f32 v49, v49, v193
 v_mfma_f32_16x16x32_bf16 v[8:11], v[148:151], a[24:27], v[8:11]
 v_add_f32 v50, v50, v194
 v_add_f32 v51, v51, v195
 v_mfma_f32_16x16x32_bf16 v[8:11], v[144:147], a[8:11], v[8:11]
 buffer_load_dwordx4 v[136:139], v251, s[52:55], s85 offen offset:2048 sc1
 v_mfma_f32_16x16x32_bf16 v[12:15], v[144:147], a[12:15], v[12:15]
 v_add_f32 v48, v48, v196
 v_add_f32 v49, v49, v197
 v_mfma_f32_16x16x32_bf16 v[12:15], v[148:151], a[28:31], v[12:15]
 v_mfma_f32_16x16x32_bf16 v[12:15], v[152:155], a[44:47], v[12:15]
 v_add_f32 v50, v50, v198
 v_add_f32 v51, v51, v199
 v_mfma_f32_16x16x32_bf16 v[12:15], v[156:159], a[60:63], v[12:15]
 buffer_load_dwordx4 v[140:143], v251, s[52:55], s85 offen offset:3072 sc1
 v_mfma_f32_16x16x32_bf16 v[0:3], v[156:159], a[48:51], v[0:3]
 s_add_u32 s85, s85, 4096
 v_lshlrev_b32 v222, 16, v210
 v_and_b32 v223, 0xffff0000, v210
 v_mfma_f32_16x16x32_bf16 v[0:3], v[152:155], a[32:35], v[0:3]
 v_lshlrev_b32 v224, 16, v211
 v_and_b32 v225, 0xffff0000, v211
 v_mfma_f32_16x16x32_bf16 v[0:3], v[148:151], a[16:19], v[0:3]
 v_mul_f32 v222, v222, v48
 v_mul_f32 v223, v223, v49
 v_mfma_f32_16x16x32_bf16 v[0:3], v[144:147], a[0:3], v[0:3]
 s_waitcnt vmcnt(8)
 v_mfma_f32_16x16x32_bf16 v[4:7], v[160:163], a[68:71], v[4:7]
 buffer_load_dwordx4 v[144:147], v251, s[52:55], s85 offen offset:0 sc1
 v_mfma_f32_16x16x32_bf16 v[4:7], v[164:167], a[84:87], v[4:7]
 v_mul_f32 v224, v224, v50
 v_mul_f32 v225, v225, v51
 v_mfma_f32_16x16x32_bf16 v[4:7], v[168:171], a[100:103], v[4:7]
 v_cvt_pk_bf16_f32 v210, v222, v223
 v_cvt_pk_bf16_f32 v211, v224, v225
 v_mfma_f32_16x16x32_bf16 v[4:7], v[172:175], a[116:119], v[4:7]
 buffer_store_dwordx4 v[208:211], v251, s[52:55], s90 offen offset:1024 sc1
 v_mfma_f32_16x16x32_bf16 v[8:11], v[172:175], a[120:123], v[8:11]
 buffer_load_dwordx4 v[148:151], v251, s[52:55], s85 offen offset:1024 sc1
 v_mfma_f32_16x16x32_bf16 v[8:11], v[168:171], a[104:107], v[8:11]
 v_mfma_f32_16x16x32_bf16 v[8:11], v[164:167], a[88:91], v[8:11]
 v_mfma_f32_16x16x32_bf16 v[8:11], v[160:163], a[72:75], v[8:11]
 buffer_load_dwordx4 v[152:155], v251, s[52:55], s85 offen offset:2048 sc1
 v_mfma_f32_16x16x32_bf16 v[12:15], v[160:163], a[76:79], v[12:15]
 v_mfma_f32_16x16x32_bf16 v[12:15], v[164:167], a[92:95], v[12:15]
 ds_write_b128 v226, v[4:7] offset:4096
 v_mfma_f32_16x16x32_bf16 v[12:15], v[168:171], a[108:111], v[12:15]
 v_mfma_f32_16x16x32_bf16 v[12:15], v[172:175], a[124:127], v[12:15]
 buffer_load_dwordx4 v[156:159], v251, s[52:55], s85 offen offset:3072 sc1
 v_mfma_f32_16x16x32_bf16 v[0:3], v[172:175], a[112:115], v[0:3]
 s_add_u32 s85, s85, 4096
 v_mfma_f32_16x16x32_bf16 v[0:3], v[168:171], a[96:99], v[0:3]
 ds_write_b128 v227, v[8:11] offset:11264
 v_mfma_f32_16x16x32_bf16 v[0:3], v[164:167], a[80:83], v[0:3]
 v_mfma_f32_16x16x32_bf16 v[0:3], v[160:163], a[64:67], v[0:3]
 s_waitcnt vmcnt(9)
 v_mfma_f32_16x16x32_bf16 v[20:23], v[112:115], a[132:135], 0
 buffer_load_dwordx4 v[160:163], v251, s[52:55], s85 offen offset:0 sc1
 v_mfma_f32_16x16x32_bf16 v[20:23], v[116:119], a[148:151], v[20:23]
 ds_write_b128 v228, v[12:15] offset:18432
 v_mfma_f32_16x16x32_bf16 v[20:23], v[120:123], a[164:167], v[20:23]
 v_mfma_f32_16x16x32_bf16 v[20:23], v[124:127], a[180:183], v[20:23]
 buffer_load_dwordx4 v[164:167], v251, s[52:55], s85 offen offset:1024 sc1
 v_mfma_f32_16x16x32_bf16 v[24:27], v[124:127], a[184:187], 0
 v_mfma_f32_16x16x32_bf16 v[24:27], v[120:123], a[168:171], v[24:27]
 v_mfma_f32_16x16x32_bf16 v[24:27], v[116:119], a[152:155], v[24:27]
 v_mfma_f32_16x16x32_bf16 v[24:27], v[112:115], a[136:139], v[24:27]
 buffer_load_dwordx4 v[168:171], v251, s[52:55], s85 offen offset:2048 sc1
 v_mfma_f32_16x16x32_bf16 v[28:31], v[112:115], a[140:143], 0
 v_mfma_f32_16x16x32_bf16 v[28:31], v[116:119], a[156:159], v[28:31]
 v_mfma_f32_16x16x32_bf16 v[28:31], v[120:123], a[172:175], v[28:31]
 v_mfma_f32_16x16x32_bf16 v[28:31], v[124:127], a[188:191], v[28:31]
 buffer_load_dwordx4 v[172:175], v251, s[52:55], s85 offen offset:3072 sc1
 v_mfma_f32_16x16x32_bf16 v[16:19], v[124:127], a[176:179], v[200:203]
 s_add_u32 s85, s85, 53248
 v_mfma_f32_16x16x32_bf16 v[16:19], v[120:123], a[160:163], v[16:19]
 v_mfma_f32_16x16x32_bf16 v[16:19], v[116:119], a[144:147], v[16:19]
 v_mfma_f32_16x16x32_bf16 v[16:19], v[112:115], a[128:131], v[16:19]
 s_waitcnt vmcnt(9)
 v_mfma_f32_16x16x32_bf16 v[20:23], v[128:131], a[196:199], v[20:23]
 buffer_load_dwordx4 v[112:115], v251, s[52:55], s85 offen offset:0 sc1
 v_mfma_f32_16x16x32_bf16 v[20:23], v[132:135], a[212:215], v[20:23]
 v_mfma_f32_16x16x32_bf16 v[20:23], v[136:139], a[228:231], v[20:23]
 v_mfma_f32_16x16x32_bf16 v[20:23], v[140:143], a[244:247], v[20:23]
 buffer_load_dwordx4 v[116:119], v251, s[52:55], s85 offen offset:1024 sc1
 v_mfma_f32_16x16x32_bf16 v[24:27], v[140:143], a[248:251], v[24:27]
 v_mfma_f32_16x16x32_bf16 v[24:27], v[136:139], a[232:235], v[24:27]
 v_mfma_f32_16x16x32_bf16 v[24:27], v[132:135], a[216:219], v[24:27]
 v_mfma_f32_16x16x32_bf16 v[24:27], v[128:131], a[200:203], v[24:27]
 buffer_load_dwordx4 v[120:123], v251, s[52:55], s85 offen offset:2048 sc1
 v_mfma_f32_16x16x32_bf16 v[28:31], v[128:131], a[204:207], v[28:31]
 v_mfma_f32_16x16x32_bf16 v[28:31], v[132:135], a[220:223], v[28:31]
 v_mfma_f32_16x16x32_bf16 v[28:31], v[136:139], a[236:239], v[28:31]
 v_mfma_f32_16x16x32_bf16 v[28:31], v[140:143], a[252:255], v[28:31]
 buffer_load_dwordx4 v[124:127], v251, s[52:55], s85 offen offset:3072 sc1
 v_mfma_f32_16x16x32_bf16 v[16:19], v[140:143], a[240:243], v[16:19]
 s_add_u32 s85, s85, 4096
 v_mfma_f32_16x16x32_bf16 v[16:19], v[136:139], a[224:227], v[16:19]
 v_mfma_f32_16x16x32_bf16 v[16:19], v[132:135], a[208:211], v[16:19]
 v_mfma_f32_16x16x32_bf16 v[16:19], v[128:131], a[192:195], v[16:19]
 s_waitcnt vmcnt(8)
 v_mfma_f32_16x16x32_bf16 v[20:23], v[144:147], a[4:7], v[20:23]
 buffer_load_dwordx4 v[128:131], v251, s[52:55], s85 offen offset:0 sc1
 v_mfma_f32_16x16x32_bf16 v[20:23], v[148:151], a[20:23], v[20:23]
 v_mfma_f32_16x16x32_bf16 v[20:23], v[152:155], a[36:39], v[20:23]
 v_mfma_f32_16x16x32_bf16 v[20:23], v[156:159], a[52:55], v[20:23]
 buffer_load_dwordx4 v[132:135], v251, s[52:55], s85 offen offset:1024 sc1
 v_mfma_f32_16x16x32_bf16 v[24:27], v[156:159], a[56:59], v[24:27]
 v_mfma_f32_16x16x32_bf16 v[24:27], v[152:155], a[40:43], v[24:27]
 v_mfma_f32_16x16x32_bf16 v[24:27], v[148:151], a[24:27], v[24:27]
 v_mfma_f32_16x16x32_bf16 v[24:27], v[144:147], a[8:11], v[24:27]
 buffer_load_dwordx4 v[136:139], v251, s[52:55], s85 offen offset:2048 sc1
 v_mfma_f32_16x16x32_bf16 v[28:31], v[144:147], a[12:15], v[28:31]
 v_mfma_f32_16x16x32_bf16 v[28:31], v[148:151], a[28:31], v[28:31]
 v_mfma_f32_16x16x32_bf16 v[28:31], v[152:155], a[44:47], v[28:31]
 v_mfma_f32_16x16x32_bf16 v[28:31], v[156:159], a[60:63], v[28:31]
 buffer_load_dwordx4 v[140:143], v251, s[52:55], s85 offen offset:3072 sc1
 v_mfma_f32_16x16x32_bf16 v[16:19], v[156:159], a[48:51], v[16:19]
 s_add_u32 s85, s85, 4096
 v_mfma_f32_16x16x32_bf16 v[16:19], v[152:155], a[32:35], v[16:19]
 v_mfma_f32_16x16x32_bf16 v[16:19], v[148:151], a[16:19], v[16:19]
 v_mfma_f32_16x16x32_bf16 v[16:19], v[144:147], a[0:3], v[16:19]
 s_waitcnt vmcnt(8)
 v_mfma_f32_16x16x32_bf16 v[20:23], v[160:163], a[68:71], v[20:23]
 buffer_load_dwordx4 v[144:147], v251, s[52:55], s85 offen offset:0 sc1
 v_mfma_f32_16x16x32_bf16 v[20:23], v[164:167], a[84:87], v[20:23]
 v_mfma_f32_16x16x32_bf16 v[20:23], v[168:171], a[100:103], v[20:23]
 v_mfma_f32_16x16x32_bf16 v[20:23], v[172:175], a[116:119], v[20:23]
 buffer_load_dwordx4 v[148:151], v251, s[52:55], s85 offen offset:1024 sc1
 v_mfma_f32_16x16x32_bf16 v[24:27], v[172:175], a[120:123], v[24:27]
 v_mfma_f32_16x16x32_bf16 v[24:27], v[168:171], a[104:107], v[24:27]
 v_mfma_f32_16x16x32_bf16 v[24:27], v[164:167], a[88:91], v[24:27]
 v_mfma_f32_16x16x32_bf16 v[24:27], v[160:163], a[72:75], v[24:27]
 buffer_load_dwordx4 v[152:155], v251, s[52:55], s85 offen offset:2048 sc1
 v_mfma_f32_16x16x32_bf16 v[28:31], v[160:163], a[76:79], v[28:31]
 v_mfma_f32_16x16x32_bf16 v[28:31], v[164:167], a[92:95], v[28:31]
 ds_write_b128 v226, v[20:23] offset:5120
 v_mfma_f32_16x16x32_bf16 v[28:31], v[168:171], a[108:111], v[28:31]
 v_mfma_f32_16x16x32_bf16 v[28:31], v[172:175], a[124:127], v[28:31]
 buffer_load_dwordx4 v[156:159], v251, s[52:55], s85 offen offset:3072 sc1
 v_mfma_f32_16x16x32_bf16 v[16:19], v[172:175], a[112:115], v[16:19]
 s_add_u32 s85, s85, 4096
 v_mfma_f32_16x16x32_bf16 v[16:19], v[168:171], a[96:99], v[16:19]
 ds_write_b128 v227, v[24:27] offset:12288
 v_mfma_f32_16x16x32_bf16 v[16:19], v[164:167], a[80:83], v[16:19]
 v_mfma_f32_16x16x32_bf16 v[16:19], v[160:163], a[64:67], v[16:19]
 s_waitcnt vmcnt(8)
 v_mfma_f32_16x16x32_bf16 v[36:39], v[112:115], a[132:135], 0
 buffer_load_dwordx4 v[160:163], v251, s[52:55], s85 offen offset:0 sc1
 v_mfma_f32_16x16x32_bf16 v[36:39], v[116:119], a[148:151], v[36:39]
 ds_write_b128 v228, v[28:31] offset:19456
 v_mfma_f32_16x16x32_bf16 v[36:39], v[120:123], a[164:167], v[36:39]
 v_mfma_f32_16x16x32_bf16 v[36:39], v[124:127], a[180:183], v[36:39]
 buffer_load_dwordx4 v[164:167], v251, s[52:55], s85 offen offset:1024 sc1
 v_mfma_f32_16x16x32_bf16 v[40:43], v[124:127], a[184:187], 0
 v_mfma_f32_16x16x32_bf16 v[40:43], v[120:123], a[168:171], v[40:43]
 v_mfma_f32_16x16x32_bf16 v[40:43], v[116:119], a[152:155], v[40:43]
 s_waitcnt lgkmcnt(0)
 v_mfma_f32_16x16x32_bf16 v[40:43], v[112:115], a[136:139], v[40:43]
 s_barrier
 ds_read_b128 v[176:179], v230 offset:4096
 ds_read_b128 v[180:183], v230 offset:11264
 v_mfma_f32_16x16x32_bf16 v[44:47], v[112:115], a[140:143], 0
 ds_read_b128 v[184:187], v230 offset:18432
 ds_read_b128 v[188:191], v230 offset:5120
 v_mfma_f32_16x16x32_bf16 v[44:47], v[116:119], a[156:159], v[44:47]
 ds_read_b128 v[192:195], v230 offset:12288
 ds_read_b128 v[196:199], v230 offset:19456
 v_mfma_f32_16x16x32_bf16 v[44:47], v[120:123], a[172:175], v[44:47]
 buffer_load_dwordx4 v[168:171], v251, s[52:55], s85 offen offset:2048 sc1
 v_mfma_f32_16x16x32_bf16 v[44:47], v[124:127], a[188:191], v[44:47]
 buffer_load_dwordx4 v[172:175], v251, s[52:55], s85 offen offset:3072 sc1
 v_mfma_f32_16x16x32_bf16 v[32:35], v[124:127], a[176:179], v[200:203]
 s_add_u32 s85, s85, 53248
 v_mfma_f32_16x16x32_bf16 v[32:35], v[120:123], a[160:163], v[32:35]
 v_mfma_f32_16x16x32_bf16 v[32:35], v[116:119], a[144:147], v[32:35]
 v_mfma_f32_16x16x32_bf16 v[32:35], v[112:115], a[128:131], v[32:35]
 s_waitcnt vmcnt(8)
 v_mfma_f32_16x16x32_bf16 v[36:39], v[128:131], a[196:199], v[36:39]
 buffer_load_dwordx4 v[64:67], v251, s[52:55], s87 offen offset:0 sc1
 v_mfma_f32_16x16x32_bf16 v[36:39], v[132:135], a[212:215], v[36:39]
 s_waitcnt lgkmcnt(0) vmcnt(55)
 v_add_f32 v0, v0, v176
 v_add_f32 v1, v1, v177
 v_mfma_f32_16x16x32_bf16 v[36:39], v[136:139], a[228:231], v[36:39]
 v_add_f32 v2, v2, v178
 v_add_f32 v3, v3, v179
 v_mfma_f32_16x16x32_bf16 v[36:39], v[140:143], a[244:247], v[36:39]
 buffer_load_dwordx4 v[68:71], v251, s[52:55], s87 offen offset:1024 sc1
 v_mfma_f32_16x16x32_bf16 v[40:43], v[140:143], a[248:251], v[40:43]
 v_add_f32 v0, v0, v180
 v_add_f32 v1, v1, v181
 v_mfma_f32_16x16x32_bf16 v[40:43], v[136:139], a[232:235], v[40:43]
 v_add_f32 v2, v2, v182
 v_add_f32 v3, v3, v183
 v_mfma_f32_16x16x32_bf16 v[40:43], v[132:135], a[216:219], v[40:43]
 v_mfma_f32_16x16x32_bf16 v[40:43], v[128:131], a[200:203], v[40:43]
 v_add_f32 v0, v0, v184
 v_add_f32 v1, v1, v185
 v_mfma_f32_16x16x32_bf16 v[44:47], v[128:131], a[204:207], v[44:47]
 buffer_load_dwordx4 v[72:75], v251, s[52:55], s87 offen offset:2048 sc1
 v_mfma_f32_16x16x32_bf16 v[44:47], v[132:135], a[220:223], v[44:47]
 v_add_f32 v2, v2, v186
 v_add_f32 v3, v3, v187
 v_mfma_f32_16x16x32_bf16 v[44:47], v[136:139], a[236:239], v[44:47]
 v_lshlrev_b32 v222, 16, v212
 v_and_b32 v223, 0xffff0000, v212
 v_mfma_f32_16x16x32_bf16 v[44:47], v[140:143], a[252:255], v[44:47]
 buffer_load_dwordx4 v[76:79], v251, s[52:55], s87 offen offset:3072 sc1
 v_mfma_f32_16x16x32_bf16 v[32:35], v[140:143], a[240:243], v[32:35]
 s_add_u32 s87, s87, 4096
 v_lshlrev_b32 v224, 16, v213
 v_and_b32 v225, 0xffff0000, v213
 v_mfma_f32_16x16x32_bf16 v[32:35], v[136:139], a[224:227], v[32:35]
 v_mul_f32 v222, v222, v0
 v_mul_f32 v223, v223, v1
 v_mfma_f32_16x16x32_bf16 v[32:35], v[132:135], a[208:211], v[32:35]
 v_mfma_f32_16x16x32_bf16 v[32:35], v[128:131], a[192:195], v[32:35]
 s_waitcnt vmcnt(8)
 v_mul_f32 v224, v224, v2
 v_mul_f32 v225, v225, v3
 v_mfma_f32_16x16x32_bf16 v[36:39], v[144:147], a[4:7], v[36:39]
 buffer_load_dwordx4 v[80:83], v251, s[52:55], s87 offen offset:0 sc1
 v_mfma_f32_16x16x32_bf16 v[36:39], v[148:151], a[20:23], v[36:39]
 v_cvt_pk_bf16_f32 v212, v222, v223
 v_cvt_pk_bf16_f32 v213, v224, v225
 v_mfma_f32_16x16x32_bf16 v[36:39], v[152:155], a[36:39], v[36:39]
 v_add_f32 v16, v16, v188
 v_add_f32 v17, v17, v189
 v_mfma_f32_16x16x32_bf16 v[36:39], v[156:159], a[52:55], v[36:39]
 buffer_load_dwordx4 v[84:87], v251, s[52:55], s87 offen offset:1024 sc1
 v_mfma_f32_16x16x32_bf16 v[40:43], v[156:159], a[56:59], v[40:43]
 v_add_f32 v18, v18, v190
 v_add_f32 v19, v19, v191
 v_mfma_f32_16x16x32_bf16 v[40:43], v[152:155], a[40:43], v[40:43]
 v_add_f32 v16, v16, v192
 v_add_f32 v17, v17, v193
 v_mfma_f32_16x16x32_bf16 v[40:43], v[148:151], a[24:27], v[40:43]
 v_add_f32 v18, v18, v194
 v_add_f32 v19, v19, v195
 v_mfma_f32_16x16x32_bf16 v[40:43], v[144:147], a[8:11], v[40:43]
 buffer_load_dwordx4 v[88:91], v251, s[52:55], s87 offen offset:2048 sc1
 v_mfma_f32_16x16x32_bf16 v[44:47], v[144:147], a[12:15], v[44:47]
 v_add_f32 v16, v16, v196
 v_add_f32 v17, v17, v197
 v_mfma_f32_16x16x32_bf16 v[44:47], v[148:151], a[28:31], v[44:47]
 v_mfma_f32_16x16x32_bf16 v[44:47], v[152:155], a[44:47], v[44:47]
 v_add_f32 v18, v18, v198
 v_add_f32 v19, v19, v199
 v_mfma_f32_16x16x32_bf16 v[44:47], v[156:159], a[60:63], v[44:47]
 buffer_load_dwordx4 v[92:95], v251, s[52:55], s87 offen offset:3072 sc1
 v_mfma_f32_16x16x32_bf16 v[32:35], v[156:159], a[48:51], v[32:35]
 s_add_u32 s87, s87, 4096
 v_lshlrev_b32 v222, 16, v214
 v_and_b32 v223, 0xffff0000, v214
 v_mfma_f32_16x16x32_bf16 v[32:35], v[152:155], a[32:35], v[32:35]
 v_lshlrev_b32 v224, 16, v215
 v_and_b32 v225, 0xffff0000, v215
 v_mfma_f32_16x16x32_bf16 v[32:35], v[148:151], a[16:19], v[32:35]
 v_mul_f32 v222, v222, v16
 v_mul_f32 v223, v223, v17
 v_mfma_f32_16x16x32_bf16 v[32:35], v[144:147], a[0:3], v[32:35]
 s_waitcnt vmcnt(8)
 v_mfma_f32_16x16x32_bf16 v[36:39], v[160:163], a[68:71], v[36:39]
 buffer_load_dwordx4 v[96:99], v251, s[52:55], s87 offen offset:0 sc1
 v_mfma_f32_16x16x32_bf16 v[36:39], v[164:167], a[84:87], v[36:39]
 v_mul_f32 v224, v224, v18
 v_mul_f32 v225, v225, v19
 v_mfma_f32_16x16x32_bf16 v[36:39], v[168:171], a[100:103], v[36:39]
 v_cvt_pk_bf16_f32 v214, v222, v223
 v_cvt_pk_bf16_f32 v215, v224, v225
 v_mfma_f32_16x16x32_bf16 v[36:39], v[172:175], a[116:119], v[36:39]
 buffer_store_dwordx4 v[212:215], v251, s[52:55], s90 offen offset:2048 sc1
 v_mfma_f32_16x16x32_bf16 v[40:43], v[172:175], a[120:123], v[40:43]
 buffer_load_dwordx4 v[100:103], v251, s[52:55], s87 offen offset:1024 sc1
 v_mfma_f32_16x16x32_bf16 v[40:43], v[168:171], a[104:107], v[40:43]
 v_mfma_f32_16x16x32_bf16 v[40:43], v[164:167], a[88:91], v[40:43]
 v_mfma_f32_16x16x32_bf16 v[40:43], v[160:163], a[72:75], v[40:43]
 buffer_load_dwordx4 v[104:107], v251, s[52:55], s87 offen offset:2048 sc1
 v_mfma_f32_16x16x32_bf16 v[44:47], v[160:163], a[76:79], v[44:47]
 v_mfma_f32_16x16x32_bf16 v[44:47], v[164:167], a[92:95], v[44:47]
 ds_write_b128 v226, v[36:39] offset:6144
 v_mfma_f32_16x16x32_bf16 v[44:47], v[168:171], a[108:111], v[44:47]
 v_mfma_f32_16x16x32_bf16 v[44:47], v[172:175], a[124:127], v[44:47]
 buffer_load_dwordx4 v[108:111], v251, s[52:55], s87 offen offset:3072 sc1
 v_mfma_f32_16x16x32_bf16 v[32:35], v[172:175], a[112:115], v[32:35]
 s_add_u32 s87, s87, 4096
 v_mfma_f32_16x16x32_bf16 v[32:35], v[168:171], a[96:99], v[32:35]
 ds_write_b128 v227, v[40:43] offset:13312
 v_mfma_f32_16x16x32_bf16 v[32:35], v[164:167], a[80:83], v[32:35]
 v_mfma_f32_16x16x32_bf16 v[32:35], v[160:163], a[64:67], v[32:35]
 v_lshlrev_b32 v222, 16, v216
 v_and_b32 v223, 0xffff0000, v216
 v_lshlrev_b32 v224, 16, v217
 v_and_b32 v225, 0xffff0000, v217
 ds_write_b128 v228, v[44:47] offset:20480
 s_waitcnt lgkmcnt(0)
 s_barrier
 ds_read_b128 v[176:179], v230 offset:6144
 ds_read_b128 v[180:183], v230 offset:13312
 ds_read_b128 v[184:187], v230 offset:20480
 s_waitcnt lgkmcnt(0)
 v_pk_add_f32 v[32:33], v[32:33], v[176:177]
 v_pk_add_f32 v[34:35], v[34:35], v[178:179]
 v_pk_add_f32 v[32:33], v[32:33], v[180:181]
 v_pk_add_f32 v[34:35], v[34:35], v[182:183]
 v_pk_add_f32 v[32:33], v[32:33], v[184:185]
 v_pk_add_f32 v[34:35], v[34:35], v[186:187]
 v_mul_f32 v222, v222, v32
 v_mul_f32 v223, v223, v33
 v_mul_f32 v224, v224, v34
 v_mul_f32 v225, v225, v35
 v_cvt_pk_bf16_f32 v216, v222, v223
 v_cvt_pk_bf16_f32 v217, v224, v225
 buffer_store_dwordx2 v[216:217], v218, s[52:55], s90 offen offset:3072 sc1
 s_lshl_b32 s77, s83, 7
 s_add_u32 s77, s77, 71312128
 v_add_u32 v250, 0, v252
 v_and_b32 v250, 3, v250
 v_mul_u32_u24 v250, 28672, v250
 v_add_u32 v172, v250, v251
 v_lshl_add_u32 v178, v253, 3, v250
 v_add_u32 v250, 1, v252
 v_and_b32 v250, 3, v250
 v_mul_u32_u24 v250, 28672, v250
 v_add_u32 v173, v250, v251
 v_lshl_add_u32 v179, v253, 3, v250
 v_add_u32 v250, 2, v252
 v_and_b32 v250, 3, v250
 v_mul_u32_u24 v250, 28672, v250
 v_add_u32 v174, v250, v251
 v_lshl_add_u32 v180, v253, 3, v250
 v_add_u32 v250, 3, v252
 v_and_b32 v250, 3, v250
 v_mul_u32_u24 v250, 28672, v250
 v_add_u32 v175, v250, v251
 v_lshl_add_u32 v181, v253, 3, v250
 v_add_u32 v250, 1, v252
 v_and_b32 v250, 3, v250
 v_lshl_add_u32 v187, v250, 13, v251
 v_add_u32 v187, 131072, v187
 v_add_u32 v250, 2, v252
 v_and_b32 v250, 3, v250
 v_lshl_add_u32 v188, v250, 13, v251
 v_add_u32 v188, 131072, v188
 v_add_u32 v250, 3, v252
 v_and_b32 v250, 3, v250
 v_lshl_add_u32 v189, v250, 15, v251
 v_lshl_add_u32 v190, v252, 13, v251
 v_add_u32 v190, 131072, v190
 v_lshl_add_u32 v191, v252, 15, v251
 v_mov_b32 v239, 0
 s_mul_i32 s92, s74, 114688
 s_mul_i32 s78, s60, 7168
 s_add_u32 s92, s92, s78
 s_add_u32 s92, s92, 67108864
 s_add_u32 s90, s92, 3584
 s_waitcnt vmcnt(0)
 s_barrier
 s_cmp_lg_u32 s60, 0
 s_cbranch_scc1 Lna87
 v_mov_b32 v250, 1
 v_mov_b32 v249, 0
 s_mov_b64 exec, 1
 buffer_atomic_add v250, v249, s[52:55], s77 offen sc1
 s_mov_b64 exec, -1
Lna87:
 buffer_load_dwordx4 a[128:131], v251, s[52:55], s87 offen offset:0 sc1
 buffer_load_dwordx4 a[132:135], v251, s[52:55], s87 offen offset:1024 sc1
 buffer_load_dwordx4 a[136:139], v251, s[52:55], s87 offen offset:2048 sc1
 buffer_load_dwordx4 a[140:143], v251, s[52:55], s87 offen offset:3072 sc1
 s_add_u32 s87, s87, 4096
 buffer_load_dwordx4 a[144:147], v251, s[52:55], s87 offen offset:0 sc1
 buffer_load_dwordx4 a[148:151], v251, s[52:55], s87 offen offset:1024 sc1
 buffer_load_dwordx4 a[152:155], v251, s[52:55], s87 offen offset:2048 sc1
 buffer_load_dwordx4 a[156:159], v251, s[52:55], s87 offen offset:3072 sc1
 s_add_u32 s87, s87, 4096
 buffer_load_dwordx4 a[160:163], v251, s[52:55], s87 offen offset:0 sc1
 buffer_load_dwordx4 a[164:167], v251, s[52:55], s87 offen offset:1024 sc1
 buffer_load_dwordx4 a[168:171], v251, s[52:55], s87 offen offset:2048 sc1
 buffer_load_dwordx4 a[172:175], v251, s[52:55], s87 offen offset:3072 sc1
 s_add_u32 s87, s87, 4096
 buffer_load_dwordx4 a[176:179], v251, s[52:55], s87 offen offset:0 sc1
 buffer_load_dwordx4 a[180:183], v251, s[52:55], s87 offen offset:1024 sc1
 buffer_load_dwordx4 a[184:187], v251, s[52:55], s87 offen offset:2048 sc1
 buffer_load_dwordx4 a[188:191], v251, s[52:55], s87 offen offset:3072 sc1
 s_add_u32 s87, s87, 4096
 s_lshl_b32 s77, s74, 7
 s_add_u32 s77, s77, 71312128
 s_cmp_lg_u32 s60, 0
 s_cbranch_scc1 Lpi88
 buffer_load_dword v238, v239, s[52:55], s77 offen sc1
Lpi88:
 s_cmp_lg_u32 s60, 0
 s_cbranch_scc1 Lpw89
 s_waitcnt vmcnt(0)
 s_mov_b32 s63, 131072
Lsp90:
 v_cmp_gt_u32 vcc, 8, v238
 s_cbranch_vccz Lgo91
 s_sub_u32 s63, s63, 1
 s_cbranch_scc1 Lgo91
 s_sleep 1
 buffer_load_dword v238, v239, s[52:55], s77 offen sc1
 s_waitcnt vmcnt(0)
 s_branch Lsp90
Lgo91:
Lpw89:
 s_barrier
 buffer_load_dwordx4 a[28:31], v173, s[52:55], s92 offen offset:0 sc1
 buffer_load_dwordx4 a[32:35], v173, s[52:55], s92 offen offset:1024 sc1
 buffer_load_dwordx4 a[36:39], v173, s[52:55], s92 offen offset:2048 sc1
 buffer_load_dwordx4 a[40:43], v173, s[52:55], s90 offen offset:0 sc1
 buffer_load_dwordx4 a[44:47], v173, s[52:55], s90 offen offset:1024 sc1
 buffer_load_dwordx4 a[48:51], v173, s[52:55], s90 offen offset:2048 sc1
 buffer_load_dwordx2 a[52:53], v179, s[52:55], s92 offen offset:3072 sc1
 buffer_load_dwordx2 a[54:55], v179, s[52:55], s90 offen offset:3072 sc1
 buffer_load_dwordx4 a[56:59], v174, s[52:55], s92 offen offset:0 sc1
 buffer_load_dwordx4 a[60:63], v174, s[52:55], s92 offen offset:1024 sc1
 buffer_load_dwordx4 a[64:67], v174, s[52:55], s92 offen offset:2048 sc1
 buffer_load_dwordx4 a[68:71], v174, s[52:55], s90 offen offset:0 sc1
 v_lshlrev_b32 v112, 16, v240
 v_and_b32 v113, 0xffff0000, v240
 v_lshlrev_b32 v114, 16, v241
 v_and_b32 v115, 0xffff0000, v241
 v_lshlrev_b32 v116, 16, v242
 v_and_b32 v117, 0xffff0000, v242
 v_lshlrev_b32 v118, 16, v243
 v_and_b32 v119, 0xffff0000, v243
 v_lshlrev_b32 v120, 16, v244
 v_and_b32 v121, 0xffff0000, v244
 v_lshlrev_b32 v122, 16, v245
 v_and_b32 v123, 0xffff0000, v245
 v_lshlrev_b32 v124, 16, v246
 v_and_b32 v125, 0xffff0000, v246
 v_lshlrev_b32 v126, 16, v247
 v_and_b32 v127, 0xffff0000, v247
 s_waitcnt vmcnt(8)
 v_mfma_f32_16x16x32_bf16 v[16:19], v[64:67], a[28:31], 0
 buffer_load_dwordx4 a[72:75], v174, s[52:55], s90 offen offset:1024 sc1
 v_mfma_f32_16x16x32_bf16 v[16:19], v[80:83], a[32:35], v[16:19]
 buffer_load_dwordx4 a[76:79], v174, s[52:55], s90 offen offset:2048 sc1
 v_mfma_f32_16x16x32_bf16 v[16:19], v[96:99], a[36:39], v[16:19]
 v_mfma_f32_16x16x32_bf16 v[16:19], a[128:131], a[40:43], v[16:19]
 buffer_load_dwordx2 a[80:81], v180, s[52:55], s92 offen offset:3072 sc1
 v_mfma_f32_16x16x32_bf16 v[20:23], a[132:135], a[40:43], 0
 v_mfma_f32_16x16x32_bf16 v[20:23], v[100:103], a[36:39], v[20:23]
 buffer_load_dwordx2 a[82:83], v180, s[52:55], s90 offen offset:3072 sc1
 v_mfma_f32_16x16x32_bf16 v[20:23], v[84:87], a[32:35], v[20:23]
 v_mfma_f32_16x16x32_bf16 v[20:23], v[68:71], a[28:31], v[20:23]
 v_mfma_f32_16x16x32_bf16 v[24:27], v[72:75], a[28:31], 0
 v_mfma_f32_16x16x32_bf16 v[24:27], v[88:91], a[32:35], v[24:27]
 v_mfma_f32_16x16x32_bf16 v[24:27], v[104:107], a[36:39], v[24:27]
 v_mfma_f32_16x16x32_bf16 v[24:27], a[136:139], a[40:43], v[24:27]
 v_mfma_f32_16x16x32_bf16 v[28:31], a[140:143], a[40:43], 0
 v_mfma_f32_16x16x32_bf16 v[28:31], v[108:111], a[36:39], v[28:31]
 v_mfma_f32_16x16x32_bf16 v[28:31], v[92:95], a[32:35], v[28:31]
 v_mfma_f32_16x16x32_bf16 v[28:31], v[76:79], a[28:31], v[28:31]
 s_waitcnt vmcnt(8)
 v_mfma_f32_16x16x32_bf16 v[16:19], a[144:147], a[44:47], v[16:19]
 buffer_load_dwordx4 a[84:87], v175, s[52:55], s92 offen offset:0 sc1
 v_mfma_f32_16x16x32_bf16 v[16:19], a[160:163], a[48:51], v[16:19]
 buffer_load_dwordx4 a[88:91], v175, s[52:55], s92 offen offset:1024 sc1
 v_mfma_f32_16x16x32_bf16 v[16:19], a[176:179], a[52:55], v[16:19]
 v_mfma_f32_16x16x32_bf16 v[20:23], a[180:183], a[52:55], v[20:23]
 buffer_load_dwordx4 a[92:95], v175, s[52:55], s92 offen offset:2048 sc1
 v_mfma_f32_16x16x32_bf16 v[20:23], a[164:167], a[48:51], v[20:23]
 v_mfma_f32_16x16x32_bf16 v[20:23], a[148:151], a[44:47], v[20:23]
 buffer_load_dwordx4 a[96:99], v175, s[52:55], s90 offen offset:0 sc1
 v_mfma_f32_16x16x32_bf16 v[24:27], a[152:155], a[44:47], v[24:27]
 v_mfma_f32_16x16x32_bf16 v[24:27], a[168:171], a[48:51], v[24:27]
 v_mfma_f32_16x16x32_bf16 v[24:27], a[184:187], a[52:55], v[24:27]
 v_mfma_f32_16x16x32_bf16 v[28:31], a[188:191], a[52:55], v[28:31]
 v_mfma_f32_16x16x32_bf16 v[28:31], a[172:175], a[48:51], v[28:31]
 v_mfma_f32_16x16x32_bf16 v[28:31], a[156:159], a[44:47], v[28:31]
 s_waitcnt vmcnt(8)
 v_mfma_f32_16x16x32_bf16 v[32:35], v[64:67], a[56:59], 0
 buffer_load_dwordx4 a[100:103], v175, s[52:55], s90 offen offset:1024 sc1
 v_mfma_f32_16x16x32_bf16 v[32:35], v[80:83], a[60:63], v[32:35]
 buffer_load_dwordx4 a[104:107], v175, s[52:55], s90 offen offset:2048 sc1
 v_mfma_f32_16x16x32_bf16 v[32:35], v[96:99], a[64:67], v[32:35]
 v_mfma_f32_16x16x32_bf16 v[32:35], a[128:131], a[68:71], v[32:35]
 buffer_load_dwordx2 a[108:109], v181, s[52:55], s92 offen offset:3072 sc1
 v_mfma_f32_16x16x32_bf16 v[36:39], a[132:135], a[68:71], 0
 v_mfma_f32_16x16x32_bf16 v[36:39], v[100:103], a[64:67], v[36:39]
 ds_write_b128 v187, v[16:19] offset:0
 ds_write_b128 v187, v[20:23] offset:1024
 v_mfma_f32_16x16x32_bf16 v[36:39], v[84:87], a[60:63], v[36:39]
 buffer_load_dwordx2 a[110:111], v181, s[52:55], s90 offen offset:3072 sc1
 v_mfma_f32_16x16x32_bf16 v[36:39], v[68:71], a[56:59], v[36:39]
 ds_write_b128 v187, v[24:27] offset:2048
 ds_write_b128 v187, v[28:31] offset:3072
 v_mfma_f32_16x16x32_bf16 v[40:43], v[72:75], a[56:59], 0
 v_mfma_f32_16x16x32_bf16 v[40:43], v[88:91], a[60:63], v[40:43]
 v_mfma_f32_16x16x32_bf16 v[40:43], v[104:107], a[64:67], v[40:43]
 v_mfma_f32_16x16x32_bf16 v[40:43], a[136:139], a[68:71], v[40:43]
 v_mfma_f32_16x16x32_bf16 v[44:47], a[140:143], a[68:71], 0
 v_mfma_f32_16x16x32_bf16 v[44:47], v[108:111], a[64:67], v[44:47]
 v_mfma_f32_16x16x32_bf16 v[44:47], v[92:95], a[60:63], v[44:47]
 v_mfma_f32_16x16x32_bf16 v[44:47], v[76:79], a[56:59], v[44:47]
 s_waitcnt vmcnt(8)
 v_mfma_f32_16x16x32_bf16 v[32:35], a[144:147], a[72:75], v[32:35]
 buffer_load_dwordx4 a[0:3], v172, s[52:55], s92 offen offset:0 sc1
 v_mfma_f32_16x16x32_bf16 v[32:35], a[160:163], a[76:79], v[32:35]
 buffer_load_dwordx4 a[4:7], v172, s[52:55], s92 offen offset:1024 sc1
 v_mfma_f32_16x16x32_bf16 v[32:35], a[176:179], a[80:83], v[32:35]
 v_mfma_f32_16x16x32_bf16 v[36:39], a[180:183], a[80:83], v[36:39]
 buffer_load_dwordx4 a[8:11], v172, s[52:55], s92 offen offset:2048 sc1
 v_mfma_f32_16x16x32_bf16 v[36:39], a[164:167], a[76:79], v[36:39]
 v_mfma_f32_16x16x32_bf16 v[36:39], a[148:151], a[72:75], v[36:39]
 buffer_load_dwordx4 a[12:15], v172, s[52:55], s90 offen offset:0 sc1
 v_mfma_f32_16x16x32_bf16 v[40:43], a[152:155], a[72:75], v[40:43]
 v_mfma_f32_16x16x32_bf16 v[40:43], a[168:171], a[76:79], v[40:43]
 v_mfma_f32_16x16x32_bf16 v[40:43], a[184:187], a[80:83], v[40:43]
 v_mfma_f32_16x16x32_bf16 v[44:47], a[188:191], a[80:83], v[44:47]
 v_mfma_f32_16x16x32_bf16 v[44:47], a[172:175], a[76:79], v[44:47]
 v_mfma_f32_16x16x32_bf16 v[44:47], a[156:159], a[72:75], v[44:47]
 s_waitcnt vmcnt(8)
 v_mfma_f32_16x16x32_bf16 v[48:51], v[64:67], a[84:87], 0
 buffer_load_dwordx4 a[16:19], v172, s[52:55], s90 offen offset:1024 sc1
 v_mfma_f32_16x16x32_bf16 v[48:51], v[80:83], a[88:91], v[48:51]
 buffer_load_dwordx4 a[20:23], v172, s[52:55], s90 offen offset:2048 sc1
 v_mfma_f32_16x16x32_bf16 v[48:51], v[96:99], a[92:95], v[48:51]
 v_mfma_f32_16x16x32_bf16 v[48:51], a[128:131], a[96:99], v[48:51]
 buffer_load_dwordx2 a[24:25], v178, s[52:55], s92 offen offset:3072 sc1
 v_mfma_f32_16x16x32_bf16 v[52:55], a[132:135], a[96:99], 0
 v_mfma_f32_16x16x32_bf16 v[52:55], v[100:103], a[92:95], v[52:55]
 ds_write_b128 v188, v[32:35] offset:4096
 ds_write_b128 v188, v[36:39] offset:5120
 v_mfma_f32_16x16x32_bf16 v[52:55], v[84:87], a[88:91], v[52:55]
 buffer_load_dwordx2 a[26:27], v178, s[52:55], s90 offen offset:3072 sc1
 v_mfma_f32_16x16x32_bf16 v[52:55], v[68:71], a[84:87], v[52:55]
 ds_write_b128 v188, v[40:43] offset:6144
 ds_write_b128 v188, v[44:47] offset:7168
 v_mfma_f32_16x16x32_bf16 v[56:59], v[72:75], a[84:87], 0
 v_mfma_f32_16x16x32_bf16 v[56:59], v[88:91], a[88:91], v[56:59]
 v_mfma_f32_16x16x32_bf16 v[56:59], v[104:107], a[92:95], v[56:59]
 v_mfma_f32_16x16x32_bf16 v[56:59], a[136:139], a[96:99], v[56:59]
 v_mfma_f32_16x16x32_bf16 v[60:63], a[140:143], a[96:99], 0
 v_mfma_f32_16x16x32_bf16 v[60:63], v[108:111], a[92:95], v[60:63]
 v_mfma_f32_16x16x32_bf16 v[60:63], v[92:95], a[88:91], v[60:63]
 v_mfma_f32_16x16x32_bf16 v[60:63], v[76:79], a[84:87], v[60:63]
 s_waitcnt vmcnt(8)
 v_mfma_f32_16x16x32_bf16 v[48:51], a[144:147], a[100:103], v[48:51]
 v_mfma_f32_16x16x32_bf16 v[48:51], a[160:163], a[104:107], v[48:51]
 v_mfma_f32_16x16x32_bf16 v[48:51], a[176:179], a[108:111], v[48:51]
 v_mfma_f32_16x16x32_bf16 v[52:55], a[180:183], a[108:111], v[52:55]
 v_mfma_f32_16x16x32_bf16 v[52:55], a[164:167], a[104:107], v[52:55]
 v_mfma_f32_16x16x32_bf16 v[52:55], a[148:151], a[100:103], v[52:55]
 v_mfma_f32_16x16x32_bf16 v[56:59], a[152:155], a[100:103], v[56:59]
 v_mfma_f32_16x16x32_bf16 v[56:59], a[168:171], a[104:107], v[56:59]
 v_mfma_f32_16x16x32_bf16 v[56:59], a[184:187], a[108:111], v[56:59]
 v_mfma_f32_16x16x32_bf16 v[60:63], a[188:191], a[108:111], v[60:63]
 v_mfma_f32_16x16x32_bf16 v[60:63], a[172:175], a[104:107], v[60:63]
 v_mfma_f32_16x16x32_bf16 v[60:63], a[156:159], a[100:103], v[60:63]
 s_waitcnt vmcnt(4)
 v_mfma_f32_16x16x32_bf16 v[0:3], v[64:67], a[0:3], 0
 v_mfma_f32_16x16x32_bf16 v[0:3], v[80:83], a[4:7], v[0:3]
 v_mfma_f32_16x16x32_bf16 v[0:3], v[96:99], a[8:11], v[0:3]
 v_mfma_f32_16x16x32_bf16 v[0:3], a[128:131], a[12:15], v[0:3]
 v_mfma_f32_16x16x32_bf16 v[4:7], a[132:135], a[12:15], 0
 v_mfma_f32_16x16x32_bf16 v[4:7], v[100:103], a[8:11], v[4:7]
 ds_write_b128 v189, v[48:51] offset:28672
 ds_write_b128 v189, v[52:55] offset:29696
 v_mfma_f32_16x16x32_bf16 v[4:7], v[84:87], a[4:7], v[4:7]
 ds_write_b128 v189, v[56:59] offset:30720
 ds_write_b128 v189, v[60:63] offset:31744
 v_mfma_f32_16x16x32_bf16 v[4:7], v[68:71], a[0:3], v[4:7]
 v_mfma_f32_16x16x32_bf16 v[8:11], v[72:75], a[0:3], 0
 v_mfma_f32_16x16x32_bf16 v[8:11], v[88:91], a[4:7], v[8:11]
 v_mfma_f32_16x16x32_bf16 v[8:11], v[104:107], a[8:11], v[8:11]
 v_mfma_f32_16x16x32_bf16 v[8:11], a[136:139], a[12:15], v[8:11]
 v_mfma_f32_16x16x32_bf16 v[12:15], a[140:143], a[12:15], 0
 s_waitcnt lgkmcnt(0)
 v_mfma_f32_16x16x32_bf16 v[12:15], v[108:111], a[8:11], v[12:15]
 s_barrier
 ds_read_b128 v[128:131], v190 offset:0
 ds_read_b128 v[132:135], v190 offset:1024
 v_mfma_f32_16x16x32_bf16 v[12:15], v[92:95], a[4:7], v[12:15]
 ds_read_b128 v[136:139], v190 offset:2048
 ds_read_b128 v[140:143], v190 offset:3072
 v_mfma_f32_16x16x32_bf16 v[12:15], v[76:79], a[0:3], v[12:15]
 s_waitcnt vmcnt(0)
 ds_read_b128 v[204:207], v190 offset:4096
 ds_read_b128 v[208:211], v190 offset:5120
 v_mfma_f32_16x16x32_bf16 v[0:3], a[144:147], a[16:19], v[0:3]
 ds_read_b128 v[212:215], v190 offset:6144
 ds_read_b128 v[216:219], v190 offset:7168
 ds_read_b128 v[220:223], v191 offset:28672
 ds_read_b128 v[224:227], v191 offset:29696
 ds_read_b128 v[228:231], v191 offset:30720
 ds_read_b128 v[232:235], v191 offset:31744
 v_mfma_f32_16x16x32_bf16 v[0:3], a[160:163], a[20:23], v[0:3]
 v_mfma_f32_16x16x32_bf16 v[0:3], a[176:179], a[24:27], v[0:3]
 v_mfma_f32_16x16x32_bf16 v[4:7], a[180:183], a[24:27], v[4:7]
 v_mfma_f32_16x16x32_bf16 v[4:7], a[164:167], a[20:23], v[4:7]
 v_mfma_f32_16x16x32_bf16 v[4:7], a[148:151], a[16:19], v[4:7]
 v_mfma_f32_16x16x32_bf16 v[8:11], a[152:155], a[16:19], v[8:11]
 v_mfma_f32_16x16x32_bf16 v[8:11], a[168:171], a[20:23], v[8:11]
 v_mfma_f32_16x16x32_bf16 v[8:11], a[184:187], a[24:27], v[8:11]
 v_mfma_f32_16x16x32_bf16 v[12:15], a[188:191], a[24:27], v[12:15]
 v_mfma_f32_16x16x32_bf16 v[12:15], a[172:175], a[20:23], v[12:15]
 v_mfma_f32_16x16x32_bf16 v[12:15], a[156:159], a[16:19], v[12:15]
 v_pk_add_f32 v[0:1], v[0:1], v[112:113]
 v_pk_add_f32 v[2:3], v[2:3], v[114:115]
 v_pk_add_f32 v[4:5], v[4:5], v[116:117]
 v_pk_add_f32 v[6:7], v[6:7], v[118:119]
 s_nop 0
 v_pk_add_f32 v[8:9], v[8:9], v[120:121]
 v_pk_add_f32 v[10:11], v[10:11], v[122:123]
 s_nop 0
 v_pk_add_f32 v[12:13], v[12:13], v[124:125]
 v_pk_add_f32 v[14:15], v[14:15], v[126:127]
 s_waitcnt lgkmcnt(0)
 v_pk_add_f32 v[0:1], v[0:1], v[128:129]
 v_pk_add_f32 v[2:3], v[2:3], v[130:131]
 v_pk_add_f32 v[4:5], v[4:5], v[132:133]
 v_pk_add_f32 v[6:7], v[6:7], v[134:135]
 v_pk_add_f32 v[8:9], v[8:9], v[136:137]
 v_pk_add_f32 v[10:11], v[10:11], v[138:139]
 v_pk_add_f32 v[12:13], v[12:13], v[140:141]
 v_pk_add_f32 v[14:15], v[14:15], v[142:143]
 v_pk_add_f32 v[0:1], v[0:1], v[204:205]
 v_pk_add_f32 v[2:3], v[2:3], v[206:207]
 v_pk_add_f32 v[4:5], v[4:5], v[208:209]
 v_pk_add_f32 v[6:7], v[6:7], v[210:211]
 v_pk_add_f32 v[8:9], v[8:9], v[212:213]
 v_pk_add_f32 v[10:11], v[10:11], v[214:215]
 v_pk_add_f32 v[12:13], v[12:13], v[216:217]
 v_pk_add_f32 v[14:15], v[14:15], v[218:219]
 v_pk_add_f32 v[0:1], v[0:1], v[220:221]
 v_pk_add_f32 v[2:3], v[2:3], v[222:223]
 v_pk_add_f32 v[4:5], v[4:5], v[224:225]
 v_pk_add_f32 v[6:7], v[6:7], v[226:227]
 v_pk_add_f32 v[8:9], v[8:9], v[228:229]
 v_pk_add_f32 v[10:11], v[10:11], v[230:231]
 v_pk_add_f32 v[12:13], v[12:13], v[232:233]
 v_pk_add_f32 v[14:15], v[14:15], v[234:235]
 v_cvt_pk_bf16_f32 v178, v0, v1
 v_cvt_pk_bf16_f32 v179, v2, v3
 v_cvt_pk_bf16_f32 v180, v4, v5
 v_cvt_pk_bf16_f32 v181, v6, v7
 v_cvt_pk_bf16_f32 v182, v8, v9
 v_cvt_pk_bf16_f32 v183, v10, v11
 v_cvt_pk_bf16_f32 v184, v12, v13
 v_cvt_pk_bf16_f32 v185, v14, v15
 v_bfe_u32 v250, v253, 4, 1
 v_mul_u32_u24 v250, 24, v250
 v_add_u32 v237, v237, v250
 v_permlane16_swap_b32 v178, v180
 v_permlane16_swap_b32 v179, v181
 buffer_store_dwordx4 v[178:181], v237, s[44:47], s89 offen offset:0
 v_permlane16_swap_b32 v182, v184
 v_permlane16_swap_b32 v183, v185
 buffer_store_dwordx4 v[182:185], v237, s[44:47], s89 offen offset:64
sequential_preLN__compressed_kv_cla__mixer_gmlp__prompt_kernel_end:
 s_endpgm
.p2align 12
Li0m9:
 s_waitcnt lgkmcnt(4)
 v_mfma_f32_16x16x32_bf16 v[8:11], a[192:195], a[164:167], 0
 ds_read_b128 a[224:227], v217 offset:57344
 v_cndmask_b32 v64, v220, 0, s[8:9]
 v_mfma_f32_16x16x32_bf16 v[8:11], a[196:199], a[172:175], v[8:11]
 v_cndmask_b32 v65, v220, 0, s[10:11]
 v_cndmask_b32 v66, v220, 0, s[12:13]
 v_mfma_f32_16x16x32_bf16 v[8:11], a[200:203], a[180:183], v[8:11]
 ds_read_b128 a[228:231], v217 offset:58368
 v_cndmask_b32 v67, v220, 0, s[14:15]
 v_mfma_f32_16x16x32_bf16 v[8:11], a[204:207], a[188:191], v[8:11]
 v_cndmask_b32 v68, v220, 0, s[16:17]
 v_cndmask_b32 v69, v220, 0, s[18:19]
 v_mfma_f32_16x16x32_bf16 v[0:3], a[204:207], a[184:187], 0
 ds_read_b128 a[232:235], v217 offset:59392
 v_cndmask_b32 v70, v220, 0, s[20:21]
 v_mfma_f32_16x16x32_bf16 v[0:3], a[200:203], a[176:179], v[0:3]
 v_cndmask_b32 v71, v220, 0, s[22:23]
 v_cndmask_b32 v80, v220, 0, s[48:49]
 v_mfma_f32_16x16x32_bf16 v[0:3], a[196:199], a[168:171], v[0:3]
 s_waitcnt lgkmcnt(3)
 ds_read_b128 a[236:239], v217 offset:60416
 v_cndmask_b32 v81, v220, 0, s[50:51]
 v_mfma_f32_16x16x32_bf16 v[0:3], a[192:195], a[160:163], v[0:3]
 v_cndmask_b32 v82, v220, 0, s[82:83]
 v_cndmask_b32 v83, v220, 0, s[84:85]
 v_mfma_f32_16x16x32_bf16 v[12:15], a[208:211], a[164:167], 0
 ds_read_b128 a[240:243], v217 offset:61440
 v_cndmask_b32 v84, v220, 0, s[86:87]
 v_mfma_f32_16x16x32_bf16 v[12:15], a[212:215], a[172:175], v[12:15]
 v_cndmask_b32 v85, v220, 0, s[88:89]
 v_cndmask_b32 v86, v220, 0, s[90:91]
 v_mfma_f32_16x16x32_bf16 v[12:15], a[216:219], a[180:183], v[12:15]
 v_cndmask_b32 v87, v220, 0, s[92:93]
 v_mov_b32 v208, 0x3f803f80
 v_mfma_f32_16x16x32_bf16 v[12:15], a[220:223], a[188:191], v[12:15]
 ds_read_b128 a[244:247], v217 offset:62464
 v_mov_b32 v209, 0x3f803f80
 v_mfma_f32_16x16x32_bf16 v[4:7], a[220:223], a[184:187], 0
 v_mov_b32 v210, 0x3f803f80
 v_mov_b32 v211, 0x3f803f80
 v_mfma_f32_16x16x32_bf16 v[4:7], a[216:219], a[176:179], v[4:7]
 v_mov_b32 v214, 0
 v_mov_b32 v215, 0
 v_mfma_f32_16x16x32_bf16 v[4:7], a[212:215], a[168:171], v[4:7]
 v_mfma_f32_16x16x32_bf16 v[4:7], a[208:211], a[160:163], v[4:7]
 v_mov_b32 v212, 0
 v_mov_b32 v213, 0
 v_mfma_f32_16x16x32_bf16 v[72:75], a[192:195], a[132:135], 0
 ds_read_b128 a[248:251], v217 offset:63488
 v_lshl_add_u32 v218, v252, 13, v251
 v_mfma_f32_16x16x32_bf16 v[72:75], a[196:199], a[140:143], v[72:75]
 ds_read_b128 a[252:255], v217 offset:64512
 v_add_u32 v219, 4096, v218
 v_mfma_f32_16x16x32_bf16 v[72:75], a[200:203], a[148:151], v[72:75]
 v_mfma_f32_16x16x32_bf16 v[72:75], a[204:207], a[156:159], v[72:75]
 v_max3_f32 v250, v0, v1, v2
 v_max3_f32 v249, v8, v9, v10
 v_mfma_f32_16x16x32_bf16 v[64:67], a[204:207], a[152:155], v[64:67]
 v_max3_f32 v250, v250, v3, v4
 v_max3_f32 v249, v249, v11, v12
 v_mfma_f32_16x16x32_bf16 v[64:67], a[200:203], a[144:147], v[64:67]
 v_max3_f32 v250, v250, v5, v6
 v_max3_f32 v249, v249, v13, v14
 v_mfma_f32_16x16x32_bf16 v[64:67], a[196:199], a[136:139], v[64:67]
 v_max_f32 v250, v250, v7
 v_max_f32 v249, v249, v15
 v_mfma_f32_16x16x32_bf16 v[64:67], a[192:195], a[128:131], v[64:67]
 v_mov_b32 v188, v250
 v_mov_b32 v189, v249
 v_mfma_f32_16x16x32_bf16 v[76:79], a[208:211], a[132:135], 0
 v_permlane16_swap_b32 v188, v250
 v_permlane16_swap_b32 v189, v249
 v_mfma_f32_16x16x32_bf16 v[76:79], a[212:215], a[140:143], v[76:79]
 v_max_f32 v250, v250, v188
 v_max_f32 v249, v249, v189
 v_mfma_f32_16x16x32_bf16 v[76:79], a[216:219], a[148:151], v[76:79]
 v_mov_b32 v188, v250
 v_mov_b32 v189, v249
 v_mfma_f32_16x16x32_bf16 v[76:79], a[220:223], a[156:159], v[76:79]
 v_permlane32_swap_b32 v188, v250
 v_permlane32_swap_b32 v189, v249
 v_mfma_f32_16x16x32_bf16 v[68:71], a[220:223], a[152:155], v[68:71]
 v_max_f32 v250, v250, v188
 v_max_f32 v249, v249, v189
 v_mfma_f32_16x16x32_bf16 v[68:71], a[216:219], a[144:147], v[68:71]
 v_sub_f32 v168, 0, v250
 v_sub_f32 v169, 0, v250
 v_mfma_f32_16x16x32_bf16 v[68:71], a[212:215], a[136:139], v[68:71]
 s_waitcnt lgkmcnt(4)
 v_xor_b32 v217, 0x10000, v217
 v_sub_f32 v170, 0, v250
 v_mfma_f32_16x16x32_bf16 v[68:71], a[208:211], a[128:131], v[68:71]
 s_waitcnt vmcnt(5)
 v_sub_f32 v171, 0, v250
 v_sub_f32 v172, 0, v249
 v_sub_f32 v173, 0, v249
 v_sub_f32 v174, 0, v249
 v_sub_f32 v175, 0, v249
 s_nop 1
 v_mfma_f32_16x16x32_bf16 v[24:27], a[224:227], a[164:167], v[172:175]
 s_barrier
 ds_read_b128 a[192:195], v217 offset:16384
 v_add_f32 v8, v8, v172
 v_mfma_f32_16x16x32_bf16 v[24:27], a[228:231], a[172:175], v[24:27]
 v_add_f32 v9, v9, v172
 v_add_f32 v10, v10, v172
 v_mfma_f32_16x16x32_bf16 v[24:27], a[232:235], a[180:183], v[24:27]
 v_add_f32 v11, v11, v172
 v_add_f32 v12, v12, v172
 v_add_f32 v13, v13, v172
 v_mfma_f32_16x16x32_bf16 v[24:27], a[236:239], a[188:191], v[24:27]
 ds_read_b128 a[196:199], v217 offset:17408
 v_max3_f32 v250, v64, v65, v66
 v_mfma_f32_16x16x32_bf16 v[16:19], a[236:239], a[184:187], v[168:171]
 v_max3_f32 v249, v72, v73, v74
 v_max3_f32 v250, v250, v67, v68
 v_mfma_f32_16x16x32_bf16 v[16:19], a[232:235], a[176:179], v[16:19]
 ds_read_b128 a[200:203], v217 offset:18432
 v_max3_f32 v249, v249, v75, v76
 v_mfma_f32_16x16x32_bf16 v[16:19], a[228:231], a[168:171], v[16:19]
 s_waitcnt lgkmcnt(3)
 v_max3_f32 v250, v250, v69, v70
 v_max3_f32 v249, v249, v77, v78
 v_mfma_f32_16x16x32_bf16 v[16:19], a[224:227], a[160:163], v[16:19]
 ds_read_b128 a[204:207], v217 offset:19456
 v_max_f32 v250, v250, v71
 v_mfma_f32_16x16x32_bf16 v[28:31], a[240:243], a[164:167], v[172:175]
 v_max_f32 v249, v249, v79
 v_mov_b32 v188, v250
 v_mfma_f32_16x16x32_bf16 v[28:31], a[244:247], a[172:175], v[28:31]
 v_mov_b32 v189, v249
 v_permlane16_swap_b32 v188, v250
 v_mfma_f32_16x16x32_bf16 v[28:31], a[248:251], a[180:183], v[28:31]
 ds_read_b128 a[208:211], v217 offset:20480
 v_permlane16_swap_b32 v189, v249
 v_mfma_f32_16x16x32_bf16 v[28:31], a[252:255], a[188:191], v[28:31]
 v_max_f32 v250, v250, v188
 v_max_f32 v249, v249, v189
 v_mfma_f32_16x16x32_bf16 v[20:23], a[252:255], a[184:187], v[168:171]
 v_mov_b32 v188, v250
 v_mov_b32 v189, v249
 v_mfma_f32_16x16x32_bf16 v[20:23], a[248:251], a[176:179], v[20:23]
 v_permlane32_swap_b32 v188, v250
 v_permlane32_swap_b32 v189, v249
 v_mfma_f32_16x16x32_bf16 v[20:23], a[244:247], a[168:171], v[20:23]
 v_max_f32 v250, v250, v188
 v_max_f32 v249, v249, v189
 v_mfma_f32_16x16x32_bf16 v[20:23], a[240:243], a[160:163], v[20:23]
 ds_read_b128 a[212:215], v217 offset:21504
 v_sub_f32 v176, 0, v250
 v_sub_f32 v177, 0, v250
 v_sub_f32 v178, 0, v250
 v_sub_f32 v179, 0, v250
 v_sub_f32 v180, 0, v249
 v_sub_f32 v181, 0, v249
 v_sub_f32 v182, 0, v249
 v_sub_f32 v183, 0, v249
 s_nop 1
 v_mfma_f32_16x16x32_bf16 v[88:91], a[224:227], a[132:135], v[180:183]
 ds_read_b128 a[216:219], v217 offset:22528
 v_add_f32 v14, v14, v172
 v_mfma_f32_16x16x32_bf16 v[88:91], a[228:231], a[140:143], v[88:91]
 buffer_load_dword v239, v238, s[52:55], s72 offen sc1
 v_mfma_f32_16x16x32_bf16 v[88:91], a[232:235], a[148:151], v[88:91]
 v_add_f32 v15, v15, v172
 v_add_f32 v0, v0, v168
 v_mfma_f32_16x16x32_bf16 v[88:91], a[236:239], a[156:159], v[88:91]
 v_add_f32 v1, v1, v168
 v_add_f32 v2, v2, v168
 v_mfma_f32_16x16x32_bf16 v[80:83], a[236:239], a[152:155], v[80:83]
 v_add_f32 v3, v3, v168
 v_add_f32 v4, v4, v168
 v_mfma_f32_16x16x32_bf16 v[80:83], a[232:235], a[144:147], v[80:83]
 v_add_f32 v5, v5, v168
 v_add_f32 v6, v6, v168
 v_mfma_f32_16x16x32_bf16 v[80:83], a[228:231], a[136:139], v[80:83]
 ds_read_b128 a[220:223], v217 offset:23552
 v_add_f32 v7, v7, v168
 v_mfma_f32_16x16x32_bf16 v[80:83], a[224:227], a[128:131], v[80:83]
 v_exp_f32 v184, v8
 v_mfma_f32_16x16x32_bf16 v[92:95], a[240:243], a[132:135], v[180:183]
 v_exp_f32 v185, v9
 v_mfma_f32_16x16x32_bf16 v[92:95], a[244:247], a[140:143], v[92:95]
 v_exp_f32 v186, v10
 v_mfma_f32_16x16x32_bf16 v[92:95], a[248:251], a[148:151], v[92:95]
 v_exp_f32 v187, v11
 v_mfma_f32_16x16x32_bf16 v[92:95], a[252:255], a[156:159], v[92:95]
 v_add_f32 v72, v72, v180
 v_add_f32 v73, v73, v180
 v_mfma_f32_16x16x32_bf16 v[84:87], a[252:255], a[152:155], v[84:87]
 v_add_f32 v74, v74, v180
 v_add_f32 v75, v75, v180
 v_mfma_f32_16x16x32_bf16 v[84:87], a[248:251], a[144:147], v[84:87]
 s_waitcnt lgkmcnt(4)
 v_add_f32 v76, v76, v180
 v_add_f32 v77, v77, v180
 v_mfma_f32_16x16x32_bf16 v[84:87], a[244:247], a[136:139], v[84:87]
 v_add_f32 v78, v78, v180
 v_add_f32 v79, v79, v180
 v_mfma_f32_16x16x32_bf16 v[84:87], a[240:243], a[128:131], v[84:87]
 v_add_f32 v64, v64, v176
 v_add_f32 v65, v65, v176
 v_add_f32 v66, v66, v176
 v_add_f32 v67, v67, v176
 v_add_f32 v68, v68, v176
 v_add_f32 v69, v69, v176
 v_add_f32 v70, v70, v176
 v_add_f32 v71, v71, v176
 s_nop 4
 v_add_f32 v80, v80, v176
 v_add_f32 v81, v81, v176
 v_add_f32 v82, v82, v176
 v_add_f32 v83, v83, v176
 v_add_f32 v84, v84, v176
 v_add_f32 v85, v85, v176
 v_add_f32 v86, v86, v176
 v_add_f32 v87, v87, v176
 s_waitcnt vmcnt(0)
 v_cmp_gt_u32 vcc, 8, v239
 s_cbranch_vccnz Lvs92
Lvb93:
 s_add_u32 m0, s73, 32768
 s_add_u32 s76, s73, 16384
 v_mfma_f32_16x16x32_bf16 v[40:43], a[192:195], a[164:167], v[172:175]
 ds_read_b128 a[224:227], v217 offset:24576
 v_cndmask_b32 v104, v220, v180, s[8:9]
 v_mfma_f32_16x16x32_bf16 v[40:43], a[196:199], a[172:175], v[40:43]
 buffer_load_dwordx4 v251, s[56:59], s76 offen offset:0 sc1 lds
 v_mfma_f32_16x16x32_bf16 v[40:43], a[200:203], a[180:183], v[40:43]
 v_cvt_pk_bf16_f32 v132, v184, v185
 v_cndmask_b32 v105, v220, v180, s[10:11]
 v_mfma_f32_16x16x32_bf16 v[40:43], a[204:207], a[188:191], v[40:43]
 v_exp_f32 v188, v12
 v_cvt_pk_bf16_f32 v133, v186, v187
 v_mfma_f32_16x16x32_bf16 v[32:35], a[204:207], a[184:187], v[168:171]
 buffer_load_dwordx4 v251, s[56:59], s76 offen offset:1024 sc1 lds
 buffer_load_dwordx4 v251, s[56:59], s76 offen offset:2048 sc1 lds
 buffer_load_dwordx4 v251, s[56:59], s76 offen offset:3072 sc1 lds
 v_exp_f32 v189, v13
 v_exp_f32 v190, v14
 v_mfma_f32_16x16x32_bf16 v[32:35], a[200:203], a[176:179], v[32:35]
 s_add_u32 m0, s73, 65536
 ds_read_b128 a[228:231], v217 offset:25600
 v_cvt_pk_bf16_f32 v134, v188, v189
 v_exp_f32 v191, v15
 v_mfma_f32_16x16x32_bf16 v[32:35], a[196:199], a[168:171], v[32:35]
 s_add_u32 s76, s73, 49152
 v_cndmask_b32 v106, v220, v180, s[12:13]
 v_cndmask_b32 v107, v220, v180, s[14:15]
 v_exp_f32 v184, v0
 v_cvt_pk_bf16_f32 v135, v190, v191
 v_exp_f32 v185, v1
 v_mfma_f32_16x16x32_bf16 v[32:35], a[192:195], a[160:163], v[32:35]
 buffer_load_dwordx4 v251, s[56:59], s76 offen offset:0 sc1 lds
 v_mfma_f32_16x16x32_bf16 v[196:199], v[208:211], v[132:135], 0
 v_exp_f32 v186, v2
 v_mfma_f32_16x16x32_bf16 v[104:107], a[192:195], a[132:135], v[104:107]
 ds_read_b128 a[232:235], v217 offset:26624
 v_cvt_pk_bf16_f32 v128, v184, v185
 v_exp_f32 v187, v3
 v_exp_f32 v188, v4
 v_mfma_f32_16x16x32_bf16 v[104:107], a[196:199], a[140:143], v[104:107]
 ds_read_b128 a[236:239], v217 offset:27648
 v_cvt_pk_bf16_f32 v129, v186, v187
 v_exp_f32 v189, v5
 v_mfma_f32_16x16x32_bf16 v[104:107], a[200:203], a[148:151], v[104:107]
 buffer_load_dwordx4 v251, s[56:59], s76 offen offset:1024 sc1 lds
 v_exp_f32 v190, v6
 v_cvt_pk_bf16_f32 v130, v188, v189
 v_mfma_f32_16x16x32_bf16 v[104:107], a[204:207], a[156:159], v[104:107]
 s_waitcnt lgkmcnt(4)
 v_exp_f32 v191, v7
 v_exp_f32 v184, v72
 v_mfma_f32_16x16x32_bf16 v[44:47], a[208:211], a[164:167], v[172:175]
 v_cvt_pk_bf16_f32 v131, v190, v191
 v_cndmask_b32 v108, v220, v180, s[16:17]
 v_exp_f32 v185, v73
 v_mfma_f32_16x16x32_bf16 v[44:47], a[212:215], a[172:175], v[44:47]
 buffer_load_dwordx4 v251, s[56:59], s76 offen offset:2048 sc1 lds
 v_mfma_f32_16x16x32_bf16 v[192:195], v[208:211], v[128:131], 0
 v_exp_f32 v186, v74
 v_cvt_pk_bf16_f32 v156, v184, v185
 v_exp_f32 v187, v75
 v_mfma_f32_16x16x32_bf16 v[44:47], a[216:219], a[180:183], v[44:47]
 v_exp_f32 v188, v76
 v_mfma_f32_16x16x32_bf16 v[44:47], a[220:223], a[188:191], v[44:47]
 ds_read_b128 a[240:243], v217 offset:28672
 buffer_load_dwordx4 v251, s[56:59], s76 offen offset:3072 sc1 lds
 v_cvt_pk_bf16_f32 v157, v186, v187
 v_exp_f32 v189, v77
 v_exp_f32 v190, v78
 v_mfma_f32_16x16x32_bf16 v[36:39], a[220:223], a[184:187], v[168:171]
 s_add_u32 m0, s67, 0
 v_cndmask_b32 v109, v220, v180, s[18:19]
 v_cvt_pk_bf16_f32 v158, v188, v189
 v_exp_f32 v191, v79
 v_mfma_f32_16x16x32_bf16 v[36:39], a[216:219], a[176:179], v[36:39]
 v_exp_f32 v184, v64
 v_cvt_pk_bf16_f32 v159, v190, v191
 v_mfma_f32_16x16x32_bf16 v[36:39], a[212:215], a[168:171], v[36:39]
 ds_read_b128 a[244:247], v217 offset:29696
 buffer_load_dwordx4 v218, s[56:59], s66 offen offset:0 sc1 lds
 v_cndmask_b32 v110, v220, v180, s[20:21]
 v_cndmask_b32 v111, v220, v180, s[22:23]
 v_exp_f32 v185, v65
 v_mfma_f32_16x16x32_bf16 v[36:39], a[208:211], a[160:163], v[36:39]
 buffer_load_dwordx4 v218, s[56:59], s66 offen offset:1024 sc1 lds
 v_mfma_f32_16x16x32_bf16 v[204:207], v[208:211], v[156:159], 0
 v_exp_f32 v186, v66
 v_cvt_pk_bf16_f32 v152, v184, v185
 v_exp_f32 v187, v67
 v_mfma_f32_16x16x32_bf16 v[108:111], a[208:211], a[132:135], v[108:111]
 v_exp_f32 v188, v68
 v_cvt_pk_bf16_f32 v153, v186, v187
 v_mfma_f32_16x16x32_bf16 v[108:111], a[212:215], a[140:143], v[108:111]
 ds_read_b128 a[248:251], v217 offset:30720
 ds_read_b128 a[252:255], v217 offset:31744
 v_exp_f32 v189, v69
 v_exp_f32 v190, v70
 v_mfma_f32_16x16x32_bf16 v[108:111], a[216:219], a[148:151], v[108:111]
 s_waitcnt lgkmcnt(4)
 v_cvt_pk_bf16_f32 v154, v188, v189
 v_cndmask_b32 v120, v220, v180, s[48:49]
 v_exp_f32 v191, v71
 v_exp_f32 v184, v24
 v_mfma_f32_16x16x32_bf16 v[108:111], a[220:223], a[156:159], v[108:111]
 buffer_load_dwordx4 v218, s[56:59], s66 offen offset:2048 sc1 lds
 v_cvt_pk_bf16_f32 v155, v190, v191
 v_exp_f32 v185, v25
 v_mfma_f32_16x16x32_bf16 v[56:59], a[224:227], a[164:167], v[172:175]
 buffer_load_dwordx4 v218, s[56:59], s66 offen offset:3072 sc1 lds
 v_mfma_f32_16x16x32_bf16 v[200:203], v[208:211], v[152:155], 0
 s_add_u32 m0, s67, 4096
 v_exp_f32 v186, v26
 v_cvt_pk_bf16_f32 v148, v184, v185
 v_mfma_f32_16x16x32_bf16 v[56:59], a[228:231], a[172:175], v[56:59]
 v_exp_f32 v187, v27
 v_exp_f32 v188, v28
 v_mfma_f32_16x16x32_bf16 v[56:59], a[232:235], a[180:183], v[56:59]
 v_cvt_pk_bf16_f32 v149, v186, v187
 v_cndmask_b32 v121, v220, v180, s[50:51]
 v_exp_f32 v189, v29
 v_mfma_f32_16x16x32_bf16 v[56:59], a[236:239], a[188:191], v[56:59]
 v_exp_f32 v190, v30
 v_cvt_pk_bf16_f32 v150, v188, v189
 v_mfma_f32_16x16x32_bf16 v[48:51], a[236:239], a[184:187], v[168:171]
 buffer_load_dwordx4 v219, s[56:59], s66 offen offset:0 sc1 lds
 v_exp_f32 v191, v31
 v_exp_f32 v184, v16
 v_mfma_f32_16x16x32_bf16 v[48:51], a[232:235], a[176:179], v[48:51]
 v_cvt_pk_bf16_f32 v151, v190, v191
 v_cndmask_b32 v122, v220, v180, s[82:83]
 v_exp_f32 v185, v17
 v_mfma_f32_16x16x32_bf16 v[48:51], a[228:231], a[168:171], v[48:51]
 v_cndmask_b32 v123, v220, v180, s[84:85]
 v_cndmask_b32 v124, v220, v180, s[86:87]
 v_mfma_f32_16x16x32_bf16 v[196:199], v[208:211], v[148:151], v[196:199]
 v_exp_f32 v186, v18
 v_cvt_pk_bf16_f32 v144, v184, v185
 v_exp_f32 v187, v19
 v_mfma_f32_16x16x32_bf16 v[48:51], a[224:227], a[160:163], v[48:51]
 buffer_load_dwordx4 v219, s[56:59], s66 offen offset:1024 sc1 lds
 v_exp_f32 v188, v20
 v_cvt_pk_bf16_f32 v145, v186, v187
 v_mfma_f32_16x16x32_bf16 v[120:123], a[224:227], a[132:135], v[120:123]
 s_waitcnt vmcnt(10)
 v_exp_f32 v189, v21
 v_exp_f32 v190, v22
 v_mfma_f32_16x16x32_bf16 v[120:123], a[228:231], a[140:143], v[120:123]
 s_barrier
 ds_read_b128 a[192:195], v217 offset:0
 buffer_load_dwordx4 v219, s[56:59], s66 offen offset:2048 sc1 lds
 v_cvt_pk_bf16_f32 v146, v188, v189
 v_exp_f32 v191, v23
 v_mfma_f32_16x16x32_bf16 v[120:123], a[232:235], a[148:151], v[120:123]
 s_waitcnt lgkmcnt(1)
 v_exp_f32 v184, v88
 v_cvt_pk_bf16_f32 v147, v190, v191
 v_mfma_f32_16x16x32_bf16 v[120:123], a[236:239], a[156:159], v[120:123]
 v_exp_f32 v185, v89
 v_mfma_f32_16x16x32_bf16 v[60:63], a[240:243], a[164:167], v[172:175]
 buffer_load_dwordx4 v219, s[56:59], s66 offen offset:3072 sc1 lds
 v_mfma_f32_16x16x32_bf16 v[192:195], v[208:211], v[144:147], v[192:195]
 s_add_u32 s66, s66, 32768
 v_exp_f32 v186, v90
 v_cvt_pk_bf16_f32 v164, v184, v185
 v_exp_f32 v187, v91
 v_mfma_f32_16x16x32_bf16 v[60:63], a[244:247], a[172:175], v[60:63]
 s_add_u32 m0, s41, 0
 ds_read_b128 a[196:199], v217 offset:1024
 v_exp_f32 v188, v92
 v_cndmask_b32 v125, v220, v180, s[88:89]
 v_cvt_pk_bf16_f32 v165, v186, v187
 v_exp_f32 v189, v93
 v_mfma_f32_16x16x32_bf16 v[60:63], a[248:251], a[180:183], v[60:63]
 buffer_load_dwordx4 v240, s[32:35], s28 offen offset:0 lds
 v_exp_f32 v190, v94
 v_mfma_f32_16x16x32_bf16 v[60:63], a[252:255], a[188:191], v[60:63]
 ds_read_b128 a[200:203], v217 offset:2048
 v_cvt_pk_bf16_f32 v166, v188, v189
 v_exp_f32 v191, v95
 v_cndmask_b32 v126, v220, v180, s[90:91]
 v_exp_f32 v184, v80
 v_mfma_f32_16x16x32_bf16 v[52:55], a[252:255], a[184:187], v[168:171]
 ds_read_b128 a[204:207], v217 offset:3072
 v_cvt_pk_bf16_f32 v167, v190, v191
 v_exp_f32 v185, v81
 v_mfma_f32_16x16x32_bf16 v[52:55], a[248:251], a[176:179], v[52:55]
 buffer_load_dwordx4 v241, s[32:35], s28 offen offset:1024 lds
 v_mfma_f32_16x16x32_bf16 v[204:207], v[208:211], v[164:167], v[204:207]
 v_exp_f32 v186, v82
 v_cvt_pk_bf16_f32 v160, v184, v185
 v_mfma_f32_16x16x32_bf16 v[52:55], a[244:247], a[168:171], v[52:55]
 ds_read_b128 a[208:211], v217 offset:4096
 v_cndmask_b32 v127, v220, v180, s[92:93]
 v_exp_f32 v187, v83
 v_exp_f32 v188, v84
 v_cvt_pk_bf16_f32 v161, v186, v187
 v_exp_f32 v189, v85
 v_exp_f32 v190, v86
 v_cvt_pk_bf16_f32 v162, v188, v189
 v_exp_f32 v191, v87
 v_exp_f32 v184, v40
 v_cvt_pk_bf16_f32 v163, v190, v191
 v_exp_f32 v185, v41
 v_mfma_f32_16x16x32_bf16 v[52:55], a[240:243], a[160:163], v[52:55]
 ds_read_b128 a[212:215], v217 offset:5120
 ds_read_b128 a[216:219], v217 offset:6144
 buffer_load_dwordx4 v242, s[32:35], s28 offen offset:2048 lds
 v_mfma_f32_16x16x32_bf16 v[200:203], v[208:211], v[160:163], v[200:203]
 buffer_load_dwordx4 v243, s[32:35], s28 offen offset:3072 lds
 v_mfma_f32_16x16x32_bf16 v[124:127], a[240:243], a[132:135], v[124:127]
 v_exp_f32 v186, v42
 v_exp_f32 v187, v43
 v_mfma_f32_16x16x32_bf16 v[124:127], a[244:247], a[140:143], v[124:127]
 s_waitcnt lgkmcnt(3)
 ds_read_b128 a[220:223], v217 offset:7168
 v_max3_f32 v250, v196, v192, v204
 v_mfma_f32_16x16x32_bf16 v[124:127], a[248:251], a[148:151], v[124:127]
 v_max_f32 v250, v250, v200
 v_cmp_lt_f32 vcc, s75, v250
 v_mfma_f32_16x16x32_bf16 v[124:127], a[252:255], a[156:159], v[124:127]
 s_cbranch_vccnz Lrare94
Lback95:
 v_add_f32 v213, v213, v196
 v_add_f32 v212, v212, v192
 v_add_f32 v215, v215, v204
 v_add_f32 v214, v214, v200
 s_branch LdrA10
LdrA711:
 v_mfma_f32_16x16x32_bf16 a[68:71], a[192:195], v[132:135], a[68:71]
 ds_read_b128 a[224:227], v217 offset:8192
 v_cndmask_b32 v0, v220, v168, s[8:9]
 v_mfma_f32_16x16x32_bf16 a[64:67], a[192:195], v[128:131], a[64:67]
 ds_read_b128 a[228:231], v217 offset:9216
 v_cvt_pk_bf16_f32 v140, v184, v185
 v_mfma_f32_16x16x32_bf16 a[4:7], a[192:195], v[156:159], a[4:7]
 v_exp_f32 v188, v44
 v_mfma_f32_16x16x32_bf16 a[0:3], a[192:195], v[152:155], a[0:3]
 buffer_load_dword v239, v238, s[52:55], s43 offen sc1
 v_mfma_f32_16x16x32_bf16 a[76:79], a[196:199], v[132:135], a[76:79]
 v_cvt_pk_bf16_f32 v141, v186, v187
 v_cndmask_b32 v1, v220, v168, s[10:11]
 v_mfma_f32_16x16x32_bf16 a[72:75], a[196:199], v[128:131], a[72:75]
 v_exp_f32 v189, v45
 v_mfma_f32_16x16x32_bf16 a[12:15], a[196:199], v[156:159], a[12:15]
 v_exp_f32 v190, v46
 v_mfma_f32_16x16x32_bf16 a[8:11], a[196:199], v[152:155], a[8:11]
 ds_read_b128 a[232:235], v217 offset:10240
 v_cvt_pk_bf16_f32 v142, v188, v189
 v_mfma_f32_16x16x32_bf16 a[84:87], a[200:203], v[132:135], a[84:87]
 v_exp_f32 v191, v47
 v_mfma_f32_16x16x32_bf16 a[80:83], a[200:203], v[128:131], a[80:83]
 v_exp_f32 v184, v32
 v_mfma_f32_16x16x32_bf16 a[20:23], a[200:203], v[156:159], a[20:23]
 v_cvt_pk_bf16_f32 v143, v190, v191
 v_cndmask_b32 v2, v220, v168, s[12:13]
 v_mfma_f32_16x16x32_bf16 a[16:19], a[200:203], v[152:155], a[16:19]
 v_exp_f32 v185, v33
 v_mfma_f32_16x16x32_bf16 a[92:95], a[204:207], v[132:135], a[92:95]
 ds_read_b128 a[236:239], v217 offset:11264
 ds_read_b128 a[240:243], v217 offset:12288
 v_mfma_f32_16x16x32_bf16 v[196:199], v[208:211], v[140:143], 0
 v_exp_f32 v186, v34
 v_mfma_f32_16x16x32_bf16 a[88:91], a[204:207], v[128:131], a[88:91]
 v_mfma_f32_16x16x32_bf16 a[28:31], a[204:207], v[156:159], a[28:31]
 s_waitcnt lgkmcnt(5)
 v_cvt_pk_bf16_f32 v136, v184, v185
 v_cndmask_b32 v3, v220, v168, s[14:15]
 v_mfma_f32_16x16x32_bf16 a[24:27], a[204:207], v[152:155], a[24:27]
 v_exp_f32 v187, v35
 v_mfma_f32_16x16x32_bf16 a[100:103], a[208:211], v[132:135], a[100:103]
 v_exp_f32 v188, v36
 v_mfma_f32_16x16x32_bf16 a[96:99], a[208:211], v[128:131], a[96:99]
 v_mfma_f32_16x16x32_bf16 a[36:39], a[208:211], v[156:159], a[36:39]
 ds_read_b128 a[244:247], v217 offset:13312
 v_cvt_pk_bf16_f32 v137, v186, v187
 v_mfma_f32_16x16x32_bf16 a[32:35], a[208:211], v[152:155], a[32:35]
 v_exp_f32 v189, v37
 v_mfma_f32_16x16x32_bf16 a[108:111], a[212:215], v[132:135], a[108:111]
 v_exp_f32 v190, v38
 v_mfma_f32_16x16x32_bf16 a[104:107], a[212:215], v[128:131], a[104:107]
 v_mfma_f32_16x16x32_bf16 a[44:47], a[212:215], v[156:159], a[44:47]
 v_cvt_pk_bf16_f32 v138, v188, v189
 v_cndmask_b32 v4, v220, v168, s[16:17]
 v_mfma_f32_16x16x32_bf16 a[40:43], a[212:215], v[152:155], a[40:43]
 s_waitcnt vmcnt(0)
 v_exp_f32 v191, v39
 v_mfma_f32_16x16x32_bf16 a[116:119], a[216:219], v[132:135], a[116:119]
 ds_read_b128 a[248:251], v217 offset:14336
 v_cmp_gt_u32 vcc, 128, v239
 v_mfma_f32_16x16x32_bf16 a[112:115], a[216:219], v[128:131], a[112:115]
 s_cbranch_vccnz Lrps96
Lrpb97:
 v_exp_f32 v184, v104
 v_mfma_f32_16x16x32_bf16 a[52:55], a[216:219], v[156:159], a[52:55]
 buffer_load_dwordx4 a[128:131], v251, s[52:55], s71 offen offset:0 sc1
 v_mfma_f32_16x16x32_bf16 a[48:51], a[216:219], v[152:155], a[48:51]
 ds_read_b128 a[252:255], v217 offset:15360
 v_cvt_pk_bf16_f32 v139, v190, v191
 v_mfma_f32_16x16x32_bf16 a[124:127], a[220:223], v[132:135], a[124:127]
 v_exp_f32 v185, v105
 v_mfma_f32_16x16x32_bf16 a[120:123], a[220:223], v[128:131], a[120:123]
 v_cndmask_b32 v5, v220, v168, s[18:19]
 v_mfma_f32_16x16x32_bf16 v[192:195], v[208:211], v[136:139], 0
 v_exp_f32 v186, v106
 v_mfma_f32_16x16x32_bf16 a[60:63], a[220:223], v[156:159], a[60:63]
 s_waitcnt lgkmcnt(4)
 v_cvt_pk_bf16_f32 v156, v184, v185
 v_mfma_f32_16x16x32_bf16 a[56:59], a[220:223], v[152:155], a[56:59]
 s_waitcnt vmcnt(18)
 v_exp_f32 v187, v107
 v_mfma_f32_16x16x32_bf16 a[68:71], a[224:227], v[148:151], a[68:71]
 s_barrier
 ds_read_b128 a[192:195], v217 offset:49152
 v_cndmask_b32 v6, v220, v168, s[20:21]
 v_mfma_f32_16x16x32_bf16 a[64:67], a[224:227], v[144:147], a[64:67]
 buffer_load_dwordx4 a[132:135], v251, s[52:55], s71 offen offset:1024 sc1
 v_mfma_f32_16x16x32_bf16 a[4:7], a[224:227], v[164:167], a[4:7]
 s_add_u32 m0, s67, 32768
 v_exp_f32 v188, v108
 v_mfma_f32_16x16x32_bf16 a[0:3], a[224:227], v[160:163], a[0:3]
 buffer_load_dwordx4 v218, s[56:59], s66 offen offset:0 sc1 lds
 v_mfma_f32_16x16x32_bf16 a[76:79], a[228:231], v[148:151], a[76:79]
 ds_read_b128 a[196:199], v217 offset:50176
 v_cvt_pk_bf16_f32 v157, v186, v187
 v_mfma_f32_16x16x32_bf16 a[72:75], a[228:231], v[144:147], a[72:75]
 v_mfma_f32_16x16x32_bf16 a[12:15], a[228:231], v[164:167], a[12:15]
 buffer_load_dwordx4 v218, s[56:59], s66 offen offset:1024 sc1 lds
 v_mfma_f32_16x16x32_bf16 a[8:11], a[228:231], v[160:163], a[8:11]
 buffer_load_dwordx4 a[136:139], v251, s[52:55], s71 offen offset:2048 sc1
 v_mfma_f32_16x16x32_bf16 a[84:87], a[232:235], v[148:151], a[84:87]
 v_exp_f32 v189, v109
 v_mfma_f32_16x16x32_bf16 a[80:83], a[232:235], v[144:147], a[80:83]
 ds_read_b128 a[200:203], v217 offset:51200
 v_cndmask_b32 v7, v220, v168, s[22:23]
 v_mfma_f32_16x16x32_bf16 a[20:23], a[232:235], v[164:167], a[20:23]
 v_exp_f32 v190, v110
 v_mfma_f32_16x16x32_bf16 a[16:19], a[232:235], v[160:163], a[16:19]
 ds_read_b128 a[204:207], v217 offset:52224
 v_cndmask_b32 v16, v220, v168, s[48:49]
 v_mfma_f32_16x16x32_bf16 a[92:95], a[236:239], v[148:151], a[92:95]
 buffer_load_dwordx4 v218, s[56:59], s66 offen offset:2048 sc1 lds
 v_mfma_f32_16x16x32_bf16 a[88:91], a[236:239], v[144:147], a[88:91]
 ds_read_b128 a[208:211], v217 offset:53248
 v_cvt_pk_bf16_f32 v158, v188, v189
 v_mfma_f32_16x16x32_bf16 a[28:31], a[236:239], v[164:167], a[28:31]
 buffer_load_dwordx4 a[140:143], v251, s[52:55], s71 offen offset:3072 sc1
 v_mfma_f32_16x16x32_bf16 a[24:27], a[236:239], v[160:163], a[24:27]
 s_waitcnt lgkmcnt(5)
 v_exp_f32 v191, v111
 v_mfma_f32_16x16x32_bf16 a[100:103], a[240:243], v[148:151], a[100:103]
 v_mfma_f32_16x16x32_bf16 a[96:99], a[240:243], v[144:147], a[96:99]
 v_exp_f32 v184, v56
 v_mfma_f32_16x16x32_bf16 a[36:39], a[240:243], v[164:167], a[36:39]
 buffer_load_dwordx4 v218, s[56:59], s66 offen offset:3072 sc1 lds
 v_mfma_f32_16x16x32_bf16 a[32:35], a[240:243], v[160:163], a[32:35]
 s_add_u32 s71, s71, 4096
 ds_read_b128 a[212:215], v217 offset:54272
 v_cndmask_b32 v17, v220, v168, s[50:51]
 v_mfma_f32_16x16x32_bf16 a[108:111], a[244:247], v[148:151], a[108:111]
 buffer_load_dwordx4 a[144:147], v251, s[52:55], s71 offen offset:0 sc1
 v_mfma_f32_16x16x32_bf16 a[104:107], a[244:247], v[144:147], a[104:107]
 ds_read_b128 a[216:219], v217 offset:55296
 v_cvt_pk_bf16_f32 v159, v190, v191
 v_mfma_f32_16x16x32_bf16 a[44:47], a[244:247], v[164:167], a[44:47]
 s_add_u32 m0, s67, 36864
 v_exp_f32 v185, v57
 v_mfma_f32_16x16x32_bf16 a[40:43], a[244:247], v[160:163], a[40:43]
 buffer_load_dwordx4 v219, s[56:59], s66 offen offset:0 sc1 lds
 v_mfma_f32_16x16x32_bf16 v[204:207], v[208:211], v[156:159], 0
 v_mfma_f32_16x16x32_bf16 a[116:119], a[248:251], v[148:151], a[116:119]
 ds_read_b128 a[220:223], v217 offset:56320
 v_cndmask_b32 v18, v220, v168, s[82:83]
 v_mfma_f32_16x16x32_bf16 a[112:115], a[248:251], v[144:147], a[112:115]
 v_exp_f32 v186, v58
 v_mfma_f32_16x16x32_bf16 a[52:55], a[248:251], v[164:167], a[52:55]
 buffer_load_dwordx4 a[148:151], v251, s[52:55], s71 offen offset:1024 sc1
 v_mfma_f32_16x16x32_bf16 a[48:51], a[248:251], v[160:163], a[48:51]
 v_mfma_f32_16x16x32_bf16 a[124:127], a[252:255], v[148:151], a[124:127]
 v_cvt_pk_bf16_f32 v148, v184, v185
 v_cndmask_b32 v19, v220, v168, s[84:85]
 v_mfma_f32_16x16x32_bf16 a[120:123], a[252:255], v[144:147], a[120:123]
 v_exp_f32 v187, v59
 v_mfma_f32_16x16x32_bf16 a[60:63], a[252:255], v[164:167], a[60:63]
 s_waitcnt lgkmcnt(4)
 v_exp_f32 v188, v60
 v_mfma_f32_16x16x32_bf16 a[56:59], a[252:255], v[160:163], a[56:59]
 buffer_load_dwordx4 v219, s[56:59], s66 offen offset:1024 sc1 lds
 v_mfma_f32_16x16x32_bf16 v[8:11], a[192:195], a[164:167], v[172:175]
 ds_read_b128 a[224:227], v217 offset:57344
 v_cvt_pk_bf16_f32 v149, v186, v187
 v_mfma_f32_16x16x32_bf16 v[8:11], a[196:199], a[172:175], v[8:11]
 v_exp_f32 v189, v61
 v_mfma_f32_16x16x32_bf16 v[8:11], a[200:203], a[180:183], v[8:11]
 v_exp_f32 v190, v62
 v_mfma_f32_16x16x32_bf16 v[8:11], a[204:207], a[188:191], v[8:11]
 buffer_load_dwordx4 a[152:155], v251, s[52:55], s71 offen offset:2048 sc1
 v_mfma_f32_16x16x32_bf16 v[0:3], a[204:207], a[184:187], v[0:3]
 ds_read_b128 a[228:231], v217 offset:58368
 v_cvt_pk_bf16_f32 v150, v188, v189
 v_exp_f32 v191, v63
 v_mfma_f32_16x16x32_bf16 v[0:3], a[200:203], a[176:179], v[0:3]
 v_exp_f32 v184, v48
 v_mfma_f32_16x16x32_bf16 v[0:3], a[196:199], a[168:171], v[0:3]
 buffer_load_dwordx4 v219, s[56:59], s66 offen offset:2048 sc1 lds
 v_cndmask_b32 v20, v220, v168, s[86:87]
 v_cvt_pk_bf16_f32 v151, v190, v191
 v_mfma_f32_16x16x32_bf16 v[0:3], a[192:195], a[160:163], v[0:3]
 s_waitcnt lgkmcnt(2)
 ds_read_b128 a[232:235], v217 offset:59392
 ds_read_b128 a[236:239], v217 offset:60416
 v_exp_f32 v185, v49
 v_mfma_f32_16x16x32_bf16 v[12:15], a[208:211], a[164:167], v[172:175]
 buffer_load_dwordx4 a[156:159], v251, s[52:55], s71 offen offset:3072 sc1
 v_mfma_f32_16x16x32_bf16 v[196:199], v[208:211], v[148:151], v[196:199]
 v_exp_f32 v186, v50
 v_mfma_f32_16x16x32_bf16 v[12:15], a[212:215], a[172:175], v[12:15]
 ds_read_b128 a[240:243], v217 offset:61440
 v_cvt_pk_bf16_f32 v144, v184, v185
 v_mfma_f32_16x16x32_bf16 v[12:15], a[216:219], a[180:183], v[12:15]
 v_exp_f32 v187, v51
 v_mfma_f32_16x16x32_bf16 v[12:15], a[220:223], a[188:191], v[12:15]
 v_exp_f32 v188, v52
 v_mfma_f32_16x16x32_bf16 v[4:7], a[220:223], a[184:187], v[4:7]
 buffer_load_dwordx4 v219, s[56:59], s66 offen offset:3072 sc1 lds
 v_cndmask_b32 v21, v220, v168, s[88:89]
 v_cvt_pk_bf16_f32 v145, v186, v187
 v_exp_f32 v189, v53
 v_mfma_f32_16x16x32_bf16 v[4:7], a[216:219], a[176:179], v[4:7]
 s_add_u32 s71, s71, 4096
 ds_read_b128 a[244:247], v217 offset:62464
 ds_read_b128 a[248:251], v217 offset:63488
 v_exp_f32 v190, v54
 v_mfma_f32_16x16x32_bf16 v[4:7], a[212:215], a[168:171], v[4:7]
 s_add_u32 s66, s66, 32768
 s_xor_b32 s67, s67, 0x10000
 v_cvt_pk_bf16_f32 v146, v188, v189
 v_mfma_f32_16x16x32_bf16 v[4:7], a[208:211], a[160:163], v[4:7]
 s_waitcnt lgkmcnt(3)
 ds_read_b128 a[252:255], v217 offset:64512
 v_cndmask_b32 v22, v220, v168, s[90:91]
 v_exp_f32 v191, v55
 v_mfma_f32_16x16x32_bf16 v[24:27], a[224:227], a[164:167], v[172:175]
 s_add_u32 m0, s41, 4096
 v_exp_f32 v184, v120
 v_mfma_f32_16x16x32_bf16 v[24:27], a[228:231], a[172:175], v[24:27]
 ds_read_b128 a[192:195], v217 offset:32768
 v_cvt_pk_bf16_f32 v147, v190, v191
 v_mfma_f32_16x16x32_bf16 v[24:27], a[232:235], a[180:183], v[24:27]
 buffer_load_dwordx4 v244, s[32:35], s28 offen offset:0 lds
 v_exp_f32 v185, v121
 v_mfma_f32_16x16x32_bf16 v[24:27], a[236:239], a[188:191], v[24:27]
 ds_read_b128 a[196:199], v217 offset:40960
 ds_read_b128 a[200:203], v217 offset:33792
 v_mfma_f32_16x16x32_bf16 v[192:195], v[208:211], v[144:147], v[192:195]
 v_exp_f32 v186, v122
 v_mfma_f32_16x16x32_bf16 v[16:19], a[236:239], a[184:187], v[16:19]
 v_cvt_pk_bf16_f32 v164, v184, v185
 v_cndmask_b32 v23, v220, v168, s[92:93]
 v_exp_f32 v187, v123
 v_mfma_f32_16x16x32_bf16 v[16:19], a[232:235], a[176:179], v[16:19]
 buffer_load_dwordx4 v245, s[32:35], s28 offen offset:1024 lds
 v_exp_f32 v188, v124
 v_mfma_f32_16x16x32_bf16 v[16:19], a[228:231], a[168:171], v[16:19]
 s_waitcnt lgkmcnt(3)
 ds_read_b128 a[204:207], v217 offset:41984
 v_cvt_pk_bf16_f32 v165, v186, v187
 v_mfma_f32_16x16x32_bf16 v[16:19], a[224:227], a[160:163], v[16:19]
 v_exp_f32 v189, v125
 v_mfma_f32_16x16x32_bf16 v[28:31], a[240:243], a[164:167], v[172:175]
 v_exp_f32 v190, v126
 v_mfma_f32_16x16x32_bf16 v[28:31], a[244:247], a[172:175], v[28:31]
 buffer_load_dwordx4 v246, s[32:35], s28 offen offset:2048 lds
 v_cvt_pk_bf16_f32 v166, v188, v189
 v_mfma_f32_16x16x32_bf16 v[28:31], a[248:251], a[180:183], v[28:31]
 v_exp_f32 v191, v127
 v_exp_f32 v184, v8
 v_cvt_pk_bf16_f32 v167, v190, v191
 v_exp_f32 v185, v9
 v_mfma_f32_16x16x32_bf16 v[28:31], a[252:255], a[188:191], v[28:31]
 ds_read_b128 a[208:211], v217 offset:34816
 ds_read_b128 a[212:215], v217 offset:43008
 v_mfma_f32_16x16x32_bf16 v[204:207], v[208:211], v[164:167], v[204:207]
 buffer_load_dwordx4 v247, s[32:35], s28 offen offset:3072 lds
 v_mfma_f32_16x16x32_bf16 v[20:23], a[252:255], a[184:187], v[20:23]
 v_exp_f32 v186, v10
 v_exp_f32 v187, v11
 v_mfma_f32_16x16x32_bf16 v[20:23], a[248:251], a[176:179], v[20:23]
 s_waitcnt lgkmcnt(2)
 ds_read_b128 a[216:219], v217 offset:35840
 s_nop 0
 v_max3_f32 v250, v196, v192, v204
 v_mfma_f32_16x16x32_bf16 v[20:23], a[244:247], a[168:171], v[20:23]
 ds_read_b128 a[220:223], v217 offset:44032
 v_cmp_lt_f32 vcc, s75, v250
 v_mfma_f32_16x16x32_bf16 v[20:23], a[240:243], a[160:163], v[20:23]
 s_cbranch_vccnz Lrare98
Lback99:
 v_add_f32 v213, v213, v196
 v_add_f32 v212, v212, v192
 v_add_f32 v215, v215, v204
 v_mfma_f32_16x16x32_bf16 a[4:7], a[192:195], v[156:159], a[4:7]
 ds_read_b128 a[224:227], v217 offset:36864
 ds_read_b128 a[228:231], v217 offset:45056
 v_mfma_f32_16x16x32_bf16 a[4:7], a[196:199], v[164:167], a[4:7]
 ds_read_b128 a[232:235], v217 offset:37888
 ds_read_b128 a[236:239], v217 offset:46080
 v_mfma_f32_16x16x32_bf16 a[12:15], a[200:203], v[156:159], a[12:15]
 s_waitcnt lgkmcnt(4)
 ds_read_b128 a[240:243], v217 offset:38912
 ds_read_b128 a[244:247], v217 offset:47104
 v_mfma_f32_16x16x32_bf16 a[12:15], a[204:207], v[164:167], a[12:15]
 ds_read_b128 a[248:251], v217 offset:39936
 ds_read_b128 a[252:255], v217 offset:48128
 v_rcp_f32 v214, v214
 v_cndmask_b32 v40, v220, v172, s[8:9]
 v_cvt_pk_bf16_f32 v132, v184, v185
 v_mfma_f32_16x16x32_bf16 a[20:23], a[208:211], v[156:159], a[20:23]
 s_lshl_b32 s76, s64, 17
 s_lshl_b32 s77, s61, 12
 s_add_u32 s76, s76, s77
 s_add_u32 s76, s76, 37748736
 s_add_u32 s77, s76, 524288
 v_exp_f32 v188, v12
 v_accvgpr_read_b32 v112, a0
 v_accvgpr_read_b32 v113, a1
 v_accvgpr_read_b32 v114, a2
 v_accvgpr_read_b32 v115, a3
 v_accvgpr_read_b32 v116, a8
 v_accvgpr_read_b32 v117, a9
 v_mfma_f32_16x16x32_bf16 a[20:23], a[212:215], v[164:167], a[20:23]
 v_accvgpr_read_b32 v118, a10
 v_accvgpr_read_b32 v119, a11
 v_mul_f32 v112, v112, v214
 v_mfma_f32_16x16x32_bf16 a[28:31], a[216:219], v[156:159], a[28:31]
 s_waitcnt lgkmcnt(4)
 v_mul_f32 v113, v113, v214
 v_mul_f32 v114, v114, v214
 v_cvt_pk_bf16_f32 v133, v186, v187
 v_mul_f32 v115, v115, v214
 v_cndmask_b32 v41, v220, v172, s[10:11]
 v_mul_f32 v116, v116, v214
 v_mfma_f32_16x16x32_bf16 a[28:31], a[220:223], v[164:167], a[28:31]
 buffer_load_dwordx4 v[64:67], v251, s[52:55], s71 offen offset:0 sc1
 v_mul_f32 v117, v117, v214
 v_mul_f32 v118, v118, v214
 v_mul_f32 v119, v119, v214
 v_exp_f32 v189, v13
 v_mfma_f32_16x16x32_bf16 a[36:39], a[224:227], v[156:159], a[36:39]
 v_cvt_pk_bf16_f32 v96, v112, v113
 v_cvt_pk_bf16_f32 v97, v114, v115
 v_cvt_pk_bf16_f32 v98, v116, v117
 v_cvt_pk_bf16_f32 v99, v118, v119
 v_mfma_f32_16x16x32_bf16 a[36:39], a[228:231], v[164:167], a[36:39]
 buffer_store_dwordx4 v[96:99], v251, s[52:55], s76 offen offset:0 sc1
 v_accvgpr_read_b32 v112, a16
 v_accvgpr_read_b32 v113, a17
 v_mfma_f32_16x16x32_bf16 a[44:47], a[232:235], v[156:159], a[44:47]
 s_waitcnt lgkmcnt(0)
 v_exp_f32 v190, v14
 v_accvgpr_read_b32 v114, a18
 v_cndmask_b32 v42, v220, v172, s[12:13]
 v_accvgpr_read_b32 v115, a19
 v_accvgpr_read_b32 v116, a24
 v_mfma_f32_16x16x32_bf16 a[44:47], a[236:239], v[164:167], a[44:47]
 v_accvgpr_read_b32 v117, a25
 v_accvgpr_read_b32 v118, a26
 v_accvgpr_read_b32 v119, a27
 v_mul_f32 v112, v112, v214
 v_mfma_f32_16x16x32_bf16 a[52:55], a[240:243], v[156:159], a[52:55]
 buffer_load_dwordx4 v[68:71], v251, s[52:55], s71 offen offset:1024 sc1
 v_mul_f32 v113, v113, v214
 v_mul_f32 v114, v114, v214
 v_cvt_pk_bf16_f32 v134, v188, v189
 v_mul_f32 v115, v115, v214
 v_mfma_f32_16x16x32_bf16 a[52:55], a[244:247], v[164:167], a[52:55]
 v_mul_f32 v116, v116, v214
 v_mul_f32 v117, v117, v214
 v_mul_f32 v118, v118, v214
 v_exp_f32 v191, v15
 v_mul_f32 v119, v119, v214
 v_cndmask_b32 v43, v220, v172, s[14:15]
 v_mfma_f32_16x16x32_bf16 a[60:63], a[248:251], v[156:159], a[60:63]
 v_cvt_pk_bf16_f32 v100, v112, v113
 v_cvt_pk_bf16_f32 v101, v114, v115
 v_cvt_pk_bf16_f32 v102, v116, v117
 v_cvt_pk_bf16_f32 v103, v118, v119
 v_mfma_f32_16x16x32_bf16 a[60:63], a[252:255], v[164:167], a[60:63]
 buffer_store_dwordx4 v[100:103], v251, s[52:55], s76 offen offset:1024 sc1
 v_accvgpr_read_b32 v112, a32
 v_mfma_f32_16x16x32_bf16 a[68:71], a[192:195], v[140:143], a[68:71]
 v_exp_f32 v184, v0
 v_accvgpr_read_b32 v113, a33
 v_accvgpr_read_b32 v114, a34
 v_accvgpr_read_b32 v115, a35
 v_accvgpr_read_b32 v116, a40
 v_mfma_f32_16x16x32_bf16 a[68:71], a[196:199], v[148:151], a[68:71]
 v_xor_b32 v217, 0x10000, v217
 v_accvgpr_read_b32 v117, a41
 v_accvgpr_read_b32 v118, a42
 v_cndmask_b32 v44, v220, v172, s[16:17]
 v_accvgpr_read_b32 v119, a43
 v_mfma_f32_16x16x32_bf16 a[64:67], a[196:199], v[144:147], a[64:67]
 s_waitcnt vmcnt(16)
 buffer_load_dwordx4 v[72:75], v251, s[52:55], s71 offen offset:2048 sc1
 v_mul_f32 v112, v112, v214
 v_mul_f32 v113, v113, v214
 v_cvt_pk_bf16_f32 v135, v190, v191
 v_mul_f32 v114, v114, v214
 v_mul_f32 v115, v115, v214
 v_mfma_f32_16x16x32_bf16 a[64:67], a[192:195], v[136:139], a[64:67]
 s_barrier
 v_mul_f32 v116, v116, v214
 v_mul_f32 v117, v117, v214
 v_exp_f32 v185, v1
 v_mul_f32 v118, v118, v214
 v_mul_f32 v119, v119, v214
 v_mfma_f32_16x16x32_bf16 a[76:79], a[200:203], v[140:143], a[76:79]
 v_cvt_pk_bf16_f32 v96, v112, v113
 v_cvt_pk_bf16_f32 v97, v114, v115
 v_cvt_pk_bf16_f32 v98, v116, v117
 v_mfma_f32_16x16x32_bf16 v[196:199], v[208:211], v[132:135], 0
 v_cvt_pk_bf16_f32 v99, v118, v119
 v_cndmask_b32 v45, v220, v172, s[18:19]
 v_mfma_f32_16x16x32_bf16 a[76:79], a[204:207], v[148:151], a[76:79]
 buffer_store_dwordx4 v[96:99], v251, s[52:55], s76 offen offset:2048 sc1
 v_accvgpr_read_b32 v112, a48
 v_exp_f32 v186, v2
 v_mfma_f32_16x16x32_bf16 a[72:75], a[204:207], v[144:147], a[72:75]
 ds_read_b128 a[192:195], v217 offset:16384
 ds_read_b128 a[196:199], v217 offset:17408
 v_accvgpr_read_b32 v113, a49
 v_accvgpr_read_b32 v114, a50
 v_accvgpr_read_b32 v115, a51
 v_mfma_f32_16x16x32_bf16 a[72:75], a[200:203], v[136:139], a[72:75]
 v_accvgpr_read_b32 v116, a56
 v_accvgpr_read_b32 v117, a57
 v_accvgpr_read_b32 v118, a58
 v_accvgpr_read_b32 v119, a59
 v_mfma_f32_16x16x32_bf16 a[84:87], a[208:211], v[140:143], a[84:87]
 buffer_load_dwordx4 v[76:79], v251, s[52:55], s71 offen offset:3072 sc1
 v_mul_f32 v112, v112, v214
 v_cvt_pk_bf16_f32 v128, v184, v185
 v_mul_f32 v113, v113, v214
 v_mul_f32 v114, v114, v214
 v_cndmask_b32 v46, v220, v172, s[20:21]
 v_mul_f32 v115, v115, v214
 v_mfma_f32_16x16x32_bf16 a[84:87], a[212:215], v[148:151], a[84:87]
 s_add_u32 s71, s71, 4096
 v_mul_f32 v116, v116, v214
 v_mul_f32 v117, v117, v214
 v_exp_f32 v187, v3
 v_mul_f32 v118, v118, v214
 v_mfma_f32_16x16x32_bf16 a[80:83], a[212:215], v[144:147], a[80:83]
 ds_read_b128 a[200:203], v217 offset:18432
 ds_read_b128 a[204:207], v217 offset:19456
 v_mul_f32 v119, v119, v214
 v_cvt_pk_bf16_f32 v100, v112, v113
 v_cvt_pk_bf16_f32 v101, v114, v115
 v_cvt_pk_bf16_f32 v102, v116, v117
 v_mfma_f32_16x16x32_bf16 a[80:83], a[208:211], v[136:139], a[80:83]
 v_cvt_pk_bf16_f32 v103, v118, v119
 v_cndmask_b32 v47, v220, v172, s[22:23]
 v_exp_f32 v188, v4
 v_mfma_f32_16x16x32_bf16 a[92:95], a[216:219], v[140:143], a[92:95]
 buffer_store_dwordx4 v[100:103], v251, s[52:55], s76 offen offset:3072 sc1
 v_rcp_f32 v215, v215
 v_accvgpr_read_b32 v112, a4
 v_accvgpr_read_b32 v113, a5
 v_mfma_f32_16x16x32_bf16 a[92:95], a[220:223], v[148:151], a[92:95]
 v_accvgpr_read_b32 v114, a6
 v_accvgpr_read_b32 v115, a7
 v_accvgpr_read_b32 v116, a12
 v_accvgpr_read_b32 v117, a13
 v_mfma_f32_16x16x32_bf16 a[88:91], a[220:223], v[144:147], a[88:91]
 ds_read_b128 a[208:211], v217 offset:20480
 ds_read_b128 a[212:215], v217 offset:21504
 buffer_load_dwordx4 v[80:83], v251, s[52:55], s71 offen offset:0 sc1
 v_accvgpr_read_b32 v118, a14
 v_cvt_pk_bf16_f32 v129, v186, v187
 v_accvgpr_read_b32 v119, a15
 v_mul_f32 v112, v112, v215
 v_mfma_f32_16x16x32_bf16 a[88:91], a[216:219], v[136:139], a[88:91]
 v_mul_f32 v113, v113, v215
 v_mul_f32 v114, v114, v215
 v_exp_f32 v189, v5
 v_mul_f32 v115, v115, v215
 v_mul_f32 v116, v116, v215
 v_mfma_f32_16x16x32_bf16 a[100:103], a[224:227], v[140:143], a[100:103]
 v_cndmask_b32 v56, v220, v172, s[48:49]
 v_mul_f32 v117, v117, v215
 v_mul_f32 v118, v118, v215
 v_mul_f32 v119, v119, v215
 v_mfma_f32_16x16x32_bf16 a[100:103], a[228:231], v[148:151], a[100:103]
 v_cvt_pk_bf16_f32 v96, v112, v113
 v_cvt_pk_bf16_f32 v97, v114, v115
 v_cvt_pk_bf16_f32 v98, v116, v117
 v_exp_f32 v190, v6
 v_cvt_pk_bf16_f32 v99, v118, v119
 v_mfma_f32_16x16x32_bf16 a[96:99], a[228:231], v[144:147], a[96:99]
 ds_read_b128 a[216:219], v217 offset:22528
 ds_read_b128 a[220:223], v217 offset:23552
 buffer_store_dwordx4 v[96:99], v251, s[52:55], s77 offen offset:0 sc1
 v_accvgpr_read_b32 v112, a20
 v_accvgpr_read_b32 v113, a21
 v_mfma_f32_16x16x32_bf16 a[96:99], a[224:227], v[136:139], a[96:99]
 buffer_load_dwordx4 v[84:87], v251, s[52:55], s71 offen offset:1024 sc1
 v_accvgpr_read_b32 v114, a22
 v_accvgpr_read_b32 v115, a23
 v_cndmask_b32 v57, v220, v172, s[50:51]
 v_accvgpr_read_b32 v116, a28
 v_mfma_f32_16x16x32_bf16 a[108:111], a[232:235], v[140:143], a[108:111]
 v_accvgpr_read_b32 v117, a29
 v_cvt_pk_bf16_f32 v130, v188, v189
 v_accvgpr_read_b32 v118, a30
 v_accvgpr_read_b32 v119, a31
 v_mul_f32 v112, v112, v215
 v_mfma_f32_16x16x32_bf16 a[108:111], a[236:239], v[148:151], a[108:111]
 v_mul_f32 v113, v113, v215
 v_mul_f32 v114, v114, v215
 v_exp_f32 v191, v7
 v_mul_f32 v115, v115, v215
 v_mfma_f32_16x16x32_bf16 a[104:107], a[236:239], v[144:147], a[104:107]
 v_mul_f32 v116, v116, v215
 v_mul_f32 v117, v117, v215
 v_mul_f32 v118, v118, v215
 v_mul_f32 v119, v119, v215
 v_mfma_f32_16x16x32_bf16 a[104:107], a[232:235], v[136:139], a[104:107]
 v_cvt_pk_bf16_f32 v100, v112, v113
 v_cndmask_b32 v58, v220, v172, s[82:83]
 v_cvt_pk_bf16_f32 v101, v114, v115
 v_cvt_pk_bf16_f32 v102, v116, v117
 v_exp_f32 v184, v24
 v_cvt_pk_bf16_f32 v103, v118, v119
 v_mfma_f32_16x16x32_bf16 a[116:119], a[240:243], v[140:143], a[116:119]
 buffer_store_dwordx4 v[100:103], v251, s[52:55], s77 offen offset:1024 sc1
 v_accvgpr_read_b32 v112, a36
 v_mfma_f32_16x16x32_bf16 a[116:119], a[244:247], v[148:151], a[116:119]
 buffer_load_dwordx4 v[88:91], v251, s[52:55], s71 offen offset:2048 sc1
 v_accvgpr_read_b32 v113, a37
 v_accvgpr_read_b32 v114, a38
 v_accvgpr_read_b32 v115, a39
 v_accvgpr_read_b32 v116, a44
 v_mfma_f32_16x16x32_bf16 a[112:115], a[244:247], v[144:147], a[112:115]
 v_cvt_pk_bf16_f32 v131, v190, v191
 v_accvgpr_read_b32 v117, a45
 v_accvgpr_read_b32 v118, a46
 v_accvgpr_read_b32 v119, a47
 v_cndmask_b32 v59, v220, v172, s[84:85]
 v_mfma_f32_16x16x32_bf16 a[112:115], a[240:243], v[136:139], a[112:115]
 v_mul_f32 v112, v112, v215
 v_mul_f32 v113, v113, v215
 v_exp_f32 v185, v25
 v_mul_f32 v114, v114, v215
 v_mul_f32 v115, v115, v215
 v_mfma_f32_16x16x32_bf16 a[124:127], a[248:251], v[140:143], a[124:127]
 v_mul_f32 v116, v116, v215
 v_mul_f32 v117, v117, v215
 v_mul_f32 v118, v118, v215
 v_mul_f32 v119, v119, v215
 v_mfma_f32_16x16x32_bf16 v[192:195], v[208:211], v[128:131], 0
 v_cvt_pk_bf16_f32 v96, v112, v113
 v_cvt_pk_bf16_f32 v97, v114, v115
 v_mfma_f32_16x16x32_bf16 a[124:127], a[252:255], v[148:151], a[124:127]
 v_exp_f32 v186, v26
 v_cvt_pk_bf16_f32 v98, v116, v117
 v_mfma_f32_16x16x32_bf16 a[120:123], a[252:255], v[144:147], a[120:123]
 s_waitcnt lgkmcnt(4)
 v_cvt_pk_bf16_f32 v99, v118, v119
 v_cndmask_b32 v60, v220, v172, s[86:87]
 v_mfma_f32_16x16x32_bf16 a[120:123], a[248:251], v[136:139], a[120:123]
 buffer_store_dwordx4 v[96:99], v251, s[52:55], s77 offen offset:2048 sc1
 ds_read_b128 a[224:227], v217 offset:24576
 ds_read_b128 a[228:231], v217 offset:25600
 ds_read_b128 a[232:235], v217 offset:26624
 ds_read_b128 a[236:239], v217 offset:27648
 buffer_load_dwordx4 v[92:95], v251, s[52:55], s71 offen offset:3072 sc1
 v_accvgpr_read_b32 v112, a52
 v_accvgpr_read_b32 v113, a53
 v_accvgpr_read_b32 v114, a54
 v_accvgpr_read_b32 v115, a55
 v_mfma_f32_16x16x32_bf16 v[40:43], a[192:195], a[164:167], v[40:43]
 s_add_u32 s71, s71, 4096
 v_accvgpr_read_b32 v116, a60
 v_accvgpr_read_b32 v117, a61
 v_accvgpr_read_b32 v118, a62
 v_accvgpr_read_b32 v119, a63
 v_mul_f32 v112, v112, v215
 v_mul_f32 v113, v113, v215
 v_mul_f32 v114, v114, v215
 v_mul_f32 v115, v115, v215
 v_mul_f32 v116, v116, v215
 v_mul_f32 v117, v117, v215
 v_mul_f32 v118, v118, v215
 v_mul_f32 v119, v119, v215
 v_cvt_pk_bf16_f32 v100, v112, v113
 v_cvt_pk_bf16_f32 v101, v114, v115
 v_cvt_pk_bf16_f32 v102, v116, v117
 v_cvt_pk_bf16_f32 v103, v118, v119
 v_cvt_pk_bf16_f32 v148, v184, v185
 v_exp_f32 v187, v27
 v_mfma_f32_16x16x32_bf16 v[40:43], a[196:199], a[172:175], v[40:43]
 buffer_store_dwordx4 v[100:103], v251, s[52:55], s77 offen offset:3072 sc1
 v_exp_f32 v188, v28
 v_cvt_pk_bf16_f32 v149, v186, v187
 v_mfma_f32_16x16x32_bf16 v[40:43], a[200:203], a[180:183], v[40:43]
 s_waitcnt lgkmcnt(4)
 ds_read_b128 a[240:243], v217 offset:28672
 v_cndmask_b32 v61, v220, v172, s[88:89]
 v_exp_f32 v189, v29
 v_mfma_f32_16x16x32_bf16 v[40:43], a[204:207], a[188:191], v[40:43]
 ds_read_b128 a[244:247], v217 offset:29696
 ds_read_b128 a[248:251], v217 offset:30720
 ds_read_b128 a[252:255], v217 offset:31744
 v_exp_f32 v190, v30
 v_cvt_pk_bf16_f32 v150, v188, v189
 v_mfma_f32_16x16x32_bf16 v[44:47], a[208:211], a[164:167], v[44:47]
 v_exp_f32 v191, v31
 v_exp_f32 v184, v16
 v_mfma_f32_16x16x32_bf16 v[44:47], a[212:215], a[172:175], v[44:47]
 v_cvt_pk_bf16_f32 v151, v190, v191
 v_cndmask_b32 v62, v220, v172, s[90:91]
 v_mfma_f32_16x16x32_bf16 v[44:47], a[216:219], a[180:183], v[44:47]
 buffer_load_dwordx4 v[96:99], v251, s[52:55], s71 offen offset:0 sc1
 v_exp_f32 v185, v17
 v_mfma_f32_16x16x32_bf16 v[44:47], a[220:223], a[188:191], v[44:47]
 s_waitcnt lgkmcnt(4)
 ds_read_b128 a[192:195], v217 offset:0
 buffer_load_dwordx4 v[100:103], v251, s[52:55], s71 offen offset:1024 sc1
 v_cndmask_b32 v63, v220, v172, s[92:93]
 v_mfma_f32_16x16x32_bf16 v[196:199], v[208:211], v[148:151], v[196:199]
 v_exp_f32 v186, v18
 v_cvt_pk_bf16_f32 v144, v184, v185
 v_mfma_f32_16x16x32_bf16 v[56:59], a[224:227], a[164:167], v[56:59]
 buffer_load_dwordx4 v[104:107], v251, s[52:55], s71 offen offset:2048 sc1
 v_exp_f32 v187, v19
 v_exp_f32 v188, v20
 v_mfma_f32_16x16x32_bf16 v[56:59], a[228:231], a[172:175], v[56:59]
 ds_read_b128 a[196:199], v217 offset:8192
 v_cvt_pk_bf16_f32 v145, v186, v187
 v_exp_f32 v189, v21
 v_mfma_f32_16x16x32_bf16 v[56:59], a[232:235], a[180:183], v[56:59]
 ds_read_b128 a[200:203], v217 offset:1024
 buffer_load_dwordx4 v[108:111], v251, s[52:55], s71 offen offset:3072 sc1
 v_exp_f32 v190, v22
 v_cvt_pk_bf16_f32 v146, v188, v189
 v_exp_f32 v191, v23
 v_exp_f32 v184, v40
 v_cvt_pk_bf16_f32 v147, v190, v191
 v_exp_f32 v185, v41
 v_mfma_f32_16x16x32_bf16 v[56:59], a[236:239], a[188:191], v[56:59]
 s_waitcnt lgkmcnt(3)
 s_add_u32 s71, s71, 4096
 ds_read_b128 a[204:207], v217 offset:9216
 ds_read_b128 a[208:211], v217 offset:2048
 buffer_load_dwordx4 a[32:35], v251, s[52:55], s71 offen offset:0 sc1
 v_mfma_f32_16x16x32_bf16 v[192:195], v[208:211], v[144:147], v[192:195]
 buffer_load_dwordx4 a[36:39], v251, s[52:55], s71 offen offset:1024 sc1
 v_mfma_f32_16x16x32_bf16 v[60:63], a[240:243], a[164:167], v[60:63]
 buffer_load_dwordx4 a[40:43], v251, s[52:55], s71 offen offset:2048 sc1
 buffer_load_dwordx4 a[44:47], v251, s[52:55], s71 offen offset:3072 sc1
 v_exp_f32 v186, v42
 v_exp_f32 v187, v43
 v_mfma_f32_16x16x32_bf16 v[60:63], a[244:247], a[172:175], v[60:63]
 s_add_u32 s71, s71, 4096
 ds_read_b128 a[212:215], v217 offset:10240
 v_max_f32 v250, v196, v192
 v_mfma_f32_16x16x32_bf16 v[60:63], a[248:251], a[180:183], v[60:63]
 s_waitcnt lgkmcnt(2)
 ds_read_b128 a[216:219], v217 offset:3072
 v_cmp_lt_f32 vcc, s75, v250
 v_mfma_f32_16x16x32_bf16 v[60:63], a[252:255], a[188:191], v[60:63]
 s_cbranch_vccnz Lrare100
Lback101:
 ds_read_b128 a[220:223], v217 offset:11264
 v_add_f32 v213, v213, v196
 v_add_f32 v212, v212, v192
 s_waitcnt vmcnt(24)
 ds_read_b128 a[0:3], v236 offset:0
 ds_read_b128 a[4:7], v236 offset:2048
 ds_read_b128 a[8:11], v236 offset:4096
 ds_read_b128 a[12:15], v236 offset:6144
 ds_read_b128 a[16:19], v237 offset:0
 ds_read_b128 a[20:23], v237 offset:2048
 ds_read_b128 a[24:27], v237 offset:4096
 ds_read_b128 a[28:31], v237 offset:6144
 buffer_load_dwordx4 a[48:51], v251, s[52:55], s71 offen offset:0 sc1
 buffer_load_dwordx4 a[52:55], v251, s[52:55], s71 offen offset:1024 sc1
 buffer_load_dwordx4 a[56:59], v251, s[52:55], s71 offen offset:2048 sc1
 buffer_load_dwordx4 a[60:63], v251, s[52:55], s71 offen offset:3072 sc1
 s_add_u32 s71, s71, 4096
 buffer_load_dwordx4 v[152:155], v251, s[52:55], s71 offen offset:0 sc1
 buffer_load_dwordx4 v[156:159], v251, s[52:55], s71 offen offset:1024 sc1
 buffer_load_dwordx4 v[160:163], v251, s[52:55], s71 offen offset:2048 sc1
 buffer_load_dwordx4 v[164:167], v251, s[52:55], s71 offen offset:3072 sc1
 s_add_u32 s71, s71, 4096
 s_waitcnt lgkmcnt(0)
 buffer_store_dwordx4 a[0:3], v251, s[52:55], s29 offen offset:0 sc1
 buffer_store_dwordx4 a[4:7], v251, s[52:55], s29 offen offset:1024 sc1
 buffer_store_dwordx4 a[8:11], v251, s[52:55], s29 offen offset:2048 sc1
 buffer_store_dwordx4 a[12:15], v251, s[52:55], s29 offen offset:3072 sc1
 buffer_store_dwordx4 a[16:19], v251, s[52:55], s40 offen offset:0 sc1
 buffer_store_dwordx4 a[20:23], v251, s[52:55], s40 offen offset:1024 sc1
 buffer_store_dwordx4 a[24:27], v251, s[52:55], s40 offen offset:2048 sc1
 buffer_store_dwordx4 a[28:31], v251, s[52:55], s40 offen offset:3072 sc1
 s_branch LdrB12
Lj641:
 buffer_load_dword v239, v238, s[52:55], s43 offen sc1
 s_waitcnt vmcnt(0)
 s_mov_b32 s63, 131072
Lsp102:
 v_cmp_gt_u32 vcc, 128, v239
 s_cbranch_vccz Lgo103
 s_sub_u32 s63, s63, 1
 s_cbranch_scc1 Lgo103
 s_sleep 1
 buffer_load_dword v239, v238, s[52:55], s43 offen sc1
 s_waitcnt vmcnt(0)
 s_branch Lsp102
Lgo103:
 buffer_load_dwordx4 a[128:131], v251, s[52:55], s71 offen offset:0 sc1
 buffer_load_dwordx4 a[132:135], v251, s[52:55], s71 offen offset:1024 sc1
 buffer_load_dwordx4 a[136:139], v251, s[52:55], s71 offen offset:2048 sc1
 buffer_load_dwordx4 a[140:143], v251, s[52:55], s71 offen offset:3072 sc1
 s_add_u32 s71, s71, 4096
 buffer_load_dwordx4 a[144:147], v251, s[52:55], s71 offen offset:0 sc1
 buffer_load_dwordx4 a[148:151], v251, s[52:55], s71 offen offset:1024 sc1
 buffer_load_dwordx4 a[152:155], v251, s[52:55], s71 offen offset:2048 sc1
 buffer_load_dwordx4 a[156:159], v251, s[52:55], s71 offen offset:3072 sc1
 s_add_u32 s71, s71, 4096
 buffer_load_dwordx4 v[64:67], v251, s[52:55], s71 offen offset:0 sc1
 buffer_load_dwordx4 v[68:71], v251, s[52:55], s71 offen offset:1024 sc1
 buffer_load_dwordx4 v[72:75], v251, s[52:55], s71 offen offset:2048 sc1
 buffer_load_dwordx4 v[76:79], v251, s[52:55], s71 offen offset:3072 sc1
 s_add_u32 s71, s71, 4096
 buffer_load_dwordx4 v[80:83], v251, s[52:55], s71 offen offset:0 sc1
 buffer_load_dwordx4 v[84:87], v251, s[52:55], s71 offen offset:1024 sc1
 buffer_load_dwordx4 v[88:91], v251, s[52:55], s71 offen offset:2048 sc1
 buffer_load_dwordx4 v[92:95], v251, s[52:55], s71 offen offset:3072 sc1
 s_add_u32 s71, s71, 4096
 s_branch Lm235
Lfs5:
 s_mov_b32 s63, 131072
Lsp104:
 v_cmp_gt_u32 vcc, 128, v239
 s_cbranch_vccz Lgo105
 s_sub_u32 s63, s63, 1
 s_cbranch_scc1 Lgo105
 s_sleep 1
 buffer_load_dword v239, v238, s[48:51], 0 offen sc1
 s_waitcnt vmcnt(0)
 s_branch Lsp104
Lgo105:
 s_branch Lfb6
Lfs7:
 s_mov_b32 s63, 131072
Lsp106:
 v_cmp_gt_u32 vcc, 8, v239
 s_cbranch_vccz Lgo107
 s_sub_u32 s63, s63, 1
 s_cbranch_scc1 Lgo107
 s_sleep 1
 buffer_load_dword v239, v238, s[52:55], s72 offen sc1
 s_waitcnt vmcnt(0)
 s_branch Lsp106
Lgo107:
 s_branch Lfb8
Lvs18:
 s_mov_b32 s63, 131072
Lsp108:
 v_cmp_gt_u32 vcc, 8, v239
 s_cbranch_vccz Lgo109
 s_sub_u32 s63, s63, 1
 s_cbranch_scc1 Lgo109
 s_sleep 1
 buffer_load_dword v239, v238, s[52:55], s72 offen sc1
 s_waitcnt vmcnt(0)
 s_branch Lsp108
Lgo109:
 s_branch Lvb19
Lrps46:
 s_mov_b32 s63, 131072
Lsp110:
 v_cmp_gt_u32 vcc, 128, v239
 s_cbranch_vccz Lgo111
 s_sub_u32 s63, s63, 1
 s_cbranch_scc1 Lgo111
 s_sleep 1
 buffer_load_dword v239, v238, s[52:55], s43 offen sc1
 s_waitcnt vmcnt(0)
 s_branch Lsp110
Lgo111:
 s_branch Lrpb47
Lts63:
 s_mov_b32 s63, 131072
Lsp112:
 v_cmp_gt_u32 vcc, 32, v238
 s_cbranch_vccz Lgo113
 s_sub_u32 s63, s63, 1
 s_cbranch_scc1 Lgo113
 s_sleep 1
 buffer_load_dword v238, v239, s[52:55], s77 offen sc1
 s_waitcnt vmcnt(0)
 s_branch Lsp112
Lgo113:
 s_branch Ltb64
Lts65:
 s_mov_b32 s63, 131072
Lsp114:
 v_cmp_gt_u32 vcc, 1, v238
 s_cbranch_vccz Lgo115
 s_sub_u32 s63, s63, 1
 s_cbranch_scc1 Lgo115
 s_sleep 1
 buffer_load_dword v238, v186, s[52:55], s91 offen sc1
 s_waitcnt vmcnt(0)
 s_branch Lsp114
Lgo115:
 s_branch Ltb66
Lts85:
 s_mov_b32 s63, 131072
Lsp116:
 v_cmp_gt_u32 vcc, 14, v238
 s_cbranch_vccz Lgo117
 s_sub_u32 s63, s63, 1
 s_cbranch_scc1 Lgo117
 s_sleep 1
 buffer_load_dword v238, v239, s[52:55], s77 offen sc1
 s_waitcnt vmcnt(0)
 s_branch Lsp116
Lgo117:
 s_branch Ltb86
Lvs92:
 s_mov_b32 s63, 131072
Lsp118:
 v_cmp_gt_u32 vcc, 8, v239
 s_cbranch_vccz Lgo119
 s_sub_u32 s63, s63, 1
 s_cbranch_scc1 Lgo119
 s_sleep 1
 buffer_load_dword v239, v238, s[52:55], s72 offen sc1
 s_waitcnt vmcnt(0)
 s_branch Lsp118
Lgo119:
 s_branch Lvb93
Lrps96:
 s_mov_b32 s63, 131072
Lsp120:
 v_cmp_gt_u32 vcc, 128, v239
 s_cbranch_vccz Lgo121
 s_sub_u32 s63, s63, 1
 s_cbranch_scc1 Lgo121
 s_sleep 1
 buffer_load_dword v239, v238, s[52:55], s43 offen sc1
 s_waitcnt vmcnt(0)
 s_branch Lsp120
Lgo121:
 s_branch Lrpb97
Lrare20:
 s_getpc_b64 s[80:81]
Lpc123:
 s_add_u32 s80, s80, LfixA00122-Lpc123
 s_addc_u32 s81, s81, 0
 s_swappc_b64 s[78:79], s[80:81]
Lret124:
 s_getpc_b64 s[80:81]
Lpc126:
 s_add_u32 s80, s80, LfixA10125-Lpc126
 s_addc_u32 s81, s81, 0
 s_swappc_b64 s[78:79], s[80:81]
Lret127:
 s_getpc_b64 s[80:81]
Lpc129:
 s_add_u32 s80, s80, LfixB00128-Lpc129
 s_addc_u32 s81, s81, 0
 s_swappc_b64 s[78:79], s[80:81]
Lret130:
 s_getpc_b64 s[80:81]
Lpc132:
 s_add_u32 s80, s80, LfixB10131-Lpc132
 s_addc_u32 s81, s81, 0
 s_swappc_b64 s[78:79], s[80:81]
Lret133:
 s_cmp_lg_u32 s74, 0
 s_branch Lback21
Lrare22:
 s_getpc_b64 s[80:81]
Lpc135:
 s_add_u32 s80, s80, LfixA01134-Lpc135
 s_addc_u32 s81, s81, 0
 s_swappc_b64 s[78:79], s[80:81]
Lret136:
 s_getpc_b64 s[80:81]
Lpc138:
 s_add_u32 s80, s80, LfixA11137-Lpc138
 s_addc_u32 s81, s81, 0
 s_swappc_b64 s[78:79], s[80:81]
Lret139:
 s_getpc_b64 s[80:81]
Lpc141:
 s_add_u32 s80, s80, LfixB01140-Lpc141
 s_addc_u32 s81, s81, 0
 s_swappc_b64 s[78:79], s[80:81]
Lret142:
 s_getpc_b64 s[80:81]
Lpc144:
 s_add_u32 s80, s80, LfixB11143-Lpc144
 s_addc_u32 s81, s81, 0
 s_swappc_b64 s[78:79], s[80:81]
Lret145:
 s_cmp_lg_u32 s74, 0
 s_branch Lback23
Lrare24:
 s_getpc_b64 s[80:81]
Lpc147:
 s_add_u32 s80, s80, LfixA00122-Lpc147
 s_addc_u32 s81, s81, 0
 s_swappc_b64 s[78:79], s[80:81]
Lret148:
 s_getpc_b64 s[80:81]
Lpc150:
 s_add_u32 s80, s80, LfixA10125-Lpc150
 s_addc_u32 s81, s81, 0
 s_swappc_b64 s[78:79], s[80:81]
Lret151:
 s_getpc_b64 s[80:81]
Lpc153:
 s_add_u32 s80, s80, LfixB00128-Lpc153
 s_addc_u32 s81, s81, 0
 s_swappc_b64 s[78:79], s[80:81]
Lret154:
 s_getpc_b64 s[80:81]
Lpc156:
 s_add_u32 s80, s80, LfixB10131-Lpc156
 s_addc_u32 s81, s81, 0
 s_swappc_b64 s[78:79], s[80:81]
Lret157:
 s_cmp_lg_u32 s74, 0
 s_branch Lback25
Lrare26:
 s_getpc_b64 s[80:81]
Lpc159:
 s_add_u32 s80, s80, LfixA01134-Lpc159
 s_addc_u32 s81, s81, 0
 s_swappc_b64 s[78:79], s[80:81]
Lret160:
 s_getpc_b64 s[80:81]
Lpc162:
 s_add_u32 s80, s80, LfixA11137-Lpc162
 s_addc_u32 s81, s81, 0
 s_swappc_b64 s[78:79], s[80:81]
Lret163:
 s_getpc_b64 s[80:81]
Lpc165:
 s_add_u32 s80, s80, LfixB01140-Lpc165
 s_addc_u32 s81, s81, 0
 s_swappc_b64 s[78:79], s[80:81]
Lret166:
 s_getpc_b64 s[80:81]
Lpc168:
 s_add_u32 s80, s80, LfixB11143-Lpc168
 s_addc_u32 s81, s81, 0
 s_swappc_b64 s[78:79], s[80:81]
Lret169:
 s_cmp_lg_u32 s74, 0
 s_branch Lback27
Lrare28:
 s_getpc_b64 s[80:81]
Lpc171:
 s_add_u32 s80, s80, LfixA00122-Lpc171
 s_addc_u32 s81, s81, 0
 s_swappc_b64 s[78:79], s[80:81]
Lret172:
 s_getpc_b64 s[80:81]
Lpc174:
 s_add_u32 s80, s80, LfixA10125-Lpc174
 s_addc_u32 s81, s81, 0
 s_swappc_b64 s[78:79], s[80:81]
Lret175:
 s_getpc_b64 s[80:81]
Lpc177:
 s_add_u32 s80, s80, LfixB00128-Lpc177
 s_addc_u32 s81, s81, 0
 s_swappc_b64 s[78:79], s[80:81]
Lret178:
 s_getpc_b64 s[80:81]
Lpc180:
 s_add_u32 s80, s80, LfixB10131-Lpc180
 s_addc_u32 s81, s81, 0
 s_swappc_b64 s[78:79], s[80:81]
Lret181:
 s_cmp_lg_u32 s74, 0
 s_branch Lback29
Lrare30:
 s_getpc_b64 s[80:81]
Lpc183:
 s_add_u32 s80, s80, LfixA11137-Lpc183
 s_addc_u32 s81, s81, 0
 s_swappc_b64 s[78:79], s[80:81]
Lret184:
 s_getpc_b64 s[80:81]
Lpc186:
 s_add_u32 s80, s80, LfixB01140-Lpc186
 s_addc_u32 s81, s81, 0
 s_swappc_b64 s[78:79], s[80:81]
Lret187:
 s_getpc_b64 s[80:81]
Lpc189:
 s_add_u32 s80, s80, LfixB11143-Lpc189
 s_addc_u32 s81, s81, 0
 s_swappc_b64 s[78:79], s[80:81]
Lret190:
 s_cmp_lg_u32 s74, 0
 s_branch Lback31
Lrare32:
 s_getpc_b64 s[80:81]
Lpc192:
 s_add_u32 s80, s80, LfixB00128-Lpc192
 s_addc_u32 s81, s81, 0
 s_swappc_b64 s[78:79], s[80:81]
Lret193:
 s_getpc_b64 s[80:81]
Lpc195:
 s_add_u32 s80, s80, LfixB10131-Lpc195
 s_addc_u32 s81, s81, 0
 s_swappc_b64 s[78:79], s[80:81]
Lret196:
 s_cmp_lg_u32 s74, 0
 s_branch Lback33
Lrare37:
 s_getpc_b64 s[80:81]
Lpc198:
 s_add_u32 s80, s80, LfixB01140-Lpc198
 s_addc_u32 s81, s81, 0
 s_swappc_b64 s[78:79], s[80:81]
Lret199:
 s_getpc_b64 s[80:81]
Lpc201:
 s_add_u32 s80, s80, LfixB11143-Lpc201
 s_addc_u32 s81, s81, 0
 s_swappc_b64 s[78:79], s[80:81]
Lret202:
 s_cmp_lg_u32 s74, 0
 s_branch Lback38
Lrare39:
 s_getpc_b64 s[80:81]
Lpc204:
 s_add_u32 s80, s80, LfixB00128-Lpc204
 s_addc_u32 s81, s81, 0
 s_swappc_b64 s[78:79], s[80:81]
Lret205:
 s_getpc_b64 s[80:81]
Lpc207:
 s_add_u32 s80, s80, LfixB10131-Lpc207
 s_addc_u32 s81, s81, 0
 s_swappc_b64 s[78:79], s[80:81]
Lret208:
 s_cmp_lg_u32 s74, 0
 s_branch Lback40
Lrare42:
 s_getpc_b64 s[80:81]
Lpc210:
 s_add_u32 s80, s80, LfixB01140-Lpc210
 s_addc_u32 s81, s81, 0
 s_swappc_b64 s[78:79], s[80:81]
Lret211:
 s_getpc_b64 s[80:81]
Lpc213:
 s_add_u32 s80, s80, LfixB11143-Lpc213
 s_addc_u32 s81, s81, 0
 s_swappc_b64 s[78:79], s[80:81]
Lret214:
 s_cmp_lg_u32 s74, 0
 s_branch Lback43
Lrare44:
 s_getpc_b64 s[80:81]
Lpc216:
 s_add_u32 s80, s80, LfixB00128-Lpc216
 s_addc_u32 s81, s81, 0
 s_swappc_b64 s[78:79], s[80:81]
Lret217:
 s_getpc_b64 s[80:81]
Lpc219:
 s_add_u32 s80, s80, LfixB10131-Lpc219
 s_addc_u32 s81, s81, 0
 s_swappc_b64 s[78:79], s[80:81]
Lret220:
 s_cmp_lg_u32 s74, 0
 s_branch Lback45
Lrare48:
 s_getpc_b64 s[80:81]
Lpc222:
 s_add_u32 s80, s80, LfixB01140-Lpc222
 s_addc_u32 s81, s81, 0
 s_swappc_b64 s[78:79], s[80:81]
Lret223:
 s_getpc_b64 s[80:81]
Lpc225:
 s_add_u32 s80, s80, LfixB11143-Lpc225
 s_addc_u32 s81, s81, 0
 s_swappc_b64 s[78:79], s[80:81]
Lret226:
 s_cmp_lg_u32 s74, 0
 s_branch Lback49
Lrare50:
 s_getpc_b64 s[80:81]
Lpc228:
 s_add_u32 s80, s80, LfixB00128-Lpc228
 s_addc_u32 s81, s81, 0
 s_swappc_b64 s[78:79], s[80:81]
Lret229:
 s_getpc_b64 s[80:81]
Lpc231:
 s_add_u32 s80, s80, LfixB10131-Lpc231
 s_addc_u32 s81, s81, 0
 s_swappc_b64 s[78:79], s[80:81]
Lret232:
 s_cmp_lg_u32 s74, 0
 s_branch Lback51
Lrare52:
 s_getpc_b64 s[80:81]
Lpc234:
 s_add_u32 s80, s80, LfixB01140-Lpc234
 s_addc_u32 s81, s81, 0
 s_swappc_b64 s[78:79], s[80:81]
Lret235:
 s_getpc_b64 s[80:81]
Lpc237:
 s_add_u32 s80, s80, LfixB11143-Lpc237
 s_addc_u32 s81, s81, 0
 s_swappc_b64 s[78:79], s[80:81]
Lret238:
 s_cmp_lg_u32 s74, 0
 s_branch Lback53
Lrare54:
 s_getpc_b64 s[80:81]
Lpc240:
 s_add_u32 s80, s80, LfixB00128-Lpc240
 s_addc_u32 s81, s81, 0
 s_swappc_b64 s[78:79], s[80:81]
Lret241:
 s_getpc_b64 s[80:81]
Lpc243:
 s_add_u32 s80, s80, LfixB10131-Lpc243
 s_addc_u32 s81, s81, 0
 s_swappc_b64 s[78:79], s[80:81]
Lret244:
 s_cmp_lg_u32 s74, 0
 s_branch Lback55
Lrare56:
 s_getpc_b64 s[80:81]
Lpc246:
 s_add_u32 s80, s80, LfixB11143-Lpc246
 s_addc_u32 s81, s81, 0
 s_swappc_b64 s[78:79], s[80:81]
Lret247:
 s_cmp_lg_u32 s74, 0
 s_branch Lback57
Lrare94:
 s_getpc_b64 s[80:81]
Lpc249:
 s_add_u32 s80, s80, LfixA00122-Lpc249
 s_addc_u32 s81, s81, 0
 s_swappc_b64 s[78:79], s[80:81]
Lret250:
 s_getpc_b64 s[80:81]
Lpc252:
 s_add_u32 s80, s80, LfixA10125-Lpc252
 s_addc_u32 s81, s81, 0
 s_swappc_b64 s[78:79], s[80:81]
Lret253:
 s_getpc_b64 s[80:81]
Lpc255:
 s_add_u32 s80, s80, LfixB00128-Lpc255
 s_addc_u32 s81, s81, 0
 s_swappc_b64 s[78:79], s[80:81]
Lret256:
 s_getpc_b64 s[80:81]
Lpc258:
 s_add_u32 s80, s80, LfixB10131-Lpc258
 s_addc_u32 s81, s81, 0
 s_swappc_b64 s[78:79], s[80:81]
Lret259:
 s_cmp_lg_u32 s74, 0
 s_branch Lback95
Lrare98:
 s_getpc_b64 s[80:81]
Lpc261:
 s_add_u32 s80, s80, LfixA11137-Lpc261
 s_addc_u32 s81, s81, 0
 s_swappc_b64 s[78:79], s[80:81]
Lret262:
 s_getpc_b64 s[80:81]
Lpc264:
 s_add_u32 s80, s80, LfixB01140-Lpc264
 s_addc_u32 s81, s81, 0
 s_swappc_b64 s[78:79], s[80:81]
Lret265:
 s_getpc_b64 s[80:81]
Lpc267:
 s_add_u32 s80, s80, LfixB11143-Lpc267
 s_addc_u32 s81, s81, 0
 s_swappc_b64 s[78:79], s[80:81]
Lret268:
 s_cmp_lg_u32 s74, 0
 s_branch Lback99
Lrare100:
 s_getpc_b64 s[80:81]
Lpc270:
 s_add_u32 s80, s80, LfixB00128-Lpc270
 s_addc_u32 s81, s81, 0
 s_swappc_b64 s[78:79], s[80:81]
Lret271:
 s_getpc_b64 s[80:81]
Lpc273:
 s_add_u32 s80, s80, LfixB10131-Lpc273
 s_addc_u32 s81, s81, 0
 s_swappc_b64 s[78:79], s[80:81]
Lret274:
 s_cmp_lg_u32 s74, 0
 s_branch Lback101
LfixA00122:
 s_nop 7
 v_max3_f32 v250, v64, v65, v66
 v_max3_f32 v250, v250, v67, v68
 v_max3_f32 v250, v250, v69, v70
 v_max3_f32 v250, v250, v71, v80
 v_max3_f32 v250, v250, v81, v82
 v_max3_f32 v250, v250, v83, v84
 v_max3_f32 v250, v250, v85, v86
 v_max_f32 v250, v250, v87
 v_mov_b32 v249, v250
 s_nop 1
 v_permlane16_swap_b32 v249, v250
 v_max_f32 v250, v250, v249
 v_mov_b32 v249, v250
 s_nop 1
 v_permlane32_swap_b32 v249, v250
 v_max_f32 v250, v250, v249
 v_max_f32 v250, 0, v250
 v_sub_f32 v248, 0, v250
 v_exp_f32 v248, v248
 v_sub_f32 v176, v176, v250
 v_sub_f32 v177, v177, v250
 v_sub_f32 v178, v178, v250
 v_sub_f32 v179, v179, v250
 v_sub_f32 v64, v64, v250
 v_sub_f32 v96, v96, v250
 v_sub_f32 v65, v65, v250
 v_sub_f32 v97, v97, v250
 v_sub_f32 v66, v66, v250
 v_sub_f32 v98, v98, v250
 v_sub_f32 v67, v67, v250
 v_sub_f32 v99, v99, v250
 v_sub_f32 v68, v68, v250
 v_sub_f32 v100, v100, v250
 v_sub_f32 v69, v69, v250
 v_sub_f32 v101, v101, v250
 v_sub_f32 v70, v70, v250
 v_sub_f32 v102, v102, v250
 v_sub_f32 v71, v71, v250
 v_sub_f32 v103, v103, v250
 v_sub_f32 v80, v80, v250
 v_sub_f32 v112, v112, v250
 v_sub_f32 v81, v81, v250
 v_sub_f32 v113, v113, v250
 v_sub_f32 v82, v82, v250
 v_sub_f32 v114, v114, v250
 v_sub_f32 v83, v83, v250
 v_sub_f32 v115, v115, v250
 v_sub_f32 v84, v84, v250
 v_sub_f32 v116, v116, v250
 v_sub_f32 v85, v85, v250
 v_sub_f32 v117, v117, v250
 v_sub_f32 v86, v86, v250
 v_sub_f32 v118, v118, v250
 v_sub_f32 v87, v87, v250
 v_sub_f32 v119, v119, v250
 v_mul_f32 v214, v214, v248
 v_accvgpr_read_b32 v184, a0
 v_mul_f32 v184, v184, v248
 v_accvgpr_write_b32 a0, v184
 v_accvgpr_read_b32 v184, a1
 v_mul_f32 v184, v184, v248
 v_accvgpr_write_b32 a1, v184
 v_accvgpr_read_b32 v184, a2
 v_mul_f32 v184, v184, v248
 v_accvgpr_write_b32 a2, v184
 v_accvgpr_read_b32 v184, a3
 v_mul_f32 v184, v184, v248
 v_accvgpr_write_b32 a3, v184
 v_accvgpr_read_b32 v184, a8
 v_mul_f32 v184, v184, v248
 v_accvgpr_write_b32 a8, v184
 v_accvgpr_read_b32 v184, a9
 v_mul_f32 v184, v184, v248
 v_accvgpr_write_b32 a9, v184
 v_accvgpr_read_b32 v184, a10
 v_mul_f32 v184, v184, v248
 v_accvgpr_write_b32 a10, v184
 v_accvgpr_read_b32 v184, a11
 v_mul_f32 v184, v184, v248
 v_accvgpr_write_b32 a11, v184
 v_accvgpr_read_b32 v184, a16
 v_mul_f32 v184, v184, v248
 v_accvgpr_write_b32 a16, v184
 v_accvgpr_read_b32 v184, a17
 v_mul_f32 v184, v184, v248
 v_accvgpr_write_b32 a17, v184
 v_accvgpr_read_b32 v184, a18
 v_mul_f32 v184, v184, v248
 v_accvgpr_write_b32 a18, v184
 v_accvgpr_read_b32 v184, a19
 v_mul_f32 v184, v184, v248
 v_accvgpr_write_b32 a19, v184
 v_accvgpr_read_b32 v184, a24
 v_mul_f32 v184, v184, v248
 v_accvgpr_write_b32 a24, v184
 v_accvgpr_read_b32 v184, a25
 v_mul_f32 v184, v184, v248
 v_accvgpr_write_b32 a25, v184
 v_accvgpr_read_b32 v184, a26
 v_mul_f32 v184, v184, v248
 v_accvgpr_write_b32 a26, v184
 v_accvgpr_read_b32 v184, a27
 v_mul_f32 v184, v184, v248
 v_accvgpr_write_b32 a27, v184
 v_accvgpr_read_b32 v184, a32
 v_mul_f32 v184, v184, v248
 v_accvgpr_write_b32 a32, v184
 v_accvgpr_read_b32 v184, a33
 v_mul_f32 v184, v184, v248
 v_accvgpr_write_b32 a33, v184
 v_accvgpr_read_b32 v184, a34
 v_mul_f32 v184, v184, v248
 v_accvgpr_write_b32 a34, v184
 v_accvgpr_read_b32 v184, a35
 v_mul_f32 v184, v184, v248
 v_accvgpr_write_b32 a35, v184
 v_accvgpr_read_b32 v184, a40
 v_mul_f32 v184, v184, v248
 v_accvgpr_write_b32 a40, v184
 v_accvgpr_read_b32 v184, a41
 v_mul_f32 v184, v184, v248
 v_accvgpr_write_b32 a41, v184
 v_accvgpr_read_b32 v184, a42
 v_mul_f32 v184, v184, v248
 v_accvgpr_write_b32 a42, v184
 v_accvgpr_read_b32 v184, a43
 v_mul_f32 v184, v184, v248
 v_accvgpr_write_b32 a43, v184
 v_accvgpr_read_b32 v184, a48
 v_mul_f32 v184, v184, v248
 v_accvgpr_write_b32 a48, v184
 v_accvgpr_read_b32 v184, a49
 v_mul_f32 v184, v184, v248
 v_accvgpr_write_b32 a49, v184
 v_accvgpr_read_b32 v184, a50
 v_mul_f32 v184, v184, v248
 v_accvgpr_write_b32 a50, v184
 v_accvgpr_read_b32 v184, a51
 v_mul_f32 v184, v184, v248
 v_accvgpr_write_b32 a51, v184
 v_accvgpr_read_b32 v184, a56
 v_mul_f32 v184, v184, v248
 v_accvgpr_write_b32 a56, v184
 v_accvgpr_read_b32 v184, a57
 v_mul_f32 v184, v184, v248
 v_accvgpr_write_b32 a57, v184
 v_accvgpr_read_b32 v184, a58
 v_mul_f32 v184, v184, v248
 v_accvgpr_write_b32 a58, v184
 v_accvgpr_read_b32 v184, a59
 v_mul_f32 v184, v184, v248
 v_accvgpr_write_b32 a59, v184
 v_exp_f32 v184, v64
 v_exp_f32 v185, v65
 v_exp_f32 v186, v66
 v_cvt_pk_bf16_f32 v152, v184, v185
 v_exp_f32 v187, v67
 v_exp_f32 v188, v68
 v_cvt_pk_bf16_f32 v153, v186, v187
 v_exp_f32 v189, v69
 v_exp_f32 v190, v70
 v_cvt_pk_bf16_f32 v154, v188, v189
 v_exp_f32 v191, v71
 v_exp_f32 v184, v80
 v_cvt_pk_bf16_f32 v155, v190, v191
 v_exp_f32 v185, v81
 s_nop 0
 v_mfma_f32_16x16x32_bf16 v[200:203], v[208:211], v[152:155], 0
 v_exp_f32 v186, v82
 v_cvt_pk_bf16_f32 v160, v184, v185
 v_exp_f32 v187, v83
 v_exp_f32 v188, v84
 v_cvt_pk_bf16_f32 v161, v186, v187
 v_exp_f32 v189, v85
 v_exp_f32 v190, v86
 v_cvt_pk_bf16_f32 v162, v188, v189
 v_exp_f32 v191, v87
 s_nop 0
 v_cvt_pk_bf16_f32 v163, v190, v191
 s_nop 1
 v_mfma_f32_16x16x32_bf16 v[200:203], v[208:211], v[160:163], v[200:203]
 s_nop 7
 s_setpc_b64 s[78:79]
LfixA10125:
 s_nop 7
 v_max3_f32 v250, v72, v73, v74
 v_max3_f32 v250, v250, v75, v76
 v_max3_f32 v250, v250, v77, v78
 v_max3_f32 v250, v250, v79, v88
 v_max3_f32 v250, v250, v89, v90
 v_max3_f32 v250, v250, v91, v92
 v_max3_f32 v250, v250, v93, v94
 v_max_f32 v250, v250, v95
 v_mov_b32 v249, v250
 s_nop 1
 v_permlane16_swap_b32 v249, v250
 v_max_f32 v250, v250, v249
 v_mov_b32 v249, v250
 s_nop 1
 v_permlane32_swap_b32 v249, v250
 v_max_f32 v250, v250, v249
 v_max_f32 v250, 0, v250
 v_sub_f32 v248, 0, v250
 v_exp_f32 v248, v248
 v_sub_f32 v180, v180, v250
 v_sub_f32 v181, v181, v250
 v_sub_f32 v182, v182, v250
 v_sub_f32 v183, v183, v250
 v_sub_f32 v72, v72, v250
 v_sub_f32 v104, v104, v250
 v_sub_f32 v73, v73, v250
 v_sub_f32 v105, v105, v250
 v_sub_f32 v74, v74, v250
 v_sub_f32 v106, v106, v250
 v_sub_f32 v75, v75, v250
 v_sub_f32 v107, v107, v250
 v_sub_f32 v76, v76, v250
 v_sub_f32 v108, v108, v250
 v_sub_f32 v77, v77, v250
 v_sub_f32 v109, v109, v250
 v_sub_f32 v78, v78, v250
 v_sub_f32 v110, v110, v250
 v_sub_f32 v79, v79, v250
 v_sub_f32 v111, v111, v250
 v_sub_f32 v88, v88, v250
 v_sub_f32 v120, v120, v250
 v_sub_f32 v89, v89, v250
 v_sub_f32 v121, v121, v250
 v_sub_f32 v90, v90, v250
 v_sub_f32 v122, v122, v250
 v_sub_f32 v91, v91, v250
 v_sub_f32 v123, v123, v250
 v_sub_f32 v92, v92, v250
 v_sub_f32 v124, v124, v250
 v_sub_f32 v93, v93, v250
 v_sub_f32 v125, v125, v250
 v_sub_f32 v94, v94, v250
 v_sub_f32 v126, v126, v250
 v_sub_f32 v95, v95, v250
 v_sub_f32 v127, v127, v250
 v_mul_f32 v215, v215, v248
 v_accvgpr_read_b32 v184, a4
 v_mul_f32 v184, v184, v248
 v_accvgpr_write_b32 a4, v184
 v_accvgpr_read_b32 v184, a5
 v_mul_f32 v184, v184, v248
 v_accvgpr_write_b32 a5, v184
 v_accvgpr_read_b32 v184, a6
 v_mul_f32 v184, v184, v248
 v_accvgpr_write_b32 a6, v184
 v_accvgpr_read_b32 v184, a7
 v_mul_f32 v184, v184, v248
 v_accvgpr_write_b32 a7, v184
 v_accvgpr_read_b32 v184, a12
 v_mul_f32 v184, v184, v248
 v_accvgpr_write_b32 a12, v184
 v_accvgpr_read_b32 v184, a13
 v_mul_f32 v184, v184, v248
 v_accvgpr_write_b32 a13, v184
 v_accvgpr_read_b32 v184, a14
 v_mul_f32 v184, v184, v248
 v_accvgpr_write_b32 a14, v184
 v_accvgpr_read_b32 v184, a15
 v_mul_f32 v184, v184, v248
 v_accvgpr_write_b32 a15, v184
 v_accvgpr_read_b32 v184, a20
 v_mul_f32 v184, v184, v248
 v_accvgpr_write_b32 a20, v184
 v_accvgpr_read_b32 v184, a21
 v_mul_f32 v184, v184, v248
 v_accvgpr_write_b32 a21, v184
 v_accvgpr_read_b32 v184, a22
 v_mul_f32 v184, v184, v248
 v_accvgpr_write_b32 a22, v184
 v_accvgpr_read_b32 v184, a23
 v_mul_f32 v184, v184, v248
 v_accvgpr_write_b32 a23, v184
 v_accvgpr_read_b32 v184, a28
 v_mul_f32 v184, v184, v248
 v_accvgpr_write_b32 a28, v184
 v_accvgpr_read_b32 v184, a29
 v_mul_f32 v184, v184, v248
 v_accvgpr_write_b32 a29, v184
 v_accvgpr_read_b32 v184, a30
 v_mul_f32 v184, v184, v248
 v_accvgpr_write_b32 a30, v184
 v_accvgpr_read_b32 v184, a31
 v_mul_f32 v184, v184, v248
 v_accvgpr_write_b32 a31, v184
 v_accvgpr_read_b32 v184, a36
 v_mul_f32 v184, v184, v248
 v_accvgpr_write_b32 a36, v184
 v_accvgpr_read_b32 v184, a37
 v_mul_f32 v184, v184, v248
 v_accvgpr_write_b32 a37, v184
 v_accvgpr_read_b32 v184, a38
 v_mul_f32 v184, v184, v248
 v_accvgpr_write_b32 a38, v184
 v_accvgpr_read_b32 v184, a39
 v_mul_f32 v184, v184, v248
 v_accvgpr_write_b32 a39, v184
 v_accvgpr_read_b32 v184, a44
 v_mul_f32 v184, v184, v248
 v_accvgpr_write_b32 a44, v184
 v_accvgpr_read_b32 v184, a45
 v_mul_f32 v184, v184, v248
 v_accvgpr_write_b32 a45, v184
 v_accvgpr_read_b32 v184, a46
 v_mul_f32 v184, v184, v248
 v_accvgpr_write_b32 a46, v184
 v_accvgpr_read_b32 v184, a47
 v_mul_f32 v184, v184, v248
 v_accvgpr_write_b32 a47, v184
 v_accvgpr_read_b32 v184, a52
 v_mul_f32 v184, v184, v248
 v_accvgpr_write_b32 a52, v184
 v_accvgpr_read_b32 v184, a53
 v_mul_f32 v184, v184, v248
 v_accvgpr_write_b32 a53, v184
 v_accvgpr_read_b32 v184, a54
 v_mul_f32 v184, v184, v248
 v_accvgpr_write_b32 a54, v184
 v_accvgpr_read_b32 v184, a55
 v_mul_f32 v184, v184, v248
 v_accvgpr_write_b32 a55, v184
 v_accvgpr_read_b32 v184, a60
 v_mul_f32 v184, v184, v248
 v_accvgpr_write_b32 a60, v184
 v_accvgpr_read_b32 v184, a61
 v_mul_f32 v184, v184, v248
 v_accvgpr_write_b32 a61, v184
 v_accvgpr_read_b32 v184, a62
 v_mul_f32 v184, v184, v248
 v_accvgpr_write_b32 a62, v184
 v_accvgpr_read_b32 v184, a63
 v_mul_f32 v184, v184, v248
 v_accvgpr_write_b32 a63, v184
 v_exp_f32 v184, v72
 v_exp_f32 v185, v73
 v_exp_f32 v186, v74
 v_cvt_pk_bf16_f32 v156, v184, v185
 v_exp_f32 v187, v75
 v_exp_f32 v188, v76
 v_cvt_pk_bf16_f32 v157, v186, v187
 v_exp_f32 v189, v77
 v_exp_f32 v190, v78
 v_cvt_pk_bf16_f32 v158, v188, v189
 v_exp_f32 v191, v79
 v_exp_f32 v184, v88
 v_cvt_pk_bf16_f32 v159, v190, v191
 v_exp_f32 v185, v89
 s_nop 0
 v_mfma_f32_16x16x32_bf16 v[204:207], v[208:211], v[156:159], 0
 v_exp_f32 v186, v90
 v_cvt_pk_bf16_f32 v164, v184, v185
 v_exp_f32 v187, v91
 v_exp_f32 v188, v92
 v_cvt_pk_bf16_f32 v165, v186, v187
 v_exp_f32 v189, v93
 v_exp_f32 v190, v94
 v_cvt_pk_bf16_f32 v166, v188, v189
 v_exp_f32 v191, v95
 s_nop 0
 v_cvt_pk_bf16_f32 v167, v190, v191
 s_nop 1
 v_mfma_f32_16x16x32_bf16 v[204:207], v[208:211], v[164:167], v[204:207]
 s_nop 7
 s_setpc_b64 s[78:79]
LfixB00128:
 s_nop 7
 v_max3_f32 v250, v0, v1, v2
 v_max3_f32 v250, v250, v3, v4
 v_max3_f32 v250, v250, v5, v6
 v_max3_f32 v250, v250, v7, v16
 v_max3_f32 v250, v250, v17, v18
 v_max3_f32 v250, v250, v19, v20
 v_max3_f32 v250, v250, v21, v22
 v_max_f32 v250, v250, v23
 v_mov_b32 v249, v250
 s_nop 1
 v_permlane16_swap_b32 v249, v250
 v_max_f32 v250, v250, v249
 v_mov_b32 v249, v250
 s_nop 1
 v_permlane32_swap_b32 v249, v250
 v_max_f32 v250, v250, v249
 v_max_f32 v250, 0, v250
 v_sub_f32 v248, 0, v250
 v_exp_f32 v248, v248
 v_sub_f32 v168, v168, v250
 v_sub_f32 v169, v169, v250
 v_sub_f32 v170, v170, v250
 v_sub_f32 v171, v171, v250
 v_sub_f32 v0, v0, v250
 v_sub_f32 v32, v32, v250
 v_sub_f32 v1, v1, v250
 v_sub_f32 v33, v33, v250
 v_sub_f32 v2, v2, v250
 v_sub_f32 v34, v34, v250
 v_sub_f32 v3, v3, v250
 v_sub_f32 v35, v35, v250
 v_sub_f32 v4, v4, v250
 v_sub_f32 v36, v36, v250
 v_sub_f32 v5, v5, v250
 v_sub_f32 v37, v37, v250
 v_sub_f32 v6, v6, v250
 v_sub_f32 v38, v38, v250
 v_sub_f32 v7, v7, v250
 v_sub_f32 v39, v39, v250
 v_sub_f32 v16, v16, v250
 v_sub_f32 v48, v48, v250
 v_sub_f32 v17, v17, v250
 v_sub_f32 v49, v49, v250
 v_sub_f32 v18, v18, v250
 v_sub_f32 v50, v50, v250
 v_sub_f32 v19, v19, v250
 v_sub_f32 v51, v51, v250
 v_sub_f32 v20, v20, v250
 v_sub_f32 v52, v52, v250
 v_sub_f32 v21, v21, v250
 v_sub_f32 v53, v53, v250
 v_sub_f32 v22, v22, v250
 v_sub_f32 v54, v54, v250
 v_sub_f32 v23, v23, v250
 v_sub_f32 v55, v55, v250
 v_mul_f32 v212, v212, v248
 v_accvgpr_read_b32 v184, a64
 v_mul_f32 v184, v184, v248
 v_accvgpr_write_b32 a64, v184
 v_accvgpr_read_b32 v184, a65
 v_mul_f32 v184, v184, v248
 v_accvgpr_write_b32 a65, v184
 v_accvgpr_read_b32 v184, a66
 v_mul_f32 v184, v184, v248
 v_accvgpr_write_b32 a66, v184
 v_accvgpr_read_b32 v184, a67
 v_mul_f32 v184, v184, v248
 v_accvgpr_write_b32 a67, v184
 v_accvgpr_read_b32 v184, a72
 v_mul_f32 v184, v184, v248
 v_accvgpr_write_b32 a72, v184
 v_accvgpr_read_b32 v184, a73
 v_mul_f32 v184, v184, v248
 v_accvgpr_write_b32 a73, v184
 v_accvgpr_read_b32 v184, a74
 v_mul_f32 v184, v184, v248
 v_accvgpr_write_b32 a74, v184
 v_accvgpr_read_b32 v184, a75
 v_mul_f32 v184, v184, v248
 v_accvgpr_write_b32 a75, v184
 v_accvgpr_read_b32 v184, a80
 v_mul_f32 v184, v184, v248
 v_accvgpr_write_b32 a80, v184
 v_accvgpr_read_b32 v184, a81
 v_mul_f32 v184, v184, v248
 v_accvgpr_write_b32 a81, v184
 v_accvgpr_read_b32 v184, a82
 v_mul_f32 v184, v184, v248
 v_accvgpr_write_b32 a82, v184
 v_accvgpr_read_b32 v184, a83
 v_mul_f32 v184, v184, v248
 v_accvgpr_write_b32 a83, v184
 v_accvgpr_read_b32 v184, a88
 v_mul_f32 v184, v184, v248
 v_accvgpr_write_b32 a88, v184
 v_accvgpr_read_b32 v184, a89
 v_mul_f32 v184, v184, v248
 v_accvgpr_write_b32 a89, v184
 v_accvgpr_read_b32 v184, a90
 v_mul_f32 v184, v184, v248
 v_accvgpr_write_b32 a90, v184
 v_accvgpr_read_b32 v184, a91
 v_mul_f32 v184, v184, v248
 v_accvgpr_write_b32 a91, v184
 v_accvgpr_read_b32 v184, a96
 v_mul_f32 v184, v184, v248
 v_accvgpr_write_b32 a96, v184
 v_accvgpr_read_b32 v184, a97
 v_mul_f32 v184, v184, v248
 v_accvgpr_write_b32 a97, v184
 v_accvgpr_read_b32 v184, a98
 v_mul_f32 v184, v184, v248
 v_accvgpr_write_b32 a98, v184
 v_accvgpr_read_b32 v184, a99
 v_mul_f32 v184, v184, v248
 v_accvgpr_write_b32 a99, v184
 v_accvgpr_read_b32 v184, a104
 v_mul_f32 v184, v184, v248
 v_accvgpr_write_b32 a104, v184
 v_accvgpr_read_b32 v184, a105
 v_mul_f32 v184, v184, v248
 v_accvgpr_write_b32 a105, v184
 v_accvgpr_read_b32 v184, a106
 v_mul_f32 v184, v184, v248
 v_accvgpr_write_b32 a106, v184
 v_accvgpr_read_b32 v184, a107
 v_mul_f32 v184, v184, v248
 v_accvgpr_write_b32 a107, v184
 v_accvgpr_read_b32 v184, a112
 v_mul_f32 v184, v184, v248
 v_accvgpr_write_b32 a112, v184
 v_accvgpr_read_b32 v184, a113
 v_mul_f32 v184, v184, v248
 v_accvgpr_write_b32 a113, v184
 v_accvgpr_read_b32 v184, a114
 v_mul_f32 v184, v184, v248
 v_accvgpr_write_b32 a114, v184
 v_accvgpr_read_b32 v184, a115
 v_mul_f32 v184, v184, v248
 v_accvgpr_write_b32 a115, v184
 v_accvgpr_read_b32 v184, a120
 v_mul_f32 v184, v184, v248
 v_accvgpr_write_b32 a120, v184
 v_accvgpr_read_b32 v184, a121
 v_mul_f32 v184, v184, v248
 v_accvgpr_write_b32 a121, v184
 v_accvgpr_read_b32 v184, a122
 v_mul_f32 v184, v184, v248
 v_accvgpr_write_b32 a122, v184
 v_accvgpr_read_b32 v184, a123
 v_mul_f32 v184, v184, v248
 v_accvgpr_write_b32 a123, v184
 v_exp_f32 v184, v0
 v_exp_f32 v185, v1
 v_exp_f32 v186, v2
 v_cvt_pk_bf16_f32 v128, v184, v185
 v_exp_f32 v187, v3
 v_exp_f32 v188, v4
 v_cvt_pk_bf16_f32 v129, v186, v187
 v_exp_f32 v189, v5
 v_exp_f32 v190, v6
 v_cvt_pk_bf16_f32 v130, v188, v189
 v_exp_f32 v191, v7
 v_exp_f32 v184, v16
 v_cvt_pk_bf16_f32 v131, v190, v191
 v_exp_f32 v185, v17
 s_nop 0
 v_mfma_f32_16x16x32_bf16 v[192:195], v[208:211], v[128:131], 0
 v_exp_f32 v186, v18
 v_cvt_pk_bf16_f32 v144, v184, v185
 v_exp_f32 v187, v19
 v_exp_f32 v188, v20
 v_cvt_pk_bf16_f32 v145, v186, v187
 v_exp_f32 v189, v21
 v_exp_f32 v190, v22
 v_cvt_pk_bf16_f32 v146, v188, v189
 v_exp_f32 v191, v23
 s_nop 0
 v_cvt_pk_bf16_f32 v147, v190, v191
 s_nop 1
 v_mfma_f32_16x16x32_bf16 v[192:195], v[208:211], v[144:147], v[192:195]
 s_nop 7
 s_setpc_b64 s[78:79]
LfixB10131:
 s_nop 7
 v_max3_f32 v250, v8, v9, v10
 v_max3_f32 v250, v250, v11, v12
 v_max3_f32 v250, v250, v13, v14
 v_max3_f32 v250, v250, v15, v24
 v_max3_f32 v250, v250, v25, v26
 v_max3_f32 v250, v250, v27, v28
 v_max3_f32 v250, v250, v29, v30
 v_max_f32 v250, v250, v31
 v_mov_b32 v249, v250
 s_nop 1
 v_permlane16_swap_b32 v249, v250
 v_max_f32 v250, v250, v249
 v_mov_b32 v249, v250
 s_nop 1
 v_permlane32_swap_b32 v249, v250
 v_max_f32 v250, v250, v249
 v_max_f32 v250, 0, v250
 v_sub_f32 v248, 0, v250
 v_exp_f32 v248, v248
 v_sub_f32 v172, v172, v250
 v_sub_f32 v173, v173, v250
 v_sub_f32 v174, v174, v250
 v_sub_f32 v175, v175, v250
 v_sub_f32 v8, v8, v250
 v_sub_f32 v40, v40, v250
 v_sub_f32 v9, v9, v250
 v_sub_f32 v41, v41, v250
 v_sub_f32 v10, v10, v250
 v_sub_f32 v42, v42, v250
 v_sub_f32 v11, v11, v250
 v_sub_f32 v43, v43, v250
 v_sub_f32 v12, v12, v250
 v_sub_f32 v44, v44, v250
 v_sub_f32 v13, v13, v250
 v_sub_f32 v45, v45, v250
 v_sub_f32 v14, v14, v250
 v_sub_f32 v46, v46, v250
 v_sub_f32 v15, v15, v250
 v_sub_f32 v47, v47, v250
 v_sub_f32 v24, v24, v250
 v_sub_f32 v56, v56, v250
 v_sub_f32 v25, v25, v250
 v_sub_f32 v57, v57, v250
 v_sub_f32 v26, v26, v250
 v_sub_f32 v58, v58, v250
 v_sub_f32 v27, v27, v250
 v_sub_f32 v59, v59, v250
 v_sub_f32 v28, v28, v250
 v_sub_f32 v60, v60, v250
 v_sub_f32 v29, v29, v250
 v_sub_f32 v61, v61, v250
 v_sub_f32 v30, v30, v250
 v_sub_f32 v62, v62, v250
 v_sub_f32 v31, v31, v250
 v_sub_f32 v63, v63, v250
 v_mul_f32 v213, v213, v248
 v_accvgpr_read_b32 v184, a68
 v_mul_f32 v184, v184, v248
 v_accvgpr_write_b32 a68, v184
 v_accvgpr_read_b32 v184, a69
 v_mul_f32 v184, v184, v248
 v_accvgpr_write_b32 a69, v184
 v_accvgpr_read_b32 v184, a70
 v_mul_f32 v184, v184, v248
 v_accvgpr_write_b32 a70, v184
 v_accvgpr_read_b32 v184, a71
 v_mul_f32 v184, v184, v248
 v_accvgpr_write_b32 a71, v184
 v_accvgpr_read_b32 v184, a76
 v_mul_f32 v184, v184, v248
 v_accvgpr_write_b32 a76, v184
 v_accvgpr_read_b32 v184, a77
 v_mul_f32 v184, v184, v248
 v_accvgpr_write_b32 a77, v184
 v_accvgpr_read_b32 v184, a78
 v_mul_f32 v184, v184, v248
 v_accvgpr_write_b32 a78, v184
 v_accvgpr_read_b32 v184, a79
 v_mul_f32 v184, v184, v248
 v_accvgpr_write_b32 a79, v184
 v_accvgpr_read_b32 v184, a84
 v_mul_f32 v184, v184, v248
 v_accvgpr_write_b32 a84, v184
 v_accvgpr_read_b32 v184, a85
 v_mul_f32 v184, v184, v248
 v_accvgpr_write_b32 a85, v184
 v_accvgpr_read_b32 v184, a86
 v_mul_f32 v184, v184, v248
 v_accvgpr_write_b32 a86, v184
 v_accvgpr_read_b32 v184, a87
 v_mul_f32 v184, v184, v248
 v_accvgpr_write_b32 a87, v184
 v_accvgpr_read_b32 v184, a92
 v_mul_f32 v184, v184, v248
 v_accvgpr_write_b32 a92, v184
 v_accvgpr_read_b32 v184, a93
 v_mul_f32 v184, v184, v248
 v_accvgpr_write_b32 a93, v184
 v_accvgpr_read_b32 v184, a94
 v_mul_f32 v184, v184, v248
 v_accvgpr_write_b32 a94, v184
 v_accvgpr_read_b32 v184, a95
 v_mul_f32 v184, v184, v248
 v_accvgpr_write_b32 a95, v184
 v_accvgpr_read_b32 v184, a100
 v_mul_f32 v184, v184, v248
 v_accvgpr_write_b32 a100, v184
 v_accvgpr_read_b32 v184, a101
 v_mul_f32 v184, v184, v248
 v_accvgpr_write_b32 a101, v184
 v_accvgpr_read_b32 v184, a102
 v_mul_f32 v184, v184, v248
 v_accvgpr_write_b32 a102, v184
 v_accvgpr_read_b32 v184, a103
 v_mul_f32 v184, v184, v248
 v_accvgpr_write_b32 a103, v184
 v_accvgpr_read_b32 v184, a108
 v_mul_f32 v184, v184, v248
 v_accvgpr_write_b32 a108, v184
 v_accvgpr_read_b32 v184, a109
 v_mul_f32 v184, v184, v248
 v_accvgpr_write_b32 a109, v184
 v_accvgpr_read_b32 v184, a110
 v_mul_f32 v184, v184, v248
 v_accvgpr_write_b32 a110, v184
 v_accvgpr_read_b32 v184, a111
 v_mul_f32 v184, v184, v248
 v_accvgpr_write_b32 a111, v184
 v_accvgpr_read_b32 v184, a116
 v_mul_f32 v184, v184, v248
 v_accvgpr_write_b32 a116, v184
 v_accvgpr_read_b32 v184, a117
 v_mul_f32 v184, v184, v248
 v_accvgpr_write_b32 a117, v184
 v_accvgpr_read_b32 v184, a118
 v_mul_f32 v184, v184, v248
 v_accvgpr_write_b32 a118, v184
 v_accvgpr_read_b32 v184, a119
 v_mul_f32 v184, v184, v248
 v_accvgpr_write_b32 a119, v184
 v_accvgpr_read_b32 v184, a124
 v_mul_f32 v184, v184, v248
 v_accvgpr_write_b32 a124, v184
 v_accvgpr_read_b32 v184, a125
 v_mul_f32 v184, v184, v248
 v_accvgpr_write_b32 a125, v184
 v_accvgpr_read_b32 v184, a126
 v_mul_f32 v184, v184, v248
 v_accvgpr_write_b32 a126, v184
 v_accvgpr_read_b32 v184, a127
 v_mul_f32 v184, v184, v248
 v_accvgpr_write_b32 a127, v184
 v_exp_f32 v184, v8
 v_exp_f32 v185, v9
 v_exp_f32 v186, v10
 v_cvt_pk_bf16_f32 v132, v184, v185
 v_exp_f32 v187, v11
 v_exp_f32 v188, v12
 v_cvt_pk_bf16_f32 v133, v186, v187
 v_exp_f32 v189, v13
 v_exp_f32 v190, v14
 v_cvt_pk_bf16_f32 v134, v188, v189
 v_exp_f32 v191, v15
 v_exp_f32 v184, v24
 v_cvt_pk_bf16_f32 v135, v190, v191
 v_exp_f32 v185, v25
 s_nop 0
 v_mfma_f32_16x16x32_bf16 v[196:199], v[208:211], v[132:135], 0
 v_exp_f32 v186, v26
 v_cvt_pk_bf16_f32 v148, v184, v185
 v_exp_f32 v187, v27
 v_exp_f32 v188, v28
 v_cvt_pk_bf16_f32 v149, v186, v187
 v_exp_f32 v189, v29
 v_exp_f32 v190, v30
 v_cvt_pk_bf16_f32 v150, v188, v189
 v_exp_f32 v191, v31
 s_nop 0
 v_cvt_pk_bf16_f32 v151, v190, v191
 s_nop 1
 v_mfma_f32_16x16x32_bf16 v[196:199], v[208:211], v[148:151], v[196:199]
 v_exp_f32 v184, v40
 v_exp_f32 v185, v41
 v_exp_f32 v186, v42
 v_exp_f32 v187, v43
 s_nop 7
 s_setpc_b64 s[78:79]
LfixA01134:
 s_nop 7
 v_max3_f32 v250, v96, v97, v98
 v_max3_f32 v250, v250, v99, v100
 v_max3_f32 v250, v250, v101, v102
 v_max3_f32 v250, v250, v103, v112
 v_max3_f32 v250, v250, v113, v114
 v_max3_f32 v250, v250, v115, v116
 v_max3_f32 v250, v250, v117, v118
 v_max_f32 v250, v250, v119
 v_mov_b32 v249, v250
 s_nop 1
 v_permlane16_swap_b32 v249, v250
 v_max_f32 v250, v250, v249
 v_mov_b32 v249, v250
 s_nop 1
 v_permlane32_swap_b32 v249, v250
 v_max_f32 v250, v250, v249
 v_max_f32 v250, 0, v250
 v_sub_f32 v248, 0, v250
 v_exp_f32 v248, v248
 v_sub_f32 v176, v176, v250
 v_sub_f32 v177, v177, v250
 v_sub_f32 v178, v178, v250
 v_sub_f32 v179, v179, v250
 v_sub_f32 v96, v96, v250
 v_sub_f32 v64, v64, v250
 v_sub_f32 v97, v97, v250
 v_sub_f32 v65, v65, v250
 v_sub_f32 v98, v98, v250
 v_sub_f32 v66, v66, v250
 v_sub_f32 v99, v99, v250
 v_sub_f32 v67, v67, v250
 v_sub_f32 v100, v100, v250
 v_sub_f32 v68, v68, v250
 v_sub_f32 v101, v101, v250
 v_sub_f32 v69, v69, v250
 v_sub_f32 v102, v102, v250
 v_sub_f32 v70, v70, v250
 v_sub_f32 v103, v103, v250
 v_sub_f32 v71, v71, v250
 v_sub_f32 v112, v112, v250
 v_sub_f32 v80, v80, v250
 v_sub_f32 v113, v113, v250
 v_sub_f32 v81, v81, v250
 v_sub_f32 v114, v114, v250
 v_sub_f32 v82, v82, v250
 v_sub_f32 v115, v115, v250
 v_sub_f32 v83, v83, v250
 v_sub_f32 v116, v116, v250
 v_sub_f32 v84, v84, v250
 v_sub_f32 v117, v117, v250
 v_sub_f32 v85, v85, v250
 v_sub_f32 v118, v118, v250
 v_sub_f32 v86, v86, v250
 v_sub_f32 v119, v119, v250
 v_sub_f32 v87, v87, v250
 v_mul_f32 v214, v214, v248
 v_accvgpr_read_b32 v184, a0
 v_mul_f32 v184, v184, v248
 v_accvgpr_write_b32 a0, v184
 v_accvgpr_read_b32 v184, a1
 v_mul_f32 v184, v184, v248
 v_accvgpr_write_b32 a1, v184
 v_accvgpr_read_b32 v184, a2
 v_mul_f32 v184, v184, v248
 v_accvgpr_write_b32 a2, v184
 v_accvgpr_read_b32 v184, a3
 v_mul_f32 v184, v184, v248
 v_accvgpr_write_b32 a3, v184
 v_accvgpr_read_b32 v184, a8
 v_mul_f32 v184, v184, v248
 v_accvgpr_write_b32 a8, v184
 v_accvgpr_read_b32 v184, a9
 v_mul_f32 v184, v184, v248
 v_accvgpr_write_b32 a9, v184
 v_accvgpr_read_b32 v184, a10
 v_mul_f32 v184, v184, v248
 v_accvgpr_write_b32 a10, v184
 v_accvgpr_read_b32 v184, a11
 v_mul_f32 v184, v184, v248
 v_accvgpr_write_b32 a11, v184
 v_accvgpr_read_b32 v184, a16
 v_mul_f32 v184, v184, v248
 v_accvgpr_write_b32 a16, v184
 v_accvgpr_read_b32 v184, a17
 v_mul_f32 v184, v184, v248
 v_accvgpr_write_b32 a17, v184
 v_accvgpr_read_b32 v184, a18
 v_mul_f32 v184, v184, v248
 v_accvgpr_write_b32 a18, v184
 v_accvgpr_read_b32 v184, a19
 v_mul_f32 v184, v184, v248
 v_accvgpr_write_b32 a19, v184
 v_accvgpr_read_b32 v184, a24
 v_mul_f32 v184, v184, v248
 v_accvgpr_write_b32 a24, v184
 v_accvgpr_read_b32 v184, a25
 v_mul_f32 v184, v184, v248
 v_accvgpr_write_b32 a25, v184
 v_accvgpr_read_b32 v184, a26
 v_mul_f32 v184, v184, v248
 v_accvgpr_write_b32 a26, v184
 v_accvgpr_read_b32 v184, a27
 v_mul_f32 v184, v184, v248
 v_accvgpr_write_b32 a27, v184
 v_accvgpr_read_b32 v184, a32
 v_mul_f32 v184, v184, v248
 v_accvgpr_write_b32 a32, v184
 v_accvgpr_read_b32 v184, a33
 v_mul_f32 v184, v184, v248
 v_accvgpr_write_b32 a33, v184
 v_accvgpr_read_b32 v184, a34
 v_mul_f32 v184, v184, v248
 v_accvgpr_write_b32 a34, v184
 v_accvgpr_read_b32 v184, a35
 v_mul_f32 v184, v184, v248
 v_accvgpr_write_b32 a35, v184
 v_accvgpr_read_b32 v184, a40
 v_mul_f32 v184, v184, v248
 v_accvgpr_write_b32 a40, v184
 v_accvgpr_read_b32 v184, a41
 v_mul_f32 v184, v184, v248
 v_accvgpr_write_b32 a41, v184
 v_accvgpr_read_b32 v184, a42
 v_mul_f32 v184, v184, v248
 v_accvgpr_write_b32 a42, v184
 v_accvgpr_read_b32 v184, a43
 v_mul_f32 v184, v184, v248
 v_accvgpr_write_b32 a43, v184
 v_accvgpr_read_b32 v184, a48
 v_mul_f32 v184, v184, v248
 v_accvgpr_write_b32 a48, v184
 v_accvgpr_read_b32 v184, a49
 v_mul_f32 v184, v184, v248
 v_accvgpr_write_b32 a49, v184
 v_accvgpr_read_b32 v184, a50
 v_mul_f32 v184, v184, v248
 v_accvgpr_write_b32 a50, v184
 v_accvgpr_read_b32 v184, a51
 v_mul_f32 v184, v184, v248
 v_accvgpr_write_b32 a51, v184
 v_accvgpr_read_b32 v184, a56
 v_mul_f32 v184, v184, v248
 v_accvgpr_write_b32 a56, v184
 v_accvgpr_read_b32 v184, a57
 v_mul_f32 v184, v184, v248
 v_accvgpr_write_b32 a57, v184
 v_accvgpr_read_b32 v184, a58
 v_mul_f32 v184, v184, v248
 v_accvgpr_write_b32 a58, v184
 v_accvgpr_read_b32 v184, a59
 v_mul_f32 v184, v184, v248
 v_accvgpr_write_b32 a59, v184
 v_exp_f32 v184, v96
 v_exp_f32 v185, v97
 v_exp_f32 v186, v98
 v_cvt_pk_bf16_f32 v152, v184, v185
 v_exp_f32 v187, v99
 v_exp_f32 v188, v100
 v_cvt_pk_bf16_f32 v153, v186, v187
 v_exp_f32 v189, v101
 v_exp_f32 v190, v102
 v_cvt_pk_bf16_f32 v154, v188, v189
 v_exp_f32 v191, v103
 v_exp_f32 v184, v112
 v_cvt_pk_bf16_f32 v155, v190, v191
 v_exp_f32 v185, v113
 s_nop 0
 v_mfma_f32_16x16x32_bf16 v[200:203], v[208:211], v[152:155], 0
 v_exp_f32 v186, v114
 v_cvt_pk_bf16_f32 v160, v184, v185
 v_exp_f32 v187, v115
 v_exp_f32 v188, v116
 v_cvt_pk_bf16_f32 v161, v186, v187
 v_exp_f32 v189, v117
 v_exp_f32 v190, v118
 v_cvt_pk_bf16_f32 v162, v188, v189
 v_exp_f32 v191, v119
 s_nop 0
 v_cvt_pk_bf16_f32 v163, v190, v191
 s_nop 1
 v_mfma_f32_16x16x32_bf16 v[200:203], v[208:211], v[160:163], v[200:203]
 s_nop 7
 s_setpc_b64 s[78:79]
LfixA11137:
 s_nop 7
 v_max3_f32 v250, v104, v105, v106
 v_max3_f32 v250, v250, v107, v108
 v_max3_f32 v250, v250, v109, v110
 v_max3_f32 v250, v250, v111, v120
 v_max3_f32 v250, v250, v121, v122
 v_max3_f32 v250, v250, v123, v124
 v_max3_f32 v250, v250, v125, v126
 v_max_f32 v250, v250, v127
 v_mov_b32 v249, v250
 s_nop 1
 v_permlane16_swap_b32 v249, v250
 v_max_f32 v250, v250, v249
 v_mov_b32 v249, v250
 s_nop 1
 v_permlane32_swap_b32 v249, v250
 v_max_f32 v250, v250, v249
 v_max_f32 v250, 0, v250
 v_sub_f32 v248, 0, v250
 v_exp_f32 v248, v248
 v_sub_f32 v180, v180, v250
 v_sub_f32 v181, v181, v250
 v_sub_f32 v182, v182, v250
 v_sub_f32 v183, v183, v250
 v_sub_f32 v104, v104, v250
 v_sub_f32 v72, v72, v250
 v_sub_f32 v105, v105, v250
 v_sub_f32 v73, v73, v250
 v_sub_f32 v106, v106, v250
 v_sub_f32 v74, v74, v250
 v_sub_f32 v107, v107, v250
 v_sub_f32 v75, v75, v250
 v_sub_f32 v108, v108, v250
 v_sub_f32 v76, v76, v250
 v_sub_f32 v109, v109, v250
 v_sub_f32 v77, v77, v250
 v_sub_f32 v110, v110, v250
 v_sub_f32 v78, v78, v250
 v_sub_f32 v111, v111, v250
 v_sub_f32 v79, v79, v250
 v_sub_f32 v120, v120, v250
 v_sub_f32 v88, v88, v250
 v_sub_f32 v121, v121, v250
 v_sub_f32 v89, v89, v250
 v_sub_f32 v122, v122, v250
 v_sub_f32 v90, v90, v250
 v_sub_f32 v123, v123, v250
 v_sub_f32 v91, v91, v250
 v_sub_f32 v124, v124, v250
 v_sub_f32 v92, v92, v250
 v_sub_f32 v125, v125, v250
 v_sub_f32 v93, v93, v250
 v_sub_f32 v126, v126, v250
 v_sub_f32 v94, v94, v250
 v_sub_f32 v127, v127, v250
 v_sub_f32 v95, v95, v250
 v_mul_f32 v215, v215, v248
 v_accvgpr_read_b32 v184, a4
 v_mul_f32 v184, v184, v248
 v_accvgpr_write_b32 a4, v184
 v_accvgpr_read_b32 v184, a5
 v_mul_f32 v184, v184, v248
 v_accvgpr_write_b32 a5, v184
 v_accvgpr_read_b32 v184, a6
 v_mul_f32 v184, v184, v248
 v_accvgpr_write_b32 a6, v184
 v_accvgpr_read_b32 v184, a7
 v_mul_f32 v184, v184, v248
 v_accvgpr_write_b32 a7, v184
 v_accvgpr_read_b32 v184, a12
 v_mul_f32 v184, v184, v248
 v_accvgpr_write_b32 a12, v184
 v_accvgpr_read_b32 v184, a13
 v_mul_f32 v184, v184, v248
 v_accvgpr_write_b32 a13, v184
 v_accvgpr_read_b32 v184, a14
 v_mul_f32 v184, v184, v248
 v_accvgpr_write_b32 a14, v184
 v_accvgpr_read_b32 v184, a15
 v_mul_f32 v184, v184, v248
 v_accvgpr_write_b32 a15, v184
 v_accvgpr_read_b32 v184, a20
 v_mul_f32 v184, v184, v248
 v_accvgpr_write_b32 a20, v184
 v_accvgpr_read_b32 v184, a21
 v_mul_f32 v184, v184, v248
 v_accvgpr_write_b32 a21, v184
 v_accvgpr_read_b32 v184, a22
 v_mul_f32 v184, v184, v248
 v_accvgpr_write_b32 a22, v184
 v_accvgpr_read_b32 v184, a23
 v_mul_f32 v184, v184, v248
 v_accvgpr_write_b32 a23, v184
 v_accvgpr_read_b32 v184, a28
 v_mul_f32 v184, v184, v248
 v_accvgpr_write_b32 a28, v184
 v_accvgpr_read_b32 v184, a29
 v_mul_f32 v184, v184, v248
 v_accvgpr_write_b32 a29, v184
 v_accvgpr_read_b32 v184, a30
 v_mul_f32 v184, v184, v248
 v_accvgpr_write_b32 a30, v184
 v_accvgpr_read_b32 v184, a31
 v_mul_f32 v184, v184, v248
 v_accvgpr_write_b32 a31, v184
 v_accvgpr_read_b32 v184, a36
 v_mul_f32 v184, v184, v248
 v_accvgpr_write_b32 a36, v184
 v_accvgpr_read_b32 v184, a37
 v_mul_f32 v184, v184, v248
 v_accvgpr_write_b32 a37, v184
 v_accvgpr_read_b32 v184, a38
 v_mul_f32 v184, v184, v248
 v_accvgpr_write_b32 a38, v184
 v_accvgpr_read_b32 v184, a39
 v_mul_f32 v184, v184, v248
 v_accvgpr_write_b32 a39, v184
 v_accvgpr_read_b32 v184, a44
 v_mul_f32 v184, v184, v248
 v_accvgpr_write_b32 a44, v184
 v_accvgpr_read_b32 v184, a45
 v_mul_f32 v184, v184, v248
 v_accvgpr_write_b32 a45, v184
 v_accvgpr_read_b32 v184, a46
 v_mul_f32 v184, v184, v248
 v_accvgpr_write_b32 a46, v184
 v_accvgpr_read_b32 v184, a47
 v_mul_f32 v184, v184, v248
 v_accvgpr_write_b32 a47, v184
 v_accvgpr_read_b32 v184, a52
 v_mul_f32 v184, v184, v248
 v_accvgpr_write_b32 a52, v184
 v_accvgpr_read_b32 v184, a53
 v_mul_f32 v184, v184, v248
 v_accvgpr_write_b32 a53, v184
 v_accvgpr_read_b32 v184, a54
 v_mul_f32 v184, v184, v248
 v_accvgpr_write_b32 a54, v184
 v_accvgpr_read_b32 v184, a55
 v_mul_f32 v184, v184, v248
 v_accvgpr_write_b32 a55, v184
 v_accvgpr_read_b32 v184, a60
 v_mul_f32 v184, v184, v248
 v_accvgpr_write_b32 a60, v184
 v_accvgpr_read_b32 v184, a61
 v_mul_f32 v184, v184, v248
 v_accvgpr_write_b32 a61, v184
 v_accvgpr_read_b32 v184, a62
 v_mul_f32 v184, v184, v248
 v_accvgpr_write_b32 a62, v184
 v_accvgpr_read_b32 v184, a63
 v_mul_f32 v184, v184, v248
 v_accvgpr_write_b32 a63, v184
 v_exp_f32 v184, v104
 v_exp_f32 v185, v105
 v_exp_f32 v186, v106
 v_cvt_pk_bf16_f32 v156, v184, v185
 v_exp_f32 v187, v107
 v_exp_f32 v188, v108
 v_cvt_pk_bf16_f32 v157, v186, v187
 v_exp_f32 v189, v109
 v_exp_f32 v190, v110
 v_cvt_pk_bf16_f32 v158, v188, v189
 v_exp_f32 v191, v111
 v_exp_f32 v184, v120
 v_cvt_pk_bf16_f32 v159, v190, v191
 v_exp_f32 v185, v121
 s_nop 0
 v_mfma_f32_16x16x32_bf16 v[204:207], v[208:211], v[156:159], 0
 v_exp_f32 v186, v122
 v_cvt_pk_bf16_f32 v164, v184, v185
 v_exp_f32 v187, v123
 v_exp_f32 v188, v124
 v_cvt_pk_bf16_f32 v165, v186, v187
 v_exp_f32 v189, v125
 v_exp_f32 v190, v126
 v_cvt_pk_bf16_f32 v166, v188, v189
 v_exp_f32 v191, v127
 s_nop 0
 v_cvt_pk_bf16_f32 v167, v190, v191
 s_nop 1
 v_mfma_f32_16x16x32_bf16 v[204:207], v[208:211], v[164:167], v[204:207]
 s_nop 7
 s_setpc_b64 s[78:79]
LfixB01140:
 s_nop 7
 v_max3_f32 v250, v32, v33, v34
 v_max3_f32 v250, v250, v35, v36
 v_max3_f32 v250, v250, v37, v38
 v_max3_f32 v250, v250, v39, v48
 v_max3_f32 v250, v250, v49, v50
 v_max3_f32 v250, v250, v51, v52
 v_max3_f32 v250, v250, v53, v54
 v_max_f32 v250, v250, v55
 v_mov_b32 v249, v250
 s_nop 1
 v_permlane16_swap_b32 v249, v250
 v_max_f32 v250, v250, v249
 v_mov_b32 v249, v250
 s_nop 1
 v_permlane32_swap_b32 v249, v250
 v_max_f32 v250, v250, v249
 v_max_f32 v250, 0, v250
 v_sub_f32 v248, 0, v250
 v_exp_f32 v248, v248
 v_sub_f32 v168, v168, v250
 v_sub_f32 v169, v169, v250
 v_sub_f32 v170, v170, v250
 v_sub_f32 v171, v171, v250
 v_sub_f32 v32, v32, v250
 v_sub_f32 v0, v0, v250
 v_sub_f32 v33, v33, v250
 v_sub_f32 v1, v1, v250
 v_sub_f32 v34, v34, v250
 v_sub_f32 v2, v2, v250
 v_sub_f32 v35, v35, v250
 v_sub_f32 v3, v3, v250
 v_sub_f32 v36, v36, v250
 v_sub_f32 v4, v4, v250
 v_sub_f32 v37, v37, v250
 v_sub_f32 v5, v5, v250
 v_sub_f32 v38, v38, v250
 v_sub_f32 v6, v6, v250
 v_sub_f32 v39, v39, v250
 v_sub_f32 v7, v7, v250
 v_sub_f32 v48, v48, v250
 v_sub_f32 v16, v16, v250
 v_sub_f32 v49, v49, v250
 v_sub_f32 v17, v17, v250
 v_sub_f32 v50, v50, v250
 v_sub_f32 v18, v18, v250
 v_sub_f32 v51, v51, v250
 v_sub_f32 v19, v19, v250
 v_sub_f32 v52, v52, v250
 v_sub_f32 v20, v20, v250
 v_sub_f32 v53, v53, v250
 v_sub_f32 v21, v21, v250
 v_sub_f32 v54, v54, v250
 v_sub_f32 v22, v22, v250
 v_sub_f32 v55, v55, v250
 v_sub_f32 v23, v23, v250
 v_mul_f32 v212, v212, v248
 v_accvgpr_read_b32 v184, a64
 v_mul_f32 v184, v184, v248
 v_accvgpr_write_b32 a64, v184
 v_accvgpr_read_b32 v184, a65
 v_mul_f32 v184, v184, v248
 v_accvgpr_write_b32 a65, v184
 v_accvgpr_read_b32 v184, a66
 v_mul_f32 v184, v184, v248
 v_accvgpr_write_b32 a66, v184
 v_accvgpr_read_b32 v184, a67
 v_mul_f32 v184, v184, v248
 v_accvgpr_write_b32 a67, v184
 v_accvgpr_read_b32 v184, a72
 v_mul_f32 v184, v184, v248
 v_accvgpr_write_b32 a72, v184
 v_accvgpr_read_b32 v184, a73
 v_mul_f32 v184, v184, v248
 v_accvgpr_write_b32 a73, v184
 v_accvgpr_read_b32 v184, a74
 v_mul_f32 v184, v184, v248
 v_accvgpr_write_b32 a74, v184
 v_accvgpr_read_b32 v184, a75
 v_mul_f32 v184, v184, v248
 v_accvgpr_write_b32 a75, v184
 v_accvgpr_read_b32 v184, a80
 v_mul_f32 v184, v184, v248
 v_accvgpr_write_b32 a80, v184
 v_accvgpr_read_b32 v184, a81
 v_mul_f32 v184, v184, v248
 v_accvgpr_write_b32 a81, v184
 v_accvgpr_read_b32 v184, a82
 v_mul_f32 v184, v184, v248
 v_accvgpr_write_b32 a82, v184
 v_accvgpr_read_b32 v184, a83
 v_mul_f32 v184, v184, v248
 v_accvgpr_write_b32 a83, v184
 v_accvgpr_read_b32 v184, a88
 v_mul_f32 v184, v184, v248
 v_accvgpr_write_b32 a88, v184
 v_accvgpr_read_b32 v184, a89
 v_mul_f32 v184, v184, v248
 v_accvgpr_write_b32 a89, v184
 v_accvgpr_read_b32 v184, a90
 v_mul_f32 v184, v184, v248
 v_accvgpr_write_b32 a90, v184
 v_accvgpr_read_b32 v184, a91
 v_mul_f32 v184, v184, v248
 v_accvgpr_write_b32 a91, v184
 v_accvgpr_read_b32 v184, a96
 v_mul_f32 v184, v184, v248
 v_accvgpr_write_b32 a96, v184
 v_accvgpr_read_b32 v184, a97
 v_mul_f32 v184, v184, v248
 v_accvgpr_write_b32 a97, v184
 v_accvgpr_read_b32 v184, a98
 v_mul_f32 v184, v184, v248
 v_accvgpr_write_b32 a98, v184
 v_accvgpr_read_b32 v184, a99
 v_mul_f32 v184, v184, v248
 v_accvgpr_write_b32 a99, v184
 v_accvgpr_read_b32 v184, a104
 v_mul_f32 v184, v184, v248
 v_accvgpr_write_b32 a104, v184
 v_accvgpr_read_b32 v184, a105
 v_mul_f32 v184, v184, v248
 v_accvgpr_write_b32 a105, v184
 v_accvgpr_read_b32 v184, a106
 v_mul_f32 v184, v184, v248
 v_accvgpr_write_b32 a106, v184
 v_accvgpr_read_b32 v184, a107
 v_mul_f32 v184, v184, v248
 v_accvgpr_write_b32 a107, v184
 v_accvgpr_read_b32 v184, a112
 v_mul_f32 v184, v184, v248
 v_accvgpr_write_b32 a112, v184
 v_accvgpr_read_b32 v184, a113
 v_mul_f32 v184, v184, v248
 v_accvgpr_write_b32 a113, v184
 v_accvgpr_read_b32 v184, a114
 v_mul_f32 v184, v184, v248
 v_accvgpr_write_b32 a114, v184
 v_accvgpr_read_b32 v184, a115
 v_mul_f32 v184, v184, v248
 v_accvgpr_write_b32 a115, v184
 v_accvgpr_read_b32 v184, a120
 v_mul_f32 v184, v184, v248
 v_accvgpr_write_b32 a120, v184
 v_accvgpr_read_b32 v184, a121
 v_mul_f32 v184, v184, v248
 v_accvgpr_write_b32 a121, v184
 v_accvgpr_read_b32 v184, a122
 v_mul_f32 v184, v184, v248
 v_accvgpr_write_b32 a122, v184
 v_accvgpr_read_b32 v184, a123
 v_mul_f32 v184, v184, v248
 v_accvgpr_write_b32 a123, v184
 v_exp_f32 v184, v32
 v_exp_f32 v185, v33
 v_exp_f32 v186, v34
 v_cvt_pk_bf16_f32 v136, v184, v185
 v_exp_f32 v187, v35
 v_exp_f32 v188, v36
 v_cvt_pk_bf16_f32 v137, v186, v187
 v_exp_f32 v189, v37
 v_exp_f32 v190, v38
 v_cvt_pk_bf16_f32 v138, v188, v189
 v_exp_f32 v191, v39
 v_exp_f32 v184, v48
 v_cvt_pk_bf16_f32 v139, v190, v191
 v_exp_f32 v185, v49
 s_nop 0
 v_mfma_f32_16x16x32_bf16 v[192:195], v[208:211], v[136:139], 0
 v_exp_f32 v186, v50
 v_cvt_pk_bf16_f32 v144, v184, v185
 v_exp_f32 v187, v51
 v_exp_f32 v188, v52
 v_cvt_pk_bf16_f32 v145, v186, v187
 v_exp_f32 v189, v53
 v_exp_f32 v190, v54
 v_cvt_pk_bf16_f32 v146, v188, v189
 v_exp_f32 v191, v55
 s_nop 0
 v_cvt_pk_bf16_f32 v147, v190, v191
 s_nop 1
 v_mfma_f32_16x16x32_bf16 v[192:195], v[208:211], v[144:147], v[192:195]
 s_nop 7
 s_setpc_b64 s[78:79]
LfixB11143:
 s_nop 7
 v_max3_f32 v250, v40, v41, v42
 v_max3_f32 v250, v250, v43, v44
 v_max3_f32 v250, v250, v45, v46
 v_max3_f32 v250, v250, v47, v56
 v_max3_f32 v250, v250, v57, v58
 v_max3_f32 v250, v250, v59, v60
 v_max3_f32 v250, v250, v61, v62
 v_max_f32 v250, v250, v63
 v_mov_b32 v249, v250
 s_nop 1
 v_permlane16_swap_b32 v249, v250
 v_max_f32 v250, v250, v249
 v_mov_b32 v249, v250
 s_nop 1
 v_permlane32_swap_b32 v249, v250
 v_max_f32 v250, v250, v249
 v_max_f32 v250, 0, v250
 v_sub_f32 v248, 0, v250
 v_exp_f32 v248, v248
 v_sub_f32 v172, v172, v250
 v_sub_f32 v173, v173, v250
 v_sub_f32 v174, v174, v250
 v_sub_f32 v175, v175, v250
 v_sub_f32 v40, v40, v250
 v_sub_f32 v8, v8, v250
 v_sub_f32 v41, v41, v250
 v_sub_f32 v9, v9, v250
 v_sub_f32 v42, v42, v250
 v_sub_f32 v10, v10, v250
 v_sub_f32 v43, v43, v250
 v_sub_f32 v11, v11, v250
 v_sub_f32 v44, v44, v250
 v_sub_f32 v12, v12, v250
 v_sub_f32 v45, v45, v250
 v_sub_f32 v13, v13, v250
 v_sub_f32 v46, v46, v250
 v_sub_f32 v14, v14, v250
 v_sub_f32 v47, v47, v250
 v_sub_f32 v15, v15, v250
 v_sub_f32 v56, v56, v250
 v_sub_f32 v24, v24, v250
 v_sub_f32 v57, v57, v250
 v_sub_f32 v25, v25, v250
 v_sub_f32 v58, v58, v250
 v_sub_f32 v26, v26, v250
 v_sub_f32 v59, v59, v250
 v_sub_f32 v27, v27, v250
 v_sub_f32 v60, v60, v250
 v_sub_f32 v28, v28, v250
 v_sub_f32 v61, v61, v250
 v_sub_f32 v29, v29, v250
 v_sub_f32 v62, v62, v250
 v_sub_f32 v30, v30, v250
 v_sub_f32 v63, v63, v250
 v_sub_f32 v31, v31, v250
 v_mul_f32 v213, v213, v248
 v_accvgpr_read_b32 v184, a68
 v_mul_f32 v184, v184, v248
 v_accvgpr_write_b32 a68, v184
 v_accvgpr_read_b32 v184, a69
 v_mul_f32 v184, v184, v248
 v_accvgpr_write_b32 a69, v184
 v_accvgpr_read_b32 v184, a70
 v_mul_f32 v184, v184, v248
 v_accvgpr_write_b32 a70, v184
 v_accvgpr_read_b32 v184, a71
 v_mul_f32 v184, v184, v248
 v_accvgpr_write_b32 a71, v184
 v_accvgpr_read_b32 v184, a76
 v_mul_f32 v184, v184, v248
 v_accvgpr_write_b32 a76, v184
 v_accvgpr_read_b32 v184, a77
 v_mul_f32 v184, v184, v248
 v_accvgpr_write_b32 a77, v184
 v_accvgpr_read_b32 v184, a78
 v_mul_f32 v184, v184, v248
 v_accvgpr_write_b32 a78, v184
 v_accvgpr_read_b32 v184, a79
 v_mul_f32 v184, v184, v248
 v_accvgpr_write_b32 a79, v184
 v_accvgpr_read_b32 v184, a84
 v_mul_f32 v184, v184, v248
 v_accvgpr_write_b32 a84, v184
 v_accvgpr_read_b32 v184, a85
 v_mul_f32 v184, v184, v248
 v_accvgpr_write_b32 a85, v184
 v_accvgpr_read_b32 v184, a86
 v_mul_f32 v184, v184, v248
 v_accvgpr_write_b32 a86, v184
 v_accvgpr_read_b32 v184, a87
 v_mul_f32 v184, v184, v248
 v_accvgpr_write_b32 a87, v184
 v_accvgpr_read_b32 v184, a92
 v_mul_f32 v184, v184, v248
 v_accvgpr_write_b32 a92, v184
 v_accvgpr_read_b32 v184, a93
 v_mul_f32 v184, v184, v248
 v_accvgpr_write_b32 a93, v184
 v_accvgpr_read_b32 v184, a94
 v_mul_f32 v184, v184, v248
 v_accvgpr_write_b32 a94, v184
 v_accvgpr_read_b32 v184, a95
 v_mul_f32 v184, v184, v248
 v_accvgpr_write_b32 a95, v184
 v_accvgpr_read_b32 v184, a100
 v_mul_f32 v184, v184, v248
 v_accvgpr_write_b32 a100, v184
 v_accvgpr_read_b32 v184, a101
 v_mul_f32 v184, v184, v248
 v_accvgpr_write_b32 a101, v184
 v_accvgpr_read_b32 v184, a102
 v_mul_f32 v184, v184, v248
 v_accvgpr_write_b32 a102, v184
 v_accvgpr_read_b32 v184, a103
 v_mul_f32 v184, v184, v248
 v_accvgpr_write_b32 a103, v184
 v_accvgpr_read_b32 v184, a108
 v_mul_f32 v184, v184, v248
 v_accvgpr_write_b32 a108, v184
 v_accvgpr_read_b32 v184, a109
 v_mul_f32 v184, v184, v248
 v_accvgpr_write_b32 a109, v184
 v_accvgpr_read_b32 v184, a110
 v_mul_f32 v184, v184, v248
 v_accvgpr_write_b32 a110, v184
 v_accvgpr_read_b32 v184, a111
 v_mul_f32 v184, v184, v248
 v_accvgpr_write_b32 a111, v184
 v_accvgpr_read_b32 v184, a116
 v_mul_f32 v184, v184, v248
 v_accvgpr_write_b32 a116, v184
 v_accvgpr_read_b32 v184, a117
 v_mul_f32 v184, v184, v248
 v_accvgpr_write_b32 a117, v184
 v_accvgpr_read_b32 v184, a118
 v_mul_f32 v184, v184, v248
 v_accvgpr_write_b32 a118, v184
 v_accvgpr_read_b32 v184, a119
 v_mul_f32 v184, v184, v248
 v_accvgpr_write_b32 a119, v184
 v_accvgpr_read_b32 v184, a124
 v_mul_f32 v184, v184, v248
 v_accvgpr_write_b32 a124, v184
 v_accvgpr_read_b32 v184, a125
 v_mul_f32 v184, v184, v248
 v_accvgpr_write_b32 a125, v184
 v_accvgpr_read_b32 v184, a126
 v_mul_f32 v184, v184, v248
 v_accvgpr_write_b32 a126, v184
 v_accvgpr_read_b32 v184, a127
 v_mul_f32 v184, v184, v248
 v_accvgpr_write_b32 a127, v184
 v_exp_f32 v184, v40
 v_exp_f32 v185, v41
 v_exp_f32 v186, v42
 v_cvt_pk_bf16_f32 v140, v184, v185
 v_exp_f32 v187, v43
 v_exp_f32 v188, v44
 v_cvt_pk_bf16_f32 v141, v186, v187
 v_exp_f32 v189, v45
 v_exp_f32 v190, v46
 v_cvt_pk_bf16_f32 v142, v188, v189
 v_exp_f32 v191, v47
 v_exp_f32 v184, v56
 v_cvt_pk_bf16_f32 v143, v190, v191
 v_exp_f32 v185, v57
 s_nop 0
 v_mfma_f32_16x16x32_bf16 v[196:199], v[208:211], v[140:143], 0
 v_exp_f32 v186, v58
 v_cvt_pk_bf16_f32 v148, v184, v185
 v_exp_f32 v187, v59
 v_exp_f32 v188, v60
 v_cvt_pk_bf16_f32 v149, v186, v187
 v_exp_f32 v189, v61
 v_exp_f32 v190, v62
 v_cvt_pk_bf16_f32 v150, v188, v189
 v_exp_f32 v191, v63
 s_nop 0
 v_cvt_pk_bf16_f32 v151, v190, v191
 s_nop 1
 v_mfma_f32_16x16x32_bf16 v[196:199], v[208:211], v[148:151], v[196:199]
 v_exp_f32 v184, v8
 v_exp_f32 v185, v9
 v_exp_f32 v186, v10
 v_exp_f32 v187, v11
 s_nop 7
 s_setpc_b64 s[78:79]
sequential_preLN__compressed_kv_cla__mixer_gmlp__prompt_kernel_last:
 s_endpgm

.section .rodata,"a"
.p2align 6
.amdhsa_kernel sequential_preLN__compressed_kv_cla__mixer_gmlp__prompt_kernel
  .amdhsa_next_free_vgpr 512
  .amdhsa_next_free_sgpr 102
  .amdhsa_accum_offset 256
  .amdhsa_group_segment_fixed_size 0
  .amdhsa_kernarg_size 112
  .amdhsa_user_sgpr_count 2
  .amdhsa_user_sgpr_kernarg_segment_ptr 1
  .amdhsa_system_sgpr_workgroup_id_x 1
.end_amdhsa_kernel
```
